```python
import torch

def _softmax(x, axis=-1):
    return torch.softmax(x, dim=axis)

def _gelu(x):
    return torch.nn.functional.gelu(x, approximate='tanh')

def _silu(x):
    return torch.nn.functional.silu(x)

def _sigmoid(x):
    return torch.sigmoid(x)

def _layernorm(x, axis=-1, eps=1e-05):
    m = x.mean(dim=axis, keepdim=True)
    v = x.var(dim=axis, keepdim=True, unbiased=False)
    return (x - m) / torch.sqrt(v + eps)

def _scatter_add(tgt, idx, src, axis=0):
    return tgt.clone().index_add_(axis, idx, src)

def _segment_sum(src, seg, n):
    out = torch.zeros((n,) + src.shape[1:], dtype=src.dtype)
    return out.index_add_(0, seg, src)

def _pad(x, pw):
    flat = tuple((v for pair in reversed(pw) for v in pair))
    return torch.nn.functional.pad(x, flat)
kernel_name = 'standalone__varlen_attn_packed__ragged'

def setup_inputs():

    _w = lambda a: (lambda t: t.to(torch.bfloat16) if t.is_floating_point() else t)(torch.as_tensor(a))
    cu = torch.tensor([0, 992, 1451, 1933, 2583, 3189, 3578, 4512, 5082], dtype=torch.int64)
    T, H, D = (int(cu[-1]), 16, 128)
    return {'q': _w((lambda *s: torch.randn(*s, dtype=torch.bfloat16) * 0.8)(T, H, D)), 'k': _w((lambda *s: torch.randn(*s, dtype=torch.bfloat16) * 0.8)(T, H, D)), 'v': _w((lambda *s: torch.randn(*s, dtype=torch.bfloat16) * 0.05)(T, H, D)), 'cu': _w(cu)}

def reference(q, k, v, cu):
    T, H, D = q.shape
    out = torch.zeros_like(q)
    scale = D ** (-0.5)
    outs = []
    for i in range(len(cu) - 1):
        s, e = (int(cu[i]), int(cu[i + 1]))
        qi, ki, vi = (q[s:e].clone(), k[s:e].clone(), v[s:e].clone())
        p = _softmax(torch.einsum('qhd,khd->hqk', qi, ki) * scale, axis=-1)
        outs.append(torch.einsum('hqk,khd->qhd', p, vi))
    return torch.concatenate(outs, axis=0)
```

```asm
; @launch grid=(256,1,1) block=(256,1,1) lds=149376
.amdgcn_target "amdgcn-amd-amdhsa--gfx950"
.text
.macro QK d,a,b,c
v_mfma_f32_16x16x32_bf16 v[\d:\d+3], a[\a:\a+3], a[\b:\b+3], v[\c:\c+3]
.endm
.macro QZ d,a,b
v_mfma_f32_16x16x32_bf16 v[\d:\d+3], a[\a:\a+3], a[\b:\b+3], 0
.endm
.macro PV d,a,b
v_mfma_f32_16x16x32_bf16 v[\d:\d+3], a[\a:\a+3], v[\b:\b+3], v[\d:\d+3]
.endm
.macro PZ d,a,b
v_mfma_f32_16x16x32_bf16 v[\d:\d+3], a[\a:\a+3], v[\b:\b+3], 0
.endm
.macro LS d,a,b
v_mfma_f32_16x16x32_bf16 a[\d:\d+3], v[\a:\a+3], v[\b:\b+3], a[\d:\d+3]
.endm
.macro LZ d,a,b
v_mfma_f32_16x16x32_bf16 a[\d:\d+3], v[\a:\a+3], v[\b:\b+3], 0
.endm
.macro RK d,a,o
ds_read_b128 a[\d:\d+3], v\a offset:\o
.endm
.macro RV d,a,o
ds_read_b64_tr_b16 a[\d:\d+1], v\a offset:\o
.endm
.macro EX d
v_exp_f32 v\d, v\d
.endm
.macro CV d,a,b
v_cvt_pk_bf16_f32 v\d, v\a, v\b
.endm
.macro PM d,r,h
v_pk_mul_f32 v[\d:\d+1], v[\d:\d+1], v[\r:\r+1] op_sel:[0,\h] op_sel_hi:[1,\h]
.endm
.globl standalone__varlen_attn_packed__ragged_kernel
.p2align 12
.p2align 8
.type standalone__varlen_attn_packed__ragged_kernel,@function
standalone__varlen_attn_packed__ragged_kernel:
s_cmp_ge_u32 s2, 256
s_cbranch_scc1 L_exit
s_load_dwordx4 s[4:7], s[0:1], 0
s_load_dwordx2 s[8:9], s[0:1], 16
s_load_dwordx2 s[10:11], s[0:1], 32
v_lshrrev_b32 v1, 6, v0
s_lshr_b32 s3, s2, 3
v_readfirstlane_b32 s12, v1
s_getpc_b64 s[68:69]
s_lshl_b32 s58, s3, 13
s_and_b32 s68, s68, 0xfffff000
v_lshl_add_u32 v126, v0, 5, s58
v_min_u32 v126, L_end8-L_type0+4092, v126
global_load_dword v127, v126, s[68:69]
s_lshr_b32 s13, s2, 4
s_mov_b32 s45, 0x2d42e78d
v_and_b32 v2, 15, v0
s_cmp_ge_u32 s13, 1
s_cselect_b32 s45, 0x118eaa17, s45
s_cmp_ge_u32 s13, 2
s_cselect_b32 s45, 0x2e340dfa, s45
s_cmp_ge_u32 s13, 3
s_cselect_b32 s45, 0x1142e78d, s45
v_bfe_u32 v71, v0, 4, 2
s_cmp_ge_u32 s13, 4
s_cselect_b32 s45, 0x307c0000, s45
s_cmp_ge_u32 s13, 8
s_cselect_b32 s45, 0x2d8eaa17, s45
v_lshlrev_b32 v3, 4, v2
s_cmp_ge_u32 s13, 10
s_cselect_b32 s45, 0x52340dfa, s45
s_cmp_ge_u32 s13, 13
s_cselect_b32 s45, 0x5142e78d, s45
s_cmp_ge_u32 s13, 14
s_cselect_b32 s45, 0x70f1a5ab, s45
v_lshl_add_u32 v72, v71, 14, v3
s_mov_b32 s60, 0xc8400c08
s_mov_b32 s61, 0x40484074
s_lshl_b32 s58, s13, 2
v_add_u32 v73, 0x1000, v72
s_lshr_b64 s[60:61], s[60:61], s58
s_and_b32 s60, s60, 15
v_add_u32 v74, 0x2000, v72
s_bfe_u32 s58, s45, 0x3001a
s_mul_i32 s58, s58, s12
s_lshl2_add_u32 s58, s60, s58
v_add_u32 v75, 0x3000, v72
s_and_b32 s40, s45, 0x1fff
s_lshl4_add_u32 s44, s58, s40
v_lshl_add_u32 v6, v1, 3, v71
s_lshl_b32 s44, s44, 12
s_bfe_u32 s58, s45, 0xd000d
s_lshl_b32 s58, s58, 12
v_xor_b32 v7, v6, v2
s_sub_u32 s26, s58, 0xf00
s_mov_b32 s27, 0x20000
v_and_b32 v7, 15, v7
s_and_b32 s58, s2, 7
s_and_b32 s3, s3, 1
s_lshl1_add_u32 s3, s58, s3
v_lshlrev_b32 v7, 4, v7
s_lshl_b32 s3, s3, 8
s_lshl_b32 s40, s40, 12
s_lshl_b32 s47, s12, 11
v_lshl_add_u32 v66, v6, 12, v7
s_bfe_u32 s59, s45, 0x1001d
s_lshl_b32 s59, s59, 13
v_xor_b32 v67, 64, v66
s_add_u32 s59, s59, s47
s_mov_b32 m0, s59
s_mov_b32 s18, 0x13d9100
v_add_u32 v67, 0x3c00, v67
s_mov_b32 s19, 0x20000
s_waitcnt lgkmcnt(0)
s_add_u32 s16, s6, s3
s_addc_u32 s17, s7, 0
s_add_u32 s24, s4, s3
s_addc_u32 s25, s5, 0
buffer_load_dwordx4 v66, s[16:19], s40 offen lds
buffer_load_dwordx4 v67, s[16:19], s40 offen offset:1024 lds
buffer_load_dwordx4 v[128:131], v72, s[24:27], s44 offen nt
buffer_load_dwordx4 v[132:135], v73, s[24:27], s44 offen nt
buffer_load_dwordx4 v[136:139], v74, s[24:27], s44 offen nt
buffer_load_dwordx4 v[140:143], v75, s[24:27], s44 offen nt
v_bfe_u32 v8, v0, 2, 2
s_add_u32 s20, s8, s3
s_addc_u32 s21, s9, 0
v_and_b32 v9, 3, v0
s_mov_b32 s22, 0x13d9100
v_lshl_add_u32 v6, v1, 3, v8
v_lshlrev_b32 v7, 4, v9
s_mov_b32 s23, 0x20000
v_lshl_add_u32 v7, v71, 6, v7
v_lshl_add_u32 v68, v6, 12, v7
s_add_u32 m0, s59, 0x10000
v_xor_b32 v69, 32, v68
s_add_u32 s58, s44, 0x10000
v_add_u32 v69, 0x3c00, v69
s_bitcmp1_b32 s45, 30
s_cbranch_scc1 L_shallow
buffer_load_dwordx4 v68, s[20:23], s40 offen lds
buffer_load_dwordx4 v69, s[20:23], s40 offen offset:1024 lds
buffer_load_dwordx4 v[160:163], v72, s[24:27], s58 offen nt
buffer_load_dwordx4 v[164:167], v73, s[24:27], s58 offen nt
buffer_load_dwordx4 v[168:171], v74, s[24:27], s58 offen nt
buffer_load_dwordx4 v[172:175], v75, s[24:27], s58 offen nt
L_shallow:
v_xor_b32 v6, v71, v2
v_lshlrev_b32 v6, 4, v6
s_add_u32 s28, s10, s3
s_addc_u32 s29, s11, 0
v_lshl_add_u32 v60, v2, 8, v6
v_xor_b32 v61, 0x40, v60
v_xor_b32 v62, 0x80, v60
v_xor_b32 v63, 0xc0, v60
s_mov_b32 s30, s26
v_and_b32 v6, 1, v71
v_lshlrev_b32 v6, 5, v6
v_lshl_add_u32 v6, v9, 3, v6
v_lshl_add_u32 v6, v8, 6, v6
s_mov_b32 s31, 0x20000
v_lshl_add_u32 v6, v71, 10, v6
v_add_u32 v64, 0x10000, v6
v_xor_b32 v65, 32, v64
v_mul_u32_u24 v6, 0x11e0, v1
s_mov_b32 s41, s47
v_add_u32 v6, 0x20000, v6
v_lshrrev_b32 v7, 1, v8
v_mul_u32_u24 v7, 2368, v7
v_and_b32 v4, 1, v8
s_mov_b32 s43, 0x4000
v_lshl_add_u32 v7, v4, 8, v7
v_add_u32 v7, v7, v6
v_mul_u32_u24 v4, 528, v9
v_lshl_add_u32 v4, v71, 3, v4
s_mov_b32 s14, 0x3e0293ee
v_add_u32 v70, v4, v7
v_mul_u32_u24 v4, 544, v9
v_lshrrev_b32 v5, 1, v9
v_lshl_add_u32 v4, v5, 6, v4
s_mov_b32 s15, 0x3e0293ee
v_lshl_add_u32 v4, v71, 4, v4
v_add_u32 v14, v4, v7
v_lshrrev_b32 v7, 1, v71
v_mul_u32_u24 v7, 2368, v7
s_mov_b32 s55, 0x53800000
v_and_b32 v4, 1, v71
v_lshl_add_u32 v7, v4, 8, v7
v_add3_u32 v15, v7, v6, v3
v_xor_b32 v6, v71, v9
s_mov_b32 s54, 0
v_cmp_gt_u32 vcc, 2, v6
v_and_b32 v7, 1, v9
v_mul_u32_u24 v7, 0xaaaa, v7
v_add_u32 v7, 0x4444, v7
s_mov_b32 s71, 0xffff0000
v_lshl_add_u32 v71, v71, 16, v7
v_mov_b32 v6, 0x3f803f80
v_cndmask_b32 v56, 0, v6, vcc
v_mov_b32 v57, v56
s_mov_b32 s70, 0xff800000
v_mov_b32 v58, v56
v_mov_b32 v59, v56
s_cmp_lt_u32 s13, 1
s_cbranch_scc1 L_to0
s_cmp_lt_u32 s13, 2
s_cbranch_scc1 L_to1
s_cmp_lt_u32 s13, 3
s_cbranch_scc1 L_to2
s_cmp_lt_u32 s13, 4
s_cbranch_scc1 L_to3
s_cmp_lt_u32 s13, 8
s_cbranch_scc1 L_to4
s_cmp_lt_u32 s13, 10
s_cbranch_scc1 L_to5
s_cmp_lt_u32 s13, 13
s_cbranch_scc1 L_to6
s_cmp_lt_u32 s13, 14
s_cbranch_scc1 L_to7
L_to8:
s_getpc_b64 s[62:63]
L_pc8:
s_sub_u32 s46, s13, 14
s_add_u32 s62, s62, L_type8-L_pc8
s_addc_u32 s63, s63, 0
s_setpc_b64 s[62:63]
L_to7:
s_getpc_b64 s[62:63]
L_pc7:
s_sub_u32 s46, s13, 13
s_add_u32 s62, s62, L_type7-L_pc7
s_addc_u32 s63, s63, 0
s_setpc_b64 s[62:63]
L_to6:
s_getpc_b64 s[62:63]
L_pc6:
s_sub_u32 s46, s13, 10
s_add_u32 s62, s62, L_type6-L_pc6
s_addc_u32 s63, s63, 0
s_setpc_b64 s[62:63]
L_to5:
s_getpc_b64 s[62:63]
L_pc5:
s_sub_u32 s46, s13, 8
s_add_u32 s62, s62, L_type5-L_pc5
s_addc_u32 s63, s63, 0
s_setpc_b64 s[62:63]
L_to4:
s_getpc_b64 s[62:63]
L_pc4:
s_sub_u32 s46, s13, 4
s_add_u32 s62, s62, L_type4-L_pc4
s_addc_u32 s63, s63, 0
s_setpc_b64 s[62:63]
L_to3:
s_getpc_b64 s[62:63]
L_pc3:
s_sub_u32 s46, s13, 3
s_add_u32 s62, s62, L_type3-L_pc3
s_addc_u32 s63, s63, 0
s_setpc_b64 s[62:63]
L_to2:
s_getpc_b64 s[62:63]
L_pc2:
s_sub_u32 s46, s13, 2
s_add_u32 s62, s62, L_type2-L_pc2
s_addc_u32 s63, s63, 0
s_setpc_b64 s[62:63]
L_to1:
s_getpc_b64 s[62:63]
L_pc1:
s_sub_u32 s46, s13, 1
s_add_u32 s62, s62, L_type1-L_pc1
s_addc_u32 s63, s63, 0
s_setpc_b64 s[62:63]
L_to0:
s_getpc_b64 s[62:63]
L_pc0:
s_sub_u32 s46, s13, 0
s_add_u32 s62, s62, L_type0-L_pc0
s_addc_u32 s63, s63, 0
s_setpc_b64 s[62:63]
L_exit:
s_endpgm
.p2align 12
L_type0:
s_mov_b64 exec, 0
s_cmp_eq_u32 s12, 0
s_cbranch_scc1 L_t0_pad1
s_cmp_eq_u32 s12, 1
s_cbranch_scc1 L_t0_pad2
s_cmp_eq_u32 s12, 2
s_cbranch_scc1 L_t0_pad3
s_branch L_t0_pad4
L_t0_go:
s_mov_b64 exec, -1
s_add_u32 s50, s44, 0x20000
s_mov_b32 s40, 0x797000
s_add_u32 m0, s47, 0x4000
s_waitcnt vmcnt(9)
buffer_load_dwordx4 v[192:195], v72, s[24:27], s50 offen nt
s_barrier
v_lshlrev_b32 v0, 16, v128
RK 0,60,8192
RK 4,61,8192
v_and_b32 v1, s71, v128
RK 8,62,8192
v_lshlrev_b32 v2, 16, v129
buffer_load_dwordx4 v[196:199], v73, s[24:27], s50 offen nt
RK 12,63,8192
v_and_b32 v3, s71, v129
v_lshlrev_b32 v4, 16, v130
v_and_b32 v5, s71, v130
v_lshlrev_b32 v6, 16, v131
v_and_b32_e64 v7, s71, v131
v_pk_mul_f32 v[0:1], v[0:1], s[14:15]
v_pk_mul_f32 v[2:3], v[2:3], s[14:15]
v_pk_mul_f32 v[4:5], v[4:5], s[14:15]
v_pk_mul_f32 v[6:7], v[6:7], s[14:15]
buffer_load_dwordx4 v[200:203], v74, s[24:27], s50 offen nt
CV 128,0,1
CV 129,2,3
CV 130,4,5
CV 131,6,7
ds_write_b128 v15, v[128:131] offset:0
s_waitcnt vmcnt(11)
v_lshlrev_b32 v0, 16, v132
buffer_load_dwordx4 v[204:207], v75, s[24:27], s50 offen nt
v_and_b32 v1, s71, v132
v_lshlrev_b32 v2, 16, v133
v_and_b32 v3, s71, v133
v_lshlrev_b32 v4, 16, v134
v_and_b32 v5, s71, v134
v_lshlrev_b32 v6, 16, v135
v_and_b32_e64 v7, s71, v135
v_pk_mul_f32 v[0:1], v[0:1], s[14:15]
v_pk_mul_f32 v[2:3], v[2:3], s[14:15]
v_pk_mul_f32 v[4:5], v[4:5], s[14:15]
v_pk_mul_f32 v[6:7], v[6:7], s[14:15]
CV 132,0,1
CV 133,2,3
CV 134,4,5
CV 135,6,7
ds_write_b128 v15, v[132:135] offset:544
s_waitcnt vmcnt(11)
v_lshlrev_b32 v0, 16, v136
v_and_b32 v1, s71, v136
v_lshlrev_b32 v2, 16, v137
v_and_b32 v3, s71, v137
v_lshlrev_b32 v4, 16, v138
v_and_b32 v5, s71, v138
v_lshlrev_b32 v6, 16, v139
v_and_b32_e64 v7, s71, v139
v_pk_mul_f32 v[0:1], v[0:1], s[14:15]
v_pk_mul_f32 v[2:3], v[2:3], s[14:15]
v_pk_mul_f32 v[4:5], v[4:5], s[14:15]
v_pk_mul_f32 v[6:7], v[6:7], s[14:15]
CV 136,0,1
CV 137,2,3
CV 138,4,5
CV 139,6,7
ds_write_b128 v15, v[136:139] offset:1152
s_waitcnt vmcnt(10)
v_lshlrev_b32 v0, 16, v140
v_and_b32 v1, s71, v140
v_lshlrev_b32 v2, 16, v141
v_and_b32 v3, s71, v141
v_lshlrev_b32 v4, 16, v142
v_and_b32 v5, s71, v142
v_lshlrev_b32 v6, 16, v143
v_and_b32_e64 v7, s71, v143
v_pk_mul_f32 v[0:1], v[0:1], s[14:15]
v_pk_mul_f32 v[2:3], v[2:3], s[14:15]
v_pk_mul_f32 v[4:5], v[4:5], s[14:15]
v_pk_mul_f32 v[6:7], v[6:7], s[14:15]
CV 140,0,1
CV 141,2,3
CV 142,4,5
CV 143,6,7
ds_write_b128 v15, v[140:143] offset:1696
RK 128,14,0
v_subrev_u32 v12, 0x30000, v71
v_subrev_u32 v13, 0x20000, v71
v_ashrrev_i32 v12, 31, v12
v_ashrrev_i32 v13, 31, v13
v_not_b32 v12, v12
v_not_b32 v13, v13
v_and_b32 v12, 0xff800000, v12
v_and_b32 v13, 0xff800000, v13
RK 132,14,64
RK 136,14,128
v_mov_b32 v36, 0
v_mov_b32 v37, 0
RK 140,14,192
v_mov_b32 v38, 0
v_mov_b32 v39, 0
v_accvgpr_write_b32 a240, 0
v_accvgpr_write_b32 a241, 0
v_xor_b32 v60, s43, v60
v_xor_b32 v61, s43, v61
v_xor_b32 v62, s43, v62
v_xor_b32 v63, s43, v63
s_sub_u32 s51, s26, s44
s_ashr_i32 s51, s51, 8
v_and_b32 v41, 0xf0, v72
s_sub_u32 s51, s51, 0
v_sub_u32 v41, s51, v41
s_sub_u32 s52, s26, s44
v_ashrrev_i32 v41, 31, v41
s_ashr_i32 s52, s52, 8
v_and_b32 v45, 0xf0, v72
s_waitcnt lgkmcnt(3)
QZ 16,0,128
s_sub_u32 s52, s52, 256
v_sub_u32 v45, s52, v45
v_accvgpr_write_b32 a244, 0
v_ashrrev_i32 v45, 31, v45
v_accvgpr_write_b32 a245, 0
v_accvgpr_write_b32 a246, 0
v_accvgpr_write_b32 a247, 0
s_sub_u32 s53, s26, s44
s_ashr_i32 s53, s53, 8
v_and_b32 v49, 0xf0, v72
s_waitcnt lgkmcnt(2)
QK 16,4,132,16
s_waitcnt lgkmcnt(1)
s_sub_u32 s53, s53, 512
v_sub_u32 v49, s53, v49
v_accvgpr_write_b32 a248, 0
QK 16,8,136,16
s_waitcnt lgkmcnt(0)
s_xor_b32 s41, s41, s43
v_ashrrev_i32 v49, 31, v49
v_accvgpr_write_b32 a249, 0
QK 16,12,140,16
s_xor_b32 s42, s41, 0xc000
v_mov_b32 v34, 0
v_mov_b32 v35, 0
v_accvgpr_write_b32 a250, 0
v_accvgpr_write_b32 a251, 0
s_mul_i32 s45, s12, 0x30000
s_add_u32 s45, s45, 0x1320000
s_mov_b64 s[32:33], s[24:25]
s_mov_b32 s34, 0x13d9100
v_max3_f32 v8, v16, v17, v18
s_mov_b32 s35, 0x20000
v_max_f32 v8, v8, v19
s_mov_b64 s[36:37], s[28:29]
v_mov_b32 v9, v8
s_mov_b32 s38, 0x13d9100
s_mov_b32 s39, 0x20000
v_permlane32_swap_b32 v8, v9
v_max_f32 v8, v8, v9
s_mov_b32 s57, 8
v_mov_b32 v9, v8
s_mov_b32 s58, 0x20000
s_mov_b32 s60, 0x7a9000
v_permlane16_swap_b32 v8, v9
v_min_f32_e64 v40, -v8, -v9
s_mov_b32 s59, 0x20000
v_add_f32 v8, v40, v12
v_add_f32 v9, v40, v13
v_add_f32 v16, v8, v16
v_add_f32 v17, v8, v17
v_add_f32 v18, v9, v18
v_add_f32 v19, v9, v19
EX 16
EX 17
EX 18
EX 19
CV 32,16,17
CV 33,18,19
v_bfi_b32 v40, v41, s70, v40
s_waitcnt vmcnt(7)
s_barrier
buffer_load_dwordx4 v66, s[16:19], s40 offen lds
RV 64,64,8192
RV 66,64,12288
v_lshlrev_b32 v0, 16, v160
RV 68,65,8192
RV 70,65,12288
v_and_b32_e64 v1, s71, v160
RV 72,64,8448
RV 74,64,12544
buffer_load_dwordx4 v67, s[16:19], s40 offen offset:1024 lds
RV 76,65,8448
s_add_u32 m0, s47, 0x14000
v_lshlrev_b32 v2, 16, v161
RV 78,65,12544
RV 80,64,8704
v_and_b32 v3, s71, v161
RV 82,64,12800
RV 84,65,8704
buffer_load_dwordx4 v68, s[20:23], s40 offen lds
RV 86,65,12800
v_lshlrev_b32 v4, 16, v162
RV 88,64,8960
RV 90,64,13056
v_and_b32 v5, s71, v162
RV 92,65,8960
v_lshlrev_b32_e64 v6, 16, v163
buffer_load_dwordx4 v69, s[20:23], s40 offen offset:1024 lds
s_mov_b32 s40, 0x7b7000
s_add_u32 m0, s47, 0x6000
RV 94,65,13056
v_and_b32_e64 v7, s71, v163
v_pk_mul_f32 v[0:1], v[0:1], s[14:15]
v_pk_mul_f32 v[2:3], v[2:3], s[14:15]
v_pk_mul_f32 v[4:5], v[4:5], s[14:15]
v_pk_mul_f32 v[6:7], v[6:7], s[14:15]
CV 160,0,1
CV 161,2,3
CV 162,4,5
CV 163,6,7
ds_write_b128 v15, v[160:163] offset:0
s_waitcnt vmcnt(10)
v_lshlrev_b32 v0, 16, v164
v_and_b32 v1, s71, v164
v_lshlrev_b32 v2, 16, v165
v_and_b32 v3, s71, v165
v_lshlrev_b32 v4, 16, v166
v_and_b32 v5, s71, v166
v_lshlrev_b32 v6, 16, v167
v_and_b32_e64 v7, s71, v167
v_pk_mul_f32 v[0:1], v[0:1], s[14:15]
v_pk_mul_f32 v[2:3], v[2:3], s[14:15]
v_pk_mul_f32 v[4:5], v[4:5], s[14:15]
v_pk_mul_f32 v[6:7], v[6:7], s[14:15]
CV 164,0,1
CV 165,2,3
CV 166,4,5
CV 167,6,7
ds_write_b128 v15, v[164:167] offset:544
s_waitcnt vmcnt(9)
v_lshlrev_b32 v0, 16, v168
v_and_b32 v1, s71, v168
v_lshlrev_b32 v2, 16, v169
v_and_b32 v3, s71, v169
v_lshlrev_b32 v4, 16, v170
v_and_b32 v5, s71, v170
v_lshlrev_b32 v6, 16, v171
v_and_b32_e64 v7, s71, v171
v_pk_mul_f32 v[0:1], v[0:1], s[14:15]
v_pk_mul_f32 v[2:3], v[2:3], s[14:15]
v_pk_mul_f32 v[4:5], v[4:5], s[14:15]
v_pk_mul_f32 v[6:7], v[6:7], s[14:15]
CV 168,0,1
CV 169,2,3
CV 170,4,5
CV 171,6,7
ds_write_b128 v15, v[168:171] offset:1152
s_waitcnt vmcnt(8)
v_lshlrev_b32 v0, 16, v172
v_and_b32 v1, s71, v172
v_lshlrev_b32 v2, 16, v173
v_and_b32 v3, s71, v173
v_lshlrev_b32 v4, 16, v174
v_and_b32 v5, s71, v174
v_lshlrev_b32 v6, 16, v175
v_and_b32_e64 v7, s71, v175
v_pk_mul_f32 v[0:1], v[0:1], s[14:15]
v_pk_mul_f32 v[2:3], v[2:3], s[14:15]
v_pk_mul_f32 v[4:5], v[4:5], s[14:15]
v_pk_mul_f32 v[6:7], v[6:7], s[14:15]
CV 172,0,1
CV 173,2,3
CV 174,4,5
CV 175,6,7
s_waitcnt lgkmcnt(15)
PZ 128,64,32
s_mov_b32 s61, 0x1a000
ds_write_b128 v15, v[172:175] offset:1696
PZ 132,68,32
s_waitcnt lgkmcnt(14)
RK 144,14,0
RK 148,14,64
PZ 136,72,32
s_waitcnt lgkmcnt(14)
RK 152,14,128
v_mov_b32 v41, v40
PZ 140,76,32
s_waitcnt lgkmcnt(13)
RK 156,14,192
v_mov_b32 v42, v40
PZ 144,80,32
s_waitcnt lgkmcnt(12)
v_mov_b32 v43, v40
v_xor_b32 v64, s43, v64
PZ 148,84,32
s_waitcnt lgkmcnt(10)
v_xor_b32 v65, s43, v65
v_accvgpr_write_b32 a252, 0
PZ 152,88,32
s_waitcnt lgkmcnt(8)
s_xor_b32 s43, s43, 0xc000
v_accvgpr_write_b32 a253, 0
v_accvgpr_write_b32 a254, 0
PZ 156,92,32
v_accvgpr_write_b32 a255, 0
v_smfmac_f32_16x16x64_bf16 a[240:243], v[56:59], v[32:39], v71
s_waitcnt lgkmcnt(3)
QZ 24,0,144
s_waitcnt lgkmcnt(2)
QK 24,4,148,24
s_waitcnt lgkmcnt(1)
QK 24,8,152,24
s_waitcnt lgkmcnt(0)
QK 24,12,156,24
v_mov_b32 v38, 0
v_mov_b32 v39, 0
s_nop 5
v_max3_f32 v10, v24, v25, v26
v_max_f32 v10, v10, v27
v_mov_b32 v11, v10
s_nop 1
v_permlane32_swap_b32 v10, v11
v_max_f32 v10, v10, v11
v_mov_b32 v11, v10
v_accvgpr_write_b32 a242, 0
v_accvgpr_write_b32 a243, 0
v_permlane16_swap_b32 v10, v11
v_min_f32_e64 v44, -v10, -v11
v_add_f32 v10, v44, v12
v_add_f32 v11, v44, v13
v_add_f32 v24, v10, v24
v_add_f32 v25, v10, v25
v_add_f32 v26, v11, v26
v_add_f32 v27, v11, v27
EX 24
EX 25
EX 26
EX 27
CV 36,24,25
CV 37,26,27
v_bfi_b32 v44, v45, s70, v44
s_waitcnt vmcnt(7)
buffer_load_dwordx4 v66, s[16:19], s40 offen lds
v_lshlrev_b32 v0, 16, v192
v_and_b32 v1, s71, v192
v_lshlrev_b32 v2, 16, v193
v_and_b32 v3, s71, v193
v_lshlrev_b32 v4, 16, v194
v_and_b32 v5, s71, v194
v_lshlrev_b32 v6, 16, v195
v_and_b32_e64 v7, s71, v195
buffer_load_dwordx4 v67, s[16:19], s40 offen offset:1024 lds
s_add_u32 m0, s47, 0x16000
v_pk_mul_f32 v[0:1], v[0:1], s[14:15]
v_pk_mul_f32 v[2:3], v[2:3], s[14:15]
v_pk_mul_f32 v[4:5], v[4:5], s[14:15]
v_pk_mul_f32 v[6:7], v[6:7], s[14:15]
CV 192,0,1
CV 193,2,3
CV 194,4,5
CV 195,6,7
ds_write_b128 v15, v[192:195] offset:0
buffer_load_dwordx4 v68, s[20:23], s40 offen lds
s_waitcnt vmcnt(9)
v_lshlrev_b32 v0, 16, v196
v_and_b32 v1, s71, v196
v_lshlrev_b32 v2, 16, v197
v_and_b32 v3, s71, v197
v_lshlrev_b32 v4, 16, v198
v_and_b32 v5, s71, v198
v_lshlrev_b32 v6, 16, v199
v_and_b32_e64 v7, s71, v199
v_pk_mul_f32 v[0:1], v[0:1], s[14:15]
v_pk_mul_f32 v[2:3], v[2:3], s[14:15]
buffer_load_dwordx4 v69, s[20:23], s40 offen offset:1024 lds
v_pk_mul_f32 v[4:5], v[4:5], s[14:15]
v_pk_mul_f32 v[6:7], v[6:7], s[14:15]
CV 196,0,1
CV 197,2,3
CV 198,4,5
CV 199,6,7
ds_write_b128 v15, v[196:199] offset:544
s_waitcnt vmcnt(9)
v_lshlrev_b32 v0, 16, v200
v_and_b32 v1, s71, v200
v_lshlrev_b32 v2, 16, v201
v_and_b32 v3, s71, v201
v_lshlrev_b32 v4, 16, v202
v_and_b32 v5, s71, v202
v_lshlrev_b32 v6, 16, v203
v_and_b32_e64 v7, s71, v203
v_pk_mul_f32 v[0:1], v[0:1], s[14:15]
v_pk_mul_f32 v[2:3], v[2:3], s[14:15]
v_pk_mul_f32 v[4:5], v[4:5], s[14:15]
v_pk_mul_f32 v[6:7], v[6:7], s[14:15]
CV 200,0,1
CV 201,2,3
CV 202,4,5
CV 203,6,7
ds_write_b128 v15, v[200:203] offset:1152
s_waitcnt vmcnt(8)
v_lshlrev_b32 v0, 16, v204
v_and_b32 v1, s71, v204
v_lshlrev_b32 v2, 16, v205
v_and_b32 v3, s71, v205
v_lshlrev_b32 v4, 16, v206
v_and_b32 v5, s71, v206
v_lshlrev_b32 v6, 16, v207
v_and_b32_e64 v7, s71, v207
v_pk_mul_f32 v[0:1], v[0:1], s[14:15]
v_pk_mul_f32 v[2:3], v[2:3], s[14:15]
v_pk_mul_f32 v[4:5], v[4:5], s[14:15]
v_pk_mul_f32 v[6:7], v[6:7], s[14:15]
CV 204,0,1
CV 205,2,3
CV 206,4,5
CV 207,6,7
PZ 160,64,36
s_mov_b32 s40, 0x7d7000
ds_write_b128 v15, v[204:207] offset:1696
PZ 164,68,36
s_add_u32 m0, s47, 0xc000
RK 160,14,0
RK 164,14,64
PZ 168,72,36
RK 168,14,128
v_mov_b32 v45, v44
PZ 172,76,36
s_waitcnt vmcnt(6)
s_barrier
PZ 176,80,36
RK 172,14,192
RK 32,60,0
PZ 180,84,36
buffer_load_dwordx4 v66, s[16:19], s40 offen lds
PZ 184,88,36
RK 36,61,0
RK 40,62,0
PZ 188,92,36
RK 44,63,0
v_mov_b32 v46, v44
v_mov_b32 v47, v44
s_waitcnt lgkmcnt(7)
QZ 16,0,160
s_waitcnt lgkmcnt(6)
buffer_load_dwordx4 v67, s[16:19], s40 offen offset:1024 lds
QK 16,4,164,16
s_waitcnt lgkmcnt(5)
s_add_u32 m0, s47, 0x1c000
RK 48,60,4096
RK 52,61,4096
QK 16,8,168,16
s_waitcnt lgkmcnt(6)
RK 56,62,4096
QK 16,12,172,16
s_waitcnt lgkmcnt(6)
RK 60,63,4096
s_nop 0
QK 24,32,128,40
s_waitcnt lgkmcnt(6)
buffer_load_dwordx4 v68, s[20:23], s40 offen lds
QK 24,36,132,24
s_waitcnt lgkmcnt(5)
v_mov_b32 v34, 0
v_mov_b32 v35, 0
QK 24,40,136,24
s_waitcnt lgkmcnt(4)
v_max3_f32 v8, v16, v17, v18
QK 24,44,140,24
s_waitcnt vmcnt(7) lgkmcnt(3)
s_barrier
QK 28,48,128,40
s_waitcnt lgkmcnt(2)
RV 96,64,0
v_max_f32 v8, v8, v19
QK 28,52,132,28
s_waitcnt lgkmcnt(1)
RV 98,64,4096
v_mov_b32 v9, v8
QK 28,56,136,28
EX 24
QK 28,60,140,28
buffer_load_dwordx4 v69, s[20:23], s40 offen offset:1024 lds
RV 100,65,0
RV 102,65,4096
v_permlane32_swap_b32 v8, v9
v_max_f32 v8, v8, v9
EX 25
v_mov_b32 v9, v8
EX 26
EX 27
v_permlane16_swap_b32 v8, v9
v_min_f32_e64 v48, -v8, -v9
v_add_f32 v8, v48, v12
v_add_f32 v9, v48, v13
v_add_f32 v16, v8, v16
v_add_f32 v17, v8, v17
v_add_f32 v18, v9, v18
v_add_f32 v19, v9, v19
EX 16
EX 17
EX 18
EX 19
CV 32,16,17
CV 33,18,19
v_bfi_b32 v48, v49, s70, v48
s_nop 0
v_smfmac_f32_16x16x64_bf16 a[244:247], v[56:59], v[32:39], v71
s_mov_b32 s40, 0x7f7000
v_mov_b32 v49, v48
QK 16,32,144,44
s_add_u32 m0, s47, 0xe000
v_mov_b32 v50, v48
v_mov_b32 v51, v48
QK 16,36,148,16
CV 36,24,25
CV 37,26,27
QK 16,40,152,16
buffer_load_dwordx4 v66, s[16:19], s40 offen lds
QK 16,44,156,16
RV 104,64,256
RV 106,64,4352
QK 20,48,144,44
RV 108,65,256
v_subrev_u32 v12, 0x30000, v71
QK 20,52,148,20
RV 110,65,4352
RV 112,64,512
QK 20,56,152,20
RV 114,64,4608
v_subrev_u32 v13, 0x20000, v71
QK 20,60,156,20
RV 116,65,512
RV 118,65,4608
PZ 192,64,32
RV 120,64,768
v_ashrrev_i32 v12, 31, v12
PZ 196,68,32
RV 122,64,4864
RV 124,65,768
PZ 200,72,32
RV 126,65,4864
v_ashrrev_i32 v13, 31, v13
PZ 204,76,32
buffer_load_dwordx4 v67, s[16:19], s40 offen offset:1024 lds
PZ 208,80,32
EX 28
PZ 212,84,32
EX 29
PZ 216,88,32
EX 30
PZ 220,92,32
EX 31
QK 24,32,160,48
CV 38,28,29
CV 39,30,31
QK 24,36,164,24
EX 16
QK 24,40,168,24
s_add_u32 m0, s47, 0x1e000
EX 17
QK 24,44,172,24
EX 18
QK 28,48,160,48
s_waitcnt vmcnt(8)
s_barrier
QK 28,52,164,28
buffer_load_dwordx4 v68, s[20:23], s40 offen lds
QK 28,56,168,28
s_waitcnt lgkmcnt(0)
RK 0,60,8192
RK 4,61,8192
QK 28,60,172,28
RK 8,62,8192
CV 32,16,17
PV 128,96,36
RK 12,63,8192
v_not_b32 v12, v12
PV 132,100,36
RK 16,60,12288
v_not_b32 v13, v13
PV 136,104,36
RK 20,61,12288
v_xor_b32 v60, s43, v60
PV 140,108,36
RK 24,62,12288
v_xor_b32 v61, s43, v61
PV 144,112,36
RK 28,63,12288
v_xor_b32 v62, s43, v62
PV 148,116,36
buffer_load_dwordx4 v69, s[20:23], s40 offen offset:1024 lds
PV 152,120,36
EX 19
PV 156,124,36
EX 20
EX 21
EX 22
EX 23
CV 33,18,19
CV 34,20,21
CV 35,22,23
v_xor_b32 v63, s43, v63
v_and_b32 v12, 0xff800000, v12
v_smfmac_f32_16x16x64_bf16 a[248:251], v[56:59], v[32:39], v71
s_waitcnt lgkmcnt(0)
v_and_b32 v13, 0xff800000, v13
QK 16,0,128,40
EX 24
QK 16,4,132,16
EX 25
QK 16,8,136,16
EX 26
QK 16,12,140,16
EX 27
QK 20,16,128,40
CV 36,24,25
CV 37,26,27
QK 20,20,132,20
EX 28
QK 20,24,136,20
EX 29
QK 20,28,140,20
EX 30
PV 160,96,32
EX 31
PV 164,100,32
CV 38,28,29
CV 39,30,31
PV 168,104,32
s_waitcnt vmcnt(8)
s_barrier
PV 172,108,32
EX 16
PV 176,112,32
EX 17
PV 180,116,32
EX 18
PV 184,120,32
s_xor_b32 s41, s41, s43
EX 19
PV 188,124,32
s_mov_b32 s40, 0x817000
CV 32,16,17
CV 33,18,19
QK 24,0,144,44
s_add_u32 m0, s47, 0x8000
EX 20
QK 24,4,148,24
L_t0_pad1:
s_cbranch_execz L_t0_pad5
s_xor_b32 s42, s41, 0xc000
RV 64,64,8192
RV 66,64,12288
QK 24,8,152,24
buffer_load_dwordx4 v66, s[16:19], s40 offen lds
QK 24,12,156,24
EX 21
QK 28,16,144,44
EX 22
QK 28,20,148,28
RV 68,65,8192
CV 34,20,21
QK 28,24,152,28
EX 23
QK 28,28,156,28
RV 70,65,12288
CV 35,22,23
PV 192,96,36
RV 72,64,8448
RV 74,64,12544
PV 196,100,36
EX 24
PV 200,104,36
RV 76,65,8448
RV 78,65,12544
PV 204,108,36
buffer_load_dwordx4 v67, s[16:19], s40 offen offset:1024 lds
PV 208,112,36
RV 80,64,8704
RV 82,64,12800
PV 212,116,36
EX 25
PV 216,120,36
RV 84,65,8704
RV 86,65,12800
PV 220,124,36
EX 26
v_smfmac_f32_16x16x64_bf16 a[240:243], v[56:59], v[32:39], v71
RV 88,64,8960
QK 16,0,160,48
RV 90,64,13056
RV 92,65,8960
QK 16,4,164,16
s_add_u32 m0, s47, 0x18000
RV 94,65,13056
CV 36,24,25
QK 16,8,168,16
EX 27
QK 16,12,172,16
s_waitcnt vmcnt(8)
s_barrier
QK 20,16,160,48
buffer_load_dwordx4 v68, s[20:23], s40 offen lds
QK 20,20,164,20
RK 32,60,0
RK 36,61,0
QK 20,24,168,20
RK 40,62,0
CV 37,26,27
QK 20,28,172,20
s_waitcnt lgkmcnt(3)
RK 44,63,0
v_xor_b32 v64, s43, v64
PV 128,64,32
RK 48,60,4096
v_xor_b32 v65, s43, v65
PV 132,68,32
s_xor_b32 s43, s43, 0xc000
RK 52,61,4096
PV 136,72,32
RK 56,62,4096
PV 140,76,32
RK 60,63,4096
PV 144,80,32
buffer_load_dwordx4 v69, s[20:23], s40 offen offset:1024 lds
PV 148,84,32
EX 28
PV 152,88,32
EX 29
PV 156,92,32
s_waitcnt lgkmcnt(7)
EX 30
QK 24,32,128,40
s_waitcnt lgkmcnt(6)
EX 31
QK 24,36,132,24
s_waitcnt lgkmcnt(0)
CV 38,28,29
CV 39,30,31
QK 24,40,136,24
EX 16
QK 24,44,140,24
EX 17
QK 28,48,128,40
EX 18
QK 28,52,132,28
EX 19
QK 28,56,136,28
EX 20
QK 28,60,140,28
EX 21
PV 160,64,36
EX 22
PV 164,68,36
EX 23
PV 168,72,36
CV 32,16,17
CV 33,18,19
PV 172,76,36
s_waitcnt vmcnt(8)
s_barrier
PV 176,80,36
CV 34,20,21
CV 35,22,23
PV 180,84,36
EX 24
PV 184,88,36
EX 25
PV 188,92,36
EX 26
v_smfmac_f32_16x16x64_bf16 a[244:247], v[56:59], v[32:39], v71
CV 36,24,25
QK 16,32,144,44
s_mov_b32 s40, 0x837000
EX 27
QK 16,36,148,16
s_add_u32 m0, s47, 0xa000
RV 96,64,0
CV 37,26,27
QK 16,40,152,16
RV 98,64,4096
RV 100,65,0
QK 16,44,156,16
buffer_load_dwordx4 v66, s[16:19], s40 offen lds
QK 20,48,144,44
RV 102,65,4096
RV 104,64,256
QK 20,52,148,20
EX 28
QK 20,56,152,20
RV 106,64,4352
RV 108,65,256
QK 20,60,156,20
EX 29
PV 192,64,32
buffer_load_dwordx4 v67, s[16:19], s40 offen offset:1024 lds
PV 196,68,32
RV 110,65,4352
RV 112,64,512
PV 200,72,32
RV 114,64,4608
CV 38,28,29
PV 204,76,32
s_add_u32 m0, s47, 0x1a000
RV 116,65,512
RV 118,65,4608
PV 208,80,32
EX 30
PV 212,84,32
buffer_load_dwordx4 v68, s[20:23], s40 offen lds
PV 216,88,32
RV 120,64,768
RV 122,64,4864
PV 220,92,32
RV 124,65,768
QK 24,32,160,48
RV 126,65,4864
QK 24,36,164,24
EX 31
QK 24,40,168,24
buffer_load_dwordx4 v69, s[20:23], s40 offen offset:1024 lds
QK 24,44,172,24
CV 39,30,31
QK 28,48,160,48
s_waitcnt vmcnt(10)
s_barrier
QK 28,52,164,28
s_mov_b32 s40, 0x857000
RK 0,60,8192
RK 4,61,8192
QK 28,56,168,28
s_waitcnt lgkmcnt(2)
RK 8,62,8192
s_add_u32 m0, s47, 0x0
QK 28,60,172,28
EX 16
PV 128,96,36
buffer_load_dwordx4 v66, s[16:19], s40 offen lds
PV 132,100,36
RK 12,63,8192
RK 16,60,12288
PV 136,104,36
RK 20,61,12288
v_xor_b32 v60, s43, v60
PV 140,108,36
RK 24,62,12288
v_xor_b32 v61, s43, v61
PV 144,112,36
RK 28,63,12288
v_xor_b32 v62, s43, v62
PV 148,116,36
buffer_load_dwordx4 v67, s[16:19], s40 offen offset:1024 lds
PV 152,120,36
EX 17
PV 156,124,36
EX 18
EX 19
EX 20
EX 21
EX 22
v_exp_f32_e64 v23, v23
CV 32,16,17
CV 33,18,19
CV 34,20,21
CV 35,22,23
v_xor_b32 v63, s43, v63
s_nop 0
v_smfmac_f32_16x16x64_bf16 a[248:251], v[56:59], v[32:39], v71
s_waitcnt lgkmcnt(0)
s_add_u32 m0, s47, 0x10000
QK 16,0,128,40
EX 24
QK 16,4,132,16
buffer_load_dwordx4 v68, s[20:23], s40 offen lds
QK 16,8,136,16
EX 25
QK 16,12,140,16
EX 26
QK 20,16,128,40
EX 27
QK 20,20,132,20
CV 36,24,25
CV 37,26,27
QK 20,24,136,20
buffer_load_dwordx4 v69, s[20:23], s40 offen offset:1024 lds
QK 20,28,140,20
EX 28
PV 160,96,32
EX 29
PV 164,100,32
EX 30
PV 168,104,32
s_waitcnt vmcnt(12)
s_barrier
PV 172,108,32
RV 64,64,8192
RV 66,64,12288
PV 176,112,32
RV 68,65,8192
CV 38,28,29
PV 180,116,32
RV 70,65,12288
RV 72,64,8448
PV 184,120,32
s_xor_b32 s41, s41, s43
EX 31
PV 188,124,32
s_mov_b32 s40, 0x877000
RV 74,64,12544
RV 76,65,8448
QK 24,0,144,44
s_add_u32 m0, s47, 0x2000
RV 78,65,12544
CV 39,30,31
QK 24,4,148,24
s_xor_b32 s42, s41, 0xc000
RV 80,64,8704
RV 82,64,12800
QK 24,8,152,24
EX 16
QK 24,12,156,24
RV 84,65,8704
RV 86,65,12800
QK 28,16,144,44
EX 17
QK 28,20,148,28
RV 88,64,8960
RV 90,64,13056
QK 28,24,152,28
RV 92,65,8960
v_xor_b32 v64, s43, v64
QK 28,28,156,28
RV 94,65,13056
CV 32,16,17
PV 192,96,36
buffer_load_dwordx4 v66, s[16:19], s40 offen lds
PV 196,100,36
EX 18
PV 200,104,36
EX 19
PV 204,108,36
buffer_load_dwordx4 v67, s[16:19], s40 offen offset:1024 lds
PV 208,112,36
EX 20
PV 212,116,36
s_waitcnt vmcnt(10) lgkmcnt(0)
s_barrier
PV 216,120,36
RK 32,60,0
RK 36,61,0
PV 220,124,36
RK 40,62,0
EX 21
EX 22
EX 23
CV 33,18,19
CV 34,20,21
CV 35,22,23
v_xor_b32 v65, s43, v65
s_xor_b32 s43, s43, 0xc000
v_smfmac_f32_16x16x64_bf16 a[240:243], v[56:59], v[32:39], v71
RK 44,63,0
QK 16,0,160,48
RK 48,60,4096
RK 52,61,4096
QK 16,4,164,16
s_add_u32 m0, s47, 0x12000
EX 24
QK 16,8,168,16
RK 56,62,4096
RK 60,63,4096
QK 16,12,172,16
buffer_load_dwordx4 v68, s[20:23], s40 offen lds
QK 20,16,160,48
RV 96,64,0
RV 98,64,4096
QK 20,20,164,20
EX 25
QK 20,24,168,20
RV 100,65,0
RV 102,65,4096
QK 20,28,172,20
RV 104,64,256
CV 36,24,25
PV 128,64,32
RV 106,64,4352
RV 108,65,256
PV 132,68,32
EX 26
PV 136,72,32
RV 110,65,4352
RV 112,64,512
PV 140,76,32
EX 27
PV 144,80,32
RV 114,64,4608
RV 116,65,512
PV 148,84,32
buffer_load_dwordx4 v69, s[20:23], s40 offen offset:1024 lds
PV 152,88,32
RV 118,65,4608
CV 37,26,27
PV 156,92,32
s_waitcnt lgkmcnt(12)
EX 28
QK 24,32,128,40
RV 120,64,768
RV 122,64,4864
QK 24,36,132,24
EX 29
QK 24,40,136,24
EX 30
QK 24,44,140,24
RV 124,65,768
RV 126,65,4864
EX 31
CV 38,28,29
CV 39,30,31
QK 28,48,128,40
EX 16
QK 28,52,132,28
EX 17
QK 28,56,136,28
EX 18
QK 28,60,140,28
EX 19
PV 160,64,36
EX 20
PV 164,68,36
EX 21
PV 168,72,36
EX 22
PV 172,76,36
EX 23
PV 176,80,36
CV 32,16,17
CV 33,18,19
PV 180,84,36
s_waitcnt vmcnt(8) lgkmcnt(0)
s_barrier
PV 184,88,36
CV 34,20,21
CV 35,22,23
PV 188,92,36
EX 24
v_smfmac_f32_16x16x64_bf16 a[244:247], v[56:59], v[32:39], v71
s_mov_b32 s40, 0x897000
RK 0,60,8192
QK 16,32,144,44
s_add_u32 m0, s47, 0x4000
EX 25
QK 16,36,148,16
RK 4,61,8192
RK 8,62,8192
QK 16,40,152,16
buffer_load_dwordx4 v66, s[16:19], s40 offen lds
QK 16,44,156,16
RK 12,63,8192
CV 36,24,25
QK 20,48,144,44
EX 26
QK 20,52,148,20
EX 27
QK 20,56,152,20
RK 16,60,12288
RK 20,61,12288
QK 20,60,156,20
RK 24,62,12288
CV 37,26,27
PV 192,64,32
EX 28
PV 196,68,32
RK 28,63,12288
v_xor_b32 v60, s43, v60
PV 200,72,32
EX 29
PV 204,76,32
buffer_load_dwordx4 v67, s[16:19], s40 offen offset:1024 lds
PV 208,80,32
RV 64,64,8192
RV 66,64,12288
PV 212,84,32
EX 30
PV 216,88,32
RV 68,65,8192
CV 38,28,29
PV 220,92,32
RV 70,65,12288
v_xor_b32 v61, s43, v61
QK 24,32,160,48
EX 31
QK 24,36,164,24
RV 72,64,8448
CV 39,30,31
QK 24,40,168,24
s_add_u32 m0, s47, 0x14000
EX 16
QK 24,44,172,24
RV 74,64,12544
v_xor_b32 v62, s43, v62
QK 28,48,160,48
buffer_load_dwordx4 v68, s[20:23], s40 offen lds
QK 28,52,164,28
RV 76,65,8448
v_xor_b32 v63, s43, v63
QK 28,56,168,28
EX 17
QK 28,60,172,28
RV 78,65,12544
CV 32,16,17
PV 128,96,36
EX 18
PV 132,100,36
RV 80,64,8704
RV 82,64,12800
PV 136,104,36
EX 19
PV 140,108,36
RV 84,65,8704
CV 33,18,19
PV 144,112,36
EX 20
PV 148,116,36
buffer_load_dwordx4 v69, s[20:23], s40 offen offset:1024 lds
PV 152,120,36
EX 21
PV 156,124,36
RV 86,65,12800
RV 88,64,8960
EX 22
EX 23
CV 34,20,21
CV 35,22,23
EX 24
s_nop 0
v_smfmac_f32_16x16x64_bf16 a[248:251], v[56:59], v[32:39], v71
s_waitcnt lgkmcnt(13)
RV 90,64,13056
QK 16,0,128,40
RV 92,65,8960
v_xor_b32 v64, s43, v64
QK 16,4,132,16
EX 25
QK 16,8,136,16
RV 94,65,13056
CV 36,24,25
QK 16,12,140,16
EX 26
QK 20,16,128,40
EX 27
QK 20,20,132,20
CV 37,26,27
v_xor_b32 v65, s43, v65
QK 20,24,136,20
EX 28
QK 20,28,140,20
EX 29
PV 160,96,32
EX 30
PV 164,100,32
EX 31
PV 168,104,32
CV 38,28,29
CV 39,30,31
PV 172,108,32
EX 16
PV 176,112,32
s_waitcnt vmcnt(8) lgkmcnt(0)
s_barrier
PV 180,116,32
EX 17
PV 184,120,32
s_xor_b32 s41, s41, s43
EX 18
PV 188,124,32
s_mov_b32 s40, 0x8b7000
RK 32,60,0
RK 36,61,0
QK 24,0,144,44
s_add_u32 m0, s47, 0x6000
EX 19
QK 24,4,148,24
s_xor_b32 s43, s43, 0xc000
RK 40,62,0
CV 32,16,17
QK 24,8,152,24
buffer_load_dwordx4 v66, s[16:19], s40 offen lds
QK 24,12,156,24
s_xor_b32 s42, s41, 0xc000
RK 44,63,0
CV 33,18,19
QK 28,16,144,44
EX 20
QK 28,20,148,28
EX 21
QK 28,24,152,28
RK 48,60,4096
RK 52,61,4096
QK 28,28,156,28
EX 22
PV 192,96,36
RK 56,62,4096
CV 34,20,21
PV 196,100,36
EX 23
PV 200,104,36
RK 60,63,4096
CV 35,22,23
PV 204,108,36
buffer_load_dwordx4 v67, s[16:19], s40 offen offset:1024 lds
PV 208,112,36
EX 24
PV 212,116,36
RV 96,64,0
RV 98,64,4096
PV 216,120,36
EX 25
PV 220,124,36
EX 26
v_smfmac_f32_16x16x64_bf16 a[240:243], v[56:59], v[32:39], v71
RV 100,65,0
QK 16,0,160,48
RV 102,65,4096
CV 36,24,25
QK 16,4,164,16
s_add_u32 m0, s47, 0x16000
EX 27
QK 16,8,168,16
L_t0_pad2:
s_cbranch_execz L_t0_pad6
RV 104,64,256
RV 106,64,4352
QK 16,12,172,16
buffer_load_dwordx4 v68, s[20:23], s40 offen lds
QK 20,16,160,48
RV 108,65,256
CV 37,26,27
QK 20,20,164,20
EX 28
QK 20,24,168,20
EX 29
QK 20,28,172,20
RV 110,65,4352
RV 112,64,512
PV 128,64,32
EX 30
PV 132,68,32
RV 114,64,4608
CV 38,28,29
PV 136,72,32
EX 31
PV 140,76,32
RV 116,65,512
CV 39,30,31
PV 144,80,32
buffer_load_dwordx4 v69, s[20:23], s40 offen offset:1024 lds
PV 148,84,32
EX 16
PV 152,88,32
RV 118,65,4608
RV 120,64,768
PV 156,92,32
s_waitcnt lgkmcnt(13)
EX 17
QK 24,32,128,40
RV 122,64,4864
CV 32,16,17
QK 24,36,132,24
EX 18
QK 24,40,136,24
EX 19
QK 24,44,140,24
RV 124,65,768
RV 126,65,4864
QK 28,48,128,40
EX 20
QK 28,52,132,28
EX 21
QK 28,56,136,28
EX 22
QK 28,60,140,28
EX 23
PV 160,64,36
CV 33,18,19
CV 34,20,21
PV 164,68,36
EX 24
PV 168,72,36
CV 35,22,23
PV 172,76,36
EX 25
PV 176,80,36
PV 180,84,36
s_waitcnt vmcnt(8) lgkmcnt(0)
s_barrier
PV 184,88,36
EX 26
PV 188,92,36
EX 27
v_smfmac_f32_16x16x64_bf16 a[244:247], v[56:59], v[32:39], v71
RK 0,60,8192
QK 16,32,144,44
s_mov_b32 s40, 0x8d7000
RK 4,61,8192
CV 36,24,25
QK 16,36,148,16
s_add_u32 m0, s47, 0xc000
RK 8,62,8192
CV 37,26,27
QK 16,40,152,16
EX 28
QK 16,44,156,16
buffer_load_dwordx4 v66, s[16:19], s40 offen lds
QK 20,48,144,44
RK 12,63,8192
RK 16,60,12288
QK 20,52,148,20
EX 29
QK 20,56,152,20
RK 20,61,12288
CV 38,28,29
QK 20,60,156,20
RK 24,62,12288
v_xor_b32 v60, s43, v60
PV 192,64,32
buffer_load_dwordx4 v67, s[16:19], s40 offen offset:1024 lds
PV 196,68,32
RK 28,63,12288
v_xor_b32 v61, s43, v61
PV 200,72,32
EX 30
PV 204,76,32
s_add_u32 m0, s47, 0x1c000
RV 64,64,8192
v_xor_b32 v62, s43, v62
PV 208,80,32
RV 66,64,12288
v_xor_b32 v63, s43, v63
PV 212,84,32
buffer_load_dwordx4 v68, s[20:23], s40 offen lds
PV 216,88,32
EX 31
PV 220,92,32
RV 68,65,8192
RV 70,65,12288
QK 24,32,160,48
EX 16
QK 24,36,164,24
RV 72,64,8448
CV 39,30,31
QK 24,40,168,24
buffer_load_dwordx4 v69, s[20:23], s40 offen offset:1024 lds
QK 24,44,172,24
EX 17
QK 28,48,160,48
RV 74,64,12544
RV 76,65,8448
QK 28,52,164,28
s_mov_b32 s40, 0x8f7000
EX 18
QK 28,56,168,28
s_add_u32 m0, s47, 0xe000
RV 78,65,12544
CV 32,16,17
QK 28,60,172,28
EX 19
PV 128,96,36
buffer_load_dwordx4 v66, s[16:19], s40 offen lds
PV 132,100,36
RV 80,64,8704
RV 82,64,12800
PV 136,104,36
EX 20
PV 140,108,36
RV 84,65,8704
CV 33,18,19
PV 144,112,36
EX 21
PV 148,116,36
buffer_load_dwordx4 v67, s[16:19], s40 offen offset:1024 lds
PV 152,120,36
EX 22
PV 156,124,36
RV 86,65,12800
RV 88,64,8960
EX 23
CV 34,20,21
CV 35,22,23
EX 24
s_nop 0
v_smfmac_f32_16x16x64_bf16 a[248:251], v[56:59], v[32:39], v71
s_waitcnt lgkmcnt(13)
s_add_u32 m0, s47, 0x1e000
QK 16,0,128,40
RV 90,64,13056
RV 92,65,8960
QK 16,4,132,16
buffer_load_dwordx4 v68, s[20:23], s40 offen lds
QK 16,8,136,16
RV 94,65,13056
v_xor_b32 v64, s43, v64
QK 16,12,140,16
EX 25
QK 20,16,128,40
EX 26
QK 20,20,132,20
EX 27
QK 20,24,136,20
buffer_load_dwordx4 v69, s[20:23], s40 offen offset:1024 lds
QK 20,28,140,20
v_exp_f32_e64 v28, v28
PV 160,96,32
EX 29
PV 164,100,32
v_exp_f32_e64 v30, v30
PV 168,104,32
EX 31
PV 172,108,32
CV 36,24,25
CV 37,26,27
PV 176,112,32
s_waitcnt vmcnt(8) lgkmcnt(0)
s_barrier
PV 180,116,32
CV 38,28,29
CV 39,30,31
v_xor_b32_e64 v65, s43, v65
s_mov_b32 s56, 1
L_t0_loop0:
PV 184,120,32
s_xor_b32 s41, s41, s43
EX 16
PV 188,124,32
s_xor_b32 s42, s41, 0xc000
RK 32,60,0
RK 36,61,0
QK 24,0,144,44
s_sub_u32 s57, s57, 1
s_cselect_b64 s[58:59], s[60:61], s[58:59]
QK 24,4,148,24
s_add_u32 s40, s40, s58
RK 40,62,0
s_add_u32 m0, s42, 0x0
QK 24,8,152,24
buffer_load_dwordx4 v66, s[16:19], s40 offen lds
QK 24,12,156,24
s_mov_b32 s58, s59
EX 17
QK 28,16,144,44
s_mov_b32 s59, 0x20000
RK 44,63,0
RK 48,60,4096
QK 28,20,148,28
s_xor_b32 s43, s43, 0xc000
EX 18
QK 28,24,152,28
RK 52,61,4096
CV 32,16,17
QK 28,28,156,28
EX 19
PV 192,96,36
RK 56,62,4096
CV 33,18,19
PV 196,100,36
EX 20
PV 200,104,36
EX 21
PV 204,108,36
buffer_load_dwordx4 v67, s[16:19], s40 offen offset:1024 lds
PV 208,112,36
RK 60,63,4096
CV 34,20,21
PV 212,116,36
EX 22
PV 216,120,36
EX 23
PV 220,124,36
RV 96,64,0
CV 35,22,23
EX 24
s_nop 0
v_smfmac_f32_16x16x64_bf16 a[240:243], v[56:59], v[32:39], v71
s_sub_u32 s57, s57, 1
s_cselect_b64 s[58:59], s[60:61], s[58:59]
RV 98,64,4096
QK 16,0,160,48
s_add_u32 m0, s42, 0x10000
RV 100,65,0
RV 102,65,4096
QK 16,4,164,16
EX 25
QK 16,8,168,16
RV 104,64,256
RV 106,64,4352
QK 16,12,172,16
buffer_load_dwordx4 v68, s[20:23], s40 offen lds
QK 20,16,160,48
RV 108,65,256
CV 36,24,25
QK 20,20,164,20
EX 26
QK 20,24,168,20
EX 27
QK 20,28,172,20
RV 110,65,4352
RV 112,64,512
PV 128,64,32
EX 28
PV 132,68,32
RV 114,64,4608
CV 37,26,27
PV 136,72,32
EX 29
PV 140,76,32
RV 116,65,512
CV 38,28,29
PV 144,80,32
buffer_load_dwordx4 v69, s[20:23], s40 offen offset:1024 lds
PV 148,84,32
EX 30
PV 152,88,32
RV 118,65,4608
RV 120,64,768
PV 156,92,32
s_waitcnt lgkmcnt(13)
EX 31
QK 24,32,128,40
RV 122,64,4864
CV 39,30,31
QK 24,36,132,24
EX 16
QK 24,40,136,24
EX 17
QK 24,44,140,24
RV 124,65,768
RV 126,65,4864
QK 28,48,128,40
EX 18
QK 28,52,132,28
EX 19
QK 28,56,136,28
EX 20
QK 28,60,140,28
EX 21
PV 160,64,36
EX 22
PV 164,68,36
EX 23
PV 168,72,36
CV 32,16,17
CV 33,18,19
PV 172,76,36
CV 34,20,21
CV 35,22,23
PV 176,80,36
EX 24
PV 180,84,36
s_waitcnt lgkmcnt(0)
EX 25
PV 184,88,36
s_add_u32 s40, s40, s58
EX 26
PV 188,92,36
s_add_u32 m0, s42, 0x2000
EX 27
v_smfmac_f32_16x16x64_bf16 a[244:247], v[56:59], v[32:39], v71
s_mov_b32 s58, s59
s_mov_b32 s59, 0x20000
RK 0,60,8192
QK 16,32,144,44
RK 4,61,8192
CV 36,24,25
QK 16,36,148,16
RK 8,62,8192
CV 37,26,27
QK 16,40,152,16
buffer_load_dwordx4 v66, s[16:19], s40 offen lds
QK 16,44,156,16
EX 28
QK 20,48,144,44
RK 12,63,8192
RK 16,60,12288
QK 20,52,148,20
EX 29
QK 20,56,152,20
RK 20,61,12288
CV 38,28,29
QK 20,60,156,20
RK 24,62,12288
v_xor_b32 v60, s43, v60
PV 192,64,32
EX 30
PV 196,68,32
RK 28,63,12288
v_xor_b32 v61, s43, v61
PV 200,72,32
EX 31
PV 204,76,32
buffer_load_dwordx4 v67, s[16:19], s40 offen offset:1024 lds
PV 208,80,32
RV 64,64,8192
RV 66,64,12288
PV 212,84,32
CV 39,30,31
v_xor_b32 v62, s43, v62
PV 216,88,32
RV 68,65,8192
v_xor_b32 v63, s43, v63
PV 220,92,32
EX 16
QK 24,32,160,48
s_add_u32 m0, s42, 0x12000
EX 17
QK 24,36,164,24
RV 70,65,12288
RV 72,64,8448
QK 24,40,168,24
EX 18
QK 24,44,172,24
RV 74,64,12544
CV 32,16,17
QK 28,48,160,48
buffer_load_dwordx4 v68, s[20:23], s40 offen lds
QK 28,52,164,28
EX 19
QK 28,56,168,28
RV 76,65,8448
RV 78,65,12544
QK 28,60,172,28
EX 20
PV 128,96,36
RV 80,64,8704
CV 33,18,19
PV 132,100,36
EX 21
PV 136,104,36
RV 82,64,12800
CV 34,20,21
PV 140,108,36
EX 22
PV 144,112,36
EX 23
PV 148,116,36
buffer_load_dwordx4 v69, s[20:23], s40 offen offset:1024 lds
PV 152,120,36
RV 84,65,8704
CV 35,22,23
PV 156,124,36
RV 86,65,12800
RV 88,64,8960
v_smfmac_f32_16x16x64_bf16 a[248:251], v[56:59], v[32:39], v71
s_waitcnt lgkmcnt(13)
RV 90,64,13056
QK 16,0,128,40
RV 92,65,8960
v_xor_b32 v64, s43, v64
QK 16,4,132,16
EX 24
QK 16,8,136,16
EX 25
QK 16,12,140,16
RV 94,65,13056
CV 36,24,25
QK 20,16,128,40
EX 26
QK 20,20,132,20
EX 27
QK 20,24,136,20
CV 37,26,27
v_xor_b32 v65, s43, v65
QK 20,28,140,20
EX 28
PV 160,96,32
EX 29
PV 164,100,32
EX 30
PV 168,104,32
EX 31
PV 172,108,32
CV 38,28,29
CV 39,30,31
PV 176,112,32
s_waitcnt vmcnt(8) lgkmcnt(0)
s_barrier
PV 180,116,32
s_sub_u32 s56, s56, 1
s_cbranch_scc0 L_t0_loop0
PV 184,120,32
s_xor_b32 s41, s41, s43
EX 16
PV 188,124,32
s_xor_b32 s42, s41, 0xc000
RK 32,60,0
RK 36,61,0
QK 24,0,144,44
s_sub_u32 s57, s57, 1
s_cselect_b64 s[58:59], s[60:61], s[58:59]
QK 24,4,148,24
s_add_u32 s40, s40, s58
RK 40,62,0
s_add_u32 m0, s42, 0x0
QK 24,8,152,24
buffer_load_dwordx4 v66, s[16:19], s40 offen lds
QK 24,12,156,24
s_add_u32 s48, s45, 0x0
EX 17
QK 28,16,144,44
s_mov_b32 s58, s59
RK 44,63,0
RK 48,60,4096
QK 28,20,148,28
s_mov_b32 s59, 0x20000
EX 18
QK 28,24,152,28
buffer_load_dwordx4 v[80:83], v72, s[32:35], s48 offen nt
QK 28,28,156,28
s_xor_b32 s43, s43, 0xc000
RK 52,61,4096
CV 32,16,17
PV 192,96,36
EX 19
PV 196,100,36
RK 56,62,4096
RK 60,63,4096
PV 200,104,36
EX 20
PV 204,108,36
buffer_load_dwordx4 v67, s[16:19], s40 offen offset:1024 lds
PV 208,112,36
RV 96,64,0
CV 33,18,19
PV 212,116,36
EX 21
PV 216,120,36
EX 22
PV 220,124,36
RV 98,64,4096
RV 100,65,0
EX 23
CV 34,20,21
CV 35,22,23
EX 24
s_nop 0
v_smfmac_f32_16x16x64_bf16 a[240:243], v[56:59], v[32:39], v71
s_sub_u32 s57, s57, 1
s_cselect_b64 s[58:59], s[60:61], s[58:59]
RV 102,65,4096
QK 16,0,160,48
s_add_u32 m0, s42, 0x10000
EX 25
QK 16,4,164,16
RV 104,64,256
CV 36,24,25
QK 16,8,168,16
EX 26
QK 16,12,172,16
buffer_load_dwordx4 v68, s[20:23], s40 offen lds
QK 20,16,160,48
RV 106,64,4352
RV 108,65,256
QK 20,20,164,20
EX 27
QK 20,24,168,20
RV 110,65,4352
CV 37,26,27
QK 20,28,172,20
EX 28
PV 128,64,32
EX 29
PV 132,68,32
RV 112,64,512
RV 114,64,4608
PV 136,72,32
EX 30
PV 140,76,32
RV 116,65,512
CV 38,28,29
PV 144,80,32
buffer_load_dwordx4 v69, s[20:23], s40 offen offset:1024 lds
PV 148,84,32
EX 31
PV 152,88,32
RV 118,65,4608
RV 120,64,768
PV 156,92,32
s_waitcnt lgkmcnt(13)
EX 16
QK 24,32,128,40
RV 122,64,4864
CV 39,30,31
QK 24,36,132,24
buffer_load_dwordx4 v[84:87], v73, s[32:35], s48 offen nt
QK 24,40,136,24
EX 17
QK 24,44,140,24
RV 124,65,768
RV 126,65,4864
QK 28,48,128,40
EX 18
QK 28,52,132,28
EX 19
QK 28,56,136,28
EX 20
QK 28,60,140,28
EX 21
PV 160,64,36
EX 22
PV 164,68,36
EX 23
PV 168,72,36
CV 32,16,17
CV 33,18,19
PV 172,76,36
CV 34,20,21
CV 35,22,23
PV 176,80,36
EX 24
PV 180,84,36
s_waitcnt lgkmcnt(0)
EX 25
PV 184,88,36
s_add_u32 s40, s40, s58
EX 26
PV 188,92,36
s_add_u32 m0, s42, 0x2000
EX 27
v_smfmac_f32_16x16x64_bf16 a[244:247], v[56:59], v[32:39], v71
L_t0_pad3:
s_cbranch_execz L_t0_pad7
s_mov_b32 s58, s59
s_mov_b32 s59, 0x20000
RK 0,60,8192
QK 16,32,144,44
RK 4,61,8192
CV 36,24,25
QK 16,36,148,16
RK 8,62,8192
CV 37,26,27
QK 16,40,152,16
buffer_load_dwordx4 v66, s[16:19], s40 offen lds
QK 16,44,156,16
EX 28
QK 20,48,144,44
RK 12,63,8192
RK 16,60,12288
QK 20,52,148,20
EX 29
QK 20,56,152,20
RK 20,61,12288
CV 38,28,29
QK 20,60,156,20
RK 24,62,12288
v_xor_b32 v60, s43, v60
PV 192,64,32
EX 30
PV 196,68,32
RK 28,63,12288
v_xor_b32 v61, s43, v61
PV 200,72,32
EX 31
PV 204,76,32
buffer_load_dwordx4 v67, s[16:19], s40 offen offset:1024 lds
PV 208,80,32
RV 64,64,8192
RV 66,64,12288
PV 212,84,32
CV 39,30,31
v_xor_b32 v62, s43, v62
PV 216,88,32
RV 68,65,8192
v_xor_b32 v63, s43, v63
PV 220,92,32
buffer_load_dwordx4 v[88:91], v74, s[32:35], s48 offen nt
QK 24,32,160,48
s_add_u32 m0, s42, 0x12000
EX 16
QK 24,36,164,24
RV 70,65,12288
RV 72,64,8448
QK 24,40,168,24
EX 17
QK 24,44,172,24
RV 74,64,12544
CV 32,16,17
QK 28,48,160,48
buffer_load_dwordx4 v68, s[20:23], s40 offen lds
QK 28,52,164,28
EX 18
QK 28,56,168,28
RV 76,65,8448
RV 78,65,12544
QK 28,60,172,28
EX 19
PV 128,96,36
RV 80,64,8704
CV 33,18,19
PV 132,100,36
EX 20
PV 136,104,36
EX 21
PV 140,108,36
RV 82,64,12800
RV 84,65,8704
PV 144,112,36
EX 22
PV 148,116,36
buffer_load_dwordx4 v69, s[20:23], s40 offen offset:1024 lds
PV 152,120,36
EX 23
PV 156,124,36
RV 86,65,12800
CV 34,20,21
CV 35,22,23
EX 24
s_nop 0
v_smfmac_f32_16x16x64_bf16 a[248:251], v[56:59], v[32:39], v71
s_waitcnt lgkmcnt(12)
RV 88,64,8960
QK 16,0,128,40
RV 90,64,13056
RV 92,65,8960
QK 16,4,132,16
EX 25
QK 16,8,136,16
RV 94,65,13056
CV 36,24,25
QK 16,12,140,16
EX 26
QK 20,16,128,40
EX 27
QK 20,20,132,20
CV 37,26,27
v_xor_b32 v64, s43, v64
QK 20,24,136,20
EX 28
QK 20,28,140,20
EX 29
PV 160,96,32
EX 30
PV 164,100,32
EX 31
PV 168,104,32
CV 38,28,29
CV 39,30,31
PV 172,108,32
EX 16
PV 176,112,32
s_waitcnt vmcnt(11) lgkmcnt(0)
s_barrier
PV 180,116,32
buffer_load_dwordx4 v[92:95], v75, s[32:35], s48 offen nt
PV 184,120,32
s_xor_b32 s41, s41, s43
RK 32,60,0
v_xor_b32 v65, s43, v65
PV 188,124,32
s_xor_b32 s42, s41, 0xc000
EX 17
QK 24,0,144,44
s_sub_u32 s57, s57, 1
s_cselect_b64 s[58:59], s[60:61], s[58:59]
RK 36,61,0
QK 24,4,148,24
s_add_u32 s40, s40, s58
RK 40,62,0
s_add_u32 m0, s42, 0x0
QK 24,8,152,24
buffer_load_dwordx4 v66, s[16:19], s40 offen lds
QK 24,12,156,24
s_mov_b32 s58, s59
RK 44,63,0
CV 32,16,17
QK 28,16,144,44
s_mov_b32 s59, 0x20000
EX 18
QK 28,20,148,28
s_xor_b32 s43, s43, 0xc000
EX 19
QK 28,24,152,28
RK 48,60,4096
RK 52,61,4096
QK 28,28,156,28
EX 20
PV 192,96,36
RK 56,62,4096
CV 33,18,19
PV 196,100,36
EX 21
PV 200,104,36
RK 60,63,4096
CV 34,20,21
PV 204,108,36
buffer_load_dwordx4 v67, s[16:19], s40 offen offset:1024 lds
PV 208,112,36
EX 22
PV 212,116,36
RV 96,64,0
RV 98,64,4096
PV 216,120,36
EX 23
PV 220,124,36
RV 100,65,0
CV 35,22,23
EX 24
s_nop 0
v_smfmac_f32_16x16x64_bf16 a[240:243], v[56:59], v[32:39], v71
s_sub_u32 s57, s57, 1
s_cselect_b64 s[58:59], s[60:61], s[58:59]
RV 102,65,4096
QK 16,0,160,48
s_add_u32 m0, s42, 0x10000
EX 25
QK 16,4,164,16
RV 104,64,256
CV 36,24,25
QK 16,8,168,16
EX 26
QK 16,12,172,16
buffer_load_dwordx4 v68, s[20:23], s40 offen lds
QK 20,16,160,48
RV 106,64,4352
RV 108,65,256
QK 20,20,164,20
EX 27
QK 20,24,168,20
RV 110,65,4352
CV 37,26,27
QK 20,28,172,20
EX 28
PV 128,64,32
EX 29
PV 132,68,32
RV 112,64,512
RV 114,64,4608
PV 136,72,32
s_add_u32 s49, s45, 0x10000
EX 30
PV 140,76,32
RV 116,65,512
CV 38,28,29
PV 144,80,32
buffer_load_dwordx4 v[96:99], v72, s[32:35], s49 offen nt
PV 148,84,32
EX 31
PV 152,88,32
RV 118,65,4608
RV 120,64,768
PV 156,92,32
s_waitcnt lgkmcnt(13)
EX 16
QK 24,32,128,40
buffer_load_dwordx4 v69, s[20:23], s40 offen offset:1024 lds
QK 24,36,132,24
RV 122,64,4864
RV 124,65,768
QK 24,40,136,24
CV 39,30,31
QK 24,44,140,24
EX 17
QK 28,48,128,40
RV 126,65,4864
CV 32,16,17
QK 28,52,132,28
EX 18
QK 28,56,136,28
EX 19
QK 28,60,140,28
EX 20
PV 160,64,36
EX 21
PV 164,68,36
EX 22
PV 168,72,36
EX 23
PV 172,76,36
CV 33,18,19
CV 34,20,21
PV 176,80,36
EX 24
PV 180,84,36
s_waitcnt lgkmcnt(0)
EX 25
PV 184,88,36
s_add_u32 s40, s40, s58
CV 35,22,23
PV 188,92,36
s_add_u32 m0, s42, 0x2000
EX 26
v_smfmac_f32_16x16x64_bf16 a[244:247], v[56:59], v[32:39], v71
s_mov_b32 s58, s59
s_mov_b32 s59, 0x20000
RK 0,60,8192
QK 16,32,144,44
RK 4,61,8192
CV 36,24,25
QK 16,36,148,16
EX 27
QK 16,40,152,16
buffer_load_dwordx4 v66, s[16:19], s40 offen lds
QK 16,44,156,16
RK 8,62,8192
RK 12,63,8192
QK 20,48,144,44
RK 16,60,12288
CV 37,26,27
QK 20,52,148,20
EX 28
QK 20,56,152,20
RK 20,61,12288
v_xor_b32 v60, s43, v60
QK 20,60,156,20
RK 24,62,12288
v_xor_b32 v61, s43, v61
PV 192,64,32
EX 29
PV 196,68,32
RK 28,63,12288
CV 38,28,29
PV 200,72,32
buffer_load_dwordx4 v[100:103], v73, s[32:35], s49 offen nt
PV 204,76,32
RV 64,64,8192
v_xor_b32 v62, s43, v62
PV 208,80,32
RV 66,64,12288
v_xor_b32 v63, s43, v63
PV 212,84,32
EX 30
PV 216,88,32
buffer_load_dwordx4 v67, s[16:19], s40 offen offset:1024 lds
PV 220,92,32
RV 68,65,8192
RV 70,65,12288
QK 24,32,160,48
s_add_u32 m0, s42, 0x12000
EX 31
QK 24,36,164,24
RV 72,64,8448
CV 39,30,31
QK 24,40,168,24
EX 16
QK 24,44,172,24
EX 17
QK 28,48,160,48
buffer_load_dwordx4 v68, s[20:23], s40 offen lds
QK 28,52,164,28
RV 74,64,12544
RV 76,65,8448
QK 28,56,168,28
RV 78,65,12544
CV 32,16,17
QK 28,60,172,28
EX 18
PV 128,96,36
EX 19
PV 132,100,36
RV 80,64,8704
RV 82,64,12800
PV 136,104,36
EX 20
PV 140,108,36
RV 84,65,8704
CV 33,18,19
PV 144,112,36
EX 21
PV 148,116,36
buffer_load_dwordx4 v69, s[20:23], s40 offen offset:1024 lds
PV 152,120,36
EX 22
PV 156,124,36
RV 86,65,12800
RV 88,64,8960
EX 23
CV 34,20,21
CV 35,22,23
EX 24
s_nop 0
v_smfmac_f32_16x16x64_bf16 a[248:251], v[56:59], v[32:39], v71
s_waitcnt lgkmcnt(13)
RV 90,64,13056
QK 16,0,128,40
RV 92,65,8960
v_xor_b32 v64, s43, v64
QK 16,4,132,16
EX 25
QK 16,8,136,16
RV 94,65,13056
CV 36,24,25
QK 16,12,140,16
EX 26
QK 20,16,128,40
EX 27
QK 20,20,132,20
CV 37,26,27
v_xor_b32 v65, s43, v65
QK 20,24,136,20
EX 28
QK 20,28,140,20
EX 29
PV 160,96,32
buffer_load_dwordx4 v[104:107], v74, s[32:35], s49 offen nt
PV 164,100,32
EX 30
PV 168,104,32
EX 31
PV 172,108,32
CV 38,28,29
CV 39,30,31
PV 176,112,32
s_waitcnt vmcnt(12) lgkmcnt(0)
s_barrier
PV 180,116,32
EX 16
PV 184,120,32
s_xor_b32 s41, s41, s43
EX 17
PV 188,124,32
s_xor_b32 s42, s41, 0xc000
RK 32,60,0
RK 36,61,0
QK 24,0,144,44
s_sub_u32 s57, s57, 1
s_cselect_b64 s[58:59], s[60:61], s[58:59]
CV 32,16,17
QK 24,4,148,24
s_add_u32 s40, s40, s58
RK 40,62,0
s_add_u32 m0, s42, 0x0
QK 24,8,152,24
buffer_load_dwordx4 v66, s[16:19], s40 offen lds
QK 24,12,156,24
s_mov_b32 s58, s59
EX 18
QK 28,16,144,44
s_mov_b32 s59, 0x20000
RK 44,63,0
RK 48,60,4096
QK 28,20,148,28
s_xor_b32 s43, s43, 0xc000
EX 19
QK 28,24,152,28
RK 52,61,4096
CV 33,18,19
QK 28,28,156,28
EX 20
PV 192,96,36
EX 21
PV 196,100,36
RK 56,62,4096
RK 60,63,4096
PV 200,104,36
EX 22
PV 204,108,36
buffer_load_dwordx4 v67, s[16:19], s40 offen offset:1024 lds
PV 208,112,36
RV 96,64,0
CV 34,20,21
PV 212,116,36
EX 23
PV 216,120,36
RV 98,64,4096
CV 35,22,23
PV 220,124,36
EX 24
v_smfmac_f32_16x16x64_bf16 a[240:243], v[56:59], v[32:39], v71
s_sub_u32 s57, s57, 1
s_cselect_b64 s[58:59], s[60:61], s[58:59]
RV 100,65,0
QK 16,0,160,48
s_add_u32 m0, s42, 0x10000
EX 25
QK 16,4,164,16
RV 102,65,4096
RV 104,64,256
QK 16,8,168,16
RV 106,64,4352
CV 36,24,25
QK 16,12,172,16
buffer_load_dwordx4 v68, s[20:23], s40 offen lds
QK 20,16,160,48
EX 26
QK 20,20,164,20
EX 27
QK 20,24,168,20
RV 108,65,256
RV 110,65,4352
QK 20,28,172,20
buffer_load_dwordx4 v[108:111], v75, s[32:35], s49 offen nt
PV 128,64,32
RV 112,64,512
CV 37,26,27
PV 132,68,32
EX 28
PV 136,72,32
EX 29
PV 140,76,32
RV 114,64,4608
RV 116,65,512
PV 144,80,32
buffer_load_dwordx4 v69, s[20:23], s40 offen offset:1024 lds
PV 148,84,32
RV 118,65,4608
CV 38,28,29
PV 152,88,32
EX 30
PV 156,92,32
s_waitcnt lgkmcnt(12)
EX 31
QK 24,32,128,40
RV 120,64,768
RV 122,64,4864
QK 24,36,132,24
RV 124,65,768
CV 39,30,31
QK 24,40,136,24
EX 16
QK 24,44,140,24
EX 17
QK 28,48,128,40
RV 126,65,4864
CV 32,16,17
QK 28,52,132,28
EX 18
QK 28,56,136,28
EX 19
QK 28,60,140,28
EX 20
PV 160,64,36
EX 21
PV 164,68,36
EX 22
PV 168,72,36
EX 23
PV 172,76,36
CV 33,18,19
CV 34,20,21
PV 176,80,36
EX 24
PV 180,84,36
s_waitcnt lgkmcnt(0)
EX 25
PV 184,88,36
s_add_u32 s40, s40, s58
CV 35,22,23
PV 188,92,36
s_add_u32 m0, s42, 0x2000
EX 26
v_smfmac_f32_16x16x64_bf16 a[244:247], v[56:59], v[32:39], v71
s_mov_b32 s58, s59
s_mov_b32 s59, 0x20000
RK 0,60,8192
QK 16,32,144,44
RK 4,61,8192
CV 36,24,25
QK 16,36,148,16
EX 27
QK 16,40,152,16
buffer_load_dwordx4 v66, s[16:19], s40 offen lds
QK 16,44,156,16
s_add_u32 s50, s45, 0x20000
RK 8,62,8192
RK 12,63,8192
QK 20,48,144,44
RK 16,60,12288
CV 37,26,27
QK 20,52,148,20
buffer_load_dwordx4 v[112:115], v72, s[32:35], s50 offen nt
QK 20,56,152,20
RK 20,61,12288
v_xor_b32 v60, s43, v60
QK 20,60,156,20
RK 24,62,12288
v_xor_b32 v61, s43, v61
PV 192,64,32
EX 28
PV 196,68,32
RK 28,63,12288
v_xor_b32 v62, s43, v62
PV 200,72,32
EX 29
PV 204,76,32
buffer_load_dwordx4 v67, s[16:19], s40 offen offset:1024 lds
PV 208,80,32
RV 64,64,8192
RV 66,64,12288
PV 212,84,32
EX 30
PV 216,88,32
RV 68,65,8192
CV 38,28,29
PV 220,92,32
RV 70,65,12288
v_xor_b32 v63, s43, v63
QK 24,32,160,48
s_add_u32 m0, s42, 0x12000
EX 31
QK 24,36,164,24
RV 72,64,8448
CV 39,30,31
QK 24,40,168,24
EX 16
QK 24,44,172,24
EX 17
QK 28,48,160,48
buffer_load_dwordx4 v68, s[20:23], s40 offen lds
QK 28,52,164,28
RV 74,64,12544
RV 76,65,8448
QK 28,56,168,28
RV 78,65,12544
CV 32,16,17
QK 28,60,172,28
L_t0_pad4:
s_cbranch_execz L_t0_go
EX 18
PV 128,96,36
EX 19
PV 132,100,36
RV 80,64,8704
RV 82,64,12800
PV 136,104,36
EX 20
PV 140,108,36
RV 84,65,8704
CV 33,18,19
PV 144,112,36
EX 21
PV 148,116,36
buffer_load_dwordx4 v69, s[20:23], s40 offen offset:1024 lds
PV 152,120,36
EX 22
PV 156,124,36
RV 86,65,12800
RV 88,64,8960
EX 23
CV 34,20,21
CV 35,22,23
EX 24
s_nop 0
v_smfmac_f32_16x16x64_bf16 a[248:251], v[56:59], v[32:39], v71
s_waitcnt lgkmcnt(13)
RV 90,64,13056
QK 16,0,128,40
RV 92,65,8960
v_xor_b32 v64, s43, v64
QK 16,4,132,16
EX 25
QK 16,8,136,16
RV 94,65,13056
CV 36,24,25
QK 16,12,140,16
buffer_load_dwordx4 v[116:119], v73, s[32:35], s50 offen nt
QK 20,16,128,40
EX 26
QK 20,20,132,20
EX 27
QK 20,24,136,20
CV 37,26,27
v_xor_b32 v65, s43, v65
QK 20,28,140,20
EX 28
PV 160,96,32
EX 29
PV 164,100,32
EX 30
PV 168,104,32
EX 31
PV 172,108,32
CV 38,28,29
CV 39,30,31
PV 176,112,32
s_waitcnt vmcnt(12) lgkmcnt(0)
s_barrier
PV 180,116,32
EX 16
PV 184,120,32
s_xor_b32 s41, s41, s43
EX 17
PV 188,124,32
s_xor_b32 s42, s41, 0xc000
RK 32,60,0
RK 36,61,0
QK 24,0,144,44
s_sub_u32 s57, s57, 1
s_cselect_b64 s[58:59], s[60:61], s[58:59]
CV 32,16,17
QK 24,4,148,24
s_add_u32 s40, s40, s58
RK 40,62,0
s_add_u32 m0, s42, 0x0
QK 24,8,152,24
buffer_load_dwordx4 v66, s[16:19], s40 offen lds
QK 24,12,156,24
s_mov_b32 s58, s59
EX 18
QK 28,16,144,44
s_mov_b32 s59, 0x20000
RK 44,63,0
RK 48,60,4096
QK 28,20,148,28
s_xor_b32 s43, s43, 0xc000
EX 19
QK 28,24,152,28
RK 52,61,4096
CV 33,18,19
QK 28,28,156,28
EX 20
PV 192,96,36
EX 21
PV 196,100,36
RK 56,62,4096
RK 60,63,4096
PV 200,104,36
EX 22
PV 204,108,36
buffer_load_dwordx4 v67, s[16:19], s40 offen offset:1024 lds
PV 208,112,36
RV 96,64,0
CV 34,20,21
PV 212,116,36
EX 23
PV 216,120,36
RV 98,64,4096
CV 35,22,23
PV 220,124,36
EX 24
v_smfmac_f32_16x16x64_bf16 a[240:243], v[56:59], v[32:39], v71
s_sub_u32 s57, s57, 1
s_cselect_b64 s[58:59], s[60:61], s[58:59]
RV 100,65,0
QK 16,0,160,48
s_add_u32 m0, s42, 0x10000
EX 25
QK 16,4,164,16
buffer_load_dwordx4 v[120:123], v74, s[32:35], s50 offen nt
QK 16,8,168,16
RV 102,65,4096
RV 104,64,256
QK 16,12,172,16
RV 106,64,4352
CV 36,24,25
QK 20,16,160,48
EX 26
QK 20,20,164,20
buffer_load_dwordx4 v68, s[20:23], s40 offen lds
QK 20,24,168,20
RV 108,65,256
RV 110,65,4352
QK 20,28,172,20
EX 27
PV 128,64,32
RV 112,64,512
CV 37,26,27
PV 132,68,32
EX 28
PV 136,72,32
EX 29
PV 140,76,32
RV 114,64,4608
RV 116,65,512
PV 144,80,32
buffer_load_dwordx4 v69, s[20:23], s40 offen offset:1024 lds
PV 148,84,32
RV 118,65,4608
CV 38,28,29
PV 152,88,32
EX 30
PV 156,92,32
s_waitcnt lgkmcnt(12)
EX 31
QK 24,32,128,40
RV 120,64,768
RV 122,64,4864
QK 24,36,132,24
RV 124,65,768
CV 39,30,31
QK 24,40,136,24
EX 16
QK 24,44,140,24
EX 17
QK 28,48,128,40
RV 126,65,4864
CV 32,16,17
QK 28,52,132,28
EX 18
QK 28,56,136,28
EX 19
QK 28,60,140,28
EX 20
PV 160,64,36
EX 21
PV 164,68,36
EX 22
PV 168,72,36
EX 23
PV 172,76,36
CV 33,18,19
CV 34,20,21
PV 176,80,36
EX 24
PV 180,84,36
s_waitcnt lgkmcnt(0)
EX 25
PV 184,88,36
s_add_u32 s40, s40, s58
CV 35,22,23
PV 188,92,36
s_add_u32 m0, s42, 0x2000
EX 26
v_smfmac_f32_16x16x64_bf16 a[244:247], v[56:59], v[32:39], v71
s_mov_b32 s58, s59
s_mov_b32 s59, 0x20000
RK 0,60,8192
QK 16,32,144,44
buffer_load_dwordx4 v[124:127], v75, s[32:35], s50 offen nt
QK 16,36,148,16
RK 4,61,8192
RK 8,62,8192
QK 16,40,152,16
RK 12,63,8192
CV 36,24,25
QK 16,44,156,16
EX 27
QK 20,48,144,44
buffer_load_dwordx4 v66, s[16:19], s40 offen lds
QK 20,52,148,20
RK 16,60,12288
CV 37,26,27
QK 20,56,152,20
RK 20,61,12288
v_xor_b32 v60, s43, v60
QK 20,60,156,20
RK 24,62,12288
v_xor_b32 v61, s43, v61
PV 192,64,32
EX 28
PV 196,68,32
RK 28,63,12288
v_xor_b32 v62, s43, v62
PV 200,72,32
EX 29
PV 204,76,32
buffer_load_dwordx4 v67, s[16:19], s40 offen offset:1024 lds
PV 208,80,32
RV 64,64,8192
RV 66,64,12288
PV 212,84,32
EX 30
PV 216,88,32
RV 68,65,8192
CV 38,28,29
PV 220,92,32
RV 70,65,12288
v_xor_b32 v63, s43, v63
QK 24,32,160,48
s_add_u32 m0, s42, 0x12000
EX 31
QK 24,36,164,24
RV 72,64,8448
CV 39,30,31
QK 24,40,168,24
EX 16
QK 24,44,172,24
EX 17
QK 28,48,160,48
buffer_load_dwordx4 v68, s[20:23], s40 offen lds
QK 28,52,164,28
RV 74,64,12544
RV 76,65,8448
QK 28,56,168,28
RV 78,65,12544
CV 32,16,17
QK 28,60,172,28
EX 18
PV 128,96,36
EX 19
PV 132,100,36
RV 80,64,8704
RV 82,64,12800
PV 136,104,36
EX 20
PV 140,108,36
RV 84,65,8704
CV 33,18,19
PV 144,112,36
EX 21
PV 148,116,36
buffer_load_dwordx4 v69, s[20:23], s40 offen offset:1024 lds
PV 152,120,36
EX 22
PV 156,124,36
RV 86,65,12800
RV 88,64,8960
EX 23
CV 34,20,21
CV 35,22,23
EX 24
s_nop 0
v_smfmac_f32_16x16x64_bf16 a[248:251], v[56:59], v[32:39], v71
s_waitcnt lgkmcnt(13)
RV 90,64,13056
QK 16,0,128,40
RV 92,65,8960
v_xor_b32 v64, s43, v64
QK 16,4,132,16
EX 25
QK 16,8,136,16
RV 94,65,13056
CV 36,24,25
QK 16,12,140,16
EX 26
QK 20,16,128,40
v_accvgpr_read_b32 v76, a250
v_accvgpr_read_b32 v77, a248
QK 20,20,132,20
v_accvgpr_read_b32 v40, a251
v_xor_b32 v65, s43, v65
QK 20,24,136,20
EX 27
QK 20,28,140,20
v_add_f32 v76, v76, v40
CV 37,26,27
PV 160,96,32
EX 28
PV 164,100,32
EX 29
PV 168,104,32
EX 30
PV 172,108,32
EX 31
PV 176,112,32
s_waitcnt vmcnt(11) lgkmcnt(0)
s_barrier
PV 180,116,32
CV 38,28,29
CV 39,30,31
PV 184,120,32
s_xor_b32 s41, s41, s43
RK 32,60,0
RK 36,61,0
PV 188,124,32
s_xor_b32 s42, s41, 0xc000
EX 16
QK 24,0,144,44
s_add_u32 m0, s42, 0x0
RK 40,62,0
RK 44,63,0
v_lshlrev_b32 v0, 16, v80
v_and_b32 v1, s71, v80
v_lshlrev_b32 v2, 16, v81
v_and_b32 v3, s71, v81
v_pk_mul_f32 v[0:1], v[0:1], s[14:15]
v_pk_mul_f32 v[2:3], v[2:3], s[14:15]
QK 24,4,148,24
s_xor_b32 s43, s43, 0xc000
RK 48,60,4096
RK 52,61,4096
v_lshlrev_b32 v4, 16, v82
v_and_b32 v5, s71, v82
v_lshlrev_b32 v6, 16, v83
v_and_b32_e64 v7, s71, v83
v_pk_mul_f32 v[4:5], v[4:5], s[14:15]
v_pk_mul_f32 v[6:7], v[6:7], s[14:15]
CV 80,0,1
CV 81,2,3
QK 24,8,152,24
RK 56,62,4096
RK 60,63,4096
CV 82,4,5
CV 83,6,7
v_lshlrev_b32 v0, 16, v84
v_and_b32 v1, s71, v84
v_lshlrev_b32 v2, 16, v85
v_and_b32 v3, s71, v85
v_pk_mul_f32 v[0:1], v[0:1], s[14:15]
v_pk_mul_f32 v[2:3], v[2:3], s[14:15]
QK 24,12,156,24
ds_write_b128 v15, v[80:83] offset:0
v_lshlrev_b32 v4, 16, v86
v_and_b32 v5, s71, v86
v_lshlrev_b32 v6, 16, v87
v_and_b32 v7, s71, v87
v_pk_mul_f32 v[4:5], v[4:5], s[14:15]
v_pk_mul_f32 v[6:7], v[6:7], s[14:15]
CV 84,0,1
CV 85,2,3
QK 28,16,144,44
CV 86,4,5
CV 87,6,7
v_lshlrev_b32 v0, 16, v88
v_accvgpr_read_b32 v44, a249
v_and_b32 v1, s71, v88
v_add_f32 v77, v77, v44
v_lshlrev_b32 v2, 16, v89
v_and_b32 v3, s71, v89
v_pk_mul_f32 v[0:1], v[0:1], s[14:15]
v_pk_mul_f32 v[2:3], v[2:3], s[14:15]
QK 28,20,148,28
ds_write_b128 v15, v[84:87] offset:544
v_lshlrev_b32 v4, 16, v90
v_and_b32 v5, s71, v90
v_lshlrev_b32 v6, 16, v91
v_and_b32_e64 v7, s71, v91
v_pk_mul_f32 v[4:5], v[4:5], s[14:15]
v_pk_mul_f32 v[6:7], v[6:7], s[14:15]
CV 88,0,1
CV 89,2,3
QK 28,24,152,28
CV 90,4,5
CV 91,6,7
v_lshlrev_b32 v0, 16, v92
v_and_b32 v1, s71, v92
v_lshlrev_b32 v2, 16, v93
v_and_b32 v3, s71, v93
v_pk_mul_f32 v[0:1], v[0:1], s[14:15]
v_pk_mul_f32 v[2:3], v[2:3], s[14:15]
QK 28,28,156,28
ds_write_b128 v15, v[88:91] offset:1152
v_lshlrev_b32 v4, 16, v94
v_and_b32 v5, s71, v94
v_lshlrev_b32 v6, 16, v95
v_and_b32 v7, s71, v95
v_pk_mul_f32 v[4:5], v[4:5], s[14:15]
v_pk_mul_f32 v[6:7], v[6:7], s[14:15]
CV 92,0,1
CV 93,2,3
PV 192,96,36
s_sub_u32 s57, s57, 1
s_cselect_b64 s[58:59], s[60:61], s[58:59]
CV 94,4,5
CV 95,6,7
PV 196,100,36
s_add_u32 s40, s40, s58
ds_write_b128 v15, v[92:95] offset:1696
PV 200,104,36
s_mov_b32 s58, s59
RK 176,14,0
RK 180,14,64
PV 204,108,36
s_mov_b32 s59, 0x20000
RK 184,14,128
PV 208,112,36
RK 188,14,192
PV 212,116,36
buffer_load_dwordx4 v66, s[16:19], s40 offen lds
PV 216,120,36
RV 96,64,0
RV 98,64,4096
PV 220,124,36
RV 100,65,0
EX 17
EX 18
EX 19
EX 20
EX 21
EX 22
v_exp_f32_e64 v23, v23
CV 32,16,17
CV 33,18,19
CV 34,20,21
CV 35,22,23
EX 24
s_nop 0
v_smfmac_f32_16x16x64_bf16 a[240:243], v[56:59], v[32:39], v71
RV 102,65,4096
QK 16,0,160,48
buffer_load_dwordx4 v67, s[16:19], s40 offen offset:1024 lds
RV 104,64,256
RV 106,64,4352
v_lshlrev_b32 v0, 16, v96
v_and_b32 v1, s71, v96
v_lshlrev_b32 v2, 16, v97
v_and_b32 v3, s71, v97
v_pk_mul_f32 v[0:1], v[0:1], s[14:15]
v_pk_mul_f32 v[2:3], v[2:3], s[14:15]
QK 16,4,164,16
s_add_u32 m0, s42, 0x10000
RV 108,65,256
RV 110,65,4352
v_accvgpr_read_b32 v41, a240
v_accvgpr_read_b32 v42, a241
v_add_f32 v76, v76, v41
v_accvgpr_read_b32 v78, a242
v_add_f32 v76, v76, v42
v_lshlrev_b32 v4, 16, v98
v_cmp_nge_f32 s[4:5], s55, v76
v_rcp_f32 v76, v76
v_and_b32 v5, s71, v98
v_lshlrev_b32 v6, 16, v99
v_and_b32_e64 v7, s71, v99
v_pk_mul_f32 v[4:5], v[4:5], s[14:15]
v_pk_mul_f32 v[6:7], v[6:7], s[14:15]
CV 96,0,1
CV 97,2,3
QK 16,8,168,16
RV 112,64,512
RV 114,64,4608
CV 98,4,5
CV 99,6,7
v_lshlrev_b32 v0, 16, v100
v_and_b32 v1, s71, v100
v_lshlrev_b32 v2, 16, v101
v_and_b32 v3, s71, v101
v_pk_mul_f32 v[0:1], v[0:1], s[14:15]
v_pk_mul_f32 v[2:3], v[2:3], s[14:15]
QK 16,12,172,16
buffer_load_dwordx4 v68, s[20:23], s40 offen lds
ds_write_b128 v15, v[96:99] offset:0
RV 116,65,512
RV 118,65,4608
v_lshlrev_b32 v4, 16, v102
v_and_b32 v5, s71, v102
v_lshlrev_b32 v6, 16, v103
v_and_b32 v7, s71, v103
v_pk_mul_f32 v[4:5], v[4:5], s[14:15]
v_pk_mul_f32 v[6:7], v[6:7], s[14:15]
CV 100,0,1
CV 101,2,3
QK 20,16,160,48
RV 120,64,768
RV 122,64,4864
CV 102,4,5
v_accvgpr_read_b32 v48, a243
CV 103,6,7
v_add_f32 v78, v78, v48
v_lshlrev_b32 v0, 16, v104
v_and_b32 v1, s71, v104
v_lshlrev_b32 v2, 16, v105
v_and_b32 v3, s71, v105
v_pk_mul_f32 v[0:1], v[0:1], s[14:15]
v_pk_mul_f32 v[2:3], v[2:3], s[14:15]
QK 20,20,164,20
ds_write_b128 v15, v[100:103] offset:544
RV 124,65,768
RV 126,65,4864
v_lshlrev_b32 v4, 16, v106
v_and_b32 v5, s71, v106
v_lshlrev_b32 v6, 16, v107
v_and_b32_e64 v7, s71, v107
v_pk_mul_f32 v[4:5], v[4:5], s[14:15]
v_pk_mul_f32 v[6:7], v[6:7], s[14:15]
CV 104,0,1
CV 105,2,3
QK 20,24,168,20
CV 106,4,5
CV 107,6,7
v_lshlrev_b32 v0, 16, v108
v_and_b32 v1, s71, v108
v_lshlrev_b32 v2, 16, v109
v_and_b32 v3, s71, v109
v_pk_mul_f32 v[0:1], v[0:1], s[14:15]
v_pk_mul_f32 v[2:3], v[2:3], s[14:15]
QK 20,28,172,20
s_add_u32 s51, s44, 0x0
ds_write_b128 v15, v[104:107] offset:1152
v_lshlrev_b32 v4, 16, v110
v_and_b32 v5, s71, v110
v_lshlrev_b32 v6, 16, v111
v_and_b32_e64 v7, s71, v111
v_pk_mul_f32 v[4:5], v[4:5], s[14:15]
v_pk_mul_f32 v[6:7], v[6:7], s[14:15]
CV 108,0,1
CV 109,2,3
PV 128,64,32
CV 110,4,5
CV 111,6,7
PV 132,68,32
ds_write_b128 v15, v[108:111] offset:1696
PV 136,72,32
RK 192,14,0
RK 196,14,64
PV 140,76,32
RK 200,14,128
v_accvgpr_write_b32 a240, 0
RK 204,14,192
PM 128,76,0
PM 130,76,0
PV 144,80,32
buffer_load_dwordx4 v69, s[20:23], s40 offen offset:1024 lds
CV 128,128,129
CV 129,130,131
PM 132,76,0
PM 134,76,0
PV 148,84,32
ds_write_b64 v70, v[128:129] offset:0
CV 132,132,133
CV 133,134,135
PM 136,76,0
PM 138,76,0
PV 152,88,32
ds_write_b64 v70, v[132:133] offset:32
CV 136,136,137
CV 137,138,139
PM 140,76,0
PM 142,76,0
PV 156,92,32
s_waitcnt lgkmcnt(15)
ds_write_b64 v70, v[136:137] offset:64
CV 140,140,141
CV 141,142,143
PM 144,76,0
PM 146,76,0
EX 25
EX 26
EX 27
CV 36,24,25
CV 37,26,27
QZ 24,32,176
ds_write_b64 v70, v[140:141] offset:96
CV 144,144,145
CV 145,146,147
PM 148,76,0
PM 150,76,0
v_lshlrev_b32 v0, 16, v112
v_and_b32 v1, s71, v112
v_lshlrev_b32 v2, 16, v113
v_and_b32 v3, s71, v113
v_pk_mul_f32 v[0:1], v[0:1], s[14:15]
v_pk_mul_f32 v[2:3], v[2:3], s[14:15]
QK 24,36,180,24
L_t0_pad5:
s_cbranch_execz L_t0_go
ds_write_b64 v70, v[144:145] offset:128
CV 148,148,149
CV 149,150,151
PM 152,76,0
PM 154,76,0
v_lshlrev_b32 v4, 16, v114
v_and_b32 v5, s71, v114
v_lshlrev_b32 v6, 16, v115
v_and_b32_e64 v7, s71, v115
v_pk_mul_f32 v[4:5], v[4:5], s[14:15]
v_pk_mul_f32 v[6:7], v[6:7], s[14:15]
CV 112,0,1
CV 113,2,3
QK 24,40,184,24
ds_write_b64 v70, v[148:149] offset:160
CV 152,152,153
CV 153,154,155
PM 156,76,0
PM 158,76,0
CV 114,4,5
CV 115,6,7
s_waitcnt vmcnt(14)
v_lshlrev_b32 v0, 16, v116
v_and_b32 v1, s71, v116
v_lshlrev_b32 v2, 16, v117
v_and_b32 v3, s71, v117
v_pk_mul_f32 v[0:1], v[0:1], s[14:15]
v_pk_mul_f32 v[2:3], v[2:3], s[14:15]
QK 24,44,188,24
ds_write_b64 v70, v[152:153] offset:192
CV 156,156,157
CV 157,158,159
v_lshlrev_b32 v4, 16, v118
v_and_b32 v5, s71, v118
v_lshlrev_b32 v6, 16, v119
v_and_b32_e64 v7, s71, v119
v_pk_mul_f32 v[4:5], v[4:5], s[14:15]
v_max3_f32 v10, v24, v25, v26
v_pk_mul_f32 v[6:7], v[6:7], s[14:15]
CV 116,0,1
CV 117,2,3
EX 28
EX 29
EX 30
EX 31
CV 38,28,29
CV 39,30,31
QZ 28,48,176
ds_write_b64 v70, v[156:157] offset:224
RK 128,15,0
RK 132,15,528
CV 118,4,5
RK 136,15,1056
CV 119,6,7
RK 140,15,1584
ds_write_b128 v15, v[112:115] offset:0
s_waitcnt vmcnt(11)
v_lshlrev_b32 v0, 16, v120
v_and_b32 v1, s71, v120
v_lshlrev_b32 v2, 16, v121
v_and_b32 v3, s71, v121
v_pk_mul_f32 v[0:1], v[0:1], s[14:15]
v_pk_mul_f32 v[2:3], v[2:3], s[14:15]
QK 28,52,180,28
ds_write_b128 v15, v[116:119] offset:544
v_lshlrev_b32 v4, 16, v122
v_and_b32 v5, s71, v122
v_lshlrev_b32 v6, 16, v123
v_and_b32 v7, s71, v123
v_pk_mul_f32 v[4:5], v[4:5], s[14:15]
v_pk_mul_f32 v[6:7], v[6:7], s[14:15]
CV 120,0,1
CV 121,2,3
QK 28,56,184,28
s_waitcnt lgkmcnt(5)
buffer_store_dwordx4 a[128:131], v72, s[28:31], s51 offen nt
CV 122,4,5
CV 123,6,7
s_waitcnt vmcnt(9)
v_lshlrev_b32 v0, 16, v124
v_and_b32 v1, s71, v124
v_lshlrev_b32 v2, 16, v125
v_and_b32 v3, s71, v125
v_pk_mul_f32 v[0:1], v[0:1], s[14:15]
v_pk_mul_f32 v[2:3], v[2:3], s[14:15]
QK 28,60,188,28
s_waitcnt lgkmcnt(4)
buffer_store_dwordx4 a[132:135], v73, s[28:31], s51 offen nt
ds_write_b128 v15, v[120:123] offset:1152
v_lshlrev_b32 v4, 16, v126
v_and_b32 v5, s71, v126
v_lshlrev_b32 v6, 16, v127
v_and_b32 v7, s71, v127
v_pk_mul_f32 v[4:5], v[4:5], s[14:15]
v_pk_mul_f32 v[6:7], v[6:7], s[14:15]
v_max3_f32 v11, v28, v29, v30
v_max3_f32 v10, v10, v27, v31
CV 124,0,1
v_max_f32 v10, v10, v11
CV 125,2,3
v_mov_b32 v11, v10
EX 16
EX 17
v_permlane32_swap_b32 v10, v11
v_max_f32 v10, v10, v11
EX 18
v_mov_b32 v11, v10
EX 19
EX 20
v_permlane16_swap_b32 v10, v11
v_min_f32_e64 v52, -v10, -v11
EX 21
EX 22
EX 23
CV 32,16,17
CV 33,18,19
CV 34,20,21
CV 35,22,23
v_add_f32 v24, v52, v24
v_add_f32 v25, v52, v25
v_smfmac_f32_16x16x64_bf16 a[244:247], v[56:59], v[32:39], v71
s_add_u32 s52, s44, 0x10000
CV 126,4,5
CV 127,6,7
PV 160,64,36
s_waitcnt lgkmcnt(4)
buffer_store_dwordx4 a[136:139], v74, s[28:31], s51 offen nt
PV 164,68,36
ds_write_b128 v15, v[124:127] offset:1696
PV 168,72,36
RK 208,14,0
RK 212,14,64
PV 172,76,36
s_waitcnt lgkmcnt(6)
buffer_store_dwordx4 a[140:143], v75, s[28:31], s51 offen nt
RK 216,14,128
v_accvgpr_read_b32 v45, a246
v_accvgpr_read_b32 v46, a247
v_add_f32 v77, v77, v45
RK 220,14,192
v_add_f32 v77, v77, v46
v_accvgpr_read_b32 v49, a244
v_cmp_nge_f32 s[6:7], s55, v77
v_rcp_f32 v77, v77
v_add_f32 v78, v78, v49
v_accvgpr_read_b32 v50, a245
PM 160,76,1
v_add_f32 v78, v78, v50
PM 162,76,1
PV 176,80,36
v_cmp_nge_f32 s[8:9], s55, v78
v_rcp_f32 v78, v78
CV 160,160,161
CV 161,162,163
PM 164,76,1
PM 166,76,1
PV 180,84,36
s_add_u32 s40, s40, 0x20000
ds_write_b64 v70, v[160:161] offset:0
CV 164,164,165
CV 165,166,167
PM 168,76,1
PM 170,76,1
PV 184,88,36
s_add_u32 m0, s42, 0x2000
ds_write_b64 v70, v[164:165] offset:32
RK 0,60,8192
RK 4,61,8192
CV 168,168,169
CV 169,170,171
PM 172,76,1
PM 174,76,1
PV 188,92,36
ds_write_b64 v70, v[168:169] offset:64
RK 8,62,8192
RK 12,63,8192
CV 172,172,173
CV 173,174,175
PM 176,76,1
PM 178,76,1
QZ 16,32,192
ds_write_b64 v70, v[172:173] offset:96
RK 16,60,12288
RK 20,61,12288
CV 176,176,177
CV 177,178,179
PM 180,76,1
PM 182,76,1
QK 16,36,196,16
ds_write_b64 v70, v[176:177] offset:128
RK 24,62,12288
RK 28,63,12288
CV 180,180,181
CV 181,182,183
PM 184,76,1
PM 186,76,1
QK 16,40,200,16
buffer_load_dwordx4 v66, s[16:19], s40 offen lds
ds_write_b64 v70, v[180:181] offset:160
CV 184,184,185
CV 185,186,187
PM 188,76,1
PM 190,76,1
QK 16,44,204,16
ds_write_b64 v70, v[184:185] offset:192
CV 188,188,189
CV 189,190,191
QZ 20,48,192
v_add_f32 v26, v52, v26
v_add_f32 v27, v52, v27
ds_write_b64 v70, v[188:189] offset:224
QK 20,52,196,20
RK 144,15,0
RK 148,15,528
QK 20,56,200,20
RK 152,15,1056
v_max3_f32 v8, v16, v17, v18
QK 20,60,204,20
s_add_u32 s53, s44, 0x20000
RK 156,15,1584
v_add_f32 v10, v52, v12
PV 192,64,32
RV 64,64,8192
v_add_f32 v11, v52, v13
PV 196,68,32
s_nop 0
v_max3_f32 v9, v20, v21, v22
PV 200,72,32
RV 66,64,12288
v_max3_f32 v8, v8, v19, v23
PV 204,76,32
RV 68,65,8192
v_max_f32 v8, v8, v9
RV 70,65,12288
v_mov_b32 v9, v8
PM 192,78,0
PM 194,78,0
PV 208,80,32
buffer_load_dwordx4 v67, s[16:19], s40 offen offset:1024 lds
RV 72,64,8448
RV 74,64,12544
v_permlane32_swap_b32 v8, v9
v_max_f32 v8, v8, v9
CV 192,192,193
v_mov_b32 v9, v8
CV 193,194,195
PM 196,78,0
v_permlane16_swap_b32 v8, v9
v_min_f32_e64 v40, -v8, -v9
PM 198,78,0
PV 212,84,32
s_waitcnt lgkmcnt(9)
buffer_store_dwordx4 a[144:147], v72, s[28:31], s52 offen nt
ds_write_b64 v70, v[192:193] offset:0
RV 76,65,8448
RV 78,65,12544
CV 196,196,197
CV 197,198,199
PM 200,78,0
PM 202,78,0
PV 216,88,32
ds_write_b64 v70, v[196:197] offset:32
RV 80,64,8704
RV 82,64,12800
s_waitcnt lgkmcnt(14)
buffer_store_dwordx4 a[148:151], v73, s[28:31], s52 offen nt
CV 200,200,201
CV 201,202,203
PM 204,78,0
PM 206,78,0
PV 220,92,32
ds_write_b64 v70, v[200:201] offset:64
RV 84,65,8704
RV 86,65,12800
CV 204,204,205
CV 205,206,207
PM 208,78,0
PM 210,78,0
EX 24
EX 25
EX 26
EX 27
CV 36,24,25
CV 37,26,27
QZ 24,32,208
s_waitcnt lgkmcnt(15)
buffer_store_dwordx4 a[152:155], v74, s[28:31], s52 offen nt
ds_write_b64 v70, v[204:205] offset:96
RV 88,64,8960
RV 90,64,13056
CV 208,208,209
CV 209,210,211
PM 212,78,0
PM 214,78,0
QK 24,36,212,24
s_add_u32 m0, s42, 0x12000
ds_write_b64 v70, v[208:209] offset:128
RV 92,65,8960
RV 94,65,13056
buffer_store_dwordx4 a[156:159], v75, s[28:31], s52 offen nt
CV 212,212,213
CV 213,214,215
PM 216,78,0
PM 218,78,0
QK 24,40,216,24
ds_write_b64 v70, v[212:213] offset:160
CV 216,216,217
CV 217,218,219
PM 220,78,0
PM 222,78,0
QK 24,44,220,24
ds_write_b64 v70, v[216:217] offset:192
CV 220,220,221
CV 221,222,223
v_add_f32 v28, v10, v28
v_add_f32 v29, v10, v29
v_add_f32 v30, v11, v30
v_add_f32 v31, v11, v31
EX 28
v_max3_f32 v10, v24, v25, v26
EX 29
EX 30
EX 31
CV 38,28,29
CV 39,30,31
QZ 28,48,208
buffer_load_dwordx4 v68, s[20:23], s40 offen lds
ds_write_b64 v70, v[220:221] offset:224
QK 28,52,212,28
RK 160,15,0
RK 164,15,528
QK 28,56,216,28
RK 168,15,1056
v_add_f32 v8, v40, v12
QK 28,60,220,28
RK 172,15,1584
v_add_f32 v9, v40, v13
PZ 224,96,36
v_add_f32 v16, v40, v16
v_add_f32 v17, v40, v17
PZ 228,100,36
v_add_f32 v18, v40, v18
v_add_f32 v19, v40, v19
PZ 232,104,36
v_max3_f32 v11, v28, v29, v30
v_max3_f32 v10, v10, v27, v31
PZ 236,108,36
v_max_f32 v10, v10, v11
v_add_f32 v20, v8, v20
PZ 240,112,36
v_mov_b32 v11, v10
v_add_f32 v21, v8, v21
PZ 244,116,36
v_permlane32_swap_b32 v10, v11
PZ 248,120,36
v_max_f32 v10, v10, v11
v_add_f32 v22, v9, v22
PZ 252,124,36
s_waitcnt lgkmcnt(3)
buffer_store_dwordx4 a[160:163], v72, s[28:31], s53 offen nt
v_mov_b32 v11, v10
v_add_f32 v23, v9, v23
EX 16
v_permlane16_swap_b32 v10, v11
v_min_f32_e64 v44, -v10, -v11
EX 17
EX 18
EX 19
EX 20
EX 21
EX 22
v_exp_f32_e64 v23, v23
CV 32,16,17
CV 33,18,19
CV 34,20,21
CV 35,22,23
v_mov_b32 v53, v52
v_mov_b32 v54, v52
v_smfmac_f32_16x16x64_bf16 a[252:255], v[56:59], v[32:39], v71
v_mov_b32 v55, v52
v_add_f32 v24, v44, v24
v_add_f32 v25, v44, v25
QK 16,0,176,52
s_waitcnt lgkmcnt(2)
buffer_store_dwordx4 a[164:167], v73, s[28:31], s53 offen nt
QK 16,4,180,16
v_add_f32 v26, v44, v26
v_add_f32 v27, v44, v27
QK 16,8,184,16
EX 24
QK 16,12,188,16
EX 25
QK 20,16,176,52
s_waitcnt lgkmcnt(1)
buffer_store_dwordx4 a[168:171], v74, s[28:31], s53 offen nt
QK 20,20,180,20
EX 26
QK 20,24,184,20
EX 27
QK 20,28,188,20
v_mov_b32 v41, v40
v_mov_b32 v42, v40
PZ 128,96,32
s_waitcnt lgkmcnt(0)
buffer_store_dwordx4 a[172:175], v75, s[28:31], s53 offen nt
PZ 132,100,32
v_mov_b32 v43, v40
CV 36,24,25
PZ 136,104,32
CV 37,26,27
v_xor_b32 v60, s43, v60
PZ 140,108,32
v_xor_b32 v61, s43, v61
v_add_f32 v10, v44, v12
PZ 144,112,32
s_waitcnt vmcnt(19) lgkmcnt(0)
s_barrier
PZ 148,116,32
buffer_load_dwordx4 v69, s[20:23], s40 offen offset:1024 lds
PZ 152,120,32
s_xor_b32 s41, s41, s43
RK 32,60,0
v_add_f32 v11, v44, v13
PZ 156,124,32
s_xor_b32 s42, s41, 0xc000
RK 36,61,0
v_add_f32 v28, v10, v28
QK 24,0,192,40
s_add_u32 s40, s40, 0x20000
v_add_f32 v29, v10, v29
v_add_f32 v30, v11, v30
QK 24,4,196,24
s_add_u32 m0, s42, 0x0
v_add_f32 v31, v11, v31
v_xor_b32 v62, s43, v62
QK 24,8,200,24
buffer_load_dwordx4 v66, s[16:19], s40 offen lds
QK 24,12,204,24
RK 40,62,0
EX 28
EX 29
EX 30
EX 31
CV 38,28,29
CV 39,30,31
QK 28,16,192,40
RK 48,60,4096
v_xor_b32 v63, s43, v63
QK 28,20,196,28
RK 44,63,0
v_xor_b32 v64, s43, v64
QK 28,24,200,28
RK 52,61,4096
v_accvgpr_write_b32 a241, 0
QK 28,28,204,28
EX 16
PZ 160,96,36
RK 56,62,4096
v_accvgpr_write_b32 a242, 0
PZ 164,100,36
RK 60,63,4096
v_accvgpr_write_b32 a243, 0
PZ 168,104,36
EX 17
PZ 172,108,36
buffer_load_dwordx4 v67, s[16:19], s40 offen offset:1024 lds
PZ 176,112,36
RV 96,64,0
CV 32,16,17
PZ 180,116,36
EX 18
PZ 184,120,36
EX 19
PZ 188,124,36
RV 98,64,4096
EX 20
EX 21
EX 22
EX 23
CV 33,18,19
CV 34,20,21
CV 35,22,23
v_xor_b32 v65, s43, v65
v_mov_b32 v45, v44
v_smfmac_f32_16x16x64_bf16 a[240:243], v[56:59], v[32:39], v71
s_add_u32 m0, s42, 0x10000
s_xor_b32 s43, s43, 0xc000
v_mov_b32 v46, v44
v_mov_b32 v47, v44
v_accvgpr_write_b32 a244, 0
v_accvgpr_write_b32 a245, 0
QK 16,0,208,44
RV 100,65,0
RV 102,65,4096
QK 16,4,212,16
RV 104,64,256
v_accvgpr_write_b32 a246, 0
QK 16,8,216,16
RV 106,64,4352
v_accvgpr_write_b32 a247, 0
QK 16,12,220,16
buffer_load_dwordx4 v68, s[20:23], s40 offen lds
QK 20,16,208,44
EX 24
QK 20,20,212,20
EX 25
QK 20,24,216,20
RV 108,65,256
RV 110,65,4352
QK 20,28,220,20
RV 112,64,512
CV 36,24,25
PV 224,64,32
EX 26
PV 228,68,32
EX 27
PV 232,72,32
RV 114,64,4608
CV 37,26,27
PV 236,76,32
EX 28
PV 240,80,32
buffer_load_dwordx4 v69, s[20:23], s40 offen offset:1024 lds
PV 244,84,32
RV 116,65,512
RV 118,65,4608
PV 248,88,32
EX 29
PV 252,92,32
s_waitcnt lgkmcnt(12)
RV 120,64,768
CV 38,28,29
QK 24,32,176,52
EX 30
QK 24,36,180,24
RV 122,64,4864
RV 124,65,768
QK 24,40,184,24
EX 31
QK 24,44,188,24
RV 126,65,4864
CV 39,30,31
QK 28,48,176,52
EX 16
QK 28,52,180,28
EX 17
QK 28,56,184,28
EX 18
QK 28,60,188,28
EX 19
PV 128,64,36
EX 20
PV 132,68,36
EX 21
PV 136,72,36
EX 22
PV 140,76,36
EX 23
PV 144,80,36
CV 32,16,17
CV 33,18,19
PV 148,84,36
s_waitcnt lgkmcnt(0)
CV 34,20,21
CV 35,22,23
PV 152,88,36
s_add_u32 s40, s40, 0x20000
EX 24
PV 156,92,36
s_add_u32 m0, s42, 0x2000
EX 25
v_smfmac_f32_16x16x64_bf16 a[244:247], v[56:59], v[32:39], v71
RK 0,60,8192
QK 16,32,192,40
RK 4,61,8192
CV 36,24,25
QK 16,36,196,16
EX 26
QK 16,40,200,16
buffer_load_dwordx4 v66, s[16:19], s40 offen lds
QK 16,44,204,16
RK 8,62,8192
RK 12,63,8192
QK 20,48,192,40
EX 27
QK 20,52,196,20
RK 16,60,12288
CV 37,26,27
QK 20,56,200,20
RK 20,61,12288
v_xor_b32 v60, s43, v60
QK 20,60,204,20
RK 24,62,12288
v_xor_b32 v61, s43, v61
PV 160,64,32
EX 28
PV 164,68,32
L_t0_pad6:
s_cbranch_execz L_t0_go
RK 28,63,12288
v_xor_b32 v62, s43, v62
PV 168,72,32
EX 29
PV 172,76,32
buffer_load_dwordx4 v67, s[16:19], s40 offen offset:1024 lds
PV 176,80,32
RV 64,64,8192
RV 66,64,12288
PV 180,84,32
EX 30
PV 184,88,32
RV 68,65,8192
CV 38,28,29
PV 188,92,32
RV 70,65,12288
v_xor_b32 v63, s43, v63
QK 24,32,208,44
s_add_u32 m0, s42, 0x12000
v_exp_f32_e64 v31, v31
QK 24,36,212,24
RV 72,64,8448
CV 39,30,31
QK 24,40,216,24
EX 16
QK 24,44,220,24
v_exp_f32_e64 v17, v17
QK 28,48,208,44
buffer_load_dwordx4 v68, s[20:23], s40 offen lds
QK 28,52,212,28
RV 74,64,12544
RV 76,65,8448
QK 28,56,216,28
RV 78,65,12544
CV 32,16,17
QK 28,60,220,28
EX 18
PV 224,96,36
v_exp_f32_e64 v19, v19
PV 228,100,36
RV 80,64,8704
RV 82,64,12800
PV 232,104,36
EX 20
PV 236,108,36
RV 84,65,8704
CV 33,18,19
PV 240,112,36
v_exp_f32_e64 v21, v21
PV 244,116,36
buffer_load_dwordx4 v69, s[20:23], s40 offen offset:1024 lds
PV 248,120,36
EX 22
PV 252,124,36
RV 86,65,12800
RV 88,64,8960
v_exp_f32_e64 v23, v23
CV 34,20,21
CV 35,22,23
EX 24
s_nop 0
v_smfmac_f32_16x16x64_bf16 a[252:255], v[56:59], v[32:39], v71
s_waitcnt lgkmcnt(13)
RV 90,64,13056
QK 16,0,176,52
RV 92,65,8960
v_xor_b32_e64 v64, s43, v64
QK 16,4,180,16
EX 25
QK 16,8,184,16
RV 94,65,13056
CV 36,24,25
QK 16,12,188,16
v_exp_f32_e64 v26, v26
QK 20,16,176,52
EX 27
QK 20,20,180,20
v_exp_f32_e64 v28, v28
QK 20,24,184,20
EX 29
QK 20,28,188,20
v_exp_f32_e64 v30, v30
PV 128,96,32
EX 31
PV 132,100,32
CV 37,26,27
CV 38,28,29
PV 136,104,32
CV 39,30,31
v_xor_b32_e64 v65, s43, v65
PV 140,108,32
PV 144,112,32
s_waitcnt vmcnt(8) lgkmcnt(0)
s_barrier
PV 148,116,32
s_mov_b32 s56, 4
L_t0_loop1:
PV 152,120,32
s_xor_b32 s41, s41, s43
EX 16
PV 156,124,32
s_xor_b32 s42, s41, 0xc000
RK 32,60,0
RK 36,61,0
QK 24,0,192,40
s_add_u32 s40, s40, 0x20000
EX 17
QK 24,4,196,24
s_add_u32 m0, s42, 0x0
RK 40,62,0
CV 32,16,17
QK 24,8,200,24
buffer_load_dwordx4 v66, s[16:19], s40 offen lds
QK 24,12,204,24
s_xor_b32 s43, s43, 0xc000
EX 18
QK 28,16,192,40
RK 44,63,0
RK 48,60,4096
QK 28,20,196,28
EX 19
QK 28,24,200,28
RK 52,61,4096
CV 33,18,19
QK 28,28,204,28
EX 20
PV 160,96,36
EX 21
PV 164,100,36
RK 56,62,4096
RK 60,63,4096
PV 168,104,36
EX 22
PV 172,108,36
buffer_load_dwordx4 v67, s[16:19], s40 offen offset:1024 lds
PV 176,112,36
EX 23
PV 180,116,36
CV 34,20,21
CV 35,22,23
PV 184,120,36
RV 96,64,0
RV 98,64,4096
PV 188,124,36
EX 24
v_smfmac_f32_16x16x64_bf16 a[240:243], v[56:59], v[32:39], v71
s_add_u32 m0, s42, 0x10000
RV 100,65,0
QK 16,0,208,44
EX 25
QK 16,4,212,16
RV 102,65,4096
RV 104,64,256
QK 16,8,216,16
RV 106,64,4352
CV 36,24,25
QK 16,12,220,16
buffer_load_dwordx4 v68, s[20:23], s40 offen lds
QK 20,16,208,44
EX 26
QK 20,20,212,20
EX 27
QK 20,24,216,20
RV 108,65,256
RV 110,65,4352
QK 20,28,220,20
RV 112,64,512
CV 37,26,27
PV 224,64,32
EX 28
PV 228,68,32
EX 29
PV 232,72,32
RV 114,64,4608
CV 38,28,29
PV 236,76,32
EX 30
PV 240,80,32
buffer_load_dwordx4 v69, s[20:23], s40 offen offset:1024 lds
PV 244,84,32
RV 116,65,512
RV 118,65,4608
PV 248,88,32
EX 31
PV 252,92,32
s_waitcnt lgkmcnt(12)
RV 120,64,768
CV 39,30,31
QK 24,32,176,52
EX 16
QK 24,36,180,24
RV 122,64,4864
RV 124,65,768
QK 24,40,184,24
EX 17
QK 24,44,188,24
RV 126,65,4864
CV 32,16,17
QK 28,48,176,52
EX 18
QK 28,52,180,28
EX 19
QK 28,56,184,28
EX 20
QK 28,60,188,28
EX 21
PV 128,64,36
EX 22
PV 132,68,36
EX 23
PV 136,72,36
CV 33,18,19
CV 34,20,21
PV 140,76,36
EX 24
PV 144,80,36
EX 25
PV 148,84,36
s_waitcnt lgkmcnt(0)
EX 26
PV 152,88,36
s_add_u32 s40, s40, 0x20000
CV 35,22,23
PV 156,92,36
s_add_u32 m0, s42, 0x2000
EX 27
v_smfmac_f32_16x16x64_bf16 a[244:247], v[56:59], v[32:39], v71
RK 0,60,8192
QK 16,32,192,40
RK 4,61,8192
CV 36,24,25
QK 16,36,196,16
RK 8,62,8192
CV 37,26,27
QK 16,40,200,16
buffer_load_dwordx4 v66, s[16:19], s40 offen lds
QK 16,44,204,16
EX 28
QK 20,48,192,40
RK 12,63,8192
RK 16,60,12288
QK 20,52,196,20
EX 29
QK 20,56,200,20
RK 20,61,12288
CV 38,28,29
QK 20,60,204,20
RK 24,62,12288
v_xor_b32 v60, s43, v60
PV 160,64,32
EX 30
PV 164,68,32
RK 28,63,12288
v_xor_b32 v61, s43, v61
PV 168,72,32
EX 31
PV 172,76,32
buffer_load_dwordx4 v67, s[16:19], s40 offen offset:1024 lds
PV 176,80,32
RV 64,64,8192
RV 66,64,12288
PV 180,84,32
CV 39,30,31
v_xor_b32 v62, s43, v62
PV 184,88,32
RV 68,65,8192
v_xor_b32 v63, s43, v63
PV 188,92,32
EX 16
QK 24,32,208,44
s_add_u32 m0, s42, 0x12000
EX 17
QK 24,36,212,24
RV 70,65,12288
RV 72,64,8448
QK 24,40,216,24
EX 18
QK 24,44,220,24
RV 74,64,12544
CV 32,16,17
QK 28,48,208,44
buffer_load_dwordx4 v68, s[20:23], s40 offen lds
QK 28,52,212,28
EX 19
QK 28,56,216,28
RV 76,65,8448
RV 78,65,12544
QK 28,60,220,28
EX 20
PV 224,96,36
RV 80,64,8704
CV 33,18,19
PV 228,100,36
EX 21
PV 232,104,36
RV 82,64,12800
CV 34,20,21
PV 236,108,36
EX 22
PV 240,112,36
EX 23
PV 244,116,36
buffer_load_dwordx4 v69, s[20:23], s40 offen offset:1024 lds
PV 248,120,36
RV 84,65,8704
CV 35,22,23
PV 252,124,36
RV 86,65,12800
RV 88,64,8960
v_smfmac_f32_16x16x64_bf16 a[252:255], v[56:59], v[32:39], v71
s_waitcnt lgkmcnt(13)
RV 90,64,13056
QK 16,0,176,52
RV 92,65,8960
v_xor_b32 v64, s43, v64
QK 16,4,180,16
EX 24
QK 16,8,184,16
EX 25
QK 16,12,188,16
RV 94,65,13056
CV 36,24,25
QK 20,16,176,52
EX 26
QK 20,20,180,20
EX 27
QK 20,24,184,20
CV 37,26,27
v_xor_b32 v65, s43, v65
QK 20,28,188,20
EX 28
PV 128,96,32
EX 29
PV 132,100,32
EX 30
PV 136,104,32
EX 31
PV 140,108,32
CV 38,28,29
CV 39,30,31
PV 144,112,32
s_waitcnt vmcnt(8) lgkmcnt(0)
s_barrier
PV 148,116,32
s_sub_u32 s56, s56, 1
s_cbranch_scc0 L_t0_loop1
PV 152,120,32
s_xor_b32 s41, s41, s43
EX 16
PV 156,124,32
s_xor_b32 s43, s43, 0xc000
RK 32,60,0
RK 36,61,0
QK 24,0,192,40
s_xor_b32 s42, s41, 0xc000
EX 17
QK 24,4,196,24
RK 40,62,0
CV 32,16,17
QK 24,8,200,24
EX 18
QK 24,12,204,24
EX 19
QK 28,16,192,40
RK 44,63,0
RK 48,60,4096
QK 28,20,196,28
EX 20
QK 28,24,200,28
RK 52,61,4096
CV 33,18,19
QK 28,28,204,28
EX 21
PV 160,96,36
RK 56,62,4096
CV 34,20,21
PV 164,100,36
EX 22
PV 168,104,36
EX 23
PV 172,108,36
RK 60,63,4096
RV 96,64,0
PV 176,112,36
EX 24
PV 180,116,36
RV 98,64,4096
CV 35,22,23
PV 184,120,36
EX 25
PV 188,124,36
EX 26
v_smfmac_f32_16x16x64_bf16 a[240:243], v[56:59], v[32:39], v71
RV 100,65,0
QK 16,0,208,44
RV 102,65,4096
CV 36,24,25
QK 16,4,212,16
EX 27
QK 16,8,216,16
RV 104,64,256
RV 106,64,4352
QK 16,12,220,16
EX 28
QK 20,16,208,44
RV 108,65,256
CV 37,26,27
QK 20,20,212,20
EX 29
QK 20,24,216,20
RV 110,65,4352
CV 38,28,29
QK 20,28,220,20
EX 30
PV 224,64,32
EX 31
PV 228,68,32
RV 112,64,512
RV 114,64,4608
PV 232,72,32
EX 16
PV 236,76,32
RV 116,65,512
CV 39,30,31
PV 240,80,32
EX 17
PV 244,84,32
EX 18
PV 248,88,32
RV 118,65,4608
RV 120,64,768
PV 252,92,32
s_waitcnt lgkmcnt(13)
EX 19
QK 24,32,176,52
RV 122,64,4864
CV 32,16,17
QK 24,36,180,24
RV 124,65,768
CV 33,18,19
QK 24,40,184,24
EX 20
QK 24,44,188,24
EX 21
QK 28,48,176,52
RV 126,65,4864
CV 34,20,21
QK 28,52,180,28
EX 22
QK 28,56,184,28
EX 23
QK 28,60,188,28
CV 35,22,23
PV 128,64,36
PV 132,68,36
EX 24
PV 136,72,36
PV 140,76,36
EX 25
PV 144,80,36
PV 148,84,36
s_waitcnt lgkmcnt(0)
EX 26
PV 152,88,36
PV 156,92,36
EX 27
v_smfmac_f32_16x16x64_bf16 a[244:247], v[56:59], v[32:39], v71
RK 0,60,8192
QK 16,32,192,40
RK 4,61,8192
CV 36,24,25
QK 16,36,196,16
RK 8,62,8192
CV 37,26,27
QK 16,40,200,16
EX 28
QK 16,44,204,16
EX 29
QK 20,48,192,40
RK 12,63,8192
RK 16,60,12288
QK 20,52,196,20
EX 30
QK 20,56,200,20
RK 20,61,12288
CV 38,28,29
QK 20,60,204,20
RK 24,62,12288
v_xor_b32 v60, s43, v60
PV 160,64,32
EX 31
PV 164,68,32
RK 28,63,12288
CV 39,30,31
PV 168,72,32
EX 16
PV 172,76,32
RV 64,64,8192
v_xor_b32 v61, s43, v61
PV 176,80,32
RV 66,64,12288
v_xor_b32 v62, s43, v62
PV 180,84,32
EX 17
PV 184,88,32
RV 68,65,8192
v_xor_b32 v63, s43, v63
PV 188,92,32
RV 70,65,12288
CV 32,16,17
QK 24,32,208,44
EX 18
QK 24,36,212,24
EX 19
QK 24,40,216,24
RV 72,64,8448
CV 33,18,19
QK 24,44,220,24
EX 20
QK 28,48,208,44
RV 74,64,12544
RV 76,65,8448
QK 28,52,212,28
EX 21
QK 28,56,216,28
RV 78,65,12544
CV 34,20,21
QK 28,60,220,28
EX 22
PV 224,96,36
EX 23
PV 228,100,36
RV 80,64,8704
RV 82,64,12800
PV 232,104,36
EX 24
PV 236,108,36
RV 84,65,8704
CV 35,22,23
PV 240,112,36
EX 25
PV 244,116,36
EX 26
PV 248,120,36
RV 86,65,12800
RV 88,64,8960
PV 252,124,36
EX 27
v_smfmac_f32_16x16x64_bf16 a[252:255], v[56:59], v[32:39], v71
s_waitcnt lgkmcnt(13)
RV 90,64,13056
QK 16,0,176,52
RV 92,65,8960
CV 36,24,25
QK 16,4,180,16
CV 37,26,27
v_xor_b32 v64, s43, v64
QK 16,8,184,16
EX 28
QK 16,12,188,16
EX 29
QK 20,16,176,52
RV 94,65,13056
CV 38,28,29
QK 20,20,180,20
EX 30
QK 20,24,184,20
EX 31
QK 20,28,188,20
CV 39,30,31
v_xor_b32 v65, s43, v65
PV 128,96,32
EX 16
PV 132,100,32
PV 136,104,32
EX 17
PV 140,108,32
PV 144,112,32
s_waitcnt vmcnt(0) lgkmcnt(0)
s_barrier
PV 148,116,32
EX 18
PV 152,120,32
s_xor_b32 s41, s41, s43
EX 19
PV 156,124,32
s_xor_b32 s42, s41, 0xc000
RK 32,60,0
RK 36,61,0
QK 24,0,192,40
s_xor_b32 s43, s43, 0xc000
L_t0_pad7:
s_cbranch_execz L_t0_go
EX 20
QK 24,4,196,24
RK 40,62,0
CV 32,16,17
QK 24,8,200,24
EX 21
QK 24,12,204,24
RK 44,63,0
CV 33,18,19
QK 28,16,192,40
RK 48,60,4096
CV 34,20,21
QK 28,20,196,28
EX 22
QK 28,24,200,28
EX 23
QK 28,28,204,28
RK 52,61,4096
CV 35,22,23
PV 160,96,36
RK 56,62,4096
PV 164,100,36
EX 24
PV 168,104,36
RK 60,63,4096
PV 172,108,36
EX 25
PV 176,112,36
RV 96,64,0
PV 180,116,36
EX 26
PV 184,120,36
RV 98,64,4096
RV 100,65,0
PV 188,124,36
EX 27
v_smfmac_f32_16x16x64_bf16 a[240:243], v[56:59], v[32:39], v71
RV 102,65,4096
QK 16,0,208,44
CV 36,24,25
CV 37,26,27
QK 16,4,212,16
EX 28
QK 16,8,216,16
RV 104,64,256
RV 106,64,4352
QK 16,12,220,16
EX 29
QK 20,16,208,44
RV 108,65,256
CV 38,28,29
QK 20,20,212,20
EX 30
QK 20,24,216,20
EX 31
QK 20,28,220,20
RV 110,65,4352
RV 112,64,512
PV 224,64,32
EX 16
PV 228,68,32
RV 114,64,4608
CV 39,30,31
PV 232,72,32
EX 17
PV 236,76,32
RV 116,65,512
PV 240,80,32
EX 18
PV 244,84,32
RV 118,65,4608
PV 248,88,32
EX 19
PV 252,92,32
s_waitcnt lgkmcnt(12)
RV 120,64,768
CV 32,16,17
QK 24,32,176,52
RV 122,64,4864
CV 33,18,19
QK 24,36,180,24
EX 20
QK 24,40,184,24
EX 21
QK 24,44,188,24
RV 124,65,768
RV 126,65,4864
QK 28,48,176,52
EX 22
QK 28,52,180,28
CV 34,20,21
QK 28,56,184,28
EX 23
QK 28,60,188,28
CV 35,22,23
PV 128,64,36
PV 132,68,36
EX 24
PV 136,72,36
PV 140,76,36
EX 25
PV 144,80,36
PV 148,84,36
s_waitcnt lgkmcnt(0)
EX 26
PV 152,88,36
PV 156,92,36
EX 27
v_smfmac_f32_16x16x64_bf16 a[244:247], v[56:59], v[32:39], v71
RK 0,60,8192
QK 16,32,192,40
RK 4,61,8192
CV 36,24,25
QK 16,36,196,16
RK 8,62,8192
CV 37,26,27
QK 16,40,200,16
EX 28
QK 16,44,204,16
EX 29
QK 20,48,192,40
RK 12,63,8192
RK 16,60,12288
QK 20,52,196,20
EX 30
QK 20,56,200,20
RK 20,61,12288
CV 38,28,29
QK 20,60,204,20
EX 31
PV 160,64,32
RK 24,62,12288
CV 39,30,31
PV 164,68,32
EX 16
PV 168,72,32
EX 17
PV 172,76,32
RK 28,63,12288
RV 64,64,8192
PV 176,80,32
EX 18
PV 180,84,32
RV 66,64,12288
PV 184,88,32
EX 19
PV 188,92,32
RV 68,65,8192
RV 70,65,12288
QK 24,32,208,44
EX 20
QK 24,36,212,24
RV 72,64,8448
CV 32,16,17
QK 24,40,216,24
EX 21
QK 24,44,220,24
RV 74,64,12544
CV 33,18,19
QK 28,48,208,44
RV 76,65,8448
CV 34,20,21
QK 28,52,212,28
EX 22
QK 28,56,216,28
EX 23
QK 28,60,220,28
RV 78,65,12544
CV 35,22,23
PV 224,96,36
RV 80,64,8704
PV 228,100,36
EX 24
PV 232,104,36
RV 82,64,12800
PV 236,108,36
EX 25
PV 240,112,36
RV 84,65,8704
RV 86,65,12800
PV 244,116,36
EX 26
PV 248,120,36
RV 88,64,8960
PV 252,124,36
EX 27
v_smfmac_f32_16x16x64_bf16 a[252:255], v[56:59], v[32:39], v71
s_waitcnt lgkmcnt(13)
RV 90,64,13056
QK 16,0,176,52
RV 92,65,8960
CV 36,24,25
QK 16,4,180,16
EX 28
QK 16,8,184,16
RV 94,65,13056
CV 37,26,27
QK 16,12,188,16
EX 29
QK 20,16,176,52
v_accvgpr_read_b32 v79, a254
v_accvgpr_read_b32 v76, a252
QK 20,20,180,20
v_accvgpr_read_b32 v52, a255
CV 38,28,29
QK 20,24,184,20
EX 30
QK 20,28,188,20
EX 31
PV 128,96,32
v_add_f32 v79, v79, v52
CV 39,30,31
PV 132,100,32
EX 16
PV 136,104,32
EX 17
PV 140,108,32
EX 18
PV 144,112,32
s_waitcnt lgkmcnt(0)
EX 19
PV 148,116,32
EX 20
PV 152,120,32
EX 21
PV 156,124,32
EX 22
QK 24,0,192,40
EX 23
QK 24,4,196,24
CV 32,16,17
CV 33,18,19
QK 24,8,200,24
CV 34,20,21
CV 35,22,23
QK 24,12,204,24
QK 28,16,192,40
QK 28,20,196,28
QK 28,24,200,28
s_nop 0
v_accvgpr_read_b32 v40, a253
QK 28,28,204,28
v_add_f32 v76, v76, v40
PV 160,96,36
PV 164,100,36
EX 24
PV 168,104,36
EX 25
PV 172,108,36
EX 26
PV 176,112,36
EX 27
PV 180,116,36
EX 28
PV 184,120,36
EX 29
PV 188,124,36
EX 30
v_smfmac_f32_16x16x64_bf16 a[240:243], v[56:59], v[32:39], v71
CV 36,24,25
QK 16,0,208,44
EX 31
QK 16,4,212,16
CV 37,26,27
CV 38,28,29
QK 16,8,216,16
CV 39,30,31
s_nop 0
QK 16,12,220,16
s_nop 0
QK 20,16,208,44
v_accvgpr_read_b32 v53, a240
v_accvgpr_read_b32 v54, a241
QK 20,20,212,20
v_add_f32 v79, v79, v53
v_accvgpr_read_b32 v77, a242
QK 20,24,216,20
v_add_f32 v79, v79, v54
v_accvgpr_read_b32 v44, a243
QK 20,28,220,20
s_add_u32 s48, s45, 0x0
v_cmp_nge_f32 s[10:11], s55, v79
v_add_f32 v77, v77, v44
PV 224,64,32
v_rcp_f32 v79, v79
PV 228,68,32
EX 16
PV 232,72,32
EX 17
PV 236,76,32
EX 18
EX 19
EX 20
PM 224,78,1
PM 226,78,1
PV 240,80,32
CV 224,224,225
CV 225,226,227
EX 21
EX 22
PM 228,78,1
PM 230,78,1
PV 244,84,32
ds_write_b64 v70, v[224:225] offset:0
CV 228,228,229
CV 229,230,231
PM 232,78,1
PM 234,78,1
PV 248,88,32
ds_write_b64 v70, v[228:229] offset:32
CV 232,232,233
CV 233,234,235
PM 236,78,1
PM 238,78,1
PV 252,92,32
ds_write_b64 v70, v[232:233] offset:64
CV 236,236,237
CV 237,238,239
PM 240,78,1
PM 242,78,1
v_exp_f32_e64 v23, v23
CV 32,16,17
CV 33,18,19
CV 34,20,21
CV 35,22,23
CV 240,240,241
CV 241,242,243
v_smfmac_f32_16x16x64_bf16 a[244:247], v[56:59], v[32:39], v71
s_add_u32 s49, s45, 0x10000
ds_write_b64 v70, v[236:237] offset:96
PM 244,78,1
PM 246,78,1
PV 128,64,36
ds_write_b64 v70, v[240:241] offset:128
CV 244,244,245
CV 245,246,247
PM 248,78,1
PM 250,78,1
PV 132,68,36
ds_write_b64 v70, v[244:245] offset:160
v_accvgpr_read_b32 v41, a246
v_accvgpr_read_b32 v42, a247
v_add_f32 v76, v76, v41
v_accvgpr_read_b32 v45, a244
v_add_f32 v76, v76, v42
v_add_f32 v77, v77, v45
v_cmp_nge_f32 s[96:97], s55, v76
v_rcp_f32 v76, v76
v_accvgpr_read_b32 v46, a245
CV 248,248,249
v_add_f32 v77, v77, v46
CV 249,250,251
v_cmp_nge_f32 s[98:99], s55, v77
v_rcp_f32 v77, v77
PM 252,78,1
PM 254,78,1
PV 136,72,36
ds_write_b64 v70, v[248:249] offset:192
CV 252,252,253
CV 253,254,255
PV 140,76,36
ds_write_b64 v70, v[252:253] offset:224
RK 176,15,0
RK 180,15,528
PM 128,76,0
RK 184,15,1056
PM 130,76,0
PV 144,80,36
RK 188,15,1584
CV 128,128,129
CV 129,130,131
PM 132,76,0
PM 134,76,0
PV 148,84,36
ds_write_b64 v70, v[128:129] offset:0
CV 132,132,133
CV 133,134,135
PM 136,76,0
PM 138,76,0
PV 152,88,36
ds_write_b64 v70, v[132:133] offset:32
CV 136,136,137
CV 137,138,139
PM 140,76,0
PM 142,76,0
PV 156,92,36
s_waitcnt lgkmcnt(5)
buffer_store_dwordx4 a[176:179], v72, s[36:39], s48 offen nt
ds_write_b64 v70, v[136:137] offset:64
CV 140,140,141
CV 141,142,143
PM 144,76,0
PM 146,76,0
PV 160,64,32
s_waitcnt lgkmcnt(5)
s_add_u32 s50, s45, 0x20000
ds_write_b64 v70, v[140:141] offset:96
buffer_store_dwordx4 a[180:183], v73, s[36:39], s48 offen nt
CV 144,144,145
CV 145,146,147
PM 148,76,0
PM 150,76,0
PV 164,68,32
ds_write_b64 v70, v[144:145] offset:128
CV 148,148,149
CV 149,150,151
PM 152,76,0
PM 154,76,0
PV 168,72,32
s_waitcnt lgkmcnt(6)
buffer_store_dwordx4 a[184:187], v74, s[36:39], s48 offen nt
ds_write_b64 v70, v[148:149] offset:160
CV 152,152,153
CV 153,154,155
PM 156,76,0
PM 158,76,0
PV 172,76,32
s_waitcnt lgkmcnt(6)
ds_write_b64 v70, v[152:153] offset:192
buffer_store_dwordx4 a[188:191], v75, s[36:39], s48 offen nt
CV 156,156,157
PM 160,76,1
CV 157,158,159
PM 162,76,1
PV 176,80,32
ds_write_b64 v70, v[156:157] offset:224
RK 192,15,0
RK 196,15,528
CV 160,160,161
RK 200,15,1056
CV 161,162,163
RK 204,15,1584
PM 164,76,1
PM 166,76,1
PV 180,84,32
ds_write_b64 v70, v[160:161] offset:0
CV 164,164,165
CV 165,166,167
PM 168,76,1
PM 170,76,1
PV 184,88,32
ds_write_b64 v70, v[164:165] offset:32
CV 168,168,169
CV 169,170,171
PM 172,76,1
PM 174,76,1
PV 188,92,32
s_waitcnt lgkmcnt(5)
ds_write_b64 v70, v[168:169] offset:64
buffer_store_dwordx4 a[192:195], v72, s[36:39], s49 offen nt
CV 172,172,173
CV 173,174,175
ds_write_b64 v70, v[172:173] offset:96
PM 176,76,1
PM 178,76,1
CV 176,176,177
CV 177,178,179
ds_write_b64 v70, v[176:177] offset:128
s_waitcnt lgkmcnt(7)
buffer_store_dwordx4 a[196:199], v73, s[36:39], s49 offen nt
PM 180,76,1
PM 182,76,1
CV 180,180,181
CV 181,182,183
ds_write_b64 v70, v[180:181] offset:160
PM 184,76,1
PM 186,76,1
CV 184,184,185
CV 185,186,187
ds_write_b64 v70, v[184:185] offset:192
s_waitcnt lgkmcnt(8)
buffer_store_dwordx4 a[200:203], v74, s[36:39], s49 offen nt
PM 188,76,1
PM 190,76,1
CV 188,188,189
CV 189,190,191
ds_write_b64 v70, v[188:189] offset:224
RK 208,15,0
RK 212,15,528
s_waitcnt lgkmcnt(10)
buffer_store_dwordx4 a[204:207], v75, s[36:39], s49 offen nt
RK 216,15,1056
RK 220,15,1584
s_waitcnt lgkmcnt(3)
buffer_store_dwordx4 a[208:211], v72, s[36:39], s50 offen nt
s_waitcnt lgkmcnt(2)
buffer_store_dwordx4 a[212:215], v73, s[36:39], s50 offen nt
s_waitcnt lgkmcnt(1)
buffer_store_dwordx4 a[216:219], v74, s[36:39], s50 offen nt
s_waitcnt lgkmcnt(0)
buffer_store_dwordx4 a[220:223], v75, s[36:39], s50 offen nt
s_cmp_lg_u64 s[4:5], 0
s_cselect_b32 s62, 1, 0
s_or_b32 s54, s54, s62
s_cmp_lg_u64 s[6:7], 0
s_cselect_b32 s62, 2, 0
s_or_b32 s54, s54, s62
s_cmp_lg_u64 s[8:9], 0
s_cselect_b32 s62, 4, 0
s_or_b32 s54, s54, s62
s_cmp_lg_u64 s[10:11], 0
s_cselect_b32 s62, 16, 0
s_or_b32 s54, s54, s62
s_cmp_lg_u64 s[96:97], 0
s_cselect_b32 s62, 32, 0
s_or_b32 s54, s54, s62
s_cmp_lg_u64 s[98:99], 0
s_cselect_b32 s62, 64, 0
s_or_b32 s54, s54, s62
s_cbranch_scc0 L_done0
s_mov_b32 s4, 0x78d000
s_mov_b32 s5, 650
s_mov_b32 s6, 0x11a0000
s_mov_b32 s7, 570
s_getpc_b64 s[62:63]
L_fpc0:
s_add_u32 s62, s62, L_fallback-L_fpc0
s_addc_u32 s63, s63, 0
s_setpc_b64 s[62:63]
L_done0:
s_endpgm
L_end0:
.p2align 12
L_type1:
s_mov_b64 exec, 0
s_cmp_eq_u32 s12, 0
s_cbranch_scc1 L_t1_pad1
s_cmp_eq_u32 s12, 1
s_cbranch_scc1 L_t1_pad2
s_cmp_eq_u32 s12, 2
s_cbranch_scc1 L_t1_pad3
s_branch L_t1_pad4
L_t1_go:
s_mov_b64 exec, -1
s_add_u32 s50, s44, 0x20000
s_add_u32 s51, s44, 0x30000
s_mov_b32 s40, 0xa35000
s_add_u32 m0, s47, 0x2000
s_waitcnt vmcnt(9)
buffer_load_dwordx4 v[192:195], v72, s[24:27], s50 offen nt
s_barrier
v_lshlrev_b32 v0, 16, v128
RK 0,60,0
RK 4,61,0
v_and_b32 v1, s71, v128
RK 8,62,0
v_lshlrev_b32 v2, 16, v129
buffer_load_dwordx4 v[196:199], v73, s[24:27], s50 offen nt
RK 12,63,0
RK 16,60,4096
v_and_b32 v3, s71, v129
RK 20,61,4096
v_lshlrev_b32 v4, 16, v130
RK 24,62,4096
v_and_b32 v5, s71, v130
buffer_load_dwordx4 v[200:203], v74, s[24:27], s50 offen nt
RK 28,63,4096
v_lshlrev_b32 v6, 16, v131
v_and_b32_e64 v7, s71, v131
v_pk_mul_f32 v[0:1], v[0:1], s[14:15]
v_pk_mul_f32 v[2:3], v[2:3], s[14:15]
v_pk_mul_f32 v[4:5], v[4:5], s[14:15]
v_pk_mul_f32 v[6:7], v[6:7], s[14:15]
CV 128,0,1
CV 129,2,3
CV 130,4,5
buffer_load_dwordx4 v[204:207], v75, s[24:27], s50 offen nt
CV 131,6,7
ds_write_b128 v15, v[128:131] offset:0
s_waitcnt vmcnt(12)
v_lshlrev_b32 v0, 16, v132
v_and_b32 v1, s71, v132
v_lshlrev_b32 v2, 16, v133
v_and_b32 v3, s71, v133
v_lshlrev_b32 v4, 16, v134
v_and_b32 v5, s71, v134
v_lshlrev_b32 v6, 16, v135
v_and_b32_e64 v7, s71, v135
v_pk_mul_f32 v[0:1], v[0:1], s[14:15]
v_pk_mul_f32 v[2:3], v[2:3], s[14:15]
v_pk_mul_f32 v[4:5], v[4:5], s[14:15]
v_pk_mul_f32 v[6:7], v[6:7], s[14:15]
CV 132,0,1
CV 133,2,3
CV 134,4,5
CV 135,6,7
ds_write_b128 v15, v[132:135] offset:544
s_waitcnt vmcnt(11)
v_lshlrev_b32 v0, 16, v136
v_and_b32 v1, s71, v136
v_lshlrev_b32 v2, 16, v137
v_and_b32 v3, s71, v137
v_lshlrev_b32 v4, 16, v138
v_and_b32 v5, s71, v138
v_lshlrev_b32 v6, 16, v139
v_and_b32_e64 v7, s71, v139
v_pk_mul_f32 v[0:1], v[0:1], s[14:15]
v_pk_mul_f32 v[2:3], v[2:3], s[14:15]
v_pk_mul_f32 v[4:5], v[4:5], s[14:15]
v_pk_mul_f32 v[6:7], v[6:7], s[14:15]
CV 136,0,1
CV 137,2,3
CV 138,4,5
CV 139,6,7
ds_write_b128 v15, v[136:139] offset:1152
s_waitcnt vmcnt(10)
v_lshlrev_b32 v0, 16, v140
v_and_b32 v1, s71, v140
v_lshlrev_b32 v2, 16, v141
v_and_b32 v3, s71, v141
v_lshlrev_b32 v4, 16, v142
v_and_b32 v5, s71, v142
v_lshlrev_b32 v6, 16, v143
v_and_b32_e64 v7, s71, v143
v_pk_mul_f32 v[0:1], v[0:1], s[14:15]
v_pk_mul_f32 v[2:3], v[2:3], s[14:15]
v_pk_mul_f32 v[4:5], v[4:5], s[14:15]
v_pk_mul_f32 v[6:7], v[6:7], s[14:15]
CV 140,0,1
CV 141,2,3
CV 142,4,5
CV 143,6,7
ds_write_b128 v15, v[140:143] offset:1696
RK 128,14,0
v_subrev_u32 v13, 0x30000, v71
RK 132,14,64
v_ashrrev_i32 v13, 31, v13
RK 136,14,128
v_not_b32 v13, v13
RK 140,14,192
v_and_b32 v13, 0xff800000, v13
v_accvgpr_write_b32 a240, 0
v_accvgpr_write_b32 a241, 0
v_accvgpr_write_b32 a242, 0
v_accvgpr_write_b32 a243, 0
v_accvgpr_write_b32 a244, 0
v_accvgpr_write_b32 a245, 0
v_accvgpr_write_b32 a246, 0
v_accvgpr_write_b32 a247, 0
s_mul_i32 s45, s12, 0x30000
s_add_u32 s45, s45, 0xd75000
s_mov_b64 s[32:33], s[24:25]
s_mov_b32 s34, 0xdf9100
s_mov_b32 s35, 0x20000
s_waitcnt lgkmcnt(3)
QZ 16,0,128
s_waitcnt lgkmcnt(2)
s_mov_b32 s57, 10
v_accvgpr_write_b32 a248, 0
v_accvgpr_write_b32 a249, 0
QK 16,4,132,16
s_waitcnt lgkmcnt(1)
s_mov_b32 s58, 0x20000
v_accvgpr_write_b32 a252, 0
v_accvgpr_write_b32 a253, 0
QK 16,8,136,16
s_waitcnt lgkmcnt(0)
s_mov_b32 s60, 0x20000
v_accvgpr_write_b32 a254, 0
v_accvgpr_write_b32 a255, 0
QK 16,12,140,16
s_mov_b32 s59, 0x20000
s_nop 1
QZ 20,16,128
s_mov_b32 s61, 0x5000
s_nop 1
QK 20,20,132,20
s_mov_b64 s[36:37], s[28:29]
v_max3_f32 v8, v16, v17, v18
QK 20,24,136,20
s_mov_b32 s38, 0xdf9100
QK 20,28,140,20
s_mov_b32 s39, 0x20000
s_nop 1
s_sub_u32 s57, s57, 1
s_cselect_b64 s[58:59], s[60:61], s[58:59]
s_nop 2
v_max3_f32 v9, v20, v21, v22
v_max3_f32 v8, v8, v19, v23
v_max_f32 v8, v8, v9
v_mov_b32 v9, v8
s_nop 1
v_permlane32_swap_b32 v8, v9
v_max_f32 v8, v8, v9
v_mov_b32 v9, v8
s_nop 1
v_permlane16_swap_b32 v8, v9
v_min_f32_e64 v40, -v8, -v9
v_add_f32 v9, v40, v13
v_add_f32 v16, v40, v16
v_add_f32 v17, v40, v17
v_add_f32 v18, v40, v18
v_add_f32 v19, v40, v19
v_add_f32 v20, v40, v20
v_add_f32 v21, v40, v21
v_add_f32 v22, v9, v22
v_add_f32 v23, v9, v23
EX 16
EX 17
EX 18
EX 19
EX 20
EX 21
EX 22
EX 23
CV 32,16,17
CV 33,18,19
CV 34,20,21
CV 35,22,23
v_mov_b32 v41, v40
s_waitcnt vmcnt(7)
buffer_load_dwordx4 v[224:227], v72, s[24:27], s51 offen nt
s_barrier
v_lshlrev_b32 v0, 16, v160
RV 64,64,0
RV 66,64,4096
v_and_b32_e64 v1, s71, v160
RV 68,65,0
buffer_load_dwordx4 v[228:231], v73, s[24:27], s51 offen nt
RV 70,65,4096
RV 72,64,256
v_lshlrev_b32 v2, 16, v161
RV 74,64,4352
RV 76,65,256
v_and_b32 v3, s71, v161
RV 78,65,4352
v_lshlrev_b32 v4, 16, v162
buffer_load_dwordx4 v[232:235], v74, s[24:27], s51 offen nt
RV 80,64,512
RV 82,64,4608
v_and_b32 v5, s71, v162
RV 84,65,512
RV 86,65,4608
v_lshlrev_b32_e64 v6, 16, v163
RV 88,64,768
RV 90,64,4864
buffer_load_dwordx4 v[236:239], v75, s[24:27], s51 offen nt
RV 92,65,768
v_and_b32_e64 v7, s71, v163
RV 94,65,4864
v_pk_mul_f32 v[0:1], v[0:1], s[14:15]
v_pk_mul_f32 v[2:3], v[2:3], s[14:15]
v_pk_mul_f32 v[4:5], v[4:5], s[14:15]
v_pk_mul_f32 v[6:7], v[6:7], s[14:15]
CV 160,0,1
CV 161,2,3
CV 162,4,5
CV 163,6,7
ds_write_b128 v15, v[160:163] offset:0
s_waitcnt vmcnt(10)
v_lshlrev_b32 v0, 16, v164
v_and_b32 v1, s71, v164
v_lshlrev_b32 v2, 16, v165
v_and_b32 v3, s71, v165
v_lshlrev_b32 v4, 16, v166
v_and_b32 v5, s71, v166
v_lshlrev_b32 v6, 16, v167
v_and_b32_e64 v7, s71, v167
v_pk_mul_f32 v[0:1], v[0:1], s[14:15]
v_pk_mul_f32 v[2:3], v[2:3], s[14:15]
v_pk_mul_f32 v[4:5], v[4:5], s[14:15]
v_pk_mul_f32 v[6:7], v[6:7], s[14:15]
CV 164,0,1
CV 165,2,3
CV 166,4,5
CV 167,6,7
ds_write_b128 v15, v[164:167] offset:544
s_waitcnt vmcnt(9)
v_lshlrev_b32 v0, 16, v168
v_and_b32 v1, s71, v168
v_lshlrev_b32 v2, 16, v169
v_and_b32 v3, s71, v169
v_lshlrev_b32 v4, 16, v170
v_and_b32 v5, s71, v170
v_lshlrev_b32 v6, 16, v171
v_and_b32_e64 v7, s71, v171
v_pk_mul_f32 v[0:1], v[0:1], s[14:15]
v_pk_mul_f32 v[2:3], v[2:3], s[14:15]
v_pk_mul_f32 v[4:5], v[4:5], s[14:15]
v_pk_mul_f32 v[6:7], v[6:7], s[14:15]
CV 168,0,1
CV 169,2,3
CV 170,4,5
CV 171,6,7
ds_write_b128 v15, v[168:171] offset:1152
s_waitcnt vmcnt(8)
v_lshlrev_b32 v0, 16, v172
v_and_b32 v1, s71, v172
v_lshlrev_b32 v2, 16, v173
v_and_b32 v3, s71, v173
v_lshlrev_b32 v4, 16, v174
v_and_b32 v5, s71, v174
v_lshlrev_b32 v6, 16, v175
v_and_b32_e64 v7, s71, v175
v_pk_mul_f32 v[0:1], v[0:1], s[14:15]
v_pk_mul_f32 v[2:3], v[2:3], s[14:15]
v_pk_mul_f32 v[4:5], v[4:5], s[14:15]
v_pk_mul_f32 v[6:7], v[6:7], s[14:15]
CV 172,0,1
CV 173,2,3
CV 174,4,5
CV 175,6,7
s_waitcnt lgkmcnt(15)
PZ 128,64,32
ds_write_b128 v15, v[172:175] offset:1696
PZ 132,68,32
s_waitcnt lgkmcnt(14)
RK 144,14,0
RK 148,14,64
PZ 136,72,32
s_waitcnt lgkmcnt(14)
RK 152,14,128
v_mov_b32 v42, v40
PZ 140,76,32
s_waitcnt lgkmcnt(13)
RK 156,14,192
v_mov_b32 v43, v40
PZ 144,80,32
s_waitcnt lgkmcnt(12)
PZ 148,84,32
s_waitcnt lgkmcnt(10)
PZ 152,88,32
s_waitcnt lgkmcnt(8)
PZ 156,92,32
s_waitcnt lgkmcnt(3)
QZ 24,0,144
s_waitcnt lgkmcnt(2)
QK 24,4,148,24
s_waitcnt lgkmcnt(1)
QK 24,8,152,24
s_waitcnt lgkmcnt(0)
QK 24,12,156,24
s_nop 2
QZ 28,16,144
s_nop 2
QK 28,20,148,28
v_max3_f32 v10, v24, v25, v26
QK 28,24,152,28
QK 28,28,156,28
s_nop 2
s_nop 4
v_max3_f32 v11, v28, v29, v30
v_max3_f32 v10, v10, v27, v31
v_max_f32 v10, v10, v11
v_mov_b32 v11, v10
s_nop 1
v_permlane32_swap_b32 v10, v11
v_max_f32 v10, v10, v11
v_mov_b32 v11, v10
s_nop 1
v_permlane16_swap_b32 v10, v11
v_min_f32_e64 v44, -v10, -v11
v_add_f32 v11, v44, v13
v_add_f32 v24, v44, v24
v_add_f32 v25, v44, v25
v_add_f32 v26, v44, v26
v_add_f32 v27, v44, v27
v_add_f32 v28, v44, v28
v_add_f32 v29, v44, v29
v_add_f32 v30, v11, v30
v_add_f32 v31, v11, v31
EX 24
EX 25
EX 26
EX 27
EX 28
EX 29
EX 30
EX 31
CV 36,24,25
CV 37,26,27
CV 38,28,29
CV 39,30,31
v_mov_b32 v45, v44
s_waitcnt vmcnt(7)
buffer_load_dwordx4 v66, s[16:19], s40 offen lds
v_lshlrev_b32 v0, 16, v192
v_and_b32 v1, s71, v192
v_lshlrev_b32 v2, 16, v193
v_and_b32 v3, s71, v193
v_lshlrev_b32 v4, 16, v194
v_and_b32 v5, s71, v194
v_lshlrev_b32 v6, 16, v195
v_and_b32 v7, s71, v195
buffer_load_dwordx4 v67, s[16:19], s40 offen offset:1024 lds
s_add_u32 m0, s47, 0x12000
v_pk_mul_f32 v[0:1], v[0:1], s[14:15]
v_pk_mul_f32 v[2:3], v[2:3], s[14:15]
v_pk_mul_f32 v[4:5], v[4:5], s[14:15]
v_pk_mul_f32 v[6:7], v[6:7], s[14:15]
CV 192,0,1
CV 193,2,3
CV 194,4,5
CV 195,6,7
ds_write_b128 v15, v[192:195] offset:0
buffer_load_dwordx4 v68, s[20:23], s40 offen lds
s_waitcnt vmcnt(9)
v_lshlrev_b32 v0, 16, v196
v_and_b32 v1, s71, v196
v_lshlrev_b32 v2, 16, v197
v_and_b32 v3, s71, v197
v_lshlrev_b32 v4, 16, v198
v_and_b32 v5, s71, v198
v_lshlrev_b32 v6, 16, v199
v_and_b32_e64 v7, s71, v199
v_pk_mul_f32 v[0:1], v[0:1], s[14:15]
v_pk_mul_f32 v[2:3], v[2:3], s[14:15]
buffer_load_dwordx4 v69, s[20:23], s40 offen offset:1024 lds
s_mov_b32 s40, 0xa55000
s_add_u32 m0, s47, 0x4000
v_pk_mul_f32 v[4:5], v[4:5], s[14:15]
v_pk_mul_f32 v[6:7], v[6:7], s[14:15]
CV 196,0,1
CV 197,2,3
CV 198,4,5
CV 199,6,7
ds_write_b128 v15, v[196:199] offset:544
s_waitcnt vmcnt(9)
v_lshlrev_b32 v0, 16, v200
v_and_b32 v1, s71, v200
v_lshlrev_b32 v2, 16, v201
v_and_b32 v3, s71, v201
v_lshlrev_b32 v4, 16, v202
v_and_b32 v5, s71, v202
v_lshlrev_b32 v6, 16, v203
v_and_b32_e64 v7, s71, v203
v_pk_mul_f32 v[0:1], v[0:1], s[14:15]
v_pk_mul_f32 v[2:3], v[2:3], s[14:15]
v_pk_mul_f32 v[4:5], v[4:5], s[14:15]
v_pk_mul_f32 v[6:7], v[6:7], s[14:15]
CV 200,0,1
CV 201,2,3
CV 202,4,5
CV 203,6,7
ds_write_b128 v15, v[200:203] offset:1152
s_waitcnt vmcnt(8)
v_lshlrev_b32 v0, 16, v204
v_and_b32 v1, s71, v204
v_lshlrev_b32 v2, 16, v205
v_and_b32 v3, s71, v205
v_lshlrev_b32 v4, 16, v206
v_and_b32 v5, s71, v206
v_lshlrev_b32 v6, 16, v207
v_and_b32_e64 v7, s71, v207
v_pk_mul_f32 v[0:1], v[0:1], s[14:15]
v_pk_mul_f32 v[2:3], v[2:3], s[14:15]
v_pk_mul_f32 v[4:5], v[4:5], s[14:15]
v_pk_mul_f32 v[6:7], v[6:7], s[14:15]
CV 204,0,1
CV 205,2,3
CV 206,4,5
CV 207,6,7
PZ 160,64,36
ds_write_b128 v15, v[204:207] offset:1696
PZ 164,68,36
RK 160,14,0
RK 164,14,64
PZ 168,72,36
RK 168,14,128
v_mov_b32 v46, v44
PZ 172,76,36
RK 172,14,192
v_mov_b32 v47, v44
PZ 176,80,36
PZ 180,84,36
PZ 184,88,36
PZ 188,92,36
v_smfmac_f32_16x16x64_bf16 a[240:243], v[56:59], v[32:39], v71
s_waitcnt lgkmcnt(3)
QZ 16,0,160
s_waitcnt lgkmcnt(2)
QK 16,4,164,16
s_waitcnt lgkmcnt(1)
QK 16,8,168,16
s_waitcnt lgkmcnt(0)
QK 16,12,172,16
s_nop 2
QZ 20,16,160
s_nop 2
QK 20,20,164,20
v_max3_f32 v8, v16, v17, v18
QK 20,24,168,20
QK 20,28,172,20
s_nop 2
s_nop 4
v_max3_f32 v9, v20, v21, v22
v_max3_f32 v8, v8, v19, v23
v_max_f32 v8, v8, v9
v_mov_b32 v9, v8
s_nop 1
v_permlane32_swap_b32 v8, v9
v_max_f32 v8, v8, v9
v_mov_b32 v9, v8
s_nop 1
v_permlane16_swap_b32 v8, v9
v_min_f32_e64 v48, -v8, -v9
v_add_f32 v9, v48, v13
v_add_f32 v16, v48, v16
v_add_f32 v17, v48, v17
v_add_f32 v18, v48, v18
v_add_f32 v19, v48, v19
v_add_f32 v20, v48, v20
v_add_f32 v21, v48, v21
v_add_f32 v22, v9, v22
v_add_f32 v23, v9, v23
EX 16
EX 17
EX 18
EX 19
EX 20
EX 21
EX 22
v_exp_f32_e64 v23, v23
CV 32,16,17
CV 33,18,19
CV 34,20,21
CV 35,22,23
v_mov_b32 v49, v48
s_waitcnt vmcnt(7)
buffer_load_dwordx4 v66, s[16:19], s40 offen lds
v_lshlrev_b32 v0, 16, v224
v_and_b32 v1, s71, v224
v_lshlrev_b32 v2, 16, v225
v_and_b32 v3, s71, v225
v_lshlrev_b32 v4, 16, v226
v_and_b32 v5, s71, v226
v_lshlrev_b32 v6, 16, v227
v_and_b32 v7, s71, v227
buffer_load_dwordx4 v67, s[16:19], s40 offen offset:1024 lds
s_add_u32 m0, s47, 0x14000
v_pk_mul_f32 v[0:1], v[0:1], s[14:15]
v_pk_mul_f32 v[2:3], v[2:3], s[14:15]
v_pk_mul_f32 v[4:5], v[4:5], s[14:15]
v_pk_mul_f32 v[6:7], v[6:7], s[14:15]
CV 224,0,1
CV 225,2,3
CV 226,4,5
CV 227,6,7
ds_write_b128 v15, v[224:227] offset:0
buffer_load_dwordx4 v68, s[20:23], s40 offen lds
s_waitcnt vmcnt(9)
v_lshlrev_b32 v0, 16, v228
v_and_b32 v1, s71, v228
v_lshlrev_b32 v2, 16, v229
v_and_b32 v3, s71, v229
v_lshlrev_b32 v4, 16, v230
v_and_b32 v5, s71, v230
v_lshlrev_b32 v6, 16, v231
v_and_b32_e64 v7, s71, v231
v_pk_mul_f32 v[0:1], v[0:1], s[14:15]
v_pk_mul_f32 v[2:3], v[2:3], s[14:15]
buffer_load_dwordx4 v69, s[20:23], s40 offen offset:1024 lds
v_pk_mul_f32 v[4:5], v[4:5], s[14:15]
v_pk_mul_f32 v[6:7], v[6:7], s[14:15]
CV 228,0,1
CV 229,2,3
CV 230,4,5
CV 231,6,7
ds_write_b128 v15, v[228:231] offset:544
s_waitcnt vmcnt(9)
v_lshlrev_b32 v0, 16, v232
v_and_b32 v1, s71, v232
v_lshlrev_b32 v2, 16, v233
v_and_b32 v3, s71, v233
v_lshlrev_b32 v4, 16, v234
v_and_b32 v5, s71, v234
v_lshlrev_b32 v6, 16, v235
v_and_b32_e64 v7, s71, v235
v_pk_mul_f32 v[0:1], v[0:1], s[14:15]
v_pk_mul_f32 v[2:3], v[2:3], s[14:15]
v_pk_mul_f32 v[4:5], v[4:5], s[14:15]
v_pk_mul_f32 v[6:7], v[6:7], s[14:15]
CV 232,0,1
CV 233,2,3
CV 234,4,5
CV 235,6,7
ds_write_b128 v15, v[232:235] offset:1152
s_waitcnt vmcnt(8)
v_lshlrev_b32 v0, 16, v236
v_and_b32 v1, s71, v236
v_lshlrev_b32 v2, 16, v237
v_and_b32 v3, s71, v237
v_lshlrev_b32 v4, 16, v238
v_and_b32 v5, s71, v238
v_lshlrev_b32 v6, 16, v239
v_and_b32_e64 v7, s71, v239
v_pk_mul_f32 v[0:1], v[0:1], s[14:15]
v_pk_mul_f32 v[2:3], v[2:3], s[14:15]
v_pk_mul_f32 v[4:5], v[4:5], s[14:15]
v_pk_mul_f32 v[6:7], v[6:7], s[14:15]
CV 236,0,1
CV 237,2,3
CV 238,4,5
CV 239,6,7
PZ 192,64,32
s_mov_b32 s40, 0xa75000
ds_write_b128 v15, v[236:239] offset:1696
PZ 196,68,32
s_add_u32 m0, s47, 0x6000
RK 176,14,0
RK 180,14,64
PZ 200,72,32
RK 184,14,128
v_mov_b32 v50, v48
PZ 204,76,32
s_waitcnt vmcnt(6)
s_barrier
PZ 208,80,32
RK 188,14,192
RK 32,60,8192
PZ 212,84,32
buffer_load_dwordx4 v66, s[16:19], s40 offen lds
PZ 216,88,32
RK 36,61,8192
RK 40,62,8192
PZ 220,92,32
s_waitcnt lgkmcnt(6)
RK 44,63,8192
v_mov_b32 v51, v48
QZ 24,0,176
s_waitcnt lgkmcnt(6)
RK 48,60,12288
v_xor_b32 v60, s43, v60
QK 24,4,180,24
s_waitcnt lgkmcnt(6)
buffer_load_dwordx4 v67, s[16:19], s40 offen offset:1024 lds
QK 24,8,184,24
s_waitcnt lgkmcnt(5)
s_add_u32 m0, s47, 0x16000
RK 52,61,12288
RK 56,62,12288
QK 24,12,188,24
RK 60,63,12288
v_xor_b32 v61, s43, v61
QZ 28,16,176
v_xor_b32 v62, s43, v62
v_xor_b32 v63, s43, v63
QK 28,20,180,28
buffer_load_dwordx4 v68, s[20:23], s40 offen lds
QK 28,24,184,28
v_max3_f32 v10, v24, v25, v26
QK 28,28,188,28
s_waitcnt lgkmcnt(7)
s_nop 2
QK 16,32,128,40
s_waitcnt lgkmcnt(6)
s_nop 2
QK 16,36,132,16
s_waitcnt lgkmcnt(0)
v_max3_f32 v11, v28, v29, v30
v_max3_f32 v10, v10, v27, v31
QK 16,40,136,16
s_waitcnt vmcnt(7)
s_barrier
QK 16,44,140,16
RV 96,64,8192
v_max_f32 v10, v10, v11
QK 20,48,128,40
RV 98,64,12288
v_mov_b32 v11, v10
QK 20,52,132,20
RV 100,65,8192
RV 102,65,12288
QK 20,56,136,20
s_xor_b32 s41, s41, s43
v_permlane32_swap_b32 v10, v11
QK 20,60,140,20
s_xor_b32 s42, s41, 0xc000
RV 104,64,8448
v_max_f32 v10, v10, v11
EX 16
v_mov_b32 v11, v10
EX 17
EX 18
v_permlane16_swap_b32 v10, v11
v_min_f32_e64 v52, -v10, -v11
EX 19
v_add_f32 v24, v52, v24
v_add_f32 v25, v52, v25
v_add_f32 v26, v52, v26
v_add_f32 v27, v52, v27
EX 24
EX 25
EX 26
EX 27
CV 36,24,25
CV 37,26,27
QK 24,32,144,44
buffer_load_dwordx4 v69, s[20:23], s40 offen offset:1024 lds
QK 24,36,148,24
s_mov_b32 s40, 0xa95000
L_t1_pad1:
s_cbranch_execz L_t1_pad5
v_add_f32 v11, v52, v13
v_add_f32 v28, v52, v28
QK 24,40,152,24
s_add_u32 m0, s47, 0xc000
v_add_f32 v29, v52, v29
v_add_f32 v30, v11, v30
QK 24,44,156,24
RV 106,64,12544
v_add_f32 v31, v11, v31
EX 28
EX 29
EX 30
EX 31
CV 38,28,29
CV 39,30,31
v_mov_b32 v53, v52
v_mov_b32 v54, v52
v_smfmac_f32_16x16x64_bf16 a[244:247], v[56:59], v[32:39], v71
CV 32,16,17
QK 28,48,144,44
buffer_load_dwordx4 v66, s[16:19], s40 offen lds
QK 28,52,148,28
RV 108,65,8448
CV 33,18,19
QK 28,56,152,28
RV 110,65,12544
RV 112,64,8704
QK 28,60,156,28
RV 114,64,12800
v_mov_b32 v55, v52
PZ 224,64,36
RV 116,65,8704
RV 118,65,12800
PZ 228,68,36
RV 120,64,8960
v_subrev_u32 v12, 0x20000, v71
PZ 232,72,36
buffer_load_dwordx4 v67, s[16:19], s40 offen offset:1024 lds
PZ 236,76,36
RV 122,64,13056
RV 124,65,8960
PZ 240,80,36
RV 126,65,13056
v_xor_b32 v64, s43, v64
PZ 244,84,36
EX 20
PZ 248,88,36
EX 21
PZ 252,92,36
EX 22
QK 16,32,160,48
s_add_u32 m0, s47, 0x1c000
EX 23
QK 16,36,164,16
CV 34,20,21
CV 35,22,23
QK 16,40,168,16
buffer_load_dwordx4 v68, s[20:23], s40 offen lds
QK 16,44,172,16
EX 24
QK 20,48,160,48
EX 25
QK 20,52,164,20
EX 26
QK 20,56,168,20
s_waitcnt lgkmcnt(0)
EX 27
QK 20,60,172,20
CV 36,24,25
CV 37,26,27
PV 128,96,32
EX 28
PV 132,100,32
buffer_load_dwordx4 v69, s[20:23], s40 offen offset:1024 lds
PV 136,104,32
EX 29
PV 140,108,32
EX 30
PV 144,112,32
EX 31
PV 148,116,32
s_mov_b32 s40, 0xab5000
CV 38,28,29
CV 39,30,31
PV 152,120,32
s_add_u32 m0, s47, 0xe000
EX 16
PV 156,124,32
EX 17
QK 24,32,176,52
buffer_load_dwordx4 v66, s[16:19], s40 offen lds
QK 24,36,180,24
EX 18
QK 24,40,184,24
EX 19
QK 24,44,188,24
EX 20
v_smfmac_f32_16x16x64_bf16 a[240:243], v[56:59], v[32:39], v71
s_waitcnt vmcnt(11)
s_barrier
QK 28,48,176,52
RK 0,60,0
RK 4,61,0
QK 28,52,180,28
RK 8,62,0
CV 32,16,17
QK 28,56,184,28
buffer_load_dwordx4 v67, s[16:19], s40 offen offset:1024 lds
QK 28,60,188,28
RK 12,63,0
RK 16,60,4096
PV 160,96,36
RK 20,61,4096
CV 33,18,19
PV 164,100,36
RK 24,62,4096
v_xor_b32 v65, s43, v65
PV 168,104,36
s_xor_b32 s43, s43, 0xc000
RK 28,63,4096
v_subrev_u32 v13, 0x10000, v71
PV 172,108,36
EX 21
PV 176,112,36
s_add_u32 m0, s47, 0x1e000
EX 22
PV 180,116,36
EX 23
PV 184,120,36
buffer_load_dwordx4 v68, s[20:23], s40 offen lds
PV 188,124,36
s_waitcnt lgkmcnt(7)
CV 34,20,21
CV 35,22,23
QK 16,0,128,40
s_waitcnt lgkmcnt(0)
EX 24
QK 16,4,132,16
EX 25
QK 16,8,136,16
EX 26
QK 16,12,140,16
EX 27
QK 20,16,128,40
CV 36,24,25
CV 37,26,27
QK 20,20,132,20
buffer_load_dwordx4 v69, s[20:23], s40 offen offset:1024 lds
QK 20,24,136,20
EX 28
QK 20,28,140,20
EX 29
PV 192,96,32
EX 30
PV 196,100,32
EX 31
PV 200,104,32
s_waitcnt vmcnt(12)
s_barrier
PV 204,108,32
CV 38,28,29
CV 39,30,31
PV 208,112,32
EX 16
PV 212,116,32
EX 17
PV 216,120,32
EX 18
PV 220,124,32
s_mov_b32 s40, 0xad5000
EX 19
QK 24,0,144,44
s_add_u32 m0, s47, 0x8000
RV 64,64,0
RV 66,64,4096
QK 24,4,148,24
RV 68,65,0
v_ashrrev_i32 v12, 31, v12
QK 24,8,152,24
buffer_load_dwordx4 v66, s[16:19], s40 offen lds
QK 24,12,156,24
RV 70,65,4096
RV 72,64,256
v_smfmac_f32_16x16x64_bf16 a[244:247], v[56:59], v[32:39], v71
CV 32,16,17
QK 28,16,144,44
RV 74,64,4352
CV 33,18,19
QK 28,20,148,28
RV 76,65,256
RV 78,65,4352
QK 28,24,152,28
RV 80,64,512
v_ashrrev_i32 v13, 31, v13
QK 28,28,156,28
RV 82,64,4608
RV 84,65,512
PV 224,96,36
RV 86,65,4608
v_not_b32 v12, v12
PV 228,100,36
buffer_load_dwordx4 v67, s[16:19], s40 offen offset:1024 lds
PV 232,104,36
RV 88,64,768
RV 90,64,4864
PV 236,108,36
s_waitcnt vmcnt(10)
s_barrier
PV 240,112,36
RK 32,60,8192
RK 36,61,8192
PV 244,116,36
RK 40,62,8192
v_not_b32 v13, v13
PV 248,120,36
RK 44,63,8192
v_and_b32 v12, 0xff800000, v12
PV 252,124,36
s_add_u32 m0, s47, 0x18000
RK 48,60,12288
v_xor_b32 v60, s43, v60
QK 16,0,160,48
RK 52,61,12288
v_xor_b32 v61, s43, v61
QK 16,4,164,16
RK 56,62,12288
v_xor_b32 v62, s43, v62
QK 16,8,168,16
RK 60,63,12288
v_xor_b32 v63, s43, v63
QK 16,12,172,16
RV 92,65,768
v_and_b32 v13, 0xff800000, v13
EX 20
EX 21
EX 22
EX 23
CV 34,20,21
CV 35,22,23
QK 20,16,160,48
RV 94,65,4864
RV 96,64,8192
QK 20,20,164,20
buffer_load_dwordx4 v68, s[20:23], s40 offen lds
QK 20,24,168,20
RV 98,64,12288
RV 100,65,8192
QK 20,28,172,20
s_waitcnt lgkmcnt(15)
RV 102,65,12288
PV 128,64,32
EX 24
PV 132,68,32
buffer_load_dwordx4 v69, s[20:23], s40 offen offset:1024 lds
PV 136,72,32
s_waitcnt lgkmcnt(4)
RV 104,64,8448
PV 140,76,32
EX 25
PV 144,80,32
RV 106,64,12544
CV 36,24,25
PV 148,84,32
EX 26
PV 152,88,32
EX 27
PV 156,92,32
RV 108,65,8448
CV 37,26,27
QK 24,0,176,52
EX 28
QK 24,4,180,24
EX 29
QK 24,8,184,24
EX 30
QK 24,12,188,24
EX 31
CV 38,28,29
CV 39,30,31
EX 16
s_nop 0
v_smfmac_f32_16x16x64_bf16 a[240:243], v[56:59], v[32:39], v71
RV 110,65,12544
QK 28,16,176,52
RV 112,64,8704
RV 114,64,12800
QK 28,20,180,28
EX 17
QK 28,24,184,28
RV 116,65,8704
CV 32,16,17
QK 28,28,188,28
EX 18
PV 160,64,36
EX 19
PV 164,68,36
RV 118,65,12800
CV 33,18,19
PV 168,72,36
EX 20
PV 172,76,36
RV 120,64,8960
PV 176,80,36
EX 21
PV 180,84,36
RV 122,64,13056
CV 34,20,21
PV 184,88,36
EX 22
PV 188,92,36
RV 124,65,8960
v_xor_b32 v64, s43, v64
QK 16,32,128,40
EX 23
QK 16,36,132,16
RV 126,65,13056
CV 35,22,23
QK 16,40,136,16
EX 24
QK 16,44,140,16
EX 25
QK 20,48,128,40
EX 26
QK 20,52,132,20
EX 27
QK 20,56,136,20
CV 36,24,25
CV 37,26,27
QK 20,60,140,20
EX 28
PV 192,64,32
EX 29
PV 196,68,32
EX 30
PV 200,72,32
EX 31
PV 204,76,32
CV 38,28,29
CV 39,30,31
PV 208,80,32
s_waitcnt vmcnt(8) lgkmcnt(0)
s_barrier
PV 212,84,32
EX 16
PV 216,88,32
s_xor_b32 s41, s41, s43
RK 0,60,0
v_xor_b32 v65, s43, v65
PV 220,92,32
s_xor_b32 s42, s41, 0xc000
EX 17
QK 24,32,144,44
s_xor_b32 s43, s43, 0xc000
EX 18
QK 24,36,148,24
s_mov_b32 s40, 0xaf5000
RK 4,61,0
QK 24,40,152,24
s_add_u32 m0, s47, 0xa000
EX 19
QK 24,44,156,24
RK 8,62,0
v_smfmac_f32_16x16x64_bf16 a[244:247], v[56:59], v[32:39], v71
CV 32,16,17
QK 28,48,144,44
buffer_load_dwordx4 v66, s[16:19], s40 offen lds
QK 28,52,148,28
RK 12,63,0
CV 33,18,19
QK 28,56,152,28
EX 20
QK 28,60,156,28
RK 16,60,4096
PV 224,64,36
EX 21
PV 228,68,36
RK 20,61,4096
CV 34,20,21
PV 232,72,36
buffer_load_dwordx4 v67, s[16:19], s40 offen offset:1024 lds
PV 236,76,36
EX 22
PV 240,80,36
RK 24,62,4096
PV 244,84,36
EX 23
PV 248,88,36
RK 28,63,4096
CV 35,22,23
PV 252,92,36
EX 24
QK 16,32,160,48
s_add_u32 m0, s47, 0x1a000
RV 64,64,0
QK 16,36,164,16
EX 25
QK 16,40,168,16
buffer_load_dwordx4 v68, s[20:23], s40 offen lds
QK 16,44,172,16
RV 66,64,4096
CV 36,24,25
QK 20,48,160,48
EX 26
QK 20,52,164,20
RV 68,65,0
QK 20,56,168,20
EX 27
QK 20,60,172,20
RV 70,65,4096
CV 37,26,27
PV 128,96,32
EX 28
PV 132,100,32
buffer_load_dwordx4 v69, s[20:23], s40 offen offset:1024 lds
PV 136,104,32
RV 72,64,256
PV 140,108,32
EX 29
PV 144,112,32
RV 74,64,4352
CV 38,28,29
PV 148,116,32
s_mov_b32 s40, 0xb15000
EX 30
PV 152,120,32
s_add_u32 m0, s47, 0x0
RV 76,65,256
PV 156,124,32
EX 31
QK 24,32,176,52
buffer_load_dwordx4 v66, s[16:19], s40 offen lds
QK 24,36,180,24
RV 78,65,4352
CV 39,30,31
QK 24,40,184,24
EX 16
QK 24,44,188,24
RV 80,64,512
v_smfmac_f32_16x16x64_bf16 a[240:243], v[56:59], v[32:39], v71
RV 82,64,4608
QK 28,48,176,52
EX 17
QK 28,52,180,28
EX 18
QK 28,56,184,28
buffer_load_dwordx4 v67, s[16:19], s40 offen offset:1024 lds
QK 28,60,188,28
RV 84,65,512
CV 32,16,17
PV 160,96,36
EX 19
PV 164,100,36
RV 86,65,4608
CV 33,18,19
PV 168,104,36
EX 20
PV 172,108,36
RV 88,64,768
PV 176,112,36
s_add_u32 m0, s47, 0x10000
EX 21
PV 180,116,36
RV 90,64,4864
CV 34,20,21
PV 184,120,36
buffer_load_dwordx4 v68, s[20:23], s40 offen lds
PV 188,124,36
s_waitcnt lgkmcnt(14)
EX 22
QK 16,0,128,40
RV 92,65,768
QK 16,4,132,16
EX 23
QK 16,8,136,16
RV 94,65,4864
CV 35,22,23
QK 16,12,140,16
EX 24
QK 20,16,128,40
EX 25
QK 20,20,132,20
buffer_load_dwordx4 v69, s[20:23], s40 offen offset:1024 lds
QK 20,24,136,20
EX 26
QK 20,28,140,20
EX 27
PV 192,96,32
CV 36,24,25
CV 37,26,27
PV 196,100,32
EX 28
PV 200,104,32
EX 29
PV 204,108,32
EX 30
PV 208,112,32
s_waitcnt vmcnt(12) lgkmcnt(0)
s_barrier
PV 212,116,32
s_add_u32 s40, s40, s58
EX 31
PV 216,120,32
s_add_u32 m0, s42, 0x2000
RK 32,60,8192
CV 38,28,29
PV 220,124,32
s_mov_b32 s58, s59
EX 16
QK 24,0,144,44
s_mov_b32 s59, 0x20000
RK 36,61,8192
CV 39,30,31
QK 24,4,148,24
EX 17
QK 24,8,152,24
buffer_load_dwordx4 v66, s[16:19], s40 offen lds
QK 24,12,156,24
RK 40,62,8192
v_smfmac_f32_16x16x64_bf16 a[244:247], v[56:59], v[32:39], v71
s_sub_u32 s57, s57, 1
s_cselect_b64 s[58:59], s[60:61], s[58:59]
CV 32,16,17
QK 28,16,144,44
EX 18
QK 28,20,148,28
RK 44,63,8192
QK 28,24,152,28
EX 19
QK 28,28,156,28
RK 48,60,12288
CV 33,18,19
PV 224,96,36
RK 52,61,12288
v_xor_b32 v60, s43, v60
PV 228,100,36
buffer_load_dwordx4 v67, s[16:19], s40 offen offset:1024 lds
PV 232,104,36
EX 20
PV 236,108,36
RK 56,62,12288
v_xor_b32 v61, s43, v61
PV 240,112,36
EX 21
PV 244,116,36
s_add_u32 m0, s42, 0x12000
RK 60,63,12288
CV 34,20,21
PV 248,120,36
EX 22
PV 252,124,36
RV 96,64,8192
v_xor_b32 v62, s43, v62
QK 16,0,160,48
EX 23
QK 16,4,164,16
buffer_load_dwordx4 v68, s[20:23], s40 offen lds
QK 16,8,168,16
RV 98,64,12288
CV 35,22,23
QK 16,12,172,16
EX 24
QK 20,16,160,48
RV 100,65,8192
v_xor_b32 v63, s43, v63
QK 20,20,164,20
EX 25
QK 20,24,168,20
RV 102,65,12288
CV 36,24,25
QK 20,28,172,20
EX 26
PV 128,64,32
EX 27
PV 132,68,32
buffer_load_dwordx4 v69, s[20:23], s40 offen offset:1024 lds
PV 136,72,32
RV 104,64,8448
CV 37,26,27
PV 140,76,32
EX 28
PV 144,80,32
RV 106,64,12544
PV 148,84,32
EX 29
PV 152,88,32
L_t1_pad2:
s_cbranch_execz L_t1_pad6
RV 108,65,8448
CV 38,28,29
PV 156,92,32
EX 30
QK 24,0,176,52
v_exp_f32_e64 v31, v31
QK 24,4,180,24
RV 110,65,12544
CV 39,30,31
QK 24,8,184,24
EX 16
QK 24,12,188,24
RV 112,64,8704
v_smfmac_f32_16x16x64_bf16 a[240:243], v[56:59], v[32:39], v71
RV 114,64,12800
QK 28,16,176,52
v_exp_f32_e64 v17, v17
QK 28,20,180,28
EX 18
QK 28,24,184,28
RV 116,65,8704
CV 32,16,17
QK 28,28,188,28
v_exp_f32_e64 v19, v19
PV 160,64,36
RV 118,65,12800
CV 33,18,19
PV 164,68,36
EX 20
PV 168,72,36
v_exp_f32_e64 v21, v21
PV 172,76,36
RV 120,64,8960
CV 34,20,21
PV 176,80,36
EX 22
PV 180,84,36
v_exp_f32_e64 v23, v23
PV 184,88,36
RV 122,64,13056
CV 35,22,23
PV 188,92,36
s_waitcnt lgkmcnt(14)
RV 124,65,8960
v_xor_b32 v64, s43, v64
QK 16,32,128,40
v_exp_f32_e64 v24, v24
QK 16,36,132,16
EX 25
QK 16,40,136,16
RV 126,65,13056
CV 36,24,25
QK 16,44,140,16
v_exp_f32_e64 v26, v26
QK 20,48,128,40
EX 27
QK 20,52,132,20
v_exp_f32_e64 v28, v28
QK 20,56,136,20
EX 29
QK 20,60,140,20
v_exp_f32_e64 v30, v30
PV 192,64,32
EX 31
PV 196,68,32
v_exp_f32_e64 v16, v16
PV 200,72,32
EX 17
PV 204,76,32
CV 37,26,27
CV 38,28,29
PV 208,80,32
s_waitcnt vmcnt(8) lgkmcnt(0)
s_barrier
PV 212,84,32
CV 39,30,31
v_xor_b32_e64 v65, s43, v65
s_mov_b32 s56, 3
L_t1_loop0:
PV 216,88,32
s_xor_b32 s41, s41, s43
EX 18
PV 220,92,32
s_xor_b32 s42, s41, 0xc000
RK 0,60,0
QK 24,32,144,44
s_add_u32 s40, s40, s58
EX 19
QK 24,36,148,24
s_add_u32 m0, s42, 0x0
RK 4,61,0
QK 24,40,152,24
buffer_load_dwordx4 v66, s[16:19], s40 offen lds
QK 24,44,156,24
s_mov_b32 s58, s59
RK 8,62,0
v_smfmac_f32_16x16x64_bf16 a[244:247], v[56:59], v[32:39], v71
s_mov_b32 s59, 0x20000
s_xor_b32 s43, s43, 0xc000
CV 32,16,17
QK 28,48,144,44
RK 12,63,0
CV 33,18,19
QK 28,52,148,28
EX 20
QK 28,56,152,28
EX 21
QK 28,60,156,28
RK 16,60,4096
CV 34,20,21
PV 224,64,36
EX 22
PV 228,68,36
buffer_load_dwordx4 v67, s[16:19], s40 offen offset:1024 lds
PV 232,72,36
RK 20,61,4096
PV 236,76,36
EX 23
PV 240,80,36
RK 24,62,4096
CV 35,22,23
PV 244,84,36
s_add_u32 m0, s42, 0x10000
EX 24
PV 248,88,36
RK 28,63,4096
PV 252,92,36
EX 25
QK 16,32,160,48
RV 64,64,0
CV 36,24,25
QK 16,36,164,16
buffer_load_dwordx4 v68, s[20:23], s40 offen lds
QK 16,40,168,16
EX 26
QK 16,44,172,16
RV 66,64,4096
QK 20,48,160,48
EX 27
QK 20,52,164,20
RV 68,65,0
CV 37,26,27
QK 20,56,168,20
EX 28
QK 20,60,172,20
RV 70,65,4096
PV 128,96,32
EX 29
PV 132,100,32
buffer_load_dwordx4 v69, s[20:23], s40 offen offset:1024 lds
PV 136,104,32
RV 72,64,256
CV 38,28,29
PV 140,108,32
EX 30
PV 144,112,32
RV 74,64,4352
PV 148,116,32
EX 31
PV 152,120,32
RV 76,65,256
CV 39,30,31
PV 156,124,32
EX 16
QK 24,32,176,52
EX 17
QK 24,36,180,24
RV 78,65,4352
QK 24,40,184,24
EX 18
QK 24,44,188,24
RV 80,64,512
v_smfmac_f32_16x16x64_bf16 a[240:243], v[56:59], v[32:39], v71
s_sub_u32 s57, s57, 1
s_cselect_b64 s[58:59], s[60:61], s[58:59]
RV 82,64,4608
QK 28,48,176,52
EX 19
QK 28,52,180,28
CV 32,16,17
CV 33,18,19
QK 28,56,184,28
EX 20
QK 28,60,188,28
RV 84,65,512
PV 160,96,36
EX 21
PV 164,100,36
RV 86,65,4608
CV 34,20,21
PV 168,104,36
EX 22
PV 172,108,36
RV 88,64,768
PV 176,112,36
EX 23
PV 180,116,36
RV 90,64,4864
CV 35,22,23
PV 184,120,36
EX 24
PV 188,124,36
s_waitcnt lgkmcnt(14)
EX 25
QK 16,0,128,40
RV 92,65,768
CV 36,24,25
QK 16,4,132,16
EX 26
QK 16,8,136,16
RV 94,65,4864
QK 16,12,140,16
EX 27
QK 20,16,128,40
EX 28
QK 20,20,132,20
EX 29
QK 20,24,136,20
CV 37,26,27
CV 38,28,29
QK 20,28,140,20
EX 30
PV 192,96,32
EX 31
PV 196,100,32
EX 16
PV 200,104,32
EX 17
PV 204,108,32
CV 39,30,31
PV 208,112,32
s_waitcnt lgkmcnt(0)
EX 18
PV 212,116,32
s_add_u32 s40, s40, s58
PV 216,120,32
s_add_u32 m0, s42, 0x2000
EX 19
PV 220,124,32
s_mov_b32 s58, s59
RK 32,60,8192
QK 24,0,144,44
s_mov_b32 s59, 0x20000
EX 20
QK 24,4,148,24
RK 36,61,8192
QK 24,8,152,24
buffer_load_dwordx4 v66, s[16:19], s40 offen lds
QK 24,12,156,24
RK 40,62,8192
v_smfmac_f32_16x16x64_bf16 a[244:247], v[56:59], v[32:39], v71
s_sub_u32 s57, s57, 1
s_cselect_b64 s[58:59], s[60:61], s[58:59]
CV 32,16,17
QK 28,16,144,44
RK 44,63,8192
CV 33,18,19
QK 28,20,148,28
EX 21
QK 28,24,152,28
RK 48,60,12288
CV 34,20,21
QK 28,28,156,28
EX 22
PV 224,96,36
RK 52,61,12288
v_xor_b32 v60, s43, v60
PV 228,100,36
buffer_load_dwordx4 v67, s[16:19], s40 offen offset:1024 lds
PV 232,104,36
EX 23
PV 236,108,36
RK 56,62,12288
CV 35,22,23
PV 240,112,36
EX 24
PV 244,116,36
s_add_u32 m0, s42, 0x12000
RK 60,63,12288
v_xor_b32 v61, s43, v61
PV 248,120,36
EX 25
PV 252,124,36
RV 96,64,8192
CV 36,24,25
QK 16,0,160,48
EX 26
QK 16,4,164,16
buffer_load_dwordx4 v68, s[20:23], s40 offen lds
QK 16,8,168,16
RV 98,64,12288
v_xor_b32 v62, s43, v62
QK 16,12,172,16
EX 27
QK 20,16,160,48
RV 100,65,8192
CV 37,26,27
QK 20,20,164,20
EX 28
QK 20,24,168,20
RV 102,65,12288
v_xor_b32 v63, s43, v63
QK 20,28,172,20
EX 29
PV 128,64,32
EX 30
PV 132,68,32
buffer_load_dwordx4 v69, s[20:23], s40 offen offset:1024 lds
PV 136,72,32
RV 104,64,8448
CV 38,28,29
PV 140,76,32
EX 31
PV 144,80,32
RV 106,64,12544
CV 39,30,31
PV 148,84,32
EX 16
PV 152,88,32
RV 108,65,8448
PV 156,92,32
EX 17
QK 24,0,176,52
EX 18
QK 24,4,180,24
RV 110,65,12544
QK 24,8,184,24
EX 19
QK 24,12,188,24
RV 112,64,8704
v_smfmac_f32_16x16x64_bf16 a[240:243], v[56:59], v[32:39], v71
RV 114,64,12800
QK 28,16,176,52
CV 32,16,17
CV 33,18,19
QK 28,20,180,28
EX 20
QK 28,24,184,28
EX 21
QK 28,28,188,28
RV 116,65,8704
CV 34,20,21
PV 160,64,36
EX 22
PV 164,68,36
RV 118,65,12800
PV 168,72,36
EX 23
PV 172,76,36
RV 120,64,8960
CV 35,22,23
PV 176,80,36
EX 24
PV 180,84,36
EX 25
PV 184,88,36
RV 122,64,13056
v_xor_b32 v64, s43, v64
PV 188,92,36
s_waitcnt lgkmcnt(14)
RV 124,65,8960
CV 36,24,25
QK 16,32,128,40
EX 26
QK 16,36,132,16
EX 27
QK 16,40,136,16
RV 126,65,13056
CV 37,26,27
QK 16,44,140,16
EX 28
QK 20,48,128,40
EX 29
QK 20,52,132,20
EX 30
QK 20,56,136,20
EX 31
QK 20,60,140,20
CV 38,28,29
CV 39,30,31
PV 192,64,32
EX 16
PV 196,68,32
v_xor_b32 v65, s43, v65
PV 200,72,32
EX 17
PV 204,76,32
PV 208,80,32
s_waitcnt vmcnt(8) lgkmcnt(0)
s_barrier
PV 212,84,32
s_sub_u32 s56, s56, 1
s_cbranch_scc0 L_t1_loop0
PV 216,88,32
s_xor_b32 s41, s41, s43
EX 18
PV 220,92,32
s_xor_b32 s42, s41, 0xc000
RK 0,60,0
QK 24,32,144,44
s_add_u32 s40, s40, s58
EX 19
QK 24,36,148,24
s_add_u32 m0, s42, 0x0
RK 4,61,0
QK 24,40,152,24
buffer_load_dwordx4 v66, s[16:19], s40 offen lds
QK 24,44,156,24
s_add_u32 s52, s45, 0x0
RK 8,62,0
v_smfmac_f32_16x16x64_bf16 a[244:247], v[56:59], v[32:39], v71
s_mov_b32 s58, s59
s_mov_b32 s59, 0x20000
CV 32,16,17
QK 28,48,144,44
s_xor_b32 s43, s43, 0xc000
RK 12,63,0
CV 33,18,19
QK 28,52,148,28
buffer_load_dwordx4 v[80:83], v72, s[32:35], s52 offen nt
QK 28,56,152,28
EX 20
QK 28,60,156,28
RK 16,60,4096
PV 224,64,36
EX 21
PV 228,68,36
buffer_load_dwordx4 v67, s[16:19], s40 offen offset:1024 lds
PV 232,72,36
RK 20,61,4096
CV 34,20,21
PV 236,76,36
EX 22
PV 240,80,36
RK 24,62,4096
PV 244,84,36
s_add_u32 m0, s42, 0x10000
EX 23
PV 248,88,36
RK 28,63,4096
CV 35,22,23
PV 252,92,36
EX 24
QK 16,32,160,48
RV 64,64,0
QK 16,36,164,16
buffer_load_dwordx4 v68, s[20:23], s40 offen lds
QK 16,40,168,16
EX 25
QK 16,44,172,16
RV 66,64,4096
CV 36,24,25
QK 20,48,160,48
EX 26
QK 20,52,164,20
RV 68,65,0
QK 20,56,168,20
EX 27
QK 20,60,172,20
RV 70,65,4096
CV 37,26,27
PV 128,96,32
EX 28
PV 132,100,32
buffer_load_dwordx4 v69, s[20:23], s40 offen offset:1024 lds
PV 136,104,32
RV 72,64,256
PV 140,108,32
EX 29
PV 144,112,32
RV 74,64,4352
CV 38,28,29
PV 148,116,32
buffer_load_dwordx4 v[84:87], v73, s[32:35], s52 offen nt
PV 152,120,32
RV 76,65,256
PV 156,124,32
EX 30
QK 24,32,176,52
EX 31
QK 24,36,180,24
RV 78,65,4352
CV 39,30,31
QK 24,40,184,24
EX 16
QK 24,44,188,24
RV 80,64,512
v_smfmac_f32_16x16x64_bf16 a[240:243], v[56:59], v[32:39], v71
s_sub_u32 s57, s57, 1
s_cselect_b64 s[58:59], s[60:61], s[58:59]
RV 82,64,4608
QK 28,48,176,52
EX 17
QK 28,52,180,28
EX 18
QK 28,56,184,28
RV 84,65,512
CV 32,16,17
QK 28,60,188,28
EX 19
PV 160,96,36
RV 86,65,4608
CV 33,18,19
PV 164,100,36
EX 20
PV 168,104,36
EX 21
PV 172,108,36
RV 88,64,768
CV 34,20,21
PV 176,112,36
EX 22
PV 180,116,36
EX 23
PV 184,120,36
RV 90,64,4864
CV 35,22,23
PV 188,124,36
s_waitcnt lgkmcnt(14)
EX 24
QK 16,0,128,40
RV 92,65,768
QK 16,4,132,16
EX 25
QK 16,8,136,16
buffer_load_dwordx4 v[88:91], v74, s[32:35], s52 offen nt
QK 16,12,140,16
RV 94,65,4864
CV 36,24,25
QK 20,16,128,40
EX 26
QK 20,20,132,20
EX 27
QK 20,24,136,20
EX 28
QK 20,28,140,20
EX 29
PV 192,96,32
CV 37,26,27
CV 38,28,29
PV 196,100,32
EX 30
PV 200,104,32
EX 31
PV 204,108,32
EX 16
PV 208,112,32
s_waitcnt lgkmcnt(0)
EX 17
PV 212,116,32
s_add_u32 s40, s40, s58
EX 18
PV 216,120,32
s_add_u32 m0, s42, 0x2000
RK 32,60,8192
CV 39,30,31
PV 220,124,32
s_mov_b32 s58, s59
EX 19
QK 24,0,144,44
s_mov_b32 s59, 0x20000
EX 20
QK 24,4,148,24
RK 36,61,8192
QK 24,8,152,24
buffer_load_dwordx4 v66, s[16:19], s40 offen lds
QK 24,12,156,24
RK 40,62,8192
v_smfmac_f32_16x16x64_bf16 a[244:247], v[56:59], v[32:39], v71
s_sub_u32 s57, s57, 1
s_cselect_b64 s[58:59], s[60:61], s[58:59]
CV 32,16,17
QK 28,16,144,44
RK 44,63,8192
CV 33,18,19
QK 28,20,148,28
EX 21
QK 28,24,152,28
RK 48,60,12288
CV 34,20,21
QK 28,28,156,28
EX 22
PV 224,96,36
RK 52,61,12288
v_xor_b32 v60, s43, v60
PV 228,100,36
buffer_load_dwordx4 v67, s[16:19], s40 offen offset:1024 lds
PV 232,104,36
L_t1_pad3:
s_cbranch_execz L_t1_pad7
EX 23
PV 236,108,36
RK 56,62,12288
CV 35,22,23
PV 240,112,36
EX 24
PV 244,116,36
buffer_load_dwordx4 v[92:95], v75, s[32:35], s52 offen nt
PV 248,120,36
s_add_u32 m0, s42, 0x12000
RK 60,63,12288
v_xor_b32 v61, s43, v61
PV 252,124,36
RV 96,64,8192
v_xor_b32 v62, s43, v62
QK 16,0,160,48
EX 25
QK 16,4,164,16
buffer_load_dwordx4 v68, s[20:23], s40 offen lds
QK 16,8,168,16
RV 98,64,12288
CV 36,24,25
QK 16,12,172,16
EX 26
QK 20,16,160,48
RV 100,65,8192
v_xor_b32 v63, s43, v63
QK 20,20,164,20
EX 27
QK 20,24,168,20
RV 102,65,12288
CV 37,26,27
QK 20,28,172,20
EX 28
PV 128,64,32
EX 29
PV 132,68,32
buffer_load_dwordx4 v69, s[20:23], s40 offen offset:1024 lds
PV 136,72,32
RV 104,64,8448
CV 38,28,29
PV 140,76,32
EX 30
PV 144,80,32
RV 106,64,12544
PV 148,84,32
EX 31
PV 152,88,32
RV 108,65,8448
CV 39,30,31
PV 156,92,32
EX 16
QK 24,0,176,52
EX 17
QK 24,4,180,24
s_add_u32 s53, s45, 0x10000
RV 110,65,12544
QK 24,8,184,24
EX 18
QK 24,12,188,24
buffer_load_dwordx4 v[96:99], v72, s[32:35], s53 offen nt
v_smfmac_f32_16x16x64_bf16 a[240:243], v[56:59], v[32:39], v71
RV 112,64,8704
QK 28,16,176,52
RV 114,64,12800
CV 32,16,17
QK 28,20,180,28
EX 19
QK 28,24,184,28
RV 116,65,8704
CV 33,18,19
QK 28,28,188,28
EX 20
PV 160,64,36
EX 21
PV 164,68,36
RV 118,65,12800
CV 34,20,21
PV 168,72,36
EX 22
PV 172,76,36
RV 120,64,8960
PV 176,80,36
EX 23
PV 180,84,36
RV 122,64,13056
CV 35,22,23
PV 184,88,36
EX 24
PV 188,92,36
s_waitcnt lgkmcnt(14)
RV 124,65,8960
v_xor_b32 v64, s43, v64
QK 16,32,128,40
EX 25
QK 16,36,132,16
RV 126,65,13056
CV 36,24,25
QK 16,40,136,16
EX 26
QK 16,44,140,16
EX 27
QK 20,48,128,40
CV 37,26,27
v_xor_b32 v65, s43, v65
QK 20,52,132,20
EX 28
QK 20,56,136,20
EX 29
QK 20,60,140,20
EX 30
PV 192,64,32
EX 31
PV 196,68,32
CV 38,28,29
CV 39,30,31
PV 200,72,32
buffer_load_dwordx4 v[100:103], v73, s[32:35], s53 offen nt
PV 204,76,32
EX 16
PV 208,80,32
s_waitcnt vmcnt(14) lgkmcnt(0)
s_barrier
PV 212,84,32
s_add_u32 s40, s40, s58
EX 17
PV 216,88,32
s_xor_b32 s41, s41, s43
EX 18
PV 220,92,32
s_xor_b32 s42, s41, 0xc000
RK 0,60,0
QK 24,32,144,44
s_add_u32 m0, s42, 0x0
EX 19
QK 24,36,148,24
s_mov_b32 s58, s59
RK 4,61,0
QK 24,40,152,24
buffer_load_dwordx4 v66, s[16:19], s40 offen lds
QK 24,44,156,24
s_mov_b32 s59, 0x20000
RK 8,62,0
v_smfmac_f32_16x16x64_bf16 a[244:247], v[56:59], v[32:39], v71
s_sub_u32 s57, s57, 1
s_cselect_b64 s[58:59], s[60:61], s[58:59]
CV 32,16,17
QK 28,48,144,44
s_xor_b32 s43, s43, 0xc000
RK 12,63,0
CV 33,18,19
QK 28,52,148,28
EX 20
QK 28,56,152,28
EX 21
QK 28,60,156,28
RK 16,60,4096
CV 34,20,21
PV 224,64,36
EX 22
PV 228,68,36
buffer_load_dwordx4 v67, s[16:19], s40 offen offset:1024 lds
PV 232,72,36
RK 20,61,4096
PV 236,76,36
EX 23
PV 240,80,36
RK 24,62,4096
CV 35,22,23
PV 244,84,36
s_add_u32 m0, s42, 0x10000
EX 24
PV 248,88,36
RK 28,63,4096
PV 252,92,36
EX 25
QK 16,32,160,48
RV 64,64,0
CV 36,24,25
QK 16,36,164,16
buffer_load_dwordx4 v68, s[20:23], s40 offen lds
QK 16,40,168,16
EX 26
QK 16,44,172,16
RV 66,64,4096
QK 20,48,160,48
EX 27
QK 20,52,164,20
buffer_load_dwordx4 v[104:107], v74, s[32:35], s53 offen nt
QK 20,56,168,20
RV 68,65,0
RV 70,65,4096
QK 20,60,172,20
EX 28
PV 128,96,32
EX 29
PV 132,100,32
buffer_load_dwordx4 v69, s[20:23], s40 offen offset:1024 lds
PV 136,104,32
RV 72,64,256
CV 37,26,27
PV 140,108,32
RV 74,64,4352
CV 38,28,29
PV 144,112,32
EX 30
PV 148,116,32
EX 31
PV 152,120,32
RV 76,65,256
CV 39,30,31
PV 156,124,32
EX 16
QK 24,32,176,52
EX 17
QK 24,36,180,24
RV 78,65,4352
QK 24,40,184,24
EX 18
QK 24,44,188,24
RV 80,64,512
v_smfmac_f32_16x16x64_bf16 a[240:243], v[56:59], v[32:39], v71
RV 82,64,4608
QK 28,48,176,52
EX 19
QK 28,52,180,28
CV 32,16,17
CV 33,18,19
QK 28,56,184,28
EX 20
QK 28,60,188,28
RV 84,65,512
PV 160,96,36
EX 21
PV 164,100,36
RV 86,65,4608
CV 34,20,21
PV 168,104,36
buffer_load_dwordx4 v[108:111], v75, s[32:35], s53 offen nt
PV 172,108,36
RV 88,64,768
PV 176,112,36
EX 22
PV 180,116,36
EX 23
PV 184,120,36
RV 90,64,4864
CV 35,22,23
PV 188,124,36
s_waitcnt lgkmcnt(14)
EX 24
QK 16,0,128,40
RV 92,65,768
QK 16,4,132,16
EX 25
QK 16,8,136,16
RV 94,65,4864
CV 36,24,25
QK 16,12,140,16
EX 26
QK 20,16,128,40
EX 27
QK 20,20,132,20
EX 28
QK 20,24,136,20
EX 29
QK 20,28,140,20
CV 37,26,27
CV 38,28,29
PV 192,96,32
EX 30
PV 196,100,32
EX 31
PV 200,104,32
EX 16
PV 204,108,32
EX 17
PV 208,112,32
s_waitcnt lgkmcnt(0)
EX 18
PV 212,116,32
s_add_u32 s40, s40, s58
CV 39,30,31
PV 216,120,32
s_add_u32 m0, s42, 0x2000
EX 19
PV 220,124,32
s_mov_b32 s58, s59
RK 32,60,8192
QK 24,0,144,44
s_mov_b32 s59, 0x20000
EX 20
QK 24,4,148,24
s_add_u32 s48, s45, 0x20000
RK 36,61,8192
QK 24,8,152,24
buffer_load_dwordx4 v66, s[16:19], s40 offen lds
QK 24,12,156,24
RK 40,62,8192
v_smfmac_f32_16x16x64_bf16 a[244:247], v[56:59], v[32:39], v71
s_sub_u32 s57, s57, 1
s_cselect_b64 s[58:59], s[60:61], s[58:59]
CV 32,16,17
QK 28,16,144,44
RK 44,63,8192
CV 33,18,19
QK 28,20,148,28
buffer_load_dwordx4 v[112:115], v72, s[32:35], s48 offen nt
QK 28,24,152,28
EX 21
QK 28,28,156,28
RK 48,60,12288
CV 34,20,21
PV 224,96,36
RK 52,61,12288
v_xor_b32 v60, s43, v60
PV 228,100,36
buffer_load_dwordx4 v67, s[16:19], s40 offen offset:1024 lds
PV 232,104,36
EX 22
PV 236,108,36
RK 56,62,12288
v_xor_b32 v61, s43, v61
PV 240,112,36
EX 23
PV 244,116,36
s_add_u32 m0, s42, 0x12000
RK 60,63,12288
CV 35,22,23
PV 248,120,36
EX 24
PV 252,124,36
RV 96,64,8192
v_xor_b32 v62, s43, v62
QK 16,0,160,48
EX 25
QK 16,4,164,16
buffer_load_dwordx4 v68, s[20:23], s40 offen lds
QK 16,8,168,16
RV 98,64,12288
CV 36,24,25
QK 16,12,172,16
EX 26
QK 20,16,160,48
RV 100,65,8192
v_xor_b32 v63, s43, v63
QK 20,20,164,20
EX 27
QK 20,24,168,20
RV 102,65,12288
CV 37,26,27
QK 20,28,172,20
EX 28
PV 128,64,32
EX 29
PV 132,68,32
buffer_load_dwordx4 v69, s[20:23], s40 offen offset:1024 lds
PV 136,72,32
RV 104,64,8448
CV 38,28,29
PV 140,76,32
EX 30
PV 144,80,32
RV 106,64,12544
PV 148,84,32
buffer_load_dwordx4 v[116:119], v73, s[32:35], s48 offen nt
PV 152,88,32
RV 108,65,8448
PV 156,92,32
EX 31
QK 24,0,176,52
RV 110,65,12544
CV 39,30,31
QK 24,4,180,24
EX 16
QK 24,8,184,24
EX 17
QK 24,12,188,24
RV 112,64,8704
v_smfmac_f32_16x16x64_bf16 a[240:243], v[56:59], v[32:39], v71
RV 114,64,12800
QK 28,16,176,52
EX 18
QK 28,20,180,28
EX 19
QK 28,24,184,28
RV 116,65,8704
CV 32,16,17
QK 28,28,188,28
EX 20
PV 160,64,36
RV 118,65,12800
CV 33,18,19
PV 164,68,36
EX 21
PV 168,72,36
RV 120,64,8960
CV 34,20,21
PV 172,76,36
EX 22
PV 176,80,36
EX 23
PV 180,84,36
RV 122,64,13056
CV 35,22,23
PV 184,88,36
EX 24
PV 188,92,36
s_waitcnt lgkmcnt(14)
RV 124,65,8960
v_xor_b32 v64, s43, v64
QK 16,32,128,40
EX 25
QK 16,36,132,16
RV 126,65,13056
CV 36,24,25
QK 16,40,136,16
buffer_load_dwordx4 v[120:123], v74, s[32:35], s48 offen nt
QK 16,44,140,16
EX 26
QK 20,48,128,40
EX 27
QK 20,52,132,20
CV 37,26,27
v_xor_b32 v65, s43, v65
QK 20,56,136,20
EX 28
QK 20,60,140,20
EX 29
PV 192,64,32
EX 30
PV 196,68,32
EX 31
PV 200,72,32
CV 38,28,29
CV 39,30,31
PV 204,76,32
EX 16
PV 208,80,32
s_waitcnt vmcnt(15) lgkmcnt(0)
s_barrier
PV 212,84,32
s_add_u32 s40, s40, s58
EX 17
PV 216,88,32
s_xor_b32 s41, s41, s43
EX 18
PV 220,92,32
s_xor_b32 s42, s41, 0xc000
RK 0,60,0
QK 24,32,144,44
s_add_u32 m0, s42, 0x0
EX 19
QK 24,36,148,24
s_mov_b32 s58, s59
RK 4,61,0
QK 24,40,152,24
buffer_load_dwordx4 v66, s[16:19], s40 offen lds
QK 24,44,156,24
s_mov_b32 s59, 0x20000
RK 8,62,0
v_smfmac_f32_16x16x64_bf16 a[244:247], v[56:59], v[32:39], v71
s_sub_u32 s57, s57, 1
s_cselect_b64 s[58:59], s[60:61], s[58:59]
CV 32,16,17
QK 28,48,144,44
s_xor_b32 s43, s43, 0xc000
RK 12,63,0
CV 33,18,19
QK 28,52,148,28
EX 20
QK 28,56,152,28
EX 21
QK 28,60,156,28
RK 16,60,4096
CV 34,20,21
PV 224,64,36
EX 22
PV 228,68,36
buffer_load_dwordx4 v67, s[16:19], s40 offen offset:1024 lds
PV 232,72,36
RK 20,61,4096
PV 236,76,36
EX 23
PV 240,80,36
RK 24,62,4096
CV 35,22,23
PV 244,84,36
buffer_load_dwordx4 v[124:127], v75, s[32:35], s48 offen nt
PV 248,88,36
s_add_u32 m0, s42, 0x10000
RK 28,63,4096
PV 252,92,36
EX 24
QK 16,32,160,48
RV 64,64,0
QK 16,36,164,16
buffer_load_dwordx4 v68, s[20:23], s40 offen lds
QK 16,40,168,16
EX 25
QK 16,44,172,16
RV 66,64,4096
CV 36,24,25
QK 20,48,160,48
EX 26
QK 20,52,164,20
RV 68,65,0
QK 20,56,168,20
EX 27
QK 20,60,172,20
RV 70,65,4096
CV 37,26,27
PV 128,96,32
EX 28
PV 132,100,32
buffer_load_dwordx4 v69, s[20:23], s40 offen offset:1024 lds
PV 136,104,32
RV 72,64,256
PV 140,108,32
EX 29
PV 144,112,32
RV 74,64,4352
CV 38,28,29
PV 148,116,32
EX 30
PV 152,120,32
RV 76,65,256
PV 156,124,32
EX 31
QK 24,32,176,52
RV 78,65,4352
CV 39,30,31
QK 24,36,180,24
EX 16
QK 24,40,184,24
EX 17
QK 24,44,188,24
RV 80,64,512
v_smfmac_f32_16x16x64_bf16 a[240:243], v[56:59], v[32:39], v71
RV 82,64,4608
QK 28,48,176,52
EX 18
QK 28,52,180,28
EX 19
QK 28,56,184,28
RV 84,65,512
CV 32,16,17
QK 28,60,188,28
EX 20
PV 160,96,36
RV 86,65,4608
CV 33,18,19
PV 164,100,36
EX 21
PV 168,104,36
RV 88,64,768
CV 34,20,21
PV 172,108,36
EX 22
PV 176,112,36
EX 23
PV 180,116,36
RV 90,64,4864
CV 35,22,23
PV 184,120,36
EX 24
PV 188,124,36
s_waitcnt lgkmcnt(14)
EX 25
QK 16,0,128,40
RV 92,65,768
CV 36,24,25
QK 16,4,132,16
EX 26
QK 16,8,136,16
RV 94,65,4864
QK 16,12,140,16
EX 27
QK 20,16,128,40
EX 28
QK 20,20,132,20
EX 29
QK 20,24,136,20
CV 37,26,27
CV 38,28,29
QK 20,28,140,20
EX 30
PV 192,96,32
EX 31
PV 196,100,32
L_t1_pad4:
s_cbranch_execz L_t1_go
EX 16
PV 200,104,32
EX 17
PV 204,108,32
EX 18
PV 208,112,32
s_waitcnt lgkmcnt(0)
EX 19
PV 212,116,32
s_add_u32 s40, s40, s58
EX 20
PV 216,120,32
s_add_u32 m0, s42, 0x2000
RK 32,60,8192
CV 39,30,31
PV 220,124,32
s_mov_b32 s58, s59
EX 21
QK 24,0,144,44
s_mov_b32 s59, 0x20000
RK 36,61,8192
v_xor_b32 v60, s43, v60
QK 24,4,148,24
EX 22
QK 24,8,152,24
buffer_load_dwordx4 v66, s[16:19], s40 offen lds
QK 24,12,156,24
RK 40,62,8192
v_xor_b32 v61, s43, v61
v_smfmac_f32_16x16x64_bf16 a[244:247], v[56:59], v[32:39], v71
RK 44,63,8192
QK 28,16,144,44
CV 32,16,17
CV 33,18,19
QK 28,20,148,28
EX 23
QK 28,24,152,28
CV 34,20,21
CV 35,22,23
QK 28,28,156,28
EX 24
PV 224,96,36
v_lshlrev_b32 v0, 16, v80
v_and_b32 v1, s71, v80
PV 228,100,36
v_lshlrev_b32 v2, 16, v81
v_and_b32 v3, s71, v81
PV 232,104,36
v_lshlrev_b32 v4, 16, v82
v_and_b32 v5, s71, v82
PV 236,108,36
v_lshlrev_b32 v6, 16, v83
v_and_b32 v7, s71, v83
PV 240,112,36
buffer_load_dwordx4 v67, s[16:19], s40 offen offset:1024 lds
PV 244,116,36
s_add_u32 m0, s42, 0x12000
EX 25
PV 248,120,36
RV 96,64,8192
v_xor_b32 v62, s43, v62
PV 252,124,36
EX 26
QK 16,0,160,48
RV 98,64,12288
CV 36,24,25
QK 16,4,164,16
buffer_load_dwordx4 v68, s[20:23], s40 offen lds
QK 16,8,168,16
EX 27
QK 16,12,172,16
RV 100,65,8192
CV 37,26,27
QK 20,16,160,48
EX 28
QK 20,20,164,20
EX 29
QK 20,24,168,20
EX 30
QK 20,28,172,20
EX 31
CV 38,28,29
CV 39,30,31
EX 16
v_pk_mul_f32 v[0:1], v[0:1], s[14:15]
v_pk_mul_f32 v[2:3], v[2:3], s[14:15]
v_pk_mul_f32 v[4:5], v[4:5], s[14:15]
v_pk_mul_f32 v[6:7], v[6:7], s[14:15]
CV 80,0,1
CV 81,2,3
CV 82,4,5
CV 83,6,7
ds_write_b128 v15, v[80:83] offset:0
v_lshlrev_b32 v0, 16, v84
v_and_b32 v1, s71, v84
v_lshlrev_b32 v2, 16, v85
v_and_b32 v3, s71, v85
v_lshlrev_b32 v4, 16, v86
v_and_b32 v5, s71, v86
v_lshlrev_b32 v6, 16, v87
v_and_b32 v7, s71, v87
v_pk_mul_f32 v[0:1], v[0:1], s[14:15]
v_pk_mul_f32 v[2:3], v[2:3], s[14:15]
v_pk_mul_f32 v[4:5], v[4:5], s[14:15]
v_pk_mul_f32 v[6:7], v[6:7], s[14:15]
CV 84,0,1
CV 85,2,3
CV 86,4,5
CV 87,6,7
ds_write_b128 v15, v[84:87] offset:544
v_lshlrev_b32 v0, 16, v88
v_and_b32 v1, s71, v88
v_lshlrev_b32 v2, 16, v89
v_and_b32 v3, s71, v89
v_lshlrev_b32 v4, 16, v90
v_and_b32 v5, s71, v90
v_lshlrev_b32 v6, 16, v91
v_and_b32 v7, s71, v91
v_pk_mul_f32 v[0:1], v[0:1], s[14:15]
v_pk_mul_f32 v[2:3], v[2:3], s[14:15]
v_pk_mul_f32 v[4:5], v[4:5], s[14:15]
v_pk_mul_f32 v[6:7], v[6:7], s[14:15]
CV 88,0,1
CV 89,2,3
CV 90,4,5
CV 91,6,7
ds_write_b128 v15, v[88:91] offset:1152
v_lshlrev_b32 v0, 16, v92
v_and_b32 v1, s71, v92
v_lshlrev_b32 v2, 16, v93
v_and_b32 v3, s71, v93
v_lshlrev_b32 v4, 16, v94
v_and_b32 v5, s71, v94
v_lshlrev_b32 v6, 16, v95
v_and_b32 v7, s71, v95
v_pk_mul_f32 v[0:1], v[0:1], s[14:15]
v_pk_mul_f32 v[2:3], v[2:3], s[14:15]
v_pk_mul_f32 v[4:5], v[4:5], s[14:15]
v_pk_mul_f32 v[6:7], v[6:7], s[14:15]
CV 92,0,1
CV 93,2,3
CV 94,4,5
CV 95,6,7
v_smfmac_f32_16x16x64_bf16 a[240:243], v[56:59], v[32:39], v71
s_add_u32 s49, s44, 0x0
RV 102,65,12288
PV 128,64,32
ds_write_b128 v15, v[92:95] offset:1696
PV 132,68,32
RK 192,14,0
RK 196,14,64
PV 136,72,32
s_waitcnt vmcnt(22)
RK 200,14,128
v_lshlrev_b32 v0, 16, v96
PV 140,76,32
v_accvgpr_read_b32 v76, a240
v_accvgpr_read_b32 v40, a241
RK 204,14,192
v_add_f32 v76, v76, v40
v_accvgpr_read_b32 v77, a242
v_cmp_nge_f32 s[4:5], s55, v76
v_rcp_f32 v76, v76
v_accvgpr_read_b32 v44, a243
PM 128,76,0
v_add_f32 v77, v77, v44
PM 130,76,0
PV 144,80,32
CV 128,128,129
v_and_b32 v1, s71, v96
v_cmp_nge_f32 s[6:7], s55, v77
v_rcp_f32 v77, v77
CV 129,130,131
PM 132,76,0
PM 134,76,0
PV 148,84,32
ds_write_b64 v70, v[128:129] offset:0
CV 132,132,133
CV 133,134,135
PM 136,76,0
PM 138,76,0
PV 152,88,32
ds_write_b64 v70, v[132:133] offset:32
CV 136,136,137
CV 137,138,139
PM 140,76,0
PM 142,76,0
PV 156,92,32
ds_write_b64 v70, v[136:137] offset:64
CV 140,140,141
CV 141,142,143
PM 144,76,0
PM 146,76,0
QK 24,0,176,52
ds_write_b64 v70, v[140:141] offset:96
CV 144,144,145
CV 145,146,147
PM 148,76,0
PM 150,76,0
QK 24,4,180,24
ds_write_b64 v70, v[144:145] offset:128
CV 148,148,149
CV 149,150,151
PM 152,76,0
PM 154,76,0
QK 24,8,184,24
ds_write_b64 v70, v[148:149] offset:160
CV 152,152,153
CV 153,154,155
PM 156,76,0
PM 158,76,0
QK 24,12,188,24
ds_write_b64 v70, v[152:153] offset:192
CV 156,156,157
CV 157,158,159
QK 28,16,176,52
v_lshlrev_b32 v2, 16, v97
v_and_b32 v3, s71, v97
ds_write_b64 v70, v[156:157] offset:224
QK 28,20,180,28
v_lshlrev_b32 v4, 16, v98
v_and_b32 v5, s71, v98
QK 28,24,184,28
v_lshlrev_b32 v6, 16, v99
v_and_b32 v7, s71, v99
QK 28,28,188,28
s_add_u32 s50, s44, 0x10000
RK 128,15,0
RK 132,15,528
buffer_load_dwordx4 v69, s[20:23], s40 offen offset:1024 lds
RK 136,15,1056
v_pk_mul_f32 v[0:1], v[0:1], s[14:15]
RK 140,15,1584
v_pk_mul_f32 v[2:3], v[2:3], s[14:15]
v_pk_mul_f32 v[4:5], v[4:5], s[14:15]
v_pk_mul_f32 v[6:7], v[6:7], s[14:15]
CV 96,0,1
CV 97,2,3
CV 98,4,5
CV 99,6,7
ds_write_b128 v15, v[96:99] offset:0
s_waitcnt vmcnt(22)
v_lshlrev_b32 v0, 16, v100
v_and_b32 v1, s71, v100
v_lshlrev_b32 v2, 16, v101
v_and_b32 v3, s71, v101
v_lshlrev_b32 v4, 16, v102
v_and_b32 v5, s71, v102
v_lshlrev_b32 v6, 16, v103
v_and_b32_e64 v7, s71, v103
v_pk_mul_f32 v[0:1], v[0:1], s[14:15]
v_pk_mul_f32 v[2:3], v[2:3], s[14:15]
v_pk_mul_f32 v[4:5], v[4:5], s[14:15]
v_pk_mul_f32 v[6:7], v[6:7], s[14:15]
CV 100,0,1
CV 101,2,3
CV 102,4,5
CV 103,6,7
ds_write_b128 v15, v[100:103] offset:544
s_waitcnt lgkmcnt(5)
buffer_store_dwordx4 a[128:131], v72, s[28:31], s49 offen nt
s_waitcnt vmcnt(19)
v_lshlrev_b32 v0, 16, v104
v_and_b32 v1, s71, v104
v_lshlrev_b32 v2, 16, v105
v_and_b32 v3, s71, v105
v_lshlrev_b32 v4, 16, v106
v_and_b32 v5, s71, v106
v_lshlrev_b32 v6, 16, v107
v_and_b32 v7, s71, v107
v_pk_mul_f32 v[0:1], v[0:1], s[14:15]
v_pk_mul_f32 v[2:3], v[2:3], s[14:15]
v_pk_mul_f32 v[4:5], v[4:5], s[14:15]
v_pk_mul_f32 v[6:7], v[6:7], s[14:15]
CV 104,0,1
CV 105,2,3
CV 106,4,5
CV 107,6,7
ds_write_b128 v15, v[104:107] offset:1152
s_waitcnt lgkmcnt(5)
buffer_store_dwordx4 a[132:135], v73, s[28:31], s49 offen nt
s_waitcnt vmcnt(18)
v_lshlrev_b32 v0, 16, v108
v_and_b32 v1, s71, v108
v_lshlrev_b32 v2, 16, v109
v_and_b32 v3, s71, v109
v_lshlrev_b32 v4, 16, v110
v_and_b32 v5, s71, v110
v_lshlrev_b32 v6, 16, v111
v_and_b32 v7, s71, v111
v_pk_mul_f32 v[0:1], v[0:1], s[14:15]
v_pk_mul_f32 v[2:3], v[2:3], s[14:15]
v_pk_mul_f32 v[4:5], v[4:5], s[14:15]
v_pk_mul_f32 v[6:7], v[6:7], s[14:15]
CV 108,0,1
CV 109,2,3
CV 110,4,5
CV 111,6,7
PV 160,64,36
ds_write_b128 v15, v[108:111] offset:1696
PV 164,68,36
RK 208,14,0
RK 212,14,64
PV 168,72,36
s_waitcnt vmcnt(16)
RK 216,14,128
v_lshlrev_b32 v0, 16, v112
PV 172,76,36
s_waitcnt lgkmcnt(8)
RK 220,14,192
v_and_b32 v1, s71, v112
buffer_store_dwordx4 a[136:139], v74, s[28:31], s49 offen nt
PM 160,76,1
PM 162,76,1
PV 176,80,36
CV 160,160,161
v_lshlrev_b32 v2, 16, v113
CV 161,162,163
v_and_b32 v3, s71, v113
v_lshlrev_b32 v4, 16, v114
PM 164,76,1
PM 166,76,1
PV 180,84,36
s_waitcnt lgkmcnt(8)
ds_write_b64 v70, v[160:161] offset:0
buffer_store_dwordx4 a[140:143], v75, s[28:31], s49 offen nt
CV 164,164,165
CV 165,166,167
PM 168,76,1
PM 170,76,1
PV 184,88,36
ds_write_b64 v70, v[164:165] offset:32
CV 168,168,169
CV 169,170,171
PM 172,76,1
PM 174,76,1
PV 188,92,36
ds_write_b64 v70, v[168:169] offset:64
CV 172,172,173
CV 173,174,175
PM 176,76,1
PM 178,76,1
EX 17
EX 18
v_exp_f32_e64 v19, v19
CV 32,16,17
CV 33,18,19
QZ 16,32,192
ds_write_b64 v70, v[172:173] offset:96
CV 176,176,177
CV 177,178,179
PM 180,76,1
PM 182,76,1
QK 16,36,196,16
ds_write_b64 v70, v[176:177] offset:128
CV 180,180,181
CV 181,182,183
PM 184,76,1
PM 186,76,1
QK 16,40,200,16
ds_write_b64 v70, v[180:181] offset:160
CV 184,184,185
CV 185,186,187
PM 188,76,1
PM 190,76,1
QK 16,44,204,16
ds_write_b64 v70, v[184:185] offset:192
v_and_b32 v5, s71, v114
v_lshlrev_b32 v6, 16, v115
v_and_b32_e64 v7, s71, v115
CV 188,188,189
CV 189,190,191
v_pk_mul_f32 v[0:1], v[0:1], s[14:15]
v_pk_mul_f32 v[2:3], v[2:3], s[14:15]
v_max3_f32 v8, v16, v17, v18
v_pk_mul_f32 v[4:5], v[4:5], s[14:15]
v_max_f32 v8, v8, v19
v_pk_mul_f32 v[6:7], v[6:7], s[14:15]
v_mov_b32 v9, v8
CV 112,0,1
CV 113,2,3
v_permlane32_swap_b32 v8, v9
v_max_f32 v8, v8, v9
CV 114,4,5
v_mov_b32 v9, v8
CV 115,6,7
s_waitcnt vmcnt(14)
v_lshlrev_b32 v0, 16, v116
v_permlane16_swap_b32 v8, v9
v_min_f32_e64 v40, -v8, -v9
v_and_b32 v1, s71, v116
v_lshlrev_b32 v2, 16, v117
v_and_b32 v3, s71, v117
v_lshlrev_b32 v4, 16, v118
v_and_b32 v5, s71, v118
v_lshlrev_b32 v6, 16, v119
v_and_b32_e64 v7, s71, v119
v_pk_mul_f32 v[0:1], v[0:1], s[14:15]
v_pk_mul_f32 v[2:3], v[2:3], s[14:15]
v_pk_mul_f32 v[4:5], v[4:5], s[14:15]
v_pk_mul_f32 v[6:7], v[6:7], s[14:15]
CV 116,0,1
CV 117,2,3
CV 118,4,5
CV 119,6,7
s_waitcnt vmcnt(13)
v_lshlrev_b32 v0, 16, v120
v_and_b32 v1, s71, v120
v_lshlrev_b32 v2, 16, v121
v_and_b32 v3, s71, v121
v_lshlrev_b32 v4, 16, v122
v_and_b32 v5, s71, v122
v_lshlrev_b32 v6, 16, v123
v_and_b32_e64 v7, s71, v123
v_pk_mul_f32 v[0:1], v[0:1], s[14:15]
v_pk_mul_f32 v[2:3], v[2:3], s[14:15]
v_pk_mul_f32 v[4:5], v[4:5], s[14:15]
v_pk_mul_f32 v[6:7], v[6:7], s[14:15]
CV 120,0,1
CV 121,2,3
CV 122,4,5
CV 123,6,7
s_waitcnt vmcnt(10)
v_lshlrev_b32 v0, 16, v124
v_and_b32 v1, s71, v124
v_lshlrev_b32 v2, 16, v125
v_and_b32 v3, s71, v125
v_lshlrev_b32 v4, 16, v126
v_and_b32 v5, s71, v126
v_lshlrev_b32 v6, 16, v127
v_and_b32_e64 v7, s71, v127
v_pk_mul_f32 v[0:1], v[0:1], s[14:15]
v_pk_mul_f32 v[2:3], v[2:3], s[14:15]
v_pk_mul_f32 v[4:5], v[4:5], s[14:15]
v_pk_mul_f32 v[6:7], v[6:7], s[14:15]
CV 124,0,1
CV 125,2,3
CV 126,4,5
CV 127,6,7
EX 20
EX 21
EX 22
EX 23
EX 24
EX 25
EX 26
EX 27
EX 28
EX 29
EX 30
EX 31
CV 34,20,21
CV 35,22,23
CV 36,24,25
CV 37,26,27
CV 38,28,29
CV 39,30,31
v_xor_b32 v63, s43, v63
v_add_f32 v8, v40, v12
v_smfmac_f32_16x16x64_bf16 a[244:247], v[56:59], v[32:39], v71
s_add_u32 s51, s44, 0x20000
RV 104,64,8448
ds_write_b64 v70, v[188:189] offset:224
PV 192,64,32
RK 144,15,0
RK 148,15,528
PV 196,68,32
RK 152,15,1056
v_add_f32 v16, v8, v16
PV 200,72,32
RK 156,15,1584
v_add_f32 v9, v40, v13
PV 204,76,32
ds_write_b128 v15, v[112:115] offset:0
v_accvgpr_read_b32 v78, a244
v_accvgpr_read_b32 v48, a245
v_accvgpr_read_b32 v79, a246
v_add_f32 v78, v78, v48
v_accvgpr_read_b32 v52, a247
v_cmp_nge_f32 s[8:9], s55, v78
ds_write_b128 v15, v[116:119] offset:544
v_rcp_f32 v78, v78
v_add_f32 v79, v79, v52
PM 192,78,0
v_cmp_nge_f32 s[10:11], s55, v79
v_rcp_f32_e64 v79, v79
ds_write_b128 v15, v[120:123] offset:1152
s_waitcnt lgkmcnt(6)
buffer_store_dwordx4 a[144:147], v72, s[28:31], s50 offen nt
PM 194,78,0
PV 208,80,32
s_add_u32 s40, s40, 0x20000
RV 106,64,12544
CV 192,192,193
ds_write_b128 v15, v[124:127] offset:1696
RK 224,14,0
RK 228,14,64
s_waitcnt lgkmcnt(9)
buffer_store_dwordx4 a[148:151], v73, s[28:31], s50 offen nt
RK 232,14,128
CV 193,194,195
RK 236,14,192
PM 196,78,0
PM 198,78,0
PV 212,84,32
s_waitcnt lgkmcnt(10)
ds_write_b64 v70, v[192:193] offset:0
buffer_store_dwordx4 a[152:155], v74, s[28:31], s50 offen nt
CV 196,196,197
CV 197,198,199
PM 200,78,0
PM 202,78,0
PV 216,88,32
s_xor_b32 s41, s41, s43
ds_write_b64 v70, v[196:197] offset:32
CV 200,200,201
CV 201,202,203
PM 204,78,0
PM 206,78,0
PV 220,92,32
s_waitcnt lgkmcnt(11)
s_xor_b32 s42, s41, 0xc000
ds_write_b64 v70, v[200:201] offset:64
buffer_store_dwordx4 a[156:159], v75, s[28:31], s50 offen nt
CV 204,204,205
CV 205,206,207
PM 208,78,0
PM 210,78,0
QZ 24,32,208
s_add_u32 m0, s42, 0x0
ds_write_b64 v70, v[204:205] offset:96
CV 208,208,209
CV 209,210,211
PM 212,78,0
PM 214,78,0
QK 24,36,212,24
ds_write_b64 v70, v[208:209] offset:128
CV 212,212,213
CV 213,214,215
PM 216,78,0
PM 218,78,0
QK 24,40,216,24
ds_write_b64 v70, v[212:213] offset:160
CV 216,216,217
CV 217,218,219
PM 220,78,0
PM 222,78,0
QK 24,44,220,24
s_add_u32 s52, s44, 0x30000
ds_write_b64 v70, v[216:217] offset:192
CV 220,220,221
CV 221,222,223
PV 224,64,36
RV 108,65,8448
RV 110,65,12544
ds_write_b64 v70, v[220:221] offset:224
PV 228,68,36
RK 160,15,0
RK 164,15,528
PV 232,72,36
RK 168,15,1056
v_max3_f32 v10, v24, v25, v26
PV 236,76,36
RK 172,15,1584
v_max_f32 v10, v10, v27
v_add_f32 v17, v9, v17
v_mov_b32 v11, v10
v_add_f32 v18, v9, v18
PM 224,78,1
v_permlane32_swap_b32 v10, v11
v_max_f32 v10, v10, v11
PM 226,78,1
PV 240,80,36
RV 112,64,8704
CV 224,224,225
v_mov_b32 v11, v10
CV 225,226,227
v_add_f32 v19, v9, v19
v_permlane16_swap_b32 v10, v11
v_min_f32_e64 v44, -v10, -v11
PM 228,78,1
PM 230,78,1
PV 244,84,36
s_waitcnt lgkmcnt(4)
ds_write_b64 v70, v[224:225] offset:0
buffer_store_dwordx4 a[160:163], v72, s[28:31], s51 offen nt
CV 228,228,229
CV 229,230,231
PM 232,78,1
PM 234,78,1
PV 248,88,36
ds_write_b64 v70, v[228:229] offset:32
CV 232,232,233
CV 233,234,235
PM 236,78,1
PM 238,78,1
PV 252,92,36
s_waitcnt lgkmcnt(5)
ds_write_b64 v70, v[232:233] offset:64
buffer_store_dwordx4 a[164:167], v73, s[28:31], s51 offen nt
CV 236,236,237
CV 237,238,239
PM 240,78,1
PM 242,78,1
EX 16
L_t1_pad5:
s_cbranch_execz L_t1_go
EX 17
EX 18
EX 19
CV 32,16,17
CV 33,18,19
v_mov_b32 v34, 0
v_mov_b32 v35, 0
CV 240,240,241
CV 241,242,243
v_smfmac_f32_16x16x64_bf16 a[248:251], v[56:59], v[32:39], v71
RV 114,64,12800
ds_write_b64 v70, v[236:237] offset:96
s_waitcnt lgkmcnt(7)
buffer_store_dwordx4 a[168:171], v74, s[28:31], s51 offen nt
PM 244,78,1
PM 246,78,1
QZ 16,32,224
ds_write_b64 v70, v[240:241] offset:128
CV 244,244,245
CV 245,246,247
PM 248,78,1
PM 250,78,1
QK 16,36,228,16
s_waitcnt lgkmcnt(7)
ds_write_b64 v70, v[244:245] offset:160
buffer_store_dwordx4 a[172:175], v75, s[28:31], s51 offen nt
CV 248,248,249
CV 249,250,251
PM 252,78,1
PM 254,78,1
QK 16,40,232,16
ds_write_b64 v70, v[248:249] offset:192
CV 252,252,253
CV 253,254,255
QK 16,44,236,16
RV 116,65,8704
RV 118,65,12800
ds_write_b64 v70, v[252:253] offset:224
PZ 128,96,32
RK 176,15,0
RK 180,15,528
PZ 132,100,32
RK 184,15,1056
v_max3_f32 v8, v16, v17, v18
PZ 136,104,32
RK 188,15,1584
v_max_f32 v8, v8, v19
PZ 140,108,32
s_waitcnt lgkmcnt(11)
RV 120,64,8960
v_mov_b32 v9, v8
PZ 144,112,32
s_waitcnt lgkmcnt(6)
RV 122,64,13056
v_xor_b32 v64, s43, v64
PZ 148,116,32
RV 124,65,8960
v_accvgpr_write_b32 a250, 0
RV 126,65,13056
v_xor_b32 v65, s43, v65
v_accvgpr_write_b32 a251, 0
v_add_f32 v10, v44, v12
v_add_f32 v11, v44, v13
v_add_f32 v24, v10, v24
v_add_f32 v25, v11, v25
v_add_f32 v26, v11, v26
v_add_f32 v27, v11, v27
v_mov_b32 v41, v40
v_mov_b32 v42, v40
v_mov_b32 v43, v40
v_mov_b32 v38, 0
v_mov_b32 v39, 0
v_mov_b32 v45, v44
v_mov_b32 v46, v44
s_waitcnt lgkmcnt(2)
PZ 152,120,32
buffer_load_dwordx4 v66, s[16:19], s40 offen lds
v_mov_b32 v47, v44
v_accvgpr_write_b32 a240, 0
s_waitcnt lgkmcnt(0)
PZ 156,124,32
s_waitcnt vmcnt(63) lgkmcnt(0)
s_barrier
v_permlane32_swap_b32 v8, v9
v_max_f32 v8, v8, v9
RK 0,60,0
v_mov_b32 v9, v8
EX 24
EX 25
v_permlane16_swap_b32 v8, v9
v_min_f32_e64 v48, -v8, -v9
EX 26
v_exp_f32_e64 v27, v27
CV 36,24,25
CV 37,26,27
RK 4,61,0
RK 8,62,0
v_add_f32 v8, v48, v12
v_add_f32 v9, v48, v13
RK 12,63,0
s_waitcnt lgkmcnt(3)
QK 24,0,192,40
s_xor_b32 s43, s43, 0xc000
RK 16,60,4096
v_add_f32 v16, v8, v16
v_add_f32 v17, v9, v17
RK 20,61,4096
v_add_f32 v18, v9, v18
RK 24,62,4096
v_add_f32 v19, v9, v19
RK 28,63,4096
v_mov_b32 v34, 0
s_waitcnt lgkmcnt(6)
QK 24,4,196,24
s_waitcnt lgkmcnt(5)
RV 64,64,0
v_mov_b32 v35, 0
QK 24,8,200,24
s_waitcnt lgkmcnt(5)
buffer_load_dwordx4 v67, s[16:19], s40 offen offset:1024 lds
QK 24,12,204,24
s_waitcnt lgkmcnt(4)
s_add_u32 m0, s42, 0x10000
RV 66,64,4096
RV 68,65,0
QK 28,16,192,40
s_waitcnt lgkmcnt(5)
RV 70,65,4096
v_mov_b32 v49, v48
QK 28,20,196,28
s_waitcnt lgkmcnt(5)
RV 72,64,256
RV 74,64,4352
QK 28,24,200,28
s_waitcnt lgkmcnt(6)
RV 76,65,256
v_mov_b32 v50, v48
QK 28,28,204,28
buffer_store_dwordx4 a[176:179], v72, s[28:31], s52 offen nt
PZ 160,96,36
RV 78,65,4352
RV 80,64,512
PZ 164,100,36
RV 82,64,4608
v_mov_b32 v51, v48
PZ 168,104,36
RV 84,65,512
RV 86,65,4608
PZ 172,108,36
buffer_load_dwordx4 v68, s[20:23], s40 offen lds
PZ 176,112,36
RV 88,64,768
RV 90,64,4864
PZ 180,116,36
RV 92,65,768
v_accvgpr_write_b32 a241, 0
PZ 184,120,36
RV 94,65,4864
v_accvgpr_write_b32 a242, 0
PZ 188,124,36
buffer_store_dwordx4 a[180:183], v73, s[28:31], s52 offen nt
EX 16
EX 17
EX 18
EX 19
CV 32,16,17
CV 33,18,19
v_accvgpr_write_b32 a243, 0
s_nop 0
v_smfmac_f32_16x16x64_bf16 a[252:255], v[56:59], v[32:39], v71
RK 32,60,8192
QK 16,0,208,44
s_waitcnt lgkmcnt(1)
RK 36,61,8192
QK 16,4,212,16
buffer_store_dwordx4 a[184:187], v74, s[28:31], s52 offen nt
QK 16,8,216,16
RK 40,62,8192
RK 44,63,8192
QK 16,12,220,16
EX 24
QK 20,16,208,44
EX 25
QK 20,20,212,20
buffer_store_dwordx4 a[188:191], v75, s[28:31], s52 offen nt
QK 20,24,216,20
RK 48,60,12288
RK 52,61,12288
QK 20,28,220,20
RK 56,62,12288
CV 36,24,25
PZ 192,96,32
EX 26
PZ 196,100,32
buffer_load_dwordx4 v69, s[20:23], s40 offen offset:1024 lds
PZ 200,104,32
s_add_u32 s40, s40, 0x20000
RK 60,63,12288
s_add_u32 m0, s42, 0x2000
PZ 204,108,32
RV 96,64,8192
v_xor_b32 v60, s43, v60
PZ 208,112,32
RV 98,64,12288
v_xor_b32 v61, s43, v61
PZ 212,116,32
buffer_load_dwordx4 v66, s[16:19], s40 offen lds
PZ 216,120,32
EX 27
PZ 220,124,32
RV 100,65,8192
CV 37,26,27
QK 24,0,224,48
RV 102,65,12288
v_xor_b32 v62, s43, v62
QK 24,4,228,24
buffer_load_dwordx4 v67, s[16:19], s40 offen offset:1024 lds
QK 24,8,232,24
s_add_u32 m0, s42, 0x12000
EX 28
QK 24,12,236,24
EX 29
EX 30
EX 31
CV 38,28,29
CV 39,30,31
QK 28,16,224,48
RV 104,64,8448
RV 106,64,12544
QK 28,20,228,28
buffer_load_dwordx4 v68, s[20:23], s40 offen lds
QK 28,24,232,28
RV 108,65,8448
RV 110,65,12544
QK 28,28,236,28
EX 16
PV 128,64,36
RV 112,64,8704
v_xor_b32 v63, s43, v63
PV 132,68,36
EX 17
PV 136,72,36
RV 114,64,12800
CV 32,16,17
PV 140,76,36
EX 18
PV 144,80,36
RV 116,65,8704
RV 118,65,12800
PV 148,84,36
buffer_load_dwordx4 v69, s[20:23], s40 offen offset:1024 lds
PV 152,88,36
EX 19
PV 156,92,36
EX 20
EX 21
EX 22
EX 23
CV 33,18,19
CV 34,20,21
CV 35,22,23
EX 24
s_nop 0
v_smfmac_f32_16x16x64_bf16 a[240:243], v[56:59], v[32:39], v71
s_waitcnt lgkmcnt(12)
RV 120,64,8960
QK 16,32,192,40
RV 122,64,13056
RV 124,65,8960
QK 16,36,196,16
EX 25
QK 16,40,200,16
RV 126,65,13056
CV 36,24,25
QK 16,44,204,16
EX 26
QK 20,48,192,40
EX 27
QK 20,52,196,20
EX 28
QK 20,56,200,20
EX 29
QK 20,60,204,20
EX 30
PV 160,64,32
EX 31
PV 164,68,32
CV 37,26,27
CV 38,28,29
PV 168,72,32
CV 39,30,31
v_xor_b32 v64, s43, v64
PV 172,76,32
v_xor_b32 v65, s43, v65
PV 176,80,32
s_waitcnt vmcnt(24) lgkmcnt(0)
s_barrier
PV 180,84,32
s_mov_b32 s56, 2
L_t1_loop1:
PV 184,88,32
s_xor_b32 s41, s41, s43
EX 16
PV 188,92,32
s_xor_b32 s42, s41, 0xc000
RK 0,60,0
RK 4,61,0
QK 24,32,208,44
s_add_u32 s40, s40, 0x20000
EX 17
QK 24,36,212,24
s_add_u32 m0, s42, 0x0
RK 8,62,0
CV 32,16,17
QK 24,40,216,24
buffer_load_dwordx4 v66, s[16:19], s40 offen lds
QK 24,44,220,24
s_xor_b32 s43, s43, 0xc000
EX 18
QK 28,48,208,44
RK 12,63,0
RK 16,60,4096
QK 28,52,212,28
EX 19
QK 28,56,216,28
RK 20,61,4096
CV 33,18,19
QK 28,60,220,28
EX 20
PV 192,64,36
EX 21
PV 196,68,36
RK 24,62,4096
RK 28,63,4096
PV 200,72,36
EX 22
PV 204,76,36
buffer_load_dwordx4 v67, s[16:19], s40 offen offset:1024 lds
PV 208,80,36
EX 23
PV 212,84,36
CV 34,20,21
CV 35,22,23
PV 216,88,36
RV 64,64,0
RV 66,64,4096
PV 220,92,36
EX 24
v_smfmac_f32_16x16x64_bf16 a[248:251], v[56:59], v[32:39], v71
s_add_u32 m0, s42, 0x10000
RV 68,65,0
QK 16,32,224,48
EX 25
QK 16,36,228,16
RV 70,65,4096
RV 72,64,256
QK 16,40,232,16
RV 74,64,4352
CV 36,24,25
QK 16,44,236,16
buffer_load_dwordx4 v68, s[20:23], s40 offen lds
QK 20,48,224,48
EX 26
QK 20,52,228,20
EX 27
QK 20,56,232,20
RV 76,65,256
RV 78,65,4352
QK 20,60,236,20
RV 80,64,512
CV 37,26,27
PV 128,96,32
EX 28
PV 132,100,32
EX 29
PV 136,104,32
RV 82,64,4608
CV 38,28,29
PV 140,108,32
EX 30
PV 144,112,32
buffer_load_dwordx4 v69, s[20:23], s40 offen offset:1024 lds
PV 148,116,32
RV 84,65,512
RV 86,65,4608
PV 152,120,32
EX 31
PV 156,124,32
s_waitcnt lgkmcnt(12)
RV 88,64,768
CV 39,30,31
QK 24,0,192,40
EX 16
QK 24,4,196,24
RV 90,64,4864
RV 92,65,768
QK 24,8,200,24
EX 17
QK 24,12,204,24
RV 94,65,4864
CV 32,16,17
QK 28,16,192,40
EX 18
QK 28,20,196,28
EX 19
QK 28,24,200,28
EX 20
QK 28,28,204,28
EX 21
PV 160,96,36
EX 22
PV 164,100,36
EX 23
PV 168,104,36
CV 33,18,19
CV 34,20,21
PV 172,108,36
EX 24
PV 176,112,36
EX 25
PV 180,116,36
s_waitcnt lgkmcnt(0)
EX 26
PV 184,120,36
s_add_u32 s40, s40, 0x20000
CV 35,22,23
PV 188,124,36
s_add_u32 m0, s42, 0x2000
EX 27
v_smfmac_f32_16x16x64_bf16 a[252:255], v[56:59], v[32:39], v71
RK 32,60,8192
QK 16,0,208,44
RK 36,61,8192
CV 36,24,25
QK 16,4,212,16
RK 40,62,8192
CV 37,26,27
QK 16,8,216,16
buffer_load_dwordx4 v66, s[16:19], s40 offen lds
QK 16,12,220,16
EX 28
QK 20,16,208,44
RK 44,63,8192
RK 48,60,12288
QK 20,20,212,20
EX 29
QK 20,24,216,20
RK 52,61,12288
CV 38,28,29
QK 20,28,220,20
RK 56,62,12288
v_xor_b32 v60, s43, v60
PV 192,96,32
EX 30
PV 196,100,32
RK 60,63,12288
v_xor_b32 v61, s43, v61
PV 200,104,32
EX 31
PV 204,108,32
buffer_load_dwordx4 v67, s[16:19], s40 offen offset:1024 lds
PV 208,112,32
RV 96,64,8192
RV 98,64,12288
PV 212,116,32
CV 39,30,31
v_xor_b32 v62, s43, v62
PV 216,120,32
RV 100,65,8192
v_xor_b32 v63, s43, v63
PV 220,124,32
EX 16
QK 24,0,224,48
s_add_u32 m0, s42, 0x12000
EX 17
QK 24,4,228,24
RV 102,65,12288
RV 104,64,8448
QK 24,8,232,24
EX 18
QK 24,12,236,24
RV 106,64,12544
CV 32,16,17
QK 28,16,224,48
buffer_load_dwordx4 v68, s[20:23], s40 offen lds
QK 28,20,228,28
EX 19
QK 28,24,232,28
RV 108,65,8448
RV 110,65,12544
QK 28,28,236,28
EX 20
PV 128,64,36
RV 112,64,8704
CV 33,18,19
PV 132,68,36
EX 21
PV 136,72,36
RV 114,64,12800
CV 34,20,21
PV 140,76,36
EX 22
PV 144,80,36
EX 23
PV 148,84,36
buffer_load_dwordx4 v69, s[20:23], s40 offen offset:1024 lds
PV 152,88,36
RV 116,65,8704
CV 35,22,23
PV 156,92,36
RV 118,65,12800
RV 120,64,8960
v_smfmac_f32_16x16x64_bf16 a[240:243], v[56:59], v[32:39], v71
s_waitcnt lgkmcnt(13)
RV 122,64,13056
QK 16,32,192,40
RV 124,65,8960
v_xor_b32 v64, s43, v64
QK 16,36,196,16
EX 24
QK 16,40,200,16
EX 25
QK 16,44,204,16
RV 126,65,13056
CV 36,24,25
QK 20,48,192,40
EX 26
QK 20,52,196,20
EX 27
QK 20,56,200,20
CV 37,26,27
v_xor_b32 v65, s43, v65
QK 20,60,204,20
EX 28
PV 160,64,32
EX 29
PV 164,68,32
EX 30
PV 168,72,32
EX 31
PV 172,76,32
CV 38,28,29
CV 39,30,31
PV 176,80,32
s_waitcnt vmcnt(8) lgkmcnt(0)
s_barrier
PV 180,84,32
s_sub_u32 s56, s56, 1
s_cbranch_scc0 L_t1_loop1
PV 184,88,32
s_xor_b32 s41, s41, s43
EX 16
PV 188,92,32
s_xor_b32 s43, s43, 0xc000
RK 0,60,0
RK 4,61,0
QK 24,32,208,44
s_xor_b32 s42, s41, 0xc000
EX 17
QK 24,36,212,24
RK 8,62,0
CV 32,16,17
QK 24,40,216,24
EX 18
QK 24,44,220,24
EX 19
QK 28,48,208,44
RK 12,63,0
RK 16,60,4096
QK 28,52,212,28
EX 20
QK 28,56,216,28
RK 20,61,4096
CV 33,18,19
QK 28,60,220,28
EX 21
PV 192,64,36
RK 24,62,4096
CV 34,20,21
PV 196,68,36
EX 22
PV 200,72,36
RK 28,63,4096
PV 204,76,36
EX 23
PV 208,80,36
RV 64,64,0
CV 35,22,23
PV 212,84,36
EX 24
PV 216,88,36
RV 66,64,4096
RV 68,65,0
PV 220,92,36
L_t1_pad6:
s_cbranch_execz L_t1_go
EX 25
v_smfmac_f32_16x16x64_bf16 a[248:251], v[56:59], v[32:39], v71
RV 70,65,4096
QK 16,32,224,48
EX 26
QK 16,36,228,16
RV 72,64,256
CV 36,24,25
QK 16,40,232,16
EX 27
QK 16,44,236,16
RV 74,64,4352
CV 37,26,27
QK 20,48,224,48
EX 28
QK 20,52,228,20
RV 76,65,256
QK 20,56,232,20
EX 29
QK 20,60,236,20
RV 78,65,4352
RV 80,64,512
PV 128,96,32
EX 30
PV 132,100,32
RV 82,64,4608
CV 38,28,29
PV 136,104,32
EX 31
PV 140,108,32
RV 84,65,512
CV 39,30,31
PV 144,112,32
EX 16
PV 148,116,32
RV 86,65,4608
PV 152,120,32
EX 17
PV 156,124,32
s_waitcnt lgkmcnt(12)
RV 88,64,768
CV 32,16,17
QK 24,0,192,40
EX 18
QK 24,4,196,24
RV 90,64,4864
RV 92,65,768
QK 24,8,200,24
EX 19
QK 24,12,204,24
RV 94,65,4864
CV 33,18,19
QK 28,16,192,40
EX 20
QK 28,20,196,28
EX 21
QK 28,24,200,28
EX 22
QK 28,28,204,28
EX 23
PV 160,96,36
CV 34,20,21
CV 35,22,23
PV 164,100,36
EX 24
PV 168,104,36
PV 172,108,36
EX 25
PV 176,112,36
PV 180,116,36
s_waitcnt lgkmcnt(0)
EX 26
PV 184,120,36
PV 188,124,36
EX 27
v_smfmac_f32_16x16x64_bf16 a[252:255], v[56:59], v[32:39], v71
RK 32,60,8192
QK 16,0,208,44
RK 36,61,8192
CV 36,24,25
QK 16,4,212,16
RK 40,62,8192
CV 37,26,27
QK 16,8,216,16
EX 28
QK 16,12,220,16
RK 44,63,8192
QK 20,16,208,44
EX 29
QK 20,20,212,20
RK 48,60,12288
CV 38,28,29
QK 20,24,216,20
RK 52,61,12288
v_xor_b32 v60, s43, v60
QK 20,28,220,20
RK 56,62,12288
v_xor_b32 v61, s43, v61
PV 192,96,32
EX 30
PV 196,100,32
RK 60,63,12288
v_xor_b32 v62, s43, v62
PV 200,104,32
EX 31
PV 204,108,32
RV 96,64,8192
CV 39,30,31
PV 208,112,32
RV 98,64,12288
v_xor_b32 v63, s43, v63
PV 212,116,32
EX 16
PV 216,120,32
EX 17
PV 220,124,32
RV 100,65,8192
RV 102,65,12288
QK 24,0,224,48
EX 18
QK 24,4,228,24
RV 104,64,8448
CV 32,16,17
QK 24,8,232,24
EX 19
QK 24,12,236,24
RV 106,64,12544
CV 33,18,19
QK 28,16,224,48
EX 20
QK 28,20,228,28
RV 108,65,8448
QK 28,24,232,28
EX 21
QK 28,28,236,28
RV 110,65,12544
CV 34,20,21
PV 128,64,36
EX 22
PV 132,68,36
RV 112,64,8704
RV 114,64,12800
PV 136,72,36
EX 23
PV 140,76,36
RV 116,65,8704
CV 35,22,23
PV 144,80,36
EX 24
PV 148,84,36
RV 118,65,12800
PV 152,88,36
EX 25
PV 156,92,36
RV 120,64,8960
v_smfmac_f32_16x16x64_bf16 a[240:243], v[56:59], v[32:39], v71
s_waitcnt lgkmcnt(13)
RV 122,64,13056
QK 16,32,192,40
RV 124,65,8960
CV 36,24,25
QK 16,36,196,16
EX 26
QK 16,40,200,16
RV 126,65,13056
v_xor_b32 v64, s43, v64
QK 16,44,204,16
EX 27
QK 20,48,192,40
CV 37,26,27
v_xor_b32 v65, s43, v65
QK 20,52,196,20
EX 28
QK 20,56,200,20
EX 29
QK 20,60,204,20
EX 30
PV 160,64,32
EX 31
PV 164,68,32
CV 38,28,29
CV 39,30,31
PV 168,72,32
EX 16
PV 172,76,32
EX 17
PV 176,80,32
s_waitcnt vmcnt(0) lgkmcnt(0)
s_barrier
PV 180,84,32
EX 18
PV 184,88,32
s_xor_b32 s41, s41, s43
EX 19
PV 188,92,32
s_xor_b32 s42, s41, 0xc000
RK 0,60,0
RK 4,61,0
QK 24,32,208,44
s_xor_b32 s43, s43, 0xc000
EX 20
QK 24,36,212,24
RK 8,62,0
CV 32,16,17
QK 24,40,216,24
EX 21
QK 24,44,220,24
RK 12,63,0
CV 33,18,19
QK 28,48,208,44
RK 16,60,4096
CV 34,20,21
QK 28,52,212,28
EX 22
QK 28,56,216,28
EX 23
QK 28,60,220,28
RK 20,61,4096
CV 35,22,23
PV 192,64,36
RK 24,62,4096
PV 196,68,36
EX 24
PV 200,72,36
RK 28,63,4096
PV 204,76,36
EX 25
PV 208,80,36
RV 64,64,0
PV 212,84,36
EX 26
PV 216,88,36
RV 66,64,4096
RV 68,65,0
PV 220,92,36
EX 27
v_smfmac_f32_16x16x64_bf16 a[248:251], v[56:59], v[32:39], v71
RV 70,65,4096
QK 16,32,224,48
CV 36,24,25
CV 37,26,27
QK 16,36,228,16
EX 28
QK 16,40,232,16
RV 72,64,256
RV 74,64,4352
QK 16,44,236,16
EX 29
QK 20,48,224,48
RV 76,65,256
CV 38,28,29
QK 20,52,228,20
EX 30
QK 20,56,232,20
EX 31
QK 20,60,236,20
RV 78,65,4352
RV 80,64,512
PV 128,96,32
EX 16
PV 132,100,32
RV 82,64,4608
CV 39,30,31
PV 136,104,32
EX 17
PV 140,108,32
RV 84,65,512
PV 144,112,32
EX 18
PV 148,116,32
RV 86,65,4608
PV 152,120,32
EX 19
PV 156,124,32
s_waitcnt lgkmcnt(12)
RV 88,64,768
CV 32,16,17
QK 24,0,192,40
RV 90,64,4864
CV 33,18,19
QK 24,4,196,24
EX 20
QK 24,8,200,24
RV 92,65,768
QK 24,12,204,24
EX 21
QK 28,16,192,40
RV 94,65,4864
CV 34,20,21
QK 28,20,196,28
EX 22
QK 28,24,200,28
EX 23
QK 28,28,204,28
CV 35,22,23
PV 160,96,36
PV 164,100,36
EX 24
PV 168,104,36
PV 172,108,36
EX 25
PV 176,112,36
PV 180,116,36
s_waitcnt lgkmcnt(0)
EX 26
PV 184,120,36
PV 188,124,36
EX 27
v_smfmac_f32_16x16x64_bf16 a[252:255], v[56:59], v[32:39], v71
RK 32,60,8192
QK 16,0,208,44
RK 36,61,8192
CV 36,24,25
QK 16,4,212,16
RK 40,62,8192
CV 37,26,27
QK 16,8,216,16
EX 28
QK 16,12,220,16
RK 44,63,8192
QK 20,16,208,44
EX 29
QK 20,20,212,20
RK 48,60,12288
CV 38,28,29
QK 20,24,216,20
EX 30
QK 20,28,220,20
RK 52,61,12288
RK 56,62,12288
PV 192,96,32
EX 31
PV 196,100,32
RK 60,63,12288
CV 39,30,31
PV 200,104,32
EX 16
PV 204,108,32
EX 17
PV 208,112,32
RV 96,64,8192
RV 98,64,12288
PV 212,116,32
EX 18
PV 216,120,32
EX 19
PV 220,124,32
RV 100,65,8192
RV 102,65,12288
QK 24,0,224,48
EX 20
QK 24,4,228,24
RV 104,64,8448
CV 32,16,17
QK 24,8,232,24
EX 21
QK 24,12,236,24
RV 106,64,12544
CV 33,18,19
QK 28,16,224,48
RV 108,65,8448
CV 34,20,21
QK 28,20,228,28
EX 22
QK 28,24,232,28
EX 23
QK 28,28,236,28
RV 110,65,12544
CV 35,22,23
PV 128,64,36
RV 112,64,8704
PV 132,68,36
EX 24
PV 136,72,36
RV 114,64,12800
PV 140,76,36
EX 25
PV 144,80,36
RV 116,65,8704
RV 118,65,12800
PV 148,84,36
EX 26
PV 152,88,36
RV 120,64,8960
PV 156,92,36
EX 27
v_smfmac_f32_16x16x64_bf16 a[240:243], v[56:59], v[32:39], v71
s_waitcnt lgkmcnt(13)
RV 122,64,13056
QK 16,32,192,40
RV 124,65,8960
CV 36,24,25
QK 16,36,196,16
EX 28
QK 16,40,200,16
RV 126,65,13056
CV 37,26,27
QK 16,44,204,16
EX 29
QK 20,48,192,40
v_accvgpr_read_b32 v76, a242
v_accvgpr_read_b32 v77, a240
QK 20,52,196,20
v_accvgpr_read_b32 v40, a243
CV 38,28,29
QK 20,56,200,20
v_add_f32 v76, v76, v40
QK 20,60,204,20
EX 30
PV 160,64,32
EX 31
PV 164,68,32
EX 16
PV 168,72,32
EX 17
PV 172,76,32
EX 18
PV 176,80,32
s_waitcnt lgkmcnt(0)
EX 19
PV 180,84,32
EX 20
PV 184,88,32
EX 21
PV 188,92,32
CV 39,30,31
CV 32,16,17
QK 24,32,208,44
EX 22
QK 24,36,212,24
EX 23
QK 24,40,216,24
CV 33,18,19
CV 34,20,21
QK 24,44,220,24
CV 35,22,23
QK 28,48,208,44
QK 28,52,212,28
QK 28,56,216,28
s_nop 0
v_accvgpr_read_b32 v44, a241
QK 28,60,220,28
v_add_f32 v77, v77, v44
PV 192,64,36
EX 24
PV 196,68,36
EX 25
PV 200,72,36
EX 26
PV 204,76,36
EX 27
PV 208,80,36
EX 28
PV 212,84,36
EX 29
PV 216,88,36
EX 30
PV 220,92,36
EX 31
v_smfmac_f32_16x16x64_bf16 a[248:251], v[56:59], v[32:39], v71
CV 36,24,25
QK 16,32,224,48
CV 37,26,27
CV 38,28,29
QK 16,36,228,16
CV 39,30,31
s_nop 0
QK 16,40,232,16
s_nop 2
QK 16,44,236,16
v_accvgpr_read_b32 v41, a248
v_accvgpr_read_b32 v42, a249
QK 20,48,224,48
v_add_f32 v76, v76, v41
v_accvgpr_read_b32 v78, a250
QK 20,52,228,20
v_add_f32 v76, v76, v42
v_accvgpr_read_b32 v48, a251
QK 20,56,232,20
v_cmp_nge_f32 s[96:97], s55, v76
v_add_f32 v78, v78, v48
QK 20,60,236,20
s_add_u32 s53, s45, 0x0
v_rcp_f32 v76, v76
PV 128,96,32
EX 16
PV 132,100,32
EX 17
PV 136,104,32
EX 18
PV 140,108,32
EX 19
EX 20
EX 21
PM 128,76,0
PM 130,76,0
PV 144,112,32
CV 128,128,129
CV 129,130,131
EX 22
v_exp_f32_e64 v23, v23
PM 132,76,0
PM 134,76,0
PV 148,116,32
ds_write_b64 v70, v[128:129] offset:0
CV 132,132,133
CV 133,134,135
PM 136,76,0
PM 138,76,0
PV 152,120,32
ds_write_b64 v70, v[132:133] offset:32
CV 136,136,137
CV 137,138,139
PM 140,76,0
PM 142,76,0
PV 156,124,32
ds_write_b64 v70, v[136:137] offset:64
CV 140,140,141
CV 141,142,143
PM 144,76,0
PM 146,76,0
CV 32,16,17
CV 33,18,19
CV 34,20,21
CV 35,22,23
CV 144,144,145
CV 145,146,147
v_smfmac_f32_16x16x64_bf16 a[252:255], v[56:59], v[32:39], v71
s_add_u32 s48, s45, 0x10000
s_nop 0
ds_write_b64 v70, v[140:141] offset:96
PM 148,76,0
PM 150,76,0
PV 160,96,36
ds_write_b64 v70, v[144:145] offset:128
CV 148,148,149
CV 149,150,151
PM 152,76,0
PM 154,76,0
PV 164,100,36
ds_write_b64 v70, v[148:149] offset:160
v_accvgpr_read_b32 v45, a254
v_accvgpr_read_b32 v46, a255
v_add_f32 v77, v77, v45
v_accvgpr_read_b32 v49, a252
v_add_f32 v77, v77, v46
v_add_f32 v78, v78, v49
v_cmp_nge_f32 s[98:99], s55, v77
v_rcp_f32 v77, v77
v_accvgpr_read_b32 v50, a253
CV 152,152,153
v_add_f32 v78, v78, v50
CV 153,154,155
v_cmp_nge_f32 s[100:101], s55, v78
v_rcp_f32_e64 v78, v78
PM 156,76,0
PM 158,76,0
PV 168,104,36
ds_write_b64 v70, v[152:153] offset:192
CV 156,156,157
CV 157,158,159
PV 172,108,36
ds_write_b64 v70, v[156:157] offset:224
RK 192,15,0
RK 196,15,528
PM 160,76,1
RK 200,15,1056
PM 162,76,1
PV 176,112,36
RK 204,15,1584
CV 160,160,161
CV 161,162,163
PM 164,76,1
PM 166,76,1
PV 180,116,36
ds_write_b64 v70, v[160:161] offset:0
CV 164,164,165
CV 165,166,167
PM 168,76,1
PM 170,76,1
PV 184,120,36
s_waitcnt lgkmcnt(4)
ds_write_b64 v70, v[164:165] offset:32
buffer_store_dwordx4 a[192:195], v72, s[36:39], s53 offen nt
CV 168,168,169
CV 169,170,171
PM 172,76,1
L_t1_pad7:
s_cbranch_execz L_t1_go
PM 174,76,1
PV 188,124,36
s_add_u32 s49, s45, 0x20000
ds_write_b64 v70, v[168:169] offset:64
CV 172,172,173
CV 173,174,175
PM 176,76,1
PM 178,76,1
PV 192,96,32
s_waitcnt lgkmcnt(5)
ds_write_b64 v70, v[172:173] offset:96
buffer_store_dwordx4 a[196:199], v73, s[36:39], s53 offen nt
CV 176,176,177
CV 177,178,179
PM 180,76,1
PM 182,76,1
PV 196,100,32
ds_write_b64 v70, v[176:177] offset:128
CV 180,180,181
CV 181,182,183
PM 184,76,1
PM 186,76,1
PV 200,104,32
s_waitcnt lgkmcnt(6)
ds_write_b64 v70, v[180:181] offset:160
buffer_store_dwordx4 a[200:203], v74, s[36:39], s53 offen nt
CV 184,184,185
CV 185,186,187
PM 188,76,1
PM 190,76,1
PV 204,108,32
ds_write_b64 v70, v[184:185] offset:192
CV 188,188,189
CV 189,190,191
PM 192,78,0
PM 194,78,0
PV 208,112,32
CV 192,192,193
CV 193,194,195
ds_write_b64 v70, v[188:189] offset:224
RK 208,15,0
RK 212,15,528
s_waitcnt lgkmcnt(10)
buffer_store_dwordx4 a[204:207], v75, s[36:39], s53 offen nt
RK 216,15,1056
PM 196,78,0
RK 220,15,1584
PM 198,78,0
PV 212,116,32
ds_write_b64 v70, v[192:193] offset:0
CV 196,196,197
CV 197,198,199
PM 200,78,0
PM 202,78,0
PV 216,120,32
ds_write_b64 v70, v[196:197] offset:32
CV 200,200,201
CV 201,202,203
PM 204,78,0
PM 206,78,0
PV 220,124,32
s_waitcnt lgkmcnt(5)
ds_write_b64 v70, v[200:201] offset:64
buffer_store_dwordx4 a[208:211], v72, s[36:39], s48 offen nt
CV 204,204,205
CV 205,206,207
ds_write_b64 v70, v[204:205] offset:96
PM 208,78,0
PM 210,78,0
CV 208,208,209
CV 209,210,211
ds_write_b64 v70, v[208:209] offset:128
s_waitcnt lgkmcnt(7)
buffer_store_dwordx4 a[212:215], v73, s[36:39], s48 offen nt
PM 212,78,0
PM 214,78,0
CV 212,212,213
CV 213,214,215
ds_write_b64 v70, v[212:213] offset:160
PM 216,78,0
PM 218,78,0
CV 216,216,217
CV 217,218,219
ds_write_b64 v70, v[216:217] offset:192
s_waitcnt lgkmcnt(8)
buffer_store_dwordx4 a[216:219], v74, s[36:39], s48 offen nt
PM 220,78,0
PM 222,78,0
CV 220,220,221
CV 221,222,223
ds_write_b64 v70, v[220:221] offset:224
RK 224,15,0
RK 228,15,528
s_waitcnt lgkmcnt(10)
buffer_store_dwordx4 a[220:223], v75, s[36:39], s48 offen nt
RK 232,15,1056
RK 236,15,1584
s_waitcnt lgkmcnt(3)
buffer_store_dwordx4 a[224:227], v72, s[36:39], s49 offen nt
s_waitcnt lgkmcnt(2)
buffer_store_dwordx4 a[228:231], v73, s[36:39], s49 offen nt
s_waitcnt lgkmcnt(1)
buffer_store_dwordx4 a[232:235], v74, s[36:39], s49 offen nt
s_waitcnt lgkmcnt(0)
buffer_store_dwordx4 a[236:239], v75, s[36:39], s49 offen nt
s_cmp_lg_u64 s[4:5], 0
s_cselect_b32 s62, 1, 0
s_or_b32 s54, s54, s62
s_cmp_lg_u64 s[6:7], 0
s_cselect_b32 s62, 2, 0
s_or_b32 s54, s54, s62
s_cmp_lg_u64 s[8:9], 0
s_cselect_b32 s62, 4, 0
s_or_b32 s54, s54, s62
s_cmp_lg_u64 s[10:11], 0
s_cselect_b32 s62, 8, 0
s_or_b32 s54, s54, s62
s_cmp_lg_u64 s[96:97], 0
s_cselect_b32 s62, 16, 0
s_or_b32 s54, s54, s62
s_cmp_lg_u64 s[98:99], 0
s_cselect_b32 s62, 32, 0
s_or_b32 s54, s54, s62
s_cmp_lg_u64 s[100:101], 0
s_cselect_b32 s62, 64, 0
s_or_b32 s54, s54, s62
s_cbranch_scc0 L_done1
s_mov_b32 s4, 0xa17000
s_mov_b32 s5, 606
s_mov_b32 s6, 0xc75000
s_mov_b32 s7, 389
s_getpc_b64 s[62:63]
L_fpc1:
s_add_u32 s62, s62, L_fallback-L_fpc1
s_addc_u32 s63, s63, 0
s_setpc_b64 s[62:63]
L_done1:
s_endpgm
L_end1:
.p2align 12
L_type2:
s_mov_b64 exec, 0
s_cmp_eq_u32 s12, 0
s_cbranch_scc1 L_t2_pad1
s_cmp_eq_u32 s12, 1
s_cbranch_scc1 L_t2_pad2
s_cmp_eq_u32 s12, 2
s_cbranch_scc1 L_t2_pad3
s_branch L_t2_pad4
L_t2_go:
s_mov_b64 exec, -1
s_add_u32 s50, s44, 0x20000
s_mov_b32 s40, 0xe00000
s_add_u32 m0, s47, 0x4000
s_waitcnt vmcnt(9)
buffer_load_dwordx4 v[192:195], v72, s[24:27], s50 offen nt
s_barrier
v_lshlrev_b32 v0, 16, v128
RK 0,60,8192
RK 4,61,8192
v_and_b32 v1, s71, v128
RK 8,62,8192
v_lshlrev_b32 v2, 16, v129
buffer_load_dwordx4 v[196:199], v73, s[24:27], s50 offen nt
RK 12,63,8192
v_and_b32 v3, s71, v129
v_lshlrev_b32 v4, 16, v130
v_and_b32 v5, s71, v130
v_lshlrev_b32 v6, 16, v131
v_and_b32_e64 v7, s71, v131
v_pk_mul_f32 v[0:1], v[0:1], s[14:15]
v_pk_mul_f32 v[2:3], v[2:3], s[14:15]
v_pk_mul_f32 v[4:5], v[4:5], s[14:15]
v_pk_mul_f32 v[6:7], v[6:7], s[14:15]
buffer_load_dwordx4 v[200:203], v74, s[24:27], s50 offen nt
CV 128,0,1
CV 129,2,3
CV 130,4,5
CV 131,6,7
ds_write_b128 v15, v[128:131] offset:0
s_waitcnt vmcnt(11)
v_lshlrev_b32 v0, 16, v132
buffer_load_dwordx4 v[204:207], v75, s[24:27], s50 offen nt
v_and_b32 v1, s71, v132
v_lshlrev_b32 v2, 16, v133
v_and_b32 v3, s71, v133
v_lshlrev_b32 v4, 16, v134
v_and_b32 v5, s71, v134
v_lshlrev_b32 v6, 16, v135
v_and_b32_e64 v7, s71, v135
v_pk_mul_f32 v[0:1], v[0:1], s[14:15]
v_pk_mul_f32 v[2:3], v[2:3], s[14:15]
v_pk_mul_f32 v[4:5], v[4:5], s[14:15]
v_pk_mul_f32 v[6:7], v[6:7], s[14:15]
CV 132,0,1
CV 133,2,3
CV 134,4,5
CV 135,6,7
ds_write_b128 v15, v[132:135] offset:544
s_waitcnt vmcnt(11)
v_lshlrev_b32 v0, 16, v136
v_and_b32 v1, s71, v136
v_lshlrev_b32 v2, 16, v137
v_and_b32 v3, s71, v137
v_lshlrev_b32 v4, 16, v138
v_and_b32 v5, s71, v138
v_lshlrev_b32 v6, 16, v139
v_and_b32_e64 v7, s71, v139
v_pk_mul_f32 v[0:1], v[0:1], s[14:15]
v_pk_mul_f32 v[2:3], v[2:3], s[14:15]
v_pk_mul_f32 v[4:5], v[4:5], s[14:15]
v_pk_mul_f32 v[6:7], v[6:7], s[14:15]
CV 136,0,1
CV 137,2,3
CV 138,4,5
CV 139,6,7
ds_write_b128 v15, v[136:139] offset:1152
s_waitcnt vmcnt(10)
v_lshlrev_b32 v0, 16, v140
v_and_b32 v1, s71, v140
v_lshlrev_b32 v2, 16, v141
v_and_b32 v3, s71, v141
v_lshlrev_b32 v4, 16, v142
v_and_b32 v5, s71, v142
v_lshlrev_b32 v6, 16, v143
v_and_b32_e64 v7, s71, v143
v_pk_mul_f32 v[0:1], v[0:1], s[14:15]
v_pk_mul_f32 v[2:3], v[2:3], s[14:15]
v_pk_mul_f32 v[4:5], v[4:5], s[14:15]
v_pk_mul_f32 v[6:7], v[6:7], s[14:15]
CV 140,0,1
CV 141,2,3
CV 142,4,5
CV 143,6,7
ds_write_b128 v15, v[140:143] offset:1696
RK 128,14,0
v_subrev_u32 v12, 0x20000, v71
v_subrev_u32 v13, 0x10000, v71
v_ashrrev_i32 v12, 31, v12
v_ashrrev_i32 v13, 31, v13
v_not_b32 v12, v12
v_not_b32 v13, v13
v_and_b32 v12, 0xff800000, v12
v_and_b32 v13, 0xff800000, v13
RK 132,14,64
RK 136,14,128
v_xor_b32 v60, s43, v60
v_xor_b32 v61, s43, v61
RK 140,14,192
v_xor_b32 v62, s43, v62
v_xor_b32 v63, s43, v63
v_accvgpr_write_b32 a240, 0
v_accvgpr_write_b32 a241, 0
v_accvgpr_write_b32 a242, 0
v_accvgpr_write_b32 a243, 0
s_sub_u32 s51, s26, s44
s_ashr_i32 s51, s51, 8
v_and_b32 v45, 0xf0, v72
s_waitcnt lgkmcnt(3)
QZ 16,0,128
s_sub_u32 s51, s51, 256
v_sub_u32 v45, s51, v45
v_and_b32 v49, 0xf0, v72
v_ashrrev_i32 v45, 31, v45
s_sub_u32 s52, s26, s44
s_ashr_i32 s52, s52, 8
s_sub_u32 s52, s52, 512
v_sub_u32 v49, s52, v49
v_accvgpr_write_b32 a244, 0
v_ashrrev_i32 v49, 31, v49
s_waitcnt lgkmcnt(2)
QK 16,4,132,16
s_waitcnt lgkmcnt(1)
s_mul_i32 s45, s12, 0x20000
v_accvgpr_write_b32 a245, 0
v_accvgpr_write_b32 a246, 0
QK 16,8,136,16
s_waitcnt lgkmcnt(0)
s_xor_b32 s41, s41, s43
v_accvgpr_write_b32 a247, 0
v_accvgpr_write_b32 a248, 0
QK 16,12,140,16
s_xor_b32 s42, s41, 0xc000
v_mov_b32 v34, 0
v_mov_b32 v35, 0
v_accvgpr_write_b32 a249, 0
v_accvgpr_write_b32 a250, 0
v_accvgpr_write_b32 a251, 0
s_mov_b32 s57, 17
s_mov_b32 s58, 0x20000
s_mov_b32 s60, 0xffaf5000
v_max3_f32 v8, v16, v17, v18
s_mov_b32 s59, 0x20000
v_max_f32 v8, v8, v19
s_mov_b32 s61, 0x5000
v_mov_b32 v9, v8
s_add_u32 s45, s45, 0xc75000
s_mov_b64 s[32:33], s[24:25]
v_permlane32_swap_b32 v8, v9
v_max_f32 v8, v8, v9
s_mov_b32 s34, 0xdf9100
v_mov_b32 v9, v8
s_mov_b32 s35, 0x20000
s_mov_b64 s[36:37], s[28:29]
v_permlane16_swap_b32 v8, v9
v_min_f32_e64 v40, -v8, -v9
s_mov_b32 s38, 0xdf9100
v_add_f32 v8, v40, v12
v_add_f32 v9, v40, v13
v_add_f32 v16, v8, v16
v_add_f32 v17, v8, v17
v_add_f32 v18, v9, v18
v_add_f32 v19, v9, v19
EX 16
EX 17
EX 18
EX 19
CV 32,16,17
CV 33,18,19
v_mov_b32 v41, v40
s_waitcnt vmcnt(7)
s_barrier
buffer_load_dwordx4 v66, s[16:19], s40 offen lds
RV 64,64,8192
RV 66,64,12288
v_lshlrev_b32 v0, 16, v160
RV 68,65,8192
RV 70,65,12288
v_and_b32_e64 v1, s71, v160
RV 72,64,8448
RV 74,64,12544
buffer_load_dwordx4 v67, s[16:19], s40 offen offset:1024 lds
RV 76,65,8448
s_add_u32 m0, s47, 0x14000
v_lshlrev_b32 v2, 16, v161
RV 78,65,12544
RV 80,64,8704
v_and_b32 v3, s71, v161
RV 82,64,12800
RV 84,65,8704
buffer_load_dwordx4 v68, s[20:23], s40 offen lds
RV 86,65,12800
v_lshlrev_b32 v4, 16, v162
RV 88,64,8960
RV 90,64,13056
v_and_b32 v5, s71, v162
RV 92,65,8960
v_lshlrev_b32_e64 v6, 16, v163
buffer_load_dwordx4 v69, s[20:23], s40 offen offset:1024 lds
s_mov_b32 s40, 0xe20000
s_add_u32 m0, s47, 0x6000
RV 94,65,13056
v_and_b32_e64 v7, s71, v163
v_pk_mul_f32 v[0:1], v[0:1], s[14:15]
v_pk_mul_f32 v[2:3], v[2:3], s[14:15]
v_pk_mul_f32 v[4:5], v[4:5], s[14:15]
v_pk_mul_f32 v[6:7], v[6:7], s[14:15]
CV 160,0,1
CV 161,2,3
CV 162,4,5
CV 163,6,7
ds_write_b128 v15, v[160:163] offset:0
s_waitcnt vmcnt(10)
v_lshlrev_b32 v0, 16, v164
v_and_b32 v1, s71, v164
v_lshlrev_b32 v2, 16, v165
v_and_b32 v3, s71, v165
v_lshlrev_b32 v4, 16, v166
v_and_b32 v5, s71, v166
v_lshlrev_b32 v6, 16, v167
v_and_b32_e64 v7, s71, v167
v_pk_mul_f32 v[0:1], v[0:1], s[14:15]
v_pk_mul_f32 v[2:3], v[2:3], s[14:15]
v_pk_mul_f32 v[4:5], v[4:5], s[14:15]
v_pk_mul_f32 v[6:7], v[6:7], s[14:15]
CV 164,0,1
CV 165,2,3
CV 166,4,5
CV 167,6,7
ds_write_b128 v15, v[164:167] offset:544
s_waitcnt vmcnt(9)
v_lshlrev_b32 v0, 16, v168
v_and_b32 v1, s71, v168
v_lshlrev_b32 v2, 16, v169
v_and_b32 v3, s71, v169
v_lshlrev_b32 v4, 16, v170
v_and_b32 v5, s71, v170
v_lshlrev_b32 v6, 16, v171
v_and_b32_e64 v7, s71, v171
v_pk_mul_f32 v[0:1], v[0:1], s[14:15]
v_pk_mul_f32 v[2:3], v[2:3], s[14:15]
v_pk_mul_f32 v[4:5], v[4:5], s[14:15]
v_pk_mul_f32 v[6:7], v[6:7], s[14:15]
CV 168,0,1
CV 169,2,3
CV 170,4,5
CV 171,6,7
ds_write_b128 v15, v[168:171] offset:1152
s_waitcnt vmcnt(8)
v_lshlrev_b32 v0, 16, v172
v_and_b32 v1, s71, v172
v_lshlrev_b32 v2, 16, v173
v_and_b32 v3, s71, v173
v_lshlrev_b32 v4, 16, v174
v_and_b32 v5, s71, v174
v_lshlrev_b32 v6, 16, v175
v_and_b32_e64 v7, s71, v175
v_pk_mul_f32 v[0:1], v[0:1], s[14:15]
v_pk_mul_f32 v[2:3], v[2:3], s[14:15]
v_pk_mul_f32 v[4:5], v[4:5], s[14:15]
v_pk_mul_f32 v[6:7], v[6:7], s[14:15]
CV 172,0,1
CV 173,2,3
CV 174,4,5
CV 175,6,7
s_waitcnt lgkmcnt(15)
PZ 128,64,32
s_mov_b32 s39, 0x20000
ds_write_b128 v15, v[172:175] offset:1696
PZ 132,68,32
s_waitcnt lgkmcnt(14)
RK 144,14,0
RK 148,14,64
PZ 136,72,32
s_waitcnt lgkmcnt(14)
RK 152,14,128
v_mov_b32 v42, v40
PZ 140,76,32
s_waitcnt lgkmcnt(13)
RK 156,14,192
v_mov_b32 v43, v40
PZ 144,80,32
s_waitcnt lgkmcnt(12)
v_xor_b32 v64, s43, v64
v_xor_b32 v65, s43, v65
PZ 148,84,32
s_waitcnt lgkmcnt(10)
s_xor_b32 s43, s43, 0xc000
v_accvgpr_write_b32 a252, 0
v_accvgpr_write_b32 a253, 0
PZ 152,88,32
s_waitcnt lgkmcnt(8)
v_accvgpr_write_b32 a254, 0
v_accvgpr_write_b32 a255, 0
PZ 156,92,32
s_waitcnt lgkmcnt(3)
s_sub_u32 s57, s57, 1
s_cselect_b64 s[58:59], s[60:61], s[58:59]
QZ 24,0,144
s_waitcnt lgkmcnt(2)
QK 24,4,148,24
s_waitcnt lgkmcnt(1)
QK 24,8,152,24
s_waitcnt lgkmcnt(0)
QK 24,12,156,24
v_mov_b32 v38, 0
v_mov_b32 v39, 0
s_nop 5
v_max3_f32 v10, v24, v25, v26
v_max_f32 v10, v10, v27
v_mov_b32 v11, v10
s_nop 1
v_permlane32_swap_b32 v10, v11
v_max_f32 v10, v10, v11
v_mov_b32 v11, v10
s_nop 1
v_permlane16_swap_b32 v10, v11
v_min_f32_e64 v44, -v10, -v11
v_add_f32 v10, v44, v12
v_add_f32 v11, v44, v13
v_add_f32 v24, v10, v24
v_add_f32 v25, v10, v25
v_add_f32 v26, v11, v26
v_add_f32 v27, v11, v27
EX 24
EX 25
EX 26
EX 27
CV 36,24,25
CV 37,26,27
v_bfi_b32 v44, v45, s70, v44
s_waitcnt vmcnt(7)
buffer_load_dwordx4 v66, s[16:19], s40 offen lds
v_lshlrev_b32 v0, 16, v192
v_and_b32 v1, s71, v192
v_lshlrev_b32 v2, 16, v193
v_and_b32 v3, s71, v193
v_lshlrev_b32 v4, 16, v194
v_and_b32 v5, s71, v194
v_lshlrev_b32 v6, 16, v195
v_and_b32_e64 v7, s71, v195
buffer_load_dwordx4 v67, s[16:19], s40 offen offset:1024 lds
s_add_u32 m0, s47, 0x16000
v_pk_mul_f32 v[0:1], v[0:1], s[14:15]
v_pk_mul_f32 v[2:3], v[2:3], s[14:15]
v_pk_mul_f32 v[4:5], v[4:5], s[14:15]
v_pk_mul_f32 v[6:7], v[6:7], s[14:15]
CV 192,0,1
CV 193,2,3
CV 194,4,5
CV 195,6,7
ds_write_b128 v15, v[192:195] offset:0
buffer_load_dwordx4 v68, s[20:23], s40 offen lds
s_waitcnt vmcnt(9)
v_lshlrev_b32 v0, 16, v196
v_and_b32 v1, s71, v196
v_lshlrev_b32 v2, 16, v197
v_and_b32 v3, s71, v197
v_lshlrev_b32 v4, 16, v198
v_and_b32 v5, s71, v198
v_lshlrev_b32 v6, 16, v199
v_and_b32_e64 v7, s71, v199
v_pk_mul_f32 v[0:1], v[0:1], s[14:15]
v_pk_mul_f32 v[2:3], v[2:3], s[14:15]
buffer_load_dwordx4 v69, s[20:23], s40 offen offset:1024 lds
v_pk_mul_f32 v[4:5], v[4:5], s[14:15]
v_pk_mul_f32 v[6:7], v[6:7], s[14:15]
CV 196,0,1
CV 197,2,3
CV 198,4,5
CV 199,6,7
ds_write_b128 v15, v[196:199] offset:544
s_waitcnt vmcnt(9)
v_lshlrev_b32 v0, 16, v200
v_and_b32 v1, s71, v200
v_lshlrev_b32 v2, 16, v201
v_and_b32 v3, s71, v201
v_lshlrev_b32 v4, 16, v202
v_and_b32 v5, s71, v202
v_lshlrev_b32 v6, 16, v203
v_and_b32_e64 v7, s71, v203
v_pk_mul_f32 v[0:1], v[0:1], s[14:15]
v_pk_mul_f32 v[2:3], v[2:3], s[14:15]
v_pk_mul_f32 v[4:5], v[4:5], s[14:15]
v_pk_mul_f32 v[6:7], v[6:7], s[14:15]
CV 200,0,1
CV 201,2,3
CV 202,4,5
CV 203,6,7
ds_write_b128 v15, v[200:203] offset:1152
s_waitcnt vmcnt(8)
v_lshlrev_b32 v0, 16, v204
v_and_b32 v1, s71, v204
v_lshlrev_b32 v2, 16, v205
v_and_b32 v3, s71, v205
v_lshlrev_b32 v4, 16, v206
v_and_b32 v5, s71, v206
v_lshlrev_b32 v6, 16, v207
v_and_b32_e64 v7, s71, v207
v_pk_mul_f32 v[0:1], v[0:1], s[14:15]
v_pk_mul_f32 v[2:3], v[2:3], s[14:15]
v_pk_mul_f32 v[4:5], v[4:5], s[14:15]
v_pk_mul_f32 v[6:7], v[6:7], s[14:15]
CV 204,0,1
CV 205,2,3
CV 206,4,5
CV 207,6,7
PZ 160,64,36
s_mov_b32 s40, 0xe40000
ds_write_b128 v15, v[204:207] offset:1696
PZ 164,68,36
s_add_u32 m0, s47, 0xc000
RK 160,14,0
RK 164,14,64
PZ 168,72,36
RK 168,14,128
v_mov_b32 v45, v44
PZ 172,76,36
s_waitcnt vmcnt(6)
s_barrier
PZ 176,80,36
RK 172,14,192
RK 32,60,0
PZ 180,84,36
buffer_load_dwordx4 v66, s[16:19], s40 offen lds
PZ 184,88,36
RK 36,61,0
RK 40,62,0
PZ 188,92,36
RK 44,63,0
v_mov_b32 v46, v44
v_smfmac_f32_16x16x64_bf16 a[240:243], v[56:59], v[32:39], v71
s_waitcnt lgkmcnt(7)
RK 48,60,4096
QZ 16,0,160
s_waitcnt lgkmcnt(7)
buffer_load_dwordx4 v67, s[16:19], s40 offen offset:1024 lds
QK 16,4,164,16
s_waitcnt lgkmcnt(6)
s_add_u32 m0, s47, 0x1c000
RK 52,61,4096
RK 56,62,4096
QK 16,8,168,16
s_waitcnt lgkmcnt(7)
RK 60,63,4096
v_mov_b32 v47, v44
QK 16,12,172,16
s_waitcnt lgkmcnt(7)
s_nop 2
QK 24,32,128,40
s_waitcnt lgkmcnt(6)
buffer_load_dwordx4 v68, s[20:23], s40 offen lds
QK 24,36,132,24
s_waitcnt lgkmcnt(5)
v_mov_b32 v34, 0
v_mov_b32 v35, 0
QK 24,40,136,24
s_waitcnt vmcnt(7) lgkmcnt(4)
s_barrier
QK 24,44,140,24
s_waitcnt lgkmcnt(3)
RV 96,64,0
v_max3_f32 v8, v16, v17, v18
QK 28,48,128,40
s_waitcnt lgkmcnt(1)
RV 98,64,4096
v_max_f32 v8, v8, v19
QK 28,52,132,28
RV 100,65,0
v_mov_b32 v9, v8
QK 28,56,136,28
EX 24
QK 28,60,140,28
buffer_load_dwordx4 v69, s[20:23], s40 offen offset:1024 lds
RV 102,65,4096
RV 104,64,256
v_permlane32_swap_b32 v8, v9
v_max_f32 v8, v8, v9
s_mov_b32 s40, 0xe60000
v_mov_b32 v9, v8
EX 25
EX 26
v_permlane16_swap_b32 v8, v9
v_min_f32_e64 v48, -v8, -v9
EX 27
v_add_f32 v8, v48, v12
v_add_f32 v9, v48, v13
v_add_f32 v16, v8, v16
v_add_f32 v17, v8, v17
v_add_f32 v18, v9, v18
v_add_f32 v19, v9, v19
EX 16
EX 17
EX 18
EX 19
CV 32,16,17
CV 33,18,19
QK 16,32,144,44
s_add_u32 m0, s47, 0xe000
EX 28
QK 16,36,148,16
CV 36,24,25
CV 37,26,27
QK 16,40,152,16
buffer_load_dwordx4 v66, s[16:19], s40 offen lds
QK 16,44,156,16
EX 29
QK 20,48,144,44
EX 30
QK 20,52,148,20
CV 38,28,29
v_bfi_b32 v48, v49, s70, v48
QK 20,56,152,20
EX 31
QK 20,60,156,20
CV 39,30,31
v_mov_b32 v49, v48
PZ 192,64,32
v_mov_b32 v50, v48
v_mov_b32 v51, v48
PZ 196,68,32
RV 106,64,4352
RV 108,65,256
PZ 200,72,32
RV 110,65,4352
v_subrev_u32 v12, 0x20000, v71
PZ 204,76,32
buffer_load_dwordx4 v67, s[16:19], s40 offen offset:1024 lds
PZ 208,80,32
RV 112,64,512
RV 114,64,4608
PZ 212,84,32
RV 116,65,512
v_subrev_u32 v13, 0x10000, v71
PZ 216,88,32
RV 118,65,4608
RV 120,64,768
PZ 220,92,32
RV 122,64,4864
v_ashrrev_i32 v12, 31, v12
v_smfmac_f32_16x16x64_bf16 a[244:247], v[56:59], v[32:39], v71
RV 124,65,768
QK 24,32,160,48
RV 126,65,4864
v_ashrrev_i32 v13, 31, v13
QK 24,36,164,24
s_add_u32 m0, s47, 0x1e000
EX 16
QK 24,40,168,24
EX 17
QK 24,44,172,24
s_waitcnt vmcnt(8)
s_barrier
QK 28,48,160,48
buffer_load_dwordx4 v68, s[20:23], s40 offen lds
QK 28,52,164,28
RK 0,60,8192
RK 4,61,8192
QK 28,56,168,28
s_waitcnt lgkmcnt(2)
RK 8,62,8192
CV 32,16,17
QK 28,60,172,28
RK 12,63,8192
v_not_b32 v12, v12
PV 128,96,36
RK 16,60,12288
v_not_b32 v13, v13
PV 132,100,36
RK 20,61,12288
v_xor_b32 v60, s43, v60
PV 136,104,36
RK 24,62,12288
v_xor_b32 v61, s43, v61
PV 140,108,36
RK 28,63,12288
v_xor_b32 v62, s43, v62
PV 144,112,36
buffer_load_dwordx4 v69, s[20:23], s40 offen offset:1024 lds
PV 148,116,36
EX 18
PV 152,120,36
EX 19
PV 156,124,36
s_waitcnt lgkmcnt(7)
CV 33,18,19
v_xor_b32 v63, s43, v63
QK 16,0,128,40
s_waitcnt lgkmcnt(6)
EX 20
QK 16,4,132,16
s_waitcnt lgkmcnt(0)
EX 21
QK 16,8,136,16
EX 22
QK 16,12,140,16
EX 23
CV 34,20,21
CV 35,22,23
QK 20,16,128,40
EX 24
QK 20,20,132,20
EX 25
QK 20,24,136,20
EX 26
QK 20,28,140,20
EX 27
PV 160,96,32
EX 28
PV 164,100,32
EX 29
PV 168,104,32
EX 30
PV 172,108,32
s_waitcnt vmcnt(8)
s_barrier
PV 176,112,32
EX 31
PV 180,116,32
CV 36,24,25
CV 37,26,27
PV 184,120,32
CV 38,28,29
CV 39,30,31
PV 188,124,32
s_xor_b32 s41, s41, s43
EX 16
v_smfmac_f32_16x16x64_bf16 a[248:251], v[56:59], v[32:39], v71
s_mov_b32 s40, 0xe80000
s_xor_b32 s42, s41, 0xc000
RV 64,64,8192
QK 24,0,144,44
s_add_u32 m0, s47, 0x8000
EX 17
QK 24,4,148,24
EX 18
QK 24,8,152,24
buffer_load_dwordx4 v66, s[16:19], s40 offen lds
QK 24,12,156,24
L_t2_pad1:
s_cbranch_execz L_t2_pad5
EX 19
QK 28,16,144,44
CV 32,16,17
CV 33,18,19
QK 28,20,148,28
RV 66,64,12288
RV 68,65,8192
QK 28,24,152,28
RV 70,65,12288
v_and_b32 v12, 0xff800000, v12
QK 28,28,156,28
RV 72,64,8448
RV 74,64,12544
PV 192,96,36
RV 76,65,8448
v_and_b32 v13, 0xff800000, v13
PV 196,100,36
RV 78,65,12544
RV 80,64,8704
PV 200,104,36
EX 20
PV 204,108,36
buffer_load_dwordx4 v67, s[16:19], s40 offen offset:1024 lds
PV 208,112,36
RV 82,64,12800
RV 84,65,8704
PV 212,116,36
EX 21
PV 216,120,36
RV 86,65,12800
RV 88,64,8960
PV 220,124,36
RV 90,64,13056
CV 34,20,21
QK 16,0,160,48
RV 92,65,8960
RV 94,65,13056
QK 16,4,164,16
EX 22
QK 16,8,168,16
s_add_u32 m0, s47, 0x18000
EX 23
QK 16,12,172,16
CV 35,22,23
v_xor_b32 v64, s43, v64
QK 20,16,160,48
s_waitcnt vmcnt(8)
s_barrier
QK 20,20,164,20
buffer_load_dwordx4 v68, s[20:23], s40 offen lds
QK 20,24,168,20
RK 32,60,0
RK 36,61,0
QK 20,28,172,20
s_waitcnt lgkmcnt(2)
RK 40,62,0
v_xor_b32 v65, s43, v65
PV 128,64,32
s_xor_b32 s43, s43, 0xc000
EX 24
PV 132,68,32
RK 44,63,0
RK 48,60,4096
PV 136,72,32
RK 52,61,4096
PV 140,76,32
RK 56,62,4096
PV 144,80,32
RK 60,63,4096
PV 148,84,32
buffer_load_dwordx4 v69, s[20:23], s40 offen offset:1024 lds
PV 152,88,32
EX 25
PV 156,92,32
EX 26
EX 27
EX 28
EX 29
EX 30
v_exp_f32_e64 v31, v31
CV 36,24,25
CV 37,26,27
CV 38,28,29
CV 39,30,31
EX 16
s_nop 0
v_smfmac_f32_16x16x64_bf16 a[240:243], v[56:59], v[32:39], v71
s_waitcnt lgkmcnt(0)
QK 24,32,128,40
EX 17
QK 24,36,132,24
EX 18
QK 24,40,136,24
EX 19
QK 24,44,140,24
CV 32,16,17
CV 33,18,19
QK 28,48,128,40
EX 20
QK 28,52,132,28
EX 21
QK 28,56,136,28
EX 22
QK 28,60,140,28
EX 23
PV 160,64,36
CV 34,20,21
CV 35,22,23
PV 164,68,36
EX 24
PV 168,72,36
s_waitcnt vmcnt(8)
s_barrier
PV 172,76,36
EX 25
PV 176,80,36
EX 26
PV 180,84,36
RV 96,64,0
RV 98,64,4096
PV 184,88,36
EX 27
PV 188,92,36
CV 36,24,25
CV 37,26,27
QK 16,32,144,44
s_mov_b32 s40, 0xea0000
EX 28
QK 16,36,148,16
s_add_u32 m0, s47, 0xa000
RV 100,65,0
RV 102,65,4096
QK 16,40,152,16
EX 29
QK 16,44,156,16
buffer_load_dwordx4 v66, s[16:19], s40 offen lds
QK 20,48,144,44
EX 30
QK 20,52,148,20
RV 104,64,256
CV 38,28,29
QK 20,56,152,20
EX 31
QK 20,60,156,20
RV 106,64,4352
CV 39,30,31
PV 192,64,32
buffer_load_dwordx4 v67, s[16:19], s40 offen offset:1024 lds
PV 196,68,32
RV 108,65,256
RV 110,65,4352
PV 200,72,32
EX 16
PV 204,76,32
RV 112,64,512
RV 114,64,4608
PV 208,80,32
s_add_u32 m0, s47, 0x1a000
EX 17
PV 212,84,32
RV 116,65,512
RV 118,65,4608
PV 216,88,32
buffer_load_dwordx4 v68, s[20:23], s40 offen lds
PV 220,92,32
RV 120,64,768
RV 122,64,4864
v_smfmac_f32_16x16x64_bf16 a[244:247], v[56:59], v[32:39], v71
RV 124,65,768
QK 24,32,160,48
RV 126,65,4864
CV 32,16,17
QK 24,36,164,24
EX 18
QK 24,40,168,24
buffer_load_dwordx4 v69, s[20:23], s40 offen offset:1024 lds
QK 24,44,172,24
s_waitcnt vmcnt(10)
s_barrier
QK 28,48,160,48
s_mov_b32 s40, 0xec0000
RK 0,60,8192
RK 4,61,8192
QK 28,52,164,28
s_add_u32 m0, s47, 0x0
EX 19
QK 28,56,168,28
s_waitcnt lgkmcnt(2)
RK 8,62,8192
RK 12,63,8192
QK 28,60,172,28
buffer_load_dwordx4 v66, s[16:19], s40 offen lds
PV 128,96,36
RK 16,60,12288
RK 20,61,12288
PV 132,100,36
RK 24,62,12288
CV 33,18,19
PV 136,104,36
RK 28,63,12288
v_xor_b32 v60, s43, v60
PV 140,108,36
EX 20
PV 144,112,36
buffer_load_dwordx4 v67, s[16:19], s40 offen offset:1024 lds
PV 148,116,36
EX 21
PV 152,120,36
EX 22
PV 156,124,36
s_waitcnt lgkmcnt(7)
EX 23
QK 16,0,128,40
s_waitcnt lgkmcnt(0)
s_add_u32 m0, s47, 0x10000
CV 34,20,21
QK 16,4,132,16
CV 35,22,23
v_xor_b32 v61, s43, v61
QK 16,8,136,16
buffer_load_dwordx4 v68, s[20:23], s40 offen lds
QK 16,12,140,16
EX 24
QK 20,16,128,40
EX 25
QK 20,20,132,20
EX 26
QK 20,24,136,20
EX 27
QK 20,28,140,20
buffer_load_dwordx4 v69, s[20:23], s40 offen offset:1024 lds
PV 160,96,32
EX 28
PV 164,100,32
EX 29
PV 168,104,32
EX 30
PV 172,108,32
s_waitcnt vmcnt(12)
s_barrier
PV 176,112,32
RV 64,64,8192
RV 66,64,12288
PV 180,116,32
RV 68,65,8192
CV 36,24,25
PV 184,120,32
RV 70,65,12288
RV 72,64,8448
PV 188,124,32
s_xor_b32 s41, s41, s43
RV 74,64,12544
EX 31
CV 37,26,27
CV 38,28,29
CV 39,30,31
v_xor_b32 v62, s43, v62
v_xor_b32 v63, s43, v63
v_smfmac_f32_16x16x64_bf16 a[248:251], v[56:59], v[32:39], v71
s_mov_b32 s40, 0xee0000
s_xor_b32 s42, s41, 0xc000
RV 76,65,8448
QK 24,0,144,44
s_add_u32 m0, s47, 0x2000
RV 78,65,12544
RV 80,64,8704
QK 24,4,148,24
EX 16
QK 24,8,152,24
RV 82,64,12800
RV 84,65,8704
QK 24,12,156,24
EX 17
QK 28,16,144,44
RV 86,65,12800
RV 88,64,8960
QK 28,20,148,28
RV 90,64,13056
CV 32,16,17
QK 28,24,152,28
RV 92,65,8960
RV 94,65,13056
QK 28,28,156,28
buffer_load_dwordx4 v66, s[16:19], s40 offen lds
PV 192,96,36
v_xor_b32 v64, s43, v64
v_xor_b32 v65, s43, v65
PV 196,100,36
s_xor_b32 s43, s43, 0xc000
EX 18
PV 200,104,36
EX 19
PV 204,108,36
buffer_load_dwordx4 v67, s[16:19], s40 offen offset:1024 lds
PV 208,112,36
s_waitcnt vmcnt(10) lgkmcnt(0)
s_barrier
PV 212,116,36
RK 32,60,0
RK 36,61,0
PV 216,120,36
RK 40,62,0
CV 33,18,19
PV 220,124,36
EX 20
QK 16,0,160,48
RK 44,63,0
RK 48,60,4096
QK 16,4,164,16
EX 21
QK 16,8,168,16
s_add_u32 m0, s47, 0x12000
RK 52,61,4096
RK 56,62,4096
QK 16,12,172,16
RK 60,63,4096
EX 22
EX 23
CV 34,20,21
CV 35,22,23
QK 20,16,160,48
RV 96,64,0
RV 98,64,4096
QK 20,20,164,20
EX 24
QK 20,24,168,20
RV 100,65,0
RV 102,65,4096
QK 20,28,172,20
EX 25
PV 128,64,32
RV 104,64,256
RV 106,64,4352
PV 132,68,32
buffer_load_dwordx4 v68, s[20:23], s40 offen lds
PV 136,72,32
RV 108,65,256
RV 110,65,4352
PV 140,76,32
RV 112,64,512
CV 36,24,25
PV 144,80,32
RV 114,64,4608
RV 116,65,512
PV 148,84,32
buffer_load_dwordx4 v69, s[20:23], s40 offen offset:1024 lds
PV 152,88,32
EX 26
PV 156,92,32
RV 118,65,4608
RV 120,64,768
EX 27
EX 28
EX 29
EX 30
EX 31
CV 37,26,27
CV 38,28,29
CV 39,30,31
EX 16
s_nop 0
v_smfmac_f32_16x16x64_bf16 a[240:243], v[56:59], v[32:39], v71
s_waitcnt lgkmcnt(13)
RV 122,64,4864
QK 24,32,128,40
EX 17
QK 24,36,132,24
RV 124,65,768
CV 32,16,17
QK 24,40,136,24
EX 18
QK 24,44,140,24
EX 19
QK 28,48,128,40
RV 126,65,4864
CV 33,18,19
QK 28,52,132,28
EX 20
QK 28,56,136,28
EX 21
QK 28,60,140,28
EX 22
PV 160,64,36
EX 23
PV 164,68,36
CV 34,20,21
CV 35,22,23
PV 168,72,36
EX 24
PV 172,76,36
EX 25
PV 176,80,36
s_waitcnt vmcnt(8) lgkmcnt(0)
s_barrier
PV 180,84,36
EX 26
PV 184,88,36
EX 27
PV 188,92,36
s_mov_b32 s40, 0xf00000
RK 0,60,8192
RK 4,61,8192
QK 16,32,144,44
s_add_u32 m0, s47, 0x4000
EX 28
QK 16,36,148,16
RK 8,62,8192
CV 36,24,25
QK 16,40,152,16
buffer_load_dwordx4 v66, s[16:19], s40 offen lds
QK 16,44,156,16
RK 12,63,8192
CV 37,26,27
QK 20,48,144,44
EX 29
QK 20,52,148,20
RK 16,60,12288
CV 38,28,29
QK 20,56,152,20
RK 20,61,12288
v_xor_b32 v60, s43, v60
QK 20,60,156,20
EX 30
PV 192,64,32
RK 24,62,12288
v_xor_b32 v61, s43, v61
PV 196,68,32
RK 28,63,12288
v_xor_b32 v62, s43, v62
PV 200,72,32
EX 31
PV 204,76,32
buffer_load_dwordx4 v67, s[16:19], s40 offen offset:1024 lds
PV 208,80,32
RV 64,64,8192
CV 39,30,31
PV 212,84,32
RV 66,64,12288
v_xor_b32 v63, s43, v63
PV 216,88,32
EX 16
PV 220,92,32
EX 17
v_smfmac_f32_16x16x64_bf16 a[244:247], v[56:59], v[32:39], v71
RV 68,65,8192
QK 24,32,160,48
RV 70,65,12288
CV 32,16,17
QK 24,36,164,24
s_add_u32 m0, s47, 0x14000
EX 18
QK 24,40,168,24
RV 72,64,8448
RV 74,64,12544
QK 24,44,172,24
buffer_load_dwordx4 v68, s[20:23], s40 offen lds
QK 28,48,160,48
EX 19
QK 28,52,164,28
RV 76,65,8448
CV 33,18,19
QK 28,56,168,28
EX 20
QK 28,60,172,28
RV 78,65,12544
RV 80,64,8704
PV 128,96,36
EX 21
PV 132,100,36
RV 82,64,12800
CV 34,20,21
PV 136,104,36
EX 22
PV 140,108,36
EX 23
PV 144,112,36
buffer_load_dwordx4 v69, s[20:23], s40 offen offset:1024 lds
PV 148,116,36
RV 84,65,8704
RV 86,65,12800
PV 152,120,36
RV 88,64,8960
CV 35,22,23
PV 156,124,36
s_waitcnt lgkmcnt(13)
EX 24
QK 16,0,128,40
EX 25
QK 16,4,132,16
RV 90,64,13056
RV 92,65,8960
QK 16,8,136,16
EX 26
QK 16,12,140,16
RV 94,65,13056
CV 36,24,25
QK 20,16,128,40
EX 27
QK 20,20,132,20
EX 28
QK 20,24,136,20
EX 29
QK 20,28,140,20
EX 30
PV 160,96,32
EX 31
PV 164,100,32
CV 37,26,27
CV 38,28,29
PV 168,104,32
CV 39,30,31
v_xor_b32 v64, s43, v64
PV 172,108,32
EX 16
PV 176,112,32
EX 17
PV 180,116,32
s_waitcnt vmcnt(8) lgkmcnt(0)
s_barrier
PV 184,120,32
EX 18
PV 188,124,32
s_xor_b32 s41, s41, s43
RK 32,60,0
v_xor_b32 v65, s43, v65
v_smfmac_f32_16x16x64_bf16 a[248:251], v[56:59], v[32:39], v71
s_mov_b32 s40, 0xf20000
s_xor_b32 s43, s43, 0xc000
RK 36,61,0
QK 24,0,144,44
s_add_u32 m0, s47, 0x6000
EX 19
QK 24,4,148,24
s_xor_b32 s42, s41, 0xc000
RK 40,62,0
CV 32,16,17
QK 24,8,152,24
buffer_load_dwordx4 v66, s[16:19], s40 offen lds
QK 24,12,156,24
RK 44,63,0
CV 33,18,19
QK 28,16,144,44
EX 20
QK 28,20,148,28
EX 21
QK 28,24,152,28
RK 48,60,4096
RK 52,61,4096
QK 28,28,156,28
RK 56,62,4096
CV 34,20,21
PV 192,96,36
EX 22
PV 196,100,36
EX 23
PV 200,104,36
RK 60,63,4096
CV 35,22,23
PV 204,108,36
buffer_load_dwordx4 v67, s[16:19], s40 offen offset:1024 lds
PV 208,112,36
RV 96,64,0
RV 98,64,4096
PV 212,116,36
EX 24
PV 216,120,36
EX 25
PV 220,124,36
RV 100,65,0
RV 102,65,4096
QK 16,0,160,48
EX 26
QK 16,4,164,16
RV 104,64,256
CV 36,24,25
QK 16,8,168,16
s_add_u32 m0, s47, 0x16000
EX 27
QK 16,12,172,16
RV 106,64,4352
CV 37,26,27
QK 20,16,160,48
buffer_load_dwordx4 v68, s[20:23], s40 offen lds
QK 20,20,164,20
L_t2_pad2:
s_cbranch_execz L_t2_pad6
EX 28
QK 20,24,168,20
RV 108,65,256
RV 110,65,4352
QK 20,28,172,20
EX 29
PV 128,64,32
RV 112,64,512
CV 38,28,29
PV 132,68,32
EX 30
PV 136,72,32
EX 31
PV 140,76,32
RV 114,64,4608
RV 116,65,512
PV 144,80,32
RV 118,65,4608
CV 39,30,31
PV 148,84,32
buffer_load_dwordx4 v69, s[20:23], s40 offen offset:1024 lds
PV 152,88,32
EX 16
PV 156,92,32
EX 17
v_smfmac_f32_16x16x64_bf16 a[240:243], v[56:59], v[32:39], v71
s_waitcnt lgkmcnt(12)
RV 120,64,768
QK 24,32,128,40
RV 122,64,4864
RV 124,65,768
QK 24,36,132,24
EX 18
QK 24,40,136,24
RV 126,65,4864
CV 32,16,17
QK 24,44,140,24
EX 19
QK 28,48,128,40
EX 20
QK 28,52,132,28
EX 21
QK 28,56,136,28
CV 33,18,19
CV 34,20,21
QK 28,60,140,28
EX 22
PV 160,64,36
EX 23
PV 164,68,36
EX 24
PV 168,72,36
EX 25
PV 172,76,36
CV 35,22,23
PV 176,80,36
s_waitcnt vmcnt(8) lgkmcnt(0)
s_barrier
PV 180,84,36
EX 26
PV 184,88,36
EX 27
PV 188,92,36
RK 0,60,8192
RK 4,61,8192
QK 16,32,144,44
s_mov_b32 s40, 0xf40000
v_exp_f32_e64 v28, v28
QK 16,36,148,16
s_add_u32 m0, s47, 0xc000
RK 8,62,8192
CV 36,24,25
QK 16,40,152,16
EX 29
QK 16,44,156,16
buffer_load_dwordx4 v66, s[16:19], s40 offen lds
QK 20,48,144,44
RK 12,63,8192
RK 16,60,12288
QK 20,52,148,20
v_exp_f32_e64 v30, v30
QK 20,56,152,20
RK 20,61,12288
CV 37,26,27
QK 20,60,156,20
EX 31
PV 192,64,32
buffer_load_dwordx4 v67, s[16:19], s40 offen offset:1024 lds
PV 196,68,32
RK 24,62,12288
RK 28,63,12288
PV 200,72,32
CV 38,28,29
CV 39,30,31
PV 204,76,32
RV 64,64,8192
v_xor_b32_e64 v60, s43, v60
PV 208,80,32
s_add_u32 m0, s47, 0x1c000
EX 16
PV 212,84,32
RV 66,64,12288
v_xor_b32_e64 v61, s43, v61
PV 216,88,32
buffer_load_dwordx4 v68, s[20:23], s40 offen lds
PV 220,92,32
RV 68,65,8192
v_xor_b32 v62, s43, v62
v_smfmac_f32_16x16x64_bf16 a[244:247], v[56:59], v[32:39], v71
RV 70,65,12288
QK 24,32,160,48
v_exp_f32_e64 v17, v17
QK 24,36,164,24
RV 72,64,8448
CV 32,16,17
QK 24,40,168,24
buffer_load_dwordx4 v69, s[20:23], s40 offen offset:1024 lds
QK 24,44,172,24
RV 74,64,12544
v_xor_b32 v63, s43, v63
QK 28,48,160,48
s_mov_b32 s40, 0xf60000
v_exp_f32_e64 v18, v18
QK 28,52,164,28
s_add_u32 m0, s47, 0xe000
EX 19
QK 28,56,168,28
RV 76,65,8448
RV 78,65,12544
QK 28,60,172,28
buffer_load_dwordx4 v66, s[16:19], s40 offen lds
PV 128,96,36
RV 80,64,8704
CV 33,18,19
PV 132,100,36
v_exp_f32_e64 v20, v20
PV 136,104,36
EX 21
PV 140,108,36
RV 82,64,12800
RV 84,65,8704
PV 144,112,36
buffer_load_dwordx4 v67, s[16:19], s40 offen offset:1024 lds
PV 148,116,36
RV 86,65,12800
CV 34,20,21
PV 152,120,36
v_exp_f32_e64 v22, v22
PV 156,124,36
s_waitcnt lgkmcnt(12)
EX 23
QK 16,0,128,40
s_add_u32 m0, s47, 0x1e000
RV 88,64,8960
RV 90,64,13056
QK 16,4,132,16
RV 92,65,8960
CV 35,22,23
QK 16,8,136,16
buffer_load_dwordx4 v68, s[20:23], s40 offen lds
QK 16,12,140,16
RV 94,65,13056
v_xor_b32_e64 v64, s43, v64
QK 20,16,128,40
EX 24
QK 20,20,132,20
v_exp_f32_e64 v25, v25
QK 20,24,136,20
EX 26
QK 20,28,140,20
buffer_load_dwordx4 v69, s[20:23], s40 offen offset:1024 lds
PV 160,96,32
v_exp_f32_e64 v27, v27
PV 164,100,32
EX 28
PV 168,104,32
v_exp_f32_e64 v29, v29
PV 172,108,32
EX 30
PV 176,112,32
v_exp_f32_e64 v31, v31
PV 180,116,32
s_waitcnt vmcnt(8) lgkmcnt(0)
s_barrier
PV 184,120,32
EX 16
CV 36,24,25
CV 37,26,27
CV 38,28,29
CV 39,30,31
v_xor_b32_e64 v65, s43, v65
s_mov_b32 s56, 6
L_t2_loop0:
PV 188,124,32
s_xor_b32 s41, s41, s43
EX 17
v_smfmac_f32_16x16x64_bf16 a[248:251], v[56:59], v[32:39], v71
s_xor_b32 s42, s41, 0xc000
s_add_u32 s40, s40, s58
RK 32,60,0
QK 24,0,144,44
s_add_u32 m0, s42, 0x0
RK 36,61,0
CV 32,16,17
QK 24,4,148,24
s_mov_b32 s58, s59
EX 18
QK 24,8,152,24
buffer_load_dwordx4 v66, s[16:19], s40 offen lds
QK 24,12,156,24
s_mov_b32 s59, 0x20000
RK 40,62,0
RK 44,63,0
QK 28,16,144,44
s_xor_b32 s43, s43, 0xc000
EX 19
QK 28,20,148,28
RK 48,60,4096
CV 33,18,19
QK 28,24,152,28
EX 20
QK 28,28,156,28
RK 52,61,4096
RK 56,62,4096
PV 192,96,36
EX 21
PV 196,100,36
RK 60,63,4096
CV 34,20,21
PV 200,104,36
EX 22
PV 204,108,36
buffer_load_dwordx4 v67, s[16:19], s40 offen offset:1024 lds
PV 208,112,36
RV 96,64,0
RV 98,64,4096
PV 212,116,36
EX 23
PV 216,120,36
RV 100,65,0
CV 35,22,23
PV 220,124,36
EX 24
QK 16,0,160,48
s_add_u32 m0, s42, 0x10000
EX 25
QK 16,4,164,16
RV 102,65,4096
RV 104,64,256
QK 16,8,168,16
EX 26
QK 16,12,172,16
RV 106,64,4352
CV 36,24,25
QK 20,16,160,48
buffer_load_dwordx4 v68, s[20:23], s40 offen lds
QK 20,20,164,20
EX 27
QK 20,24,168,20
RV 108,65,256
RV 110,65,4352
QK 20,28,172,20
EX 28
PV 128,64,32
RV 112,64,512
CV 37,26,27
PV 132,68,32
EX 29
PV 136,72,32
RV 114,64,4608
CV 38,28,29
PV 140,76,32
EX 30
PV 144,80,32
EX 31
PV 148,84,32
buffer_load_dwordx4 v69, s[20:23], s40 offen offset:1024 lds
PV 152,88,32
RV 116,65,512
CV 39,30,31
PV 156,92,32
RV 118,65,4608
RV 120,64,768
v_smfmac_f32_16x16x64_bf16 a[240:243], v[56:59], v[32:39], v71
s_waitcnt lgkmcnt(13)
RV 122,64,4864
QK 24,32,128,40
EX 16
QK 24,36,132,24
EX 17
QK 24,40,136,24
RV 124,65,768
RV 126,65,4864
QK 24,44,140,24
EX 18
QK 28,48,128,40
EX 19
QK 28,52,132,28
CV 32,16,17
CV 33,18,19
QK 28,56,136,28
EX 20
QK 28,60,140,28
EX 21
PV 160,64,36
EX 22
PV 164,68,36
EX 23
PV 168,72,36
CV 34,20,21
CV 35,22,23
PV 172,76,36
EX 24
PV 176,80,36
s_waitcnt lgkmcnt(0)
EX 25
PV 180,84,36
EX 26
PV 184,88,36
s_add_u32 m0, s42, 0x2000
EX 27
PV 188,92,36
RK 0,60,8192
RK 4,61,8192
QK 16,32,144,44
s_sub_u32 s57, s57, 1
s_cselect_b64 s[58:59], s[60:61], s[58:59]
CV 36,24,25
QK 16,36,148,16
s_add_u32 s40, s40, s58
RK 8,62,8192
CV 37,26,27
QK 16,40,152,16
buffer_load_dwordx4 v66, s[16:19], s40 offen lds
QK 16,44,156,16
s_mov_b32 s58, s59
EX 28
QK 20,48,144,44
s_mov_b32 s59, 0x20000
RK 12,63,8192
RK 16,60,12288
QK 20,52,148,20
EX 29
QK 20,56,152,20
RK 20,61,12288
CV 38,28,29
QK 20,60,156,20
EX 30
PV 192,64,32
RK 24,62,12288
v_xor_b32 v60, s43, v60
PV 196,68,32
RK 28,63,12288
v_xor_b32 v61, s43, v61
PV 200,72,32
EX 31
PV 204,76,32
buffer_load_dwordx4 v67, s[16:19], s40 offen offset:1024 lds
PV 208,80,32
RV 64,64,8192
CV 39,30,31
PV 212,84,32
RV 66,64,12288
v_xor_b32 v62, s43, v62
PV 216,88,32
RV 68,65,8192
v_xor_b32 v63, s43, v63
PV 220,92,32
EX 16
v_smfmac_f32_16x16x64_bf16 a[244:247], v[56:59], v[32:39], v71
s_sub_u32 s57, s57, 1
s_cselect_b64 s[58:59], s[60:61], s[58:59]
RV 70,65,12288
QK 24,32,160,48
s_add_u32 m0, s42, 0x12000
EX 17
QK 24,36,164,24
RV 72,64,8448
CV 32,16,17
QK 24,40,168,24
EX 18
QK 24,44,172,24
buffer_load_dwordx4 v68, s[20:23], s40 offen lds
QK 28,48,160,48
RV 74,64,12544
RV 76,65,8448
QK 28,52,164,28
EX 19
QK 28,56,168,28
RV 78,65,12544
CV 33,18,19
QK 28,60,172,28
EX 20
PV 128,96,36
EX 21
PV 132,100,36
RV 80,64,8704
RV 82,64,12800
PV 136,104,36
EX 22
PV 140,108,36
RV 84,65,8704
CV 34,20,21
PV 144,112,36
buffer_load_dwordx4 v69, s[20:23], s40 offen offset:1024 lds
PV 148,116,36
EX 23
PV 152,120,36
RV 86,65,12800
RV 88,64,8960
PV 156,124,36
s_waitcnt lgkmcnt(13)
EX 24
QK 16,0,128,40
RV 90,64,13056
CV 35,22,23
QK 16,4,132,16
RV 92,65,8960
v_xor_b32 v64, s43, v64
QK 16,8,136,16
EX 25
QK 16,12,140,16
RV 94,65,13056
CV 36,24,25
QK 20,16,128,40
EX 26
QK 20,20,132,20
EX 27
QK 20,24,136,20
EX 28
QK 20,28,140,20
EX 29
PV 160,96,32
EX 30
PV 164,100,32
EX 31
PV 168,104,32
CV 37,26,27
CV 38,28,29
PV 172,108,32
CV 39,30,31
v_xor_b32 v65, s43, v65
PV 176,112,32
EX 16
PV 180,116,32
s_waitcnt vmcnt(8) lgkmcnt(0)
s_barrier
PV 184,120,32
s_sub_u32 s56, s56, 1
s_cbranch_scc0 L_t2_loop0
PV 188,124,32
s_xor_b32 s41, s41, s43
EX 17
v_smfmac_f32_16x16x64_bf16 a[248:251], v[56:59], v[32:39], v71
s_xor_b32 s42, s41, 0xc000
s_add_u32 s40, s40, s58
RK 32,60,0
QK 24,0,144,44
s_add_u32 m0, s42, 0x0
RK 36,61,0
CV 32,16,17
QK 24,4,148,24
s_add_u32 s53, s45, 0x0
EX 18
QK 24,8,152,24
buffer_load_dwordx4 v66, s[16:19], s40 offen lds
QK 24,12,156,24
s_mov_b32 s58, s59
RK 40,62,0
RK 44,63,0
QK 28,16,144,44
s_mov_b32 s59, 0x20000
EX 19
QK 28,20,148,28
buffer_load_dwordx4 v[80:83], v72, s[32:35], s53 offen nt
QK 28,24,152,28
s_xor_b32 s43, s43, 0xc000
RK 48,60,4096
RK 52,61,4096
QK 28,28,156,28
RK 56,62,4096
CV 33,18,19
PV 192,96,36
EX 20
PV 196,100,36
EX 21
PV 200,104,36
RK 60,63,4096
CV 34,20,21
PV 204,108,36
buffer_load_dwordx4 v67, s[16:19], s40 offen offset:1024 lds
PV 208,112,36
RV 96,64,0
RV 98,64,4096
PV 212,116,36
EX 22
PV 216,120,36
EX 23
PV 220,124,36
RV 100,65,0
RV 102,65,4096
QK 16,0,160,48
s_add_u32 m0, s42, 0x10000
EX 24
QK 16,4,164,16
RV 104,64,256
CV 35,22,23
QK 16,8,168,16
EX 25
QK 16,12,172,16
RV 106,64,4352
CV 36,24,25
QK 20,16,160,48
buffer_load_dwordx4 v68, s[20:23], s40 offen lds
QK 20,20,164,20
EX 26
QK 20,24,168,20
RV 108,65,256
RV 110,65,4352
QK 20,28,172,20
EX 27
PV 128,64,32
RV 112,64,512
CV 37,26,27
PV 132,68,32
EX 28
PV 136,72,32
EX 29
PV 140,76,32
RV 114,64,4608
RV 116,65,512
PV 144,80,32
EX 30
PV 148,84,32
buffer_load_dwordx4 v69, s[20:23], s40 offen offset:1024 lds
PV 152,88,32
EX 31
PV 156,92,32
RV 118,65,4608
CV 38,28,29
CV 39,30,31
EX 16
s_nop 0
v_smfmac_f32_16x16x64_bf16 a[240:243], v[56:59], v[32:39], v71
s_waitcnt lgkmcnt(12)
RV 120,64,768
QK 24,32,128,40
RV 122,64,4864
RV 124,65,768
QK 24,36,132,24
EX 17
QK 24,40,136,24
RV 126,65,4864
CV 32,16,17
QK 24,44,140,24
EX 18
QK 28,48,128,40
EX 19
QK 28,52,132,28
EX 20
QK 28,56,136,28
EX 21
QK 28,60,140,28
CV 33,18,19
CV 34,20,21
PV 160,64,36
EX 22
PV 164,68,36
buffer_load_dwordx4 v[84:87], v73, s[32:35], s53 offen nt
PV 168,72,36
EX 23
PV 172,76,36
EX 24
PV 176,80,36
s_waitcnt lgkmcnt(0)
EX 25
PV 180,84,36
EX 26
PV 184,88,36
s_add_u32 m0, s42, 0x2000
RK 0,60,8192
CV 35,22,23
PV 188,92,36
L_t2_pad3:
s_cbranch_execz L_t2_go
RK 4,61,8192
CV 36,24,25
QK 16,32,144,44
s_sub_u32 s57, s57, 1
s_cselect_b64 s[58:59], s[60:61], s[58:59]
QK 16,36,148,16
s_add_u32 s40, s40, s58
EX 27
QK 16,40,152,16
buffer_load_dwordx4 v66, s[16:19], s40 offen lds
QK 16,44,156,16
s_mov_b32 s58, s59
RK 8,62,8192
RK 12,63,8192
QK 20,48,144,44
s_mov_b32 s59, 0x20000
RK 16,60,12288
CV 37,26,27
QK 20,52,148,20
EX 28
QK 20,56,152,20
RK 20,61,12288
v_xor_b32 v60, s43, v60
QK 20,60,156,20
EX 29
PV 192,64,32
RK 24,62,12288
CV 38,28,29
PV 196,68,32
RK 28,63,12288
v_xor_b32 v61, s43, v61
PV 200,72,32
EX 30
PV 204,76,32
buffer_load_dwordx4 v67, s[16:19], s40 offen offset:1024 lds
PV 208,80,32
RV 64,64,8192
v_xor_b32 v62, s43, v62
PV 212,84,32
EX 31
PV 216,88,32
RV 66,64,12288
CV 39,30,31
PV 220,92,32
RV 68,65,8192
v_xor_b32 v63, s43, v63
v_smfmac_f32_16x16x64_bf16 a[244:247], v[56:59], v[32:39], v71
s_sub_u32 s57, s57, 1
s_cselect_b64 s[58:59], s[60:61], s[58:59]
RV 70,65,12288
QK 24,32,160,48
s_add_u32 m0, s42, 0x12000
EX 16
QK 24,36,164,24
EX 17
QK 24,40,168,24
RV 72,64,8448
RV 74,64,12544
QK 24,44,172,24
buffer_load_dwordx4 v68, s[20:23], s40 offen lds
QK 28,48,160,48
RV 76,65,8448
CV 32,16,17
QK 28,52,164,28
EX 18
QK 28,56,168,28
EX 19
QK 28,60,172,28
RV 78,65,12544
RV 80,64,8704
PV 128,96,36
EX 20
PV 132,100,36
RV 82,64,12800
CV 33,18,19
PV 136,104,36
EX 21
PV 140,108,36
RV 84,65,8704
CV 34,20,21
PV 144,112,36
buffer_load_dwordx4 v69, s[20:23], s40 offen offset:1024 lds
PV 148,116,36
EX 22
PV 152,120,36
RV 86,65,12800
RV 88,64,8960
PV 156,124,36
s_waitcnt lgkmcnt(13)
EX 23
QK 16,0,128,40
buffer_load_dwordx4 v[88:91], v74, s[32:35], s53 offen nt
QK 16,4,132,16
RV 90,64,13056
RV 92,65,8960
QK 16,8,136,16
CV 35,22,23
v_xor_b32 v64, s43, v64
QK 16,12,140,16
EX 24
QK 20,16,128,40
EX 25
QK 20,20,132,20
RV 94,65,13056
CV 36,24,25
QK 20,24,136,20
EX 26
QK 20,28,140,20
EX 27
PV 160,96,32
EX 28
PV 164,100,32
EX 29
PV 168,104,32
EX 30
PV 172,108,32
EX 31
PV 176,112,32
CV 37,26,27
CV 38,28,29
PV 180,116,32
s_waitcnt vmcnt(11) lgkmcnt(0)
s_barrier
PV 184,120,32
s_add_u32 s40, s40, s58
CV 39,30,31
v_xor_b32 v65, s43, v65
PV 188,124,32
s_xor_b32 s41, s41, s43
EX 16
v_smfmac_f32_16x16x64_bf16 a[248:251], v[56:59], v[32:39], v71
s_xor_b32 s42, s41, 0xc000
s_add_u32 m0, s42, 0x0
RK 32,60,0
QK 24,0,144,44
s_mov_b32 s58, s59
EX 17
QK 24,4,148,24
s_mov_b32 s59, 0x20000
RK 36,61,0
RK 40,62,0
QK 24,8,152,24
buffer_load_dwordx4 v66, s[16:19], s40 offen lds
QK 24,12,156,24
s_xor_b32 s43, s43, 0xc000
RK 44,63,0
CV 32,16,17
QK 28,16,144,44
EX 18
QK 28,20,148,28
EX 19
QK 28,24,152,28
RK 48,60,4096
RK 52,61,4096
QK 28,28,156,28
RK 56,62,4096
CV 33,18,19
PV 192,96,36
EX 20
PV 196,100,36
EX 21
PV 200,104,36
RK 60,63,4096
CV 34,20,21
PV 204,108,36
buffer_load_dwordx4 v67, s[16:19], s40 offen offset:1024 lds
PV 208,112,36
RV 96,64,0
RV 98,64,4096
PV 212,116,36
EX 22
PV 216,120,36
EX 23
PV 220,124,36
RV 100,65,0
RV 102,65,4096
QK 16,0,160,48
s_add_u32 m0, s42, 0x10000
EX 24
QK 16,4,164,16
RV 104,64,256
CV 35,22,23
QK 16,8,168,16
EX 25
QK 16,12,172,16
RV 106,64,4352
CV 36,24,25
QK 20,16,160,48
buffer_load_dwordx4 v68, s[20:23], s40 offen lds
QK 20,20,164,20
EX 26
QK 20,24,168,20
RV 108,65,256
RV 110,65,4352
QK 20,28,172,20
EX 27
PV 128,64,32
buffer_load_dwordx4 v[92:95], v75, s[32:35], s53 offen nt
PV 132,68,32
RV 112,64,512
RV 114,64,4608
PV 136,72,32
EX 28
PV 140,76,32
RV 116,65,512
CV 37,26,27
PV 144,80,32
EX 29
PV 148,84,32
buffer_load_dwordx4 v69, s[20:23], s40 offen offset:1024 lds
PV 152,88,32
EX 30
PV 156,92,32
RV 118,65,4608
RV 120,64,768
EX 31
CV 38,28,29
CV 39,30,31
EX 16
s_nop 0
v_smfmac_f32_16x16x64_bf16 a[240:243], v[56:59], v[32:39], v71
s_waitcnt lgkmcnt(13)
RV 122,64,4864
QK 24,32,128,40
EX 17
QK 24,36,132,24
RV 124,65,768
CV 32,16,17
QK 24,40,136,24
EX 18
QK 24,44,140,24
EX 19
QK 28,48,128,40
RV 126,65,4864
CV 33,18,19
QK 28,52,132,28
EX 20
QK 28,56,136,28
EX 21
QK 28,60,140,28
EX 22
PV 160,64,36
EX 23
PV 164,68,36
CV 34,20,21
CV 35,22,23
PV 168,72,36
EX 24
PV 172,76,36
EX 25
PV 176,80,36
s_waitcnt lgkmcnt(0)
EX 26
PV 180,84,36
PV 184,88,36
s_add_u32 m0, s42, 0x2000
EX 27
PV 188,92,36
RK 0,60,8192
RK 4,61,8192
QK 16,32,144,44
s_sub_u32 s57, s57, 1
s_cselect_b64 s[58:59], s[60:61], s[58:59]
CV 36,24,25
QK 16,36,148,16
s_add_u32 s40, s40, s58
RK 8,62,8192
CV 37,26,27
QK 16,40,152,16
buffer_load_dwordx4 v66, s[16:19], s40 offen lds
QK 16,44,156,16
s_mov_b32 s58, s59
EX 28
QK 20,48,144,44
s_mov_b32 s59, 0x20000
RK 12,63,8192
RK 16,60,12288
QK 20,52,148,20
EX 29
QK 20,56,152,20
RK 20,61,12288
CV 38,28,29
QK 20,60,156,20
EX 30
PV 192,64,32
RK 24,62,12288
v_xor_b32 v60, s43, v60
PV 196,68,32
RK 28,63,12288
v_xor_b32 v61, s43, v61
PV 200,72,32
EX 31
PV 204,76,32
buffer_load_dwordx4 v67, s[16:19], s40 offen offset:1024 lds
PV 208,80,32
s_add_u32 s48, s45, 0x10000
RV 64,64,8192
CV 39,30,31
PV 212,84,32
RV 66,64,12288
v_xor_b32 v62, s43, v62
PV 216,88,32
RV 68,65,8192
v_xor_b32 v63, s43, v63
PV 220,92,32
buffer_load_dwordx4 v[96:99], v72, s[32:35], s48 offen nt
v_smfmac_f32_16x16x64_bf16 a[244:247], v[56:59], v[32:39], v71
s_sub_u32 s57, s57, 1
s_cselect_b64 s[58:59], s[60:61], s[58:59]
RV 70,65,12288
QK 24,32,160,48
s_add_u32 m0, s42, 0x12000
EX 16
QK 24,36,164,24
EX 17
QK 24,40,168,24
RV 72,64,8448
RV 74,64,12544
QK 24,44,172,24
buffer_load_dwordx4 v68, s[20:23], s40 offen lds
QK 28,48,160,48
RV 76,65,8448
CV 32,16,17
QK 28,52,164,28
EX 18
QK 28,56,168,28
EX 19
QK 28,60,172,28
RV 78,65,12544
RV 80,64,8704
PV 128,96,36
EX 20
PV 132,100,36
RV 82,64,12800
CV 33,18,19
PV 136,104,36
EX 21
PV 140,108,36
RV 84,65,8704
CV 34,20,21
PV 144,112,36
buffer_load_dwordx4 v69, s[20:23], s40 offen offset:1024 lds
PV 148,116,36
EX 22
PV 152,120,36
RV 86,65,12800
RV 88,64,8960
PV 156,124,36
s_waitcnt lgkmcnt(13)
EX 23
QK 16,0,128,40
RV 90,64,13056
CV 35,22,23
QK 16,4,132,16
RV 92,65,8960
v_xor_b32 v64, s43, v64
QK 16,8,136,16
EX 24
QK 16,12,140,16
EX 25
QK 20,16,128,40
RV 94,65,13056
CV 36,24,25
QK 20,20,132,20
EX 26
QK 20,24,136,20
EX 27
QK 20,28,140,20
EX 28
PV 160,96,32
EX 29
PV 164,100,32
EX 30
PV 168,104,32
EX 31
PV 172,108,32
CV 37,26,27
CV 38,28,29
PV 176,112,32
CV 39,30,31
v_xor_b32 v65, s43, v65
PV 180,116,32
s_waitcnt vmcnt(11) lgkmcnt(0)
s_barrier
PV 184,120,32
s_add_u32 s40, s40, s58
EX 16
PV 188,124,32
s_xor_b32 s41, s41, s43
EX 17
v_smfmac_f32_16x16x64_bf16 a[248:251], v[56:59], v[32:39], v71
s_xor_b32 s42, s41, 0xc000
s_add_u32 m0, s42, 0x0
RK 32,60,0
QK 24,0,144,44
s_mov_b32 s58, s59
RK 36,61,0
CV 32,16,17
QK 24,4,148,24
s_mov_b32 s59, 0x20000
EX 18
QK 24,8,152,24
buffer_load_dwordx4 v66, s[16:19], s40 offen lds
QK 24,12,156,24
s_xor_b32 s43, s43, 0xc000
RK 40,62,0
RK 44,63,0
QK 28,16,144,44
EX 19
QK 28,20,148,28
buffer_load_dwordx4 v[100:103], v73, s[32:35], s48 offen nt
QK 28,24,152,28
RK 48,60,4096
RK 52,61,4096
QK 28,28,156,28
RK 56,62,4096
CV 33,18,19
PV 192,96,36
EX 20
PV 196,100,36
EX 21
PV 200,104,36
RK 60,63,4096
CV 34,20,21
PV 204,108,36
buffer_load_dwordx4 v67, s[16:19], s40 offen offset:1024 lds
PV 208,112,36
RV 96,64,0
RV 98,64,4096
PV 212,116,36
EX 22
PV 216,120,36
EX 23
PV 220,124,36
RV 100,65,0
RV 102,65,4096
QK 16,0,160,48
s_add_u32 m0, s42, 0x10000
EX 24
QK 16,4,164,16
RV 104,64,256
CV 35,22,23
QK 16,8,168,16
EX 25
QK 16,12,172,16
RV 106,64,4352
CV 36,24,25
QK 20,16,160,48
buffer_load_dwordx4 v68, s[20:23], s40 offen lds
QK 20,20,164,20
EX 26
QK 20,24,168,20
RV 108,65,256
RV 110,65,4352
QK 20,28,172,20
EX 27
PV 128,64,32
RV 112,64,512
CV 37,26,27
PV 132,68,32
EX 28
PV 136,72,32
EX 29
PV 140,76,32
RV 114,64,4608
RV 116,65,512
PV 144,80,32
EX 30
PV 148,84,32
buffer_load_dwordx4 v69, s[20:23], s40 offen offset:1024 lds
PV 152,88,32
EX 31
PV 156,92,32
RV 118,65,4608
CV 38,28,29
CV 39,30,31
EX 16
s_nop 0
v_smfmac_f32_16x16x64_bf16 a[240:243], v[56:59], v[32:39], v71
s_waitcnt lgkmcnt(12)
RV 120,64,768
QK 24,32,128,40
RV 122,64,4864
RV 124,65,768
QK 24,36,132,24
EX 17
QK 24,40,136,24
RV 126,65,4864
CV 32,16,17
QK 24,44,140,24
EX 18
QK 28,48,128,40
EX 19
QK 28,52,132,28
EX 20
QK 28,56,136,28
EX 21
QK 28,60,140,28
CV 33,18,19
CV 34,20,21
PV 160,64,36
EX 22
PV 164,68,36
EX 23
PV 168,72,36
buffer_load_dwordx4 v[104:107], v74, s[32:35], s48 offen nt
PV 172,76,36
EX 24
PV 176,80,36
s_waitcnt lgkmcnt(0)
EX 25
PV 180,84,36
EX 26
PV 184,88,36
s_add_u32 m0, s42, 0x2000
RK 0,60,8192
CV 35,22,23
PV 188,92,36
RK 4,61,8192
CV 36,24,25
QK 16,32,144,44
s_sub_u32 s57, s57, 1
s_cselect_b64 s[58:59], s[60:61], s[58:59]
QK 16,36,148,16
s_add_u32 s40, s40, s58
EX 27
QK 16,40,152,16
buffer_load_dwordx4 v66, s[16:19], s40 offen lds
QK 16,44,156,16
s_mov_b32 s58, s59
RK 8,62,8192
RK 12,63,8192
QK 20,48,144,44
s_mov_b32 s59, 0x20000
RK 16,60,12288
CV 37,26,27
QK 20,52,148,20
EX 28
QK 20,56,152,20
RK 20,61,12288
v_xor_b32 v60, s43, v60
QK 20,60,156,20
EX 29
PV 192,64,32
RK 24,62,12288
CV 38,28,29
PV 196,68,32
RK 28,63,12288
v_xor_b32 v61, s43, v61
PV 200,72,32
EX 30
PV 204,76,32
buffer_load_dwordx4 v67, s[16:19], s40 offen offset:1024 lds
PV 208,80,32
RV 64,64,8192
v_xor_b32 v62, s43, v62
PV 212,84,32
EX 31
PV 216,88,32
RV 66,64,12288
CV 39,30,31
PV 220,92,32
RV 68,65,8192
v_xor_b32 v63, s43, v63
v_smfmac_f32_16x16x64_bf16 a[244:247], v[56:59], v[32:39], v71
s_sub_u32 s57, s57, 1
s_cselect_b64 s[58:59], s[60:61], s[58:59]
RV 70,65,12288
QK 24,32,160,48
s_add_u32 m0, s42, 0x12000
EX 16
QK 24,36,164,24
EX 17
QK 24,40,168,24
RV 72,64,8448
RV 74,64,12544
QK 24,44,172,24
buffer_load_dwordx4 v68, s[20:23], s40 offen lds
QK 28,48,160,48
RV 76,65,8448
CV 32,16,17
QK 28,52,164,28
EX 18
QK 28,56,168,28
EX 19
QK 28,60,172,28
RV 78,65,12544
RV 80,64,8704
PV 128,96,36
EX 20
PV 132,100,36
L_t2_pad4:
s_cbranch_execz L_t2_go
RV 82,64,12800
CV 33,18,19
PV 136,104,36
EX 21
PV 140,108,36
RV 84,65,8704
CV 34,20,21
PV 144,112,36
buffer_load_dwordx4 v69, s[20:23], s40 offen offset:1024 lds
PV 148,116,36
EX 22
PV 152,120,36
RV 86,65,12800
RV 88,64,8960
PV 156,124,36
s_waitcnt lgkmcnt(13)
EX 23
QK 16,0,128,40
RV 90,64,13056
CV 35,22,23
QK 16,4,132,16
buffer_load_dwordx4 v[108:111], v75, s[32:35], s48 offen nt
QK 16,8,136,16
RV 92,65,8960
v_xor_b32 v64, s43, v64
QK 16,12,140,16
EX 24
QK 20,16,128,40
EX 25
QK 20,20,132,20
RV 94,65,13056
CV 36,24,25
QK 20,24,136,20
EX 26
QK 20,28,140,20
EX 27
PV 160,96,32
EX 28
PV 164,100,32
EX 29
PV 168,104,32
EX 30
PV 172,108,32
EX 31
PV 176,112,32
CV 37,26,27
CV 38,28,29
PV 180,116,32
s_waitcnt vmcnt(11) lgkmcnt(0)
s_barrier
PV 184,120,32
s_add_u32 s40, s40, s58
CV 39,30,31
v_xor_b32 v65, s43, v65
PV 188,124,32
s_xor_b32 s41, s41, s43
EX 16
v_smfmac_f32_16x16x64_bf16 a[248:251], v[56:59], v[32:39], v71
s_xor_b32 s42, s41, 0xc000
s_add_u32 m0, s42, 0x0
RK 32,60,0
QK 24,0,144,44
s_mov_b32 s58, s59
EX 17
QK 24,4,148,24
s_mov_b32 s59, 0x20000
RK 36,61,0
RK 40,62,0
QK 24,8,152,24
buffer_load_dwordx4 v66, s[16:19], s40 offen lds
QK 24,12,156,24
s_xor_b32 s43, s43, 0xc000
RK 44,63,0
CV 32,16,17
QK 28,16,144,44
EX 18
QK 28,20,148,28
EX 19
QK 28,24,152,28
RK 48,60,4096
RK 52,61,4096
QK 28,28,156,28
RK 56,62,4096
CV 33,18,19
PV 192,96,36
EX 20
PV 196,100,36
EX 21
PV 200,104,36
RK 60,63,4096
CV 34,20,21
PV 204,108,36
buffer_load_dwordx4 v67, s[16:19], s40 offen offset:1024 lds
PV 208,112,36
RV 96,64,0
RV 98,64,4096
PV 212,116,36
EX 22
PV 216,120,36
EX 23
PV 220,124,36
RV 100,65,0
RV 102,65,4096
QK 16,0,160,48
s_add_u32 m0, s42, 0x10000
EX 24
QK 16,4,164,16
RV 104,64,256
CV 35,22,23
QK 16,8,168,16
EX 25
QK 16,12,172,16
RV 106,64,4352
CV 36,24,25
QK 20,16,160,48
buffer_load_dwordx4 v68, s[20:23], s40 offen lds
QK 20,20,164,20
EX 26
QK 20,24,168,20
RV 108,65,256
RV 110,65,4352
QK 20,28,172,20
EX 27
PV 128,64,32
RV 112,64,512
CV 37,26,27
PV 132,68,32
EX 28
PV 136,72,32
EX 29
PV 140,76,32
RV 114,64,4608
RV 116,65,512
PV 144,80,32
EX 30
PV 148,84,32
buffer_load_dwordx4 v69, s[20:23], s40 offen offset:1024 lds
PV 152,88,32
EX 31
PV 156,92,32
RV 118,65,4608
CV 38,28,29
CV 39,30,31
EX 16
s_nop 0
v_smfmac_f32_16x16x64_bf16 a[240:243], v[56:59], v[32:39], v71
s_waitcnt lgkmcnt(12)
RV 120,64,768
QK 24,32,128,40
RV 122,64,4864
RV 124,65,768
QK 24,36,132,24
EX 17
QK 24,40,136,24
RV 126,65,4864
CV 32,16,17
QK 24,44,140,24
EX 18
QK 28,48,128,40
v_accvgpr_read_b32 v76, a240
v_accvgpr_read_b32 v77, a242
QK 28,52,132,28
EX 19
QK 28,56,136,28
v_accvgpr_read_b32 v40, a241
CV 33,18,19
QK 28,60,140,28
EX 20
PV 160,64,36
EX 21
PV 164,68,36
v_add_f32 v76, v76, v40
CV 34,20,21
PV 168,72,36
EX 22
PV 172,76,36
EX 23
PV 176,80,36
s_waitcnt lgkmcnt(0)
EX 24
PV 180,84,36
EX 25
PV 184,88,36
s_add_u32 m0, s42, 0x2000
RK 0,60,8192
RK 4,61,8192
PV 188,92,36
RK 8,62,8192
CV 35,22,23
QK 16,32,144,44
s_sub_u32 s57, s57, 1
s_cselect_b64 s[58:59], s[60:61], s[58:59]
RK 12,63,8192
QK 16,36,148,16
s_add_u32 s40, s40, s58
EX 26
QK 16,40,152,16
buffer_load_dwordx4 v66, s[16:19], s40 offen lds
QK 16,44,156,16
s_mov_b32 s58, s59
EX 27
QK 20,48,144,44
s_mov_b32 s59, 0x20000
EX 28
QK 20,52,148,20
v_accvgpr_read_b32 v44, a243
CV 36,24,25
QK 20,56,152,20
v_add_f32 v77, v77, v44
CV 37,26,27
QK 20,60,156,20
EX 29
PV 192,64,32
RV 64,64,8192
RV 66,64,12288
PV 196,68,32
RV 68,65,8192
CV 38,28,29
PV 200,72,32
RV 70,65,12288
RV 72,64,8448
PV 204,76,32
RV 74,64,12544
v_xor_b32 v60, s43, v60
PV 208,80,32
RV 76,65,8448
RV 78,65,12544
PV 212,84,32
RV 80,64,8704
v_xor_b32 v61, s43, v61
PV 216,88,32
RV 82,64,12800
RV 84,65,8704
PV 220,92,32
buffer_load_dwordx4 v67, s[16:19], s40 offen offset:1024 lds
RV 86,65,12800
RV 88,64,8960
EX 30
EX 31
EX 16
CV 39,30,31
v_xor_b32 v62, s43, v62
v_xor_b32 v63, s43, v63
v_smfmac_f32_16x16x64_bf16 a[244:247], v[56:59], v[32:39], v71
s_add_u32 m0, s42, 0x12000
RV 90,64,13056
QK 24,32,160,48
RV 92,65,8960
RV 94,65,13056
v_lshlrev_b32 v0, 16, v80
v_and_b32 v1, s71, v80
v_lshlrev_b32 v2, 16, v81
v_and_b32 v3, s71, v81
v_pk_mul_f32 v[0:1], v[0:1], s[14:15]
v_pk_mul_f32 v[2:3], v[2:3], s[14:15]
QK 24,36,164,24
v_accvgpr_read_b32 v41, a246
v_accvgpr_read_b32 v42, a247
v_add_f32 v76, v76, v41
v_accvgpr_read_b32 v78, a244
v_add_f32 v76, v76, v42
v_lshlrev_b32 v4, 16, v82
v_cmp_nge_f32 s[4:5], s55, v76
v_rcp_f32 v76, v76
v_and_b32 v5, s71, v82
v_lshlrev_b32 v6, 16, v83
v_and_b32 v7, s71, v83
v_pk_mul_f32 v[4:5], v[4:5], s[14:15]
v_pk_mul_f32 v[6:7], v[6:7], s[14:15]
CV 80,0,1
CV 81,2,3
QK 24,40,168,24
CV 82,4,5
CV 83,6,7
v_lshlrev_b32 v0, 16, v84
v_and_b32 v1, s71, v84
v_lshlrev_b32 v2, 16, v85
v_and_b32 v3, s71, v85
v_pk_mul_f32 v[0:1], v[0:1], s[14:15]
v_pk_mul_f32 v[2:3], v[2:3], s[14:15]
QK 24,44,172,24
buffer_load_dwordx4 v68, s[20:23], s40 offen lds
ds_write_b128 v15, v[80:83] offset:0
v_lshlrev_b32 v4, 16, v86
v_and_b32 v5, s71, v86
v_lshlrev_b32 v6, 16, v87
v_and_b32 v7, s71, v87
v_pk_mul_f32 v[4:5], v[4:5], s[14:15]
v_pk_mul_f32 v[6:7], v[6:7], s[14:15]
CV 84,0,1
CV 85,2,3
QK 28,48,160,48
CV 86,4,5
CV 87,6,7
v_lshlrev_b32 v0, 16, v88
v_accvgpr_read_b32 v48, a245
v_and_b32 v1, s71, v88
v_add_f32 v78, v78, v48
v_lshlrev_b32 v2, 16, v89
v_and_b32 v3, s71, v89
v_pk_mul_f32 v[0:1], v[0:1], s[14:15]
v_pk_mul_f32 v[2:3], v[2:3], s[14:15]
QK 28,52,164,28
ds_write_b128 v15, v[84:87] offset:544
v_lshlrev_b32 v4, 16, v90
v_and_b32 v5, s71, v90
v_lshlrev_b32 v6, 16, v91
v_and_b32_e64 v7, s71, v91
v_pk_mul_f32 v[4:5], v[4:5], s[14:15]
v_pk_mul_f32 v[6:7], v[6:7], s[14:15]
CV 88,0,1
CV 89,2,3
QK 28,56,168,28
CV 90,4,5
CV 91,6,7
v_lshlrev_b32 v0, 16, v92
v_and_b32 v1, s71, v92
v_lshlrev_b32 v2, 16, v93
v_and_b32 v3, s71, v93
v_pk_mul_f32 v[0:1], v[0:1], s[14:15]
v_pk_mul_f32 v[2:3], v[2:3], s[14:15]
QK 28,60,172,28
s_add_u32 s49, s44, 0x0
ds_write_b128 v15, v[88:91] offset:1152
v_lshlrev_b32 v4, 16, v94
v_and_b32 v5, s71, v94
v_lshlrev_b32 v6, 16, v95
v_and_b32 v7, s71, v95
v_pk_mul_f32 v[4:5], v[4:5], s[14:15]
v_pk_mul_f32 v[6:7], v[6:7], s[14:15]
CV 92,0,1
CV 93,2,3
PV 128,96,36
CV 94,4,5
CV 95,6,7
PV 132,100,36
ds_write_b128 v15, v[92:95] offset:1696
PV 136,104,36
RK 176,14,0
RK 180,14,64
PV 140,108,36
RK 184,14,128
v_xor_b32 v64, s43, v64
RK 188,14,192
PM 128,76,0
PM 130,76,0
PV 144,112,36
buffer_load_dwordx4 v69, s[20:23], s40 offen offset:1024 lds
CV 128,128,129
CV 129,130,131
PM 132,76,0
PM 134,76,0
PV 148,116,36
ds_write_b64 v70, v[128:129] offset:0
CV 132,132,133
CV 133,134,135
PM 136,76,0
PM 138,76,0
PV 152,120,36
ds_write_b64 v70, v[132:133] offset:32
CV 136,136,137
CV 137,138,139
PM 140,76,0
PM 142,76,0
PV 156,124,36
s_waitcnt lgkmcnt(15)
ds_write_b64 v70, v[136:137] offset:64
CV 140,140,141
CV 141,142,143
PM 144,76,0
PM 146,76,0
EX 17
EX 18
EX 19
CV 32,16,17
CV 33,18,19
s_waitcnt lgkmcnt(6)
QZ 16,0,176
ds_write_b64 v70, v[140:141] offset:96
CV 144,144,145
CV 145,146,147
PM 148,76,0
PM 150,76,0
v_lshlrev_b32 v0, 16, v96
v_and_b32 v1, s71, v96
v_lshlrev_b32 v2, 16, v97
v_and_b32 v3, s71, v97
v_pk_mul_f32 v[0:1], v[0:1], s[14:15]
v_pk_mul_f32 v[2:3], v[2:3], s[14:15]
s_waitcnt lgkmcnt(6)
QK 16,4,180,16
ds_write_b64 v70, v[144:145] offset:128
CV 148,148,149
CV 149,150,151
PM 152,76,0
PM 154,76,0
v_lshlrev_b32 v4, 16, v98
v_and_b32 v5, s71, v98
v_lshlrev_b32 v6, 16, v99
v_and_b32 v7, s71, v99
v_pk_mul_f32 v[4:5], v[4:5], s[14:15]
v_pk_mul_f32 v[6:7], v[6:7], s[14:15]
CV 96,0,1
CV 97,2,3
s_waitcnt lgkmcnt(6)
QK 16,8,184,16
ds_write_b64 v70, v[148:149] offset:160
CV 152,152,153
CV 153,154,155
PM 156,76,0
PM 158,76,0
CV 98,4,5
CV 99,6,7
s_waitcnt vmcnt(17)
v_lshlrev_b32 v0, 16, v100
v_and_b32 v1, s71, v100
v_lshlrev_b32 v2, 16, v101
v_and_b32 v3, s71, v101
v_pk_mul_f32 v[0:1], v[0:1], s[14:15]
v_pk_mul_f32 v[2:3], v[2:3], s[14:15]
s_waitcnt lgkmcnt(6)
QK 16,12,188,16
ds_write_b64 v70, v[152:153] offset:192
CV 156,156,157
CV 157,158,159
v_lshlrev_b32 v4, 16, v102
v_and_b32 v5, s71, v102
v_lshlrev_b32 v6, 16, v103
v_and_b32 v7, s71, v103
v_pk_mul_f32 v[4:5], v[4:5], s[14:15]
v_max3_f32 v10, v16, v17, v18
v_pk_mul_f32 v[6:7], v[6:7], s[14:15]
v_max_f32 v10, v10, v19
CV 100,0,1
v_mov_b32 v11, v10
CV 101,2,3
EX 20
v_permlane32_swap_b32 v10, v11
v_max_f32 v10, v10, v11
EX 21
v_mov_b32 v11, v10
EX 22
EX 23
v_permlane16_swap_b32 v10, v11
v_min_f32_e64 v52, -v10, -v11
EX 24
EX 25
EX 26
EX 27
EX 28
EX 29
EX 30
v_exp_f32_e64 v31, v31
CV 34,20,21
CV 35,22,23
CV 36,24,25
CV 37,26,27
CV 38,28,29
CV 39,30,31
v_xor_b32 v65, s43, v65
v_add_f32 v10, v52, v12
v_smfmac_f32_16x16x64_bf16 a[248:251], v[56:59], v[32:39], v71
s_add_u32 s50, s44, 0x10000
ds_write_b64 v70, v[156:157] offset:224
RK 128,15,0
RK 132,15,528
CV 102,4,5
RK 136,15,1056
CV 103,6,7
RK 140,15,1584
ds_write_b128 v15, v[96:99] offset:0
s_waitcnt vmcnt(13)
v_lshlrev_b32 v0, 16, v104
v_and_b32 v1, s71, v104
v_lshlrev_b32 v2, 16, v105
v_accvgpr_read_b32 v45, a248
v_accvgpr_read_b32 v46, a249
v_add_f32 v77, v77, v45
v_accvgpr_read_b32 v49, a250
v_add_f32 v77, v77, v46
v_add_f32 v78, v78, v49
v_cmp_nge_f32 s[6:7], s55, v77
v_rcp_f32 v77, v77
v_accvgpr_read_b32 v50, a251
v_and_b32 v3, s71, v105
v_add_f32 v78, v78, v50
v_pk_mul_f32 v[0:1], v[0:1], s[14:15]
v_cmp_nge_f32 s[8:9], s55, v78
v_rcp_f32 v78, v78
v_pk_mul_f32 v[2:3], v[2:3], s[14:15]
PV 160,96,32
s_waitcnt lgkmcnt(4)
buffer_store_dwordx4 a[128:131], v72, s[28:31], s49 offen nt
ds_write_b128 v15, v[100:103] offset:544
v_lshlrev_b32 v4, 16, v106
v_and_b32 v5, s71, v106
v_lshlrev_b32 v6, 16, v107
v_and_b32 v7, s71, v107
v_pk_mul_f32 v[4:5], v[4:5], s[14:15]
v_pk_mul_f32 v[6:7], v[6:7], s[14:15]
CV 104,0,1
CV 105,2,3
PV 164,100,32
s_waitcnt vmcnt(9) lgkmcnt(4)
buffer_store_dwordx4 a[132:135], v73, s[28:31], s49 offen nt
CV 106,4,5
CV 107,6,7
v_lshlrev_b32 v0, 16, v108
v_and_b32 v1, s71, v108
v_lshlrev_b32 v2, 16, v109
v_and_b32 v3, s71, v109
v_pk_mul_f32 v[0:1], v[0:1], s[14:15]
v_pk_mul_f32 v[2:3], v[2:3], s[14:15]
PV 168,104,32
ds_write_b128 v15, v[104:107] offset:1152
s_waitcnt lgkmcnt(4)
buffer_store_dwordx4 a[136:139], v74, s[28:31], s49 offen nt
v_lshlrev_b32 v4, 16, v110
v_and_b32 v5, s71, v110
v_lshlrev_b32 v6, 16, v111
v_and_b32 v7, s71, v111
v_pk_mul_f32 v[4:5], v[4:5], s[14:15]
v_pk_mul_f32 v[6:7], v[6:7], s[14:15]
CV 108,0,1
CV 109,2,3
PV 172,108,32
s_waitcnt lgkmcnt(3)
CV 110,4,5
CV 111,6,7
buffer_store_dwordx4 a[140:143], v75, s[28:31], s49 offen nt
PM 160,76,1
PM 162,76,1
PV 176,112,32
s_waitcnt vmcnt(63) lgkmcnt(0)
s_barrier
ds_write_b128 v15, v[108:111] offset:1696
RK 192,14,0
RK 196,14,64
CV 160,160,161
RK 200,14,128
CV 161,162,163
RK 204,14,192
PM 164,76,1
PM 166,76,1
PV 180,116,32
s_add_u32 s40, s40, 0x20000
ds_write_b64 v70, v[160:161] offset:0
CV 164,164,165
CV 165,166,167
PM 168,76,1
PM 170,76,1
PV 184,120,32
s_xor_b32 s41, s41, s43
ds_write_b64 v70, v[164:165] offset:32
RK 32,60,0
RK 36,61,0
CV 168,168,169
CV 169,170,171
PM 172,76,1
PM 174,76,1
PV 188,124,32
s_xor_b32 s42, s41, 0xc000
ds_write_b64 v70, v[168:169] offset:64
RK 40,62,0
RK 44,63,0
CV 172,172,173
CV 173,174,175
PM 176,76,1
PM 178,76,1
s_waitcnt lgkmcnt(10)
QZ 24,0,192
s_add_u32 m0, s42, 0x0
ds_write_b64 v70, v[172:173] offset:96
RK 48,60,4096
RK 52,61,4096
CV 176,176,177
CV 177,178,179
PM 180,76,1
PM 182,76,1
s_waitcnt lgkmcnt(12)
QK 24,4,196,24
s_xor_b32 s43, s43, 0xc000
ds_write_b64 v70, v[176:177] offset:128
RK 56,62,4096
RK 60,63,4096
CV 180,180,181
CV 181,182,183
PM 184,76,1
PM 186,76,1
s_waitcnt lgkmcnt(14)
QK 24,8,200,24
buffer_load_dwordx4 v66, s[16:19], s40 offen lds
ds_write_b64 v70, v[180:181] offset:160
CV 184,184,185
CV 185,186,187
PM 188,76,1
PM 190,76,1
s_waitcnt lgkmcnt(14)
QK 24,12,204,24
s_add_u32 s51, s44, 0x20000
ds_write_b64 v70, v[184:185] offset:192
CV 188,188,189
CV 189,190,191
PV 192,96,36
L_t2_pad5:
s_cbranch_execz L_t2_go
RV 96,64,0
RV 98,64,4096
ds_write_b64 v70, v[188:189] offset:224
PV 196,100,36
RK 144,15,0
RK 148,15,528
PV 200,104,36
RK 152,15,1056
v_max3_f32 v8, v24, v25, v26
PV 204,108,36
RK 156,15,1584
v_max_f32 v8, v8, v27
v_add_f32 v11, v52, v13
v_mov_b32 v9, v8
v_add_f32 v16, v10, v16
PM 192,78,0
v_permlane32_swap_b32 v8, v9
v_max_f32 v8, v8, v9
PM 194,78,0
PV 208,112,36
RV 100,65,0
RV 102,65,4096
v_mov_b32 v9, v8
CV 192,192,193
CV 193,194,195
v_permlane16_swap_b32 v8, v9
v_min_f32_e64 v40, -v8, -v9
PM 196,78,0
PM 198,78,0
PV 212,116,36
s_waitcnt lgkmcnt(5)
buffer_store_dwordx4 a[144:147], v72, s[28:31], s50 offen nt
ds_write_b64 v70, v[192:193] offset:0
RV 104,64,256
RV 106,64,4352
CV 196,196,197
CV 197,198,199
PM 200,78,0
PM 202,78,0
PV 216,120,36
s_waitcnt lgkmcnt(7)
buffer_store_dwordx4 a[148:151], v73, s[28:31], s50 offen nt
ds_write_b64 v70, v[196:197] offset:32
RV 108,65,256
RV 110,65,4352
CV 200,200,201
CV 201,202,203
PM 204,78,0
PM 206,78,0
PV 220,124,36
ds_write_b64 v70, v[200:201] offset:64
RV 112,64,512
RV 114,64,4608
s_waitcnt lgkmcnt(12)
buffer_store_dwordx4 a[152:155], v74, s[28:31], s50 offen nt
CV 204,204,205
CV 205,206,207
PM 208,78,0
PM 210,78,0
v_add_f32 v17, v11, v17
v_add_f32 v18, v11, v18
v_add_f32 v19, v11, v19
EX 16
EX 17
EX 18
EX 19
v_mov_b32 v53, v52
v_mov_b32 v54, v52
v_mov_b32_e64 v55, v52
CV 32,16,17
CV 33,18,19
QK 16,32,176,52
buffer_load_dwordx4 v67, s[16:19], s40 offen offset:1024 lds
ds_write_b64 v70, v[204:205] offset:96
RV 116,65,512
RV 118,65,4608
CV 208,208,209
CV 209,210,211
PM 212,78,0
PM 214,78,0
QK 16,36,180,16
ds_write_b64 v70, v[208:209] offset:128
RV 120,64,768
RV 122,64,4864
s_waitcnt lgkmcnt(15)
buffer_store_dwordx4 a[156:159], v75, s[28:31], s50 offen nt
CV 212,212,213
CV 213,214,215
PM 216,78,0
PM 218,78,0
QK 16,40,184,16
s_add_u32 m0, s42, 0x10000
ds_write_b64 v70, v[212:213] offset:160
RV 124,65,768
RV 126,65,4864
CV 216,216,217
CV 217,218,219
PM 220,78,0
PM 222,78,0
QK 16,44,188,16
ds_write_b64 v70, v[216:217] offset:192
CV 220,220,221
CV 221,222,223
QK 20,48,176,52
v_mov_b32 v34, 0
v_mov_b32 v35, 0
ds_write_b64 v70, v[220:221] offset:224
QK 20,52,180,20
RK 160,15,0
RK 164,15,528
QK 20,56,184,20
RK 168,15,1056
v_add_f32 v8, v40, v12
QK 20,60,188,20
RK 172,15,1584
v_add_f32 v9, v40, v13
PZ 224,64,32
buffer_load_dwordx4 v68, s[20:23], s40 offen lds
PZ 228,68,32
v_add_f32 v24, v8, v24
v_add_f32 v25, v9, v25
PZ 232,72,32
v_add_f32 v26, v9, v26
v_add_f32 v27, v9, v27
PZ 236,76,32
v_exp_f32_e64 v24, v24
PZ 240,80,32
s_waitcnt lgkmcnt(6)
EX 25
PZ 244,84,32
s_waitcnt lgkmcnt(3)
buffer_store_dwordx4 a[160:163], v72, s[28:31], s51 offen nt
PZ 248,88,32
v_exp_f32_e64 v26, v26
PZ 252,92,32
RK 0,60,8192
RK 4,61,8192
EX 27
v_mov_b32_e64 v41, v40
v_mov_b32 v42, v40
v_mov_b32_e64 v43, v40
CV 36,24,25
CV 37,26,27
QK 24,32,192,40
s_waitcnt lgkmcnt(4)
buffer_store_dwordx4 a[164:167], v73, s[28:31], s51 offen nt
QK 24,36,196,24
RK 8,62,8192
RK 12,63,8192
QK 24,40,200,24
v_mov_b32 v38, 0
v_mov_b32_e64 v39, 0
QK 24,44,204,24
RK 16,60,12288
RK 20,61,12288
v_smfmac_f32_16x16x64_bf16 a[252:255], v[56:59], v[32:39], v71
RK 24,62,12288
QK 28,48,192,40
s_waitcnt lgkmcnt(8)
buffer_store_dwordx4 a[168:171], v74, s[28:31], s51 offen nt
QK 28,52,196,28
RK 28,63,12288
v_xor_b32 v60, s43, v60
QK 28,56,200,28
v_exp_f32_e64 v16, v16
QK 28,60,204,28
EX 17
PZ 128,64,36
s_waitcnt lgkmcnt(8)
buffer_store_dwordx4 a[172:175], v75, s[28:31], s51 offen nt
PZ 132,68,36
RV 64,64,8192
RV 66,64,12288
PZ 136,72,36
RV 68,65,8192
CV 32,16,17
PZ 140,76,36
RV 70,65,12288
RV 72,64,8448
PZ 144,80,36
buffer_load_dwordx4 v69, s[20:23], s40 offen offset:1024 lds
PZ 148,84,36
s_add_u32 s40, s40, 0x20000
RV 74,64,12544
s_add_u32 m0, s42, 0x2000
PZ 152,88,36
RV 76,65,8448
RV 78,65,12544
PZ 156,92,36
s_waitcnt lgkmcnt(8)
RV 80,64,8704
v_exp_f32_e64 v18, v18
EX 19
v_exp_f32_e64 v20, v20
CV 33,18,19
QK 16,0,176,52
buffer_load_dwordx4 v66, s[16:19], s40 offen lds
QK 16,4,180,16
RV 82,64,12800
RV 84,65,8704
QK 16,8,184,16
RV 86,65,12800
v_xor_b32 v61, s43, v61
QK 16,12,188,16
RV 88,64,8960
RV 90,64,13056
v_exp_f32_e64 v21, v21
EX 22
v_exp_f32_e64 v23, v23
CV 34,20,21
CV 35,22,23
QK 20,16,176,52
buffer_load_dwordx4 v67, s[16:19], s40 offen offset:1024 lds
QK 20,20,180,20
s_add_u32 m0, s42, 0x12000
RV 92,65,8960
RV 94,65,13056
QK 20,24,184,20
EX 24
QK 20,28,188,20
v_exp_f32_e64 v25, v25
PV 224,96,32
buffer_load_dwordx4 v68, s[20:23], s40 offen lds
PV 228,100,32
EX 26
PV 232,104,32
v_exp_f32_e64 v27, v27
PV 236,108,32
CV 36,24,25
CV 37,26,27
PV 240,112,32
s_waitcnt vmcnt(19) lgkmcnt(0)
s_barrier
PV 244,116,32
buffer_load_dwordx4 v69, s[20:23], s40 offen offset:1024 lds
v_xor_b32 v62, s43, v62
v_xor_b32_e64 v63, s43, v63
s_mov_b32 s56, 2
L_t2_loop1:
PV 248,120,32
s_xor_b32 s41, s41, s43
RK 32,60,0
RK 36,61,0
PV 252,124,32
s_xor_b32 s42, s41, 0xc000
RK 40,62,0
v_xor_b32 v64, s43, v64
QK 24,0,192,40
s_add_u32 s40, s40, 0x20000
EX 28
QK 24,4,196,24
s_add_u32 m0, s42, 0x0
EX 29
QK 24,8,200,24
buffer_load_dwordx4 v66, s[16:19], s40 offen lds
QK 24,12,204,24
EX 30
EX 31
CV 38,28,29
CV 39,30,31
v_xor_b32 v65, s43, v65
s_xor_b32 s43, s43, 0xc000
v_smfmac_f32_16x16x64_bf16 a[252:255], v[56:59], v[32:39], v71
RK 44,63,0
QK 28,16,192,40
RK 48,60,4096
RK 52,61,4096
QK 28,20,196,28
EX 16
QK 28,24,200,28
RK 56,62,4096
RK 60,63,4096
QK 28,28,204,28
EX 17
PV 128,96,36
RV 96,64,0
RV 98,64,4096
PV 132,100,36
RV 100,65,0
CV 32,16,17
PV 136,104,36
buffer_load_dwordx4 v67, s[16:19], s40 offen offset:1024 lds
PV 140,108,36
RV 102,65,4096
RV 104,64,256
PV 144,112,36
RV 106,64,4352
PV 148,116,36
s_add_u32 m0, s42, 0x10000
RV 108,65,256
RV 110,65,4352
PV 152,120,36
RV 112,64,512
PV 156,124,36
s_waitcnt lgkmcnt(9)
EX 18
EX 19
EX 20
CV 33,18,19
QK 16,32,176,52
RV 114,64,4608
RV 116,65,512
QK 16,36,180,16
buffer_load_dwordx4 v68, s[20:23], s40 offen lds
QK 16,40,184,16
RV 118,65,4608
RV 120,64,768
QK 16,44,188,16
EX 21
EX 22
EX 23
CV 34,20,21
CV 35,22,23
QK 20,48,176,52
RV 122,64,4864
RV 124,65,768
QK 20,52,180,20
RV 126,65,4864
QK 20,56,184,20
EX 24
QK 20,60,188,20
EX 25
PV 224,64,32
EX 26
PV 228,68,32
buffer_load_dwordx4 v69, s[20:23], s40 offen offset:1024 lds
PV 232,72,32
EX 27
PV 236,76,32
s_add_u32 s40, s40, 0x20000
CV 36,24,25
CV 37,26,27
PV 240,80,32
s_waitcnt lgkmcnt(0)
EX 28
PV 244,84,32
s_add_u32 m0, s42, 0x2000
EX 29
PV 248,88,32
RK 0,60,8192
RK 4,61,8192
PV 252,92,32
RK 8,62,8192
CV 38,28,29
QK 24,32,192,40
EX 30
QK 24,36,196,24
buffer_load_dwordx4 v66, s[16:19], s40 offen lds
QK 24,40,200,24
EX 31
QK 24,44,204,24
RK 12,63,8192
CV 39,30,31
EX 16
s_nop 0
v_smfmac_f32_16x16x64_bf16 a[252:255], v[56:59], v[32:39], v71
RK 16,60,12288
QK 28,48,192,40
RK 20,61,12288
RK 24,62,12288
QK 28,52,196,28
EX 17
QK 28,56,200,28
RK 28,63,12288
CV 32,16,17
QK 28,60,204,28
EX 18
PV 128,64,36
RV 64,64,8192
RV 66,64,12288
PV 132,68,36
buffer_load_dwordx4 v67, s[16:19], s40 offen offset:1024 lds
PV 136,72,36
RV 68,65,8192
RV 70,65,12288
PV 140,76,36
RV 72,64,8448
v_xor_b32 v60, s43, v60
PV 144,80,36
s_add_u32 m0, s42, 0x12000
RV 74,64,12544
RV 76,65,8448
PV 148,84,36
RV 78,65,12544
v_xor_b32 v61, s43, v61
PV 152,88,36
RV 80,64,8704
RV 82,64,12800
PV 156,92,36
s_waitcnt lgkmcnt(10)
EX 19
EX 20
CV 33,18,19
QK 16,0,176,52
buffer_load_dwordx4 v68, s[20:23], s40 offen lds
QK 16,4,180,16
RV 84,65,8704
RV 86,65,12800
QK 16,8,184,16
RV 88,64,8960
v_xor_b32 v62, s43, v62
QK 16,12,188,16
EX 21
EX 22
EX 23
CV 34,20,21
CV 35,22,23
QK 20,16,176,52
RV 90,64,13056
RV 92,65,8960
QK 20,20,180,20
RV 94,65,13056
v_xor_b32 v63, s43, v63
QK 20,24,184,20
EX 24
QK 20,28,188,20
EX 25
PV 224,96,32
buffer_load_dwordx4 v69, s[20:23], s40 offen offset:1024 lds
PV 228,100,32
EX 26
PV 232,104,32
EX 27
PV 236,108,32
CV 36,24,25
CV 37,26,27
PV 240,112,32
s_waitcnt vmcnt(8) lgkmcnt(0)
s_barrier
PV 244,116,32
s_sub_u32 s56, s56, 1
s_cbranch_scc0 L_t2_loop1
PV 248,120,32
s_xor_b32 s41, s41, s43
RK 32,60,0
RK 36,61,0
PV 252,124,32
s_xor_b32 s42, s41, 0xc000
RK 40,62,0
v_xor_b32 v64, s43, v64
QK 24,0,192,40
EX 28
QK 24,4,196,24
EX 29
QK 24,8,200,24
EX 30
QK 24,12,204,24
RK 44,63,0
RK 48,60,4096
EX 31
CV 38,28,29
CV 39,30,31
v_xor_b32 v65, s43, v65
s_xor_b32 s43, s43, 0xc000
v_smfmac_f32_16x16x64_bf16 a[252:255], v[56:59], v[32:39], v71
RK 52,61,4096
QK 28,16,192,40
RK 56,62,4096
RK 60,63,4096
QK 28,20,196,28
EX 16
QK 28,24,200,28
EX 17
QK 28,28,204,28
EX 18
PV 128,96,36
RV 96,64,0
RV 98,64,4096
PV 132,100,36
RV 100,65,0
CV 32,16,17
PV 136,104,36
RV 102,65,4096
RV 104,64,256
PV 140,108,36
EX 19
PV 144,112,36
RV 106,64,4352
RV 108,65,256
PV 148,116,36
RV 110,65,4352
CV 33,18,19
PV 152,120,36
RV 112,64,512
RV 114,64,4608
PV 156,124,36
s_waitcnt lgkmcnt(10)
EX 20
QK 16,32,176,52
RV 116,65,512
RV 118,65,4608
QK 16,36,180,16
EX 21
QK 16,40,184,16
RV 120,64,768
RV 122,64,4864
QK 16,44,188,16
RV 124,65,768
EX 22
EX 23
CV 34,20,21
CV 35,22,23
QK 20,48,176,52
EX 24
QK 20,52,180,20
RV 126,65,4864
QK 20,56,184,20
EX 25
QK 20,60,188,20
EX 26
PV 224,64,32
EX 27
PV 228,68,32
CV 36,24,25
CV 37,26,27
PV 232,72,32
EX 28
PV 236,76,32
EX 29
PV 240,80,32
s_waitcnt lgkmcnt(0)
EX 30
PV 244,84,32
EX 31
PV 248,88,32
RK 0,60,8192
RK 4,61,8192
PV 252,92,32
RK 8,62,8192
CV 38,28,29
QK 24,32,192,40
RK 12,63,8192
CV 39,30,31
QK 24,36,196,24
EX 16
QK 24,40,200,24
RK 16,60,12288
RK 20,61,12288
QK 24,44,204,24
RK 24,62,12288
v_xor_b32 v60, s43, v60
v_smfmac_f32_16x16x64_bf16 a[252:255], v[56:59], v[32:39], v71
RK 28,63,12288
QK 28,48,192,40
EX 17
QK 28,52,196,28
EX 18
QK 28,56,200,28
EX 19
QK 28,60,204,28
CV 32,16,17
CV 33,18,19
PV 128,64,36
RV 64,64,8192
RV 66,64,12288
PV 132,68,36
RV 68,65,8192
v_xor_b32 v61, s43, v61
PV 136,72,36
RV 70,65,12288
RV 72,64,8448
PV 140,76,36
RV 74,64,12544
v_xor_b32 v62, s43, v62
PV 144,80,36
RV 76,65,8448
RV 78,65,12544
PV 148,84,36
RV 80,64,8704
v_xor_b32 v63, s43, v63
PV 152,88,36
RV 82,64,12800
RV 84,65,8704
PV 156,92,36
s_waitcnt lgkmcnt(11)
EX 20
QK 16,0,176,52
L_t2_pad6:
s_cbranch_execz L_t2_go
RV 86,65,12800
RV 88,64,8960
QK 16,4,180,16
EX 21
QK 16,8,184,16
EX 22
QK 16,12,188,16
RV 90,64,13056
RV 92,65,8960
EX 23
CV 34,20,21
CV 35,22,23
QK 20,16,176,52
RV 94,65,13056
v_xor_b32 v64, s43, v64
QK 20,20,180,20
EX 24
QK 20,24,184,20
EX 25
QK 20,28,188,20
EX 26
PV 224,96,32
EX 27
PV 228,100,32
CV 36,24,25
CV 37,26,27
PV 232,104,32
EX 28
PV 236,108,32
EX 29
PV 240,112,32
s_waitcnt vmcnt(0) lgkmcnt(0)
s_barrier
PV 244,116,32
EX 30
PV 248,120,32
s_xor_b32 s41, s41, s43
RK 32,60,0
RK 36,61,0
PV 252,124,32
s_xor_b32 s42, s41, 0xc000
RK 40,62,0
CV 38,28,29
QK 24,0,192,40
EX 31
QK 24,4,196,24
RK 44,63,0
CV 39,30,31
QK 24,8,200,24
RK 48,60,4096
RK 52,61,4096
QK 24,12,204,24
RK 56,62,4096
v_xor_b32 v65, s43, v65
v_smfmac_f32_16x16x64_bf16 a[252:255], v[56:59], v[32:39], v71
s_xor_b32 s43, s43, 0xc000
RK 60,63,4096
QK 28,16,192,40
EX 16
QK 28,20,196,28
EX 17
QK 28,24,200,28
EX 18
QK 28,28,204,28
EX 19
PV 128,96,36
RV 96,64,0
RV 98,64,4096
PV 132,100,36
RV 100,65,0
CV 32,16,17
PV 136,104,36
RV 102,65,4096
RV 104,64,256
PV 140,108,36
RV 106,64,4352
CV 33,18,19
PV 144,112,36
RV 108,65,256
RV 110,65,4352
PV 148,116,36
EX 20
PV 152,120,36
RV 112,64,512
RV 114,64,4608
PV 156,124,36
s_waitcnt lgkmcnt(10)
EX 21
QK 16,32,176,52
RV 116,65,512
RV 118,65,4608
QK 16,36,180,16
RV 120,64,768
CV 34,20,21
QK 16,40,184,16
EX 22
QK 16,44,188,16
EX 23
EX 24
CV 35,22,23
QK 20,48,176,52
RV 122,64,4864
RV 124,65,768
QK 20,52,180,20
RV 126,65,4864
QK 20,56,184,20
EX 25
QK 20,60,188,20
EX 26
PV 224,64,32
EX 27
PV 228,68,32
CV 36,24,25
CV 37,26,27
PV 232,72,32
EX 28
PV 236,76,32
EX 29
PV 240,80,32
s_waitcnt lgkmcnt(0)
EX 30
PV 244,84,32
EX 31
PV 248,88,32
RK 0,60,8192
RK 4,61,8192
PV 252,92,32
RK 8,62,8192
CV 38,28,29
QK 24,32,192,40
RK 12,63,8192
CV 39,30,31
QK 24,36,196,24
EX 16
QK 24,40,200,24
RK 16,60,12288
RK 20,61,12288
QK 24,44,204,24
EX 17
v_smfmac_f32_16x16x64_bf16 a[252:255], v[56:59], v[32:39], v71
RK 24,62,12288
QK 28,48,192,40
RK 28,63,12288
CV 32,16,17
QK 28,52,196,28
EX 18
QK 28,56,200,28
EX 19
QK 28,60,204,28
EX 20
PV 128,64,36
RV 64,64,8192
RV 66,64,12288
PV 132,68,36
RV 68,65,8192
CV 33,18,19
PV 136,72,36
RV 70,65,12288
RV 72,64,8448
PV 140,76,36
EX 21
PV 144,80,36
RV 74,64,12544
RV 76,65,8448
PV 148,84,36
RV 78,65,12544
CV 34,20,21
PV 152,88,36
RV 80,64,8704
RV 82,64,12800
PV 156,92,36
s_waitcnt lgkmcnt(10)
EX 22
QK 16,0,176,52
RV 84,65,8704
RV 86,65,12800
QK 16,4,180,16
EX 23
QK 16,8,184,16
RV 88,64,8960
RV 90,64,13056
QK 16,12,188,16
RV 92,65,8960
CV 35,22,23
QK 20,16,176,52
EX 24
QK 20,20,180,20
RV 94,65,13056
QK 20,24,184,20
EX 25
QK 20,28,188,20
EX 26
PV 224,96,32
EX 27
PV 228,100,32
CV 36,24,25
CV 37,26,27
PV 232,104,32
EX 28
PV 236,108,32
EX 29
PV 240,112,32
s_waitcnt lgkmcnt(0)
EX 30
PV 244,116,32
EX 31
PV 248,120,32
CV 38,28,29
CV 39,30,31
PV 252,124,32
EX 16
QK 24,0,192,40
EX 17
QK 24,4,196,24
EX 18
QK 24,8,200,24
EX 19
QK 24,12,204,24
EX 20
v_smfmac_f32_16x16x64_bf16 a[252:255], v[56:59], v[32:39], v71
CV 32,16,17
QK 28,16,192,40
EX 21
QK 28,20,196,28
EX 22
QK 28,24,200,28
EX 23
QK 28,28,204,28
EX 24
PV 128,96,36
EX 25
PV 132,100,36
EX 26
PV 136,104,36
EX 27
PV 140,108,36
EX 28
PV 144,112,36
EX 29
PV 148,116,36
EX 30
PV 152,120,36
EX 31
PV 156,124,36
CV 33,18,19
CV 34,20,21
CV 35,22,23
CV 36,24,25
CV 37,26,27
CV 38,28,29
CV 39,30,31
s_nop 1
v_smfmac_f32_16x16x64_bf16 a[252:255], v[56:59], v[32:39], v71
s_add_u32 s52, s45, 0x0
s_nop 0
PV 224,64,32
s_nop 2
PV 228,68,32
s_nop 2
PV 232,72,32
s_nop 0
v_accvgpr_read_b32 v79, a252
PV 236,76,32
v_accvgpr_read_b32 v52, a253
v_accvgpr_read_b32 v76, a254
v_add_f32 v79, v79, v52
v_accvgpr_read_b32 v40, a255
v_cmp_nge_f32 s[10:11], s55, v79
v_rcp_f32 v79, v79
v_add_f32 v76, v76, v40
PM 224,78,1
v_cmp_nge_f32 s[96:97], s55, v76
v_rcp_f32 v76, v76
PM 226,78,1
PV 240,80,32
CV 224,224,225
CV 225,226,227
PM 228,78,1
PM 230,78,1
PV 244,84,32
ds_write_b64 v70, v[224:225] offset:0
CV 228,228,229
CV 229,230,231
PM 232,78,1
PM 234,78,1
PV 248,88,32
ds_write_b64 v70, v[228:229] offset:32
CV 232,232,233
CV 233,234,235
PM 236,78,1
PM 238,78,1
PV 252,92,32
s_add_u32 s53, s45, 0x10000
ds_write_b64 v70, v[232:233] offset:64
CV 236,236,237
CV 237,238,239
PM 240,78,1
PM 242,78,1
PV 128,64,36
ds_write_b64 v70, v[236:237] offset:96
CV 240,240,241
CV 241,242,243
PM 244,78,1
PM 246,78,1
PV 132,68,36
ds_write_b64 v70, v[240:241] offset:128
CV 244,244,245
CV 245,246,247
PM 248,78,1
PM 250,78,1
PV 136,72,36
ds_write_b64 v70, v[244:245] offset:160
CV 248,248,249
CV 249,250,251
PM 252,78,1
PM 254,78,1
PV 140,76,36
ds_write_b64 v70, v[248:249] offset:192
CV 252,252,253
CV 253,254,255
PM 128,76,0
PM 130,76,0
PV 144,80,36
ds_write_b64 v70, v[252:253] offset:224
RK 176,15,0
RK 180,15,528
CV 128,128,129
RK 184,15,1056
CV 129,130,131
RK 188,15,1584
PM 132,76,0
PM 134,76,0
PV 148,84,36
ds_write_b64 v70, v[128:129] offset:0
CV 132,132,133
CV 133,134,135
PM 136,76,0
PM 138,76,0
PV 152,88,36
ds_write_b64 v70, v[132:133] offset:32
CV 136,136,137
CV 137,138,139
PM 140,76,0
PM 142,76,0
PV 156,92,36
s_waitcnt lgkmcnt(5)
ds_write_b64 v70, v[136:137] offset:64
buffer_store_dwordx4 a[176:179], v72, s[36:39], s52 offen nt
CV 140,140,141
CV 141,142,143
ds_write_b64 v70, v[140:141] offset:96
PM 144,76,0
PM 146,76,0
CV 144,144,145
CV 145,146,147
ds_write_b64 v70, v[144:145] offset:128
s_waitcnt lgkmcnt(7)
buffer_store_dwordx4 a[180:183], v73, s[36:39], s52 offen nt
PM 148,76,0
PM 150,76,0
CV 148,148,149
CV 149,150,151
ds_write_b64 v70, v[148:149] offset:160
PM 152,76,0
PM 154,76,0
CV 152,152,153
CV 153,154,155
ds_write_b64 v70, v[152:153] offset:192
s_waitcnt lgkmcnt(8)
buffer_store_dwordx4 a[184:187], v74, s[36:39], s52 offen nt
PM 156,76,0
PM 158,76,0
CV 156,156,157
CV 157,158,159
ds_write_b64 v70, v[156:157] offset:224
RK 192,15,0
RK 196,15,528
s_waitcnt lgkmcnt(10)
buffer_store_dwordx4 a[188:191], v75, s[36:39], s52 offen nt
RK 200,15,1056
RK 204,15,1584
s_waitcnt lgkmcnt(3)
buffer_store_dwordx4 a[192:195], v72, s[36:39], s53 offen nt
s_waitcnt lgkmcnt(2)
buffer_store_dwordx4 a[196:199], v73, s[36:39], s53 offen nt
s_waitcnt lgkmcnt(1)
buffer_store_dwordx4 a[200:203], v74, s[36:39], s53 offen nt
s_waitcnt lgkmcnt(0)
buffer_store_dwordx4 a[204:207], v75, s[36:39], s53 offen nt
s_cmp_lg_u64 s[4:5], 0
s_cselect_b32 s62, 1, 0
s_or_b32 s54, s54, s62
s_cmp_lg_u64 s[6:7], 0
s_cselect_b32 s62, 2, 0
s_or_b32 s54, s54, s62
s_cmp_lg_u64 s[8:9], 0
s_cselect_b32 s62, 4, 0
s_or_b32 s54, s54, s62
s_cmp_lg_u64 s[10:11], 0
s_cselect_b32 s62, 16, 0
s_or_b32 s54, s54, s62
s_cmp_lg_u64 s[96:97], 0
s_cselect_b32 s62, 32, 0
s_or_b32 s54, s54, s62
s_cbranch_scc0 L_done2
s_mov_b32 s4, 0xdfa000
s_mov_b32 s5, 934
s_mov_b32 s6, 0xc75000
s_mov_b32 s7, 389
s_getpc_b64 s[62:63]
L_fpc2:
s_add_u32 s62, s62, L_fallback-L_fpc2
s_addc_u32 s63, s63, 0
s_setpc_b64 s[62:63]
L_done2:
s_endpgm
L_end2:
.p2align 12
L_type3:
s_mov_b64 exec, 0
s_cmp_eq_u32 s12, 0
s_cbranch_scc1 L_t3_pad1
s_cmp_eq_u32 s12, 1
s_cbranch_scc1 L_t3_pad2
s_cmp_eq_u32 s12, 2
s_cbranch_scc1 L_t3_pad3
s_branch L_t3_pad4
L_t3_go:
s_mov_b64 exec, -1
s_add_u32 s50, s44, 0x20000
s_add_u32 s51, s44, 0x30000
s_mov_b32 s40, 0x797000
s_add_u32 m0, s47, 0x2000
s_waitcnt vmcnt(9)
buffer_load_dwordx4 v[192:195], v72, s[24:27], s50 offen nt
s_barrier
v_lshlrev_b32 v0, 16, v128
RK 0,60,0
RK 4,61,0
v_and_b32 v1, s71, v128
RK 8,62,0
v_lshlrev_b32 v2, 16, v129
buffer_load_dwordx4 v[196:199], v73, s[24:27], s50 offen nt
RK 12,63,0
v_and_b32 v3, s71, v129
v_lshlrev_b32 v4, 16, v130
v_and_b32 v5, s71, v130
v_lshlrev_b32 v6, 16, v131
v_and_b32_e64 v7, s71, v131
v_pk_mul_f32 v[0:1], v[0:1], s[14:15]
v_pk_mul_f32 v[2:3], v[2:3], s[14:15]
v_pk_mul_f32 v[4:5], v[4:5], s[14:15]
v_pk_mul_f32 v[6:7], v[6:7], s[14:15]
buffer_load_dwordx4 v[200:203], v74, s[24:27], s50 offen nt
CV 128,0,1
CV 129,2,3
CV 130,4,5
CV 131,6,7
ds_write_b128 v15, v[128:131] offset:0
s_waitcnt vmcnt(11)
v_lshlrev_b32 v0, 16, v132
buffer_load_dwordx4 v[204:207], v75, s[24:27], s50 offen nt
v_and_b32 v1, s71, v132
v_lshlrev_b32 v2, 16, v133
v_and_b32 v3, s71, v133
v_lshlrev_b32 v4, 16, v134
v_and_b32 v5, s71, v134
v_lshlrev_b32 v6, 16, v135
v_and_b32_e64 v7, s71, v135
v_pk_mul_f32 v[0:1], v[0:1], s[14:15]
v_pk_mul_f32 v[2:3], v[2:3], s[14:15]
v_pk_mul_f32 v[4:5], v[4:5], s[14:15]
v_pk_mul_f32 v[6:7], v[6:7], s[14:15]
CV 132,0,1
CV 133,2,3
CV 134,4,5
CV 135,6,7
ds_write_b128 v15, v[132:135] offset:544
s_waitcnt vmcnt(11)
v_lshlrev_b32 v0, 16, v136
v_and_b32 v1, s71, v136
v_lshlrev_b32 v2, 16, v137
v_and_b32 v3, s71, v137
v_lshlrev_b32 v4, 16, v138
v_and_b32 v5, s71, v138
v_lshlrev_b32 v6, 16, v139
v_and_b32_e64 v7, s71, v139
v_pk_mul_f32 v[0:1], v[0:1], s[14:15]
v_pk_mul_f32 v[2:3], v[2:3], s[14:15]
v_pk_mul_f32 v[4:5], v[4:5], s[14:15]
v_pk_mul_f32 v[6:7], v[6:7], s[14:15]
CV 136,0,1
CV 137,2,3
CV 138,4,5
CV 139,6,7
ds_write_b128 v15, v[136:139] offset:1152
s_waitcnt vmcnt(10)
v_lshlrev_b32 v0, 16, v140
v_and_b32 v1, s71, v140
v_lshlrev_b32 v2, 16, v141
v_and_b32 v3, s71, v141
v_lshlrev_b32 v4, 16, v142
v_and_b32 v5, s71, v142
v_lshlrev_b32 v6, 16, v143
v_and_b32_e64 v7, s71, v143
v_pk_mul_f32 v[0:1], v[0:1], s[14:15]
v_pk_mul_f32 v[2:3], v[2:3], s[14:15]
v_pk_mul_f32 v[4:5], v[4:5], s[14:15]
v_pk_mul_f32 v[6:7], v[6:7], s[14:15]
CV 140,0,1
CV 141,2,3
CV 142,4,5
CV 143,6,7
ds_write_b128 v15, v[140:143] offset:1696
RK 128,14,0
v_subrev_u32 v12, 0x30000, v71
v_subrev_u32 v13, 0x20000, v71
v_ashrrev_i32 v12, 31, v12
v_ashrrev_i32 v13, 31, v13
v_not_b32 v12, v12
v_not_b32 v13, v13
v_and_b32 v12, 0xff800000, v12
v_and_b32 v13, 0xff800000, v13
RK 132,14,64
RK 136,14,128
v_accvgpr_write_b32 a240, 0
v_accvgpr_write_b32 a241, 0
RK 140,14,192
v_accvgpr_write_b32 a242, 0
v_accvgpr_write_b32 a243, 0
v_accvgpr_write_b32 a244, 0
v_accvgpr_write_b32 a245, 0
s_waitcnt lgkmcnt(3)
QZ 16,0,128
s_mov_b32 s57, 12
v_accvgpr_write_b32 a246, 0
v_accvgpr_write_b32 a247, 0
s_mov_b32 s58, 0x20000
s_mov_b32 s60, 0xff9e9000
s_mov_b32 s59, 0x20000
s_mov_b32 s61, 0xb000
s_mul_i32 s45, s12, 0x20000
s_add_u32 s45, s45, 0x560000
s_mov_b64 s[32:33], s[24:25]
s_waitcnt lgkmcnt(2)
QK 16,4,132,16
s_waitcnt lgkmcnt(1)
s_mov_b32 s34, 0x5aa100
v_accvgpr_write_b32 a248, 0
v_accvgpr_write_b32 a249, 0
QK 16,8,136,16
s_waitcnt lgkmcnt(0)
s_mov_b32 s35, 0x20000
v_accvgpr_write_b32 a250, 0
v_accvgpr_write_b32 a251, 0
QK 16,12,140,16
s_mov_b64 s[36:37], s[28:29]
v_mov_b32 v34, 0
v_mov_b32 v35, 0
s_sub_u32 s57, s57, 1
s_cselect_b64 s[58:59], s[60:61], s[58:59]
s_mov_b32 s38, 0x5aa100
s_mov_b32 s39, 0x20000
s_nop 0
v_max3_f32 v8, v16, v17, v18
v_max_f32 v8, v8, v19
v_mov_b32 v9, v8
s_nop 1
v_permlane32_swap_b32 v8, v9
v_max_f32 v8, v8, v9
v_mov_b32 v9, v8
s_nop 1
v_permlane16_swap_b32 v8, v9
v_min_f32_e64 v40, -v8, -v9
v_add_f32 v8, v40, v12
v_add_f32 v9, v40, v13
v_add_f32 v16, v8, v16
v_add_f32 v17, v8, v17
v_add_f32 v18, v9, v18
v_add_f32 v19, v9, v19
EX 16
EX 17
EX 18
EX 19
CV 32,16,17
CV 33,18,19
v_mov_b32 v41, v40
s_waitcnt vmcnt(7)
buffer_load_dwordx4 v[224:227], v72, s[24:27], s51 offen nt
s_barrier
v_lshlrev_b32 v0, 16, v160
RV 64,64,0
RV 66,64,4096
v_and_b32_e64 v1, s71, v160
RV 68,65,0
buffer_load_dwordx4 v[228:231], v73, s[24:27], s51 offen nt
RV 70,65,4096
RV 72,64,256
v_lshlrev_b32 v2, 16, v161
RV 74,64,4352
RV 76,65,256
v_and_b32 v3, s71, v161
RV 78,65,4352
v_lshlrev_b32 v4, 16, v162
buffer_load_dwordx4 v[232:235], v74, s[24:27], s51 offen nt
RV 80,64,512
RV 82,64,4608
v_and_b32 v5, s71, v162
RV 84,65,512
RV 86,65,4608
v_lshlrev_b32_e64 v6, 16, v163
RV 88,64,768
RV 90,64,4864
buffer_load_dwordx4 v[236:239], v75, s[24:27], s51 offen nt
RV 92,65,768
v_and_b32_e64 v7, s71, v163
RV 94,65,4864
v_pk_mul_f32 v[0:1], v[0:1], s[14:15]
v_pk_mul_f32 v[2:3], v[2:3], s[14:15]
v_pk_mul_f32 v[4:5], v[4:5], s[14:15]
v_pk_mul_f32 v[6:7], v[6:7], s[14:15]
CV 160,0,1
CV 161,2,3
CV 162,4,5
CV 163,6,7
ds_write_b128 v15, v[160:163] offset:0
s_waitcnt vmcnt(10)
v_lshlrev_b32 v0, 16, v164
v_and_b32 v1, s71, v164
v_lshlrev_b32 v2, 16, v165
v_and_b32 v3, s71, v165
v_lshlrev_b32 v4, 16, v166
v_and_b32 v5, s71, v166
v_lshlrev_b32 v6, 16, v167
v_and_b32_e64 v7, s71, v167
v_pk_mul_f32 v[0:1], v[0:1], s[14:15]
v_pk_mul_f32 v[2:3], v[2:3], s[14:15]
v_pk_mul_f32 v[4:5], v[4:5], s[14:15]
v_pk_mul_f32 v[6:7], v[6:7], s[14:15]
CV 164,0,1
CV 165,2,3
CV 166,4,5
CV 167,6,7
ds_write_b128 v15, v[164:167] offset:544
s_waitcnt vmcnt(9)
v_lshlrev_b32 v0, 16, v168
v_and_b32 v1, s71, v168
v_lshlrev_b32 v2, 16, v169
v_and_b32 v3, s71, v169
v_lshlrev_b32 v4, 16, v170
v_and_b32 v5, s71, v170
v_lshlrev_b32 v6, 16, v171
v_and_b32_e64 v7, s71, v171
v_pk_mul_f32 v[0:1], v[0:1], s[14:15]
v_pk_mul_f32 v[2:3], v[2:3], s[14:15]
v_pk_mul_f32 v[4:5], v[4:5], s[14:15]
v_pk_mul_f32 v[6:7], v[6:7], s[14:15]
CV 168,0,1
CV 169,2,3
CV 170,4,5
CV 171,6,7
ds_write_b128 v15, v[168:171] offset:1152
s_waitcnt vmcnt(8)
v_lshlrev_b32 v0, 16, v172
v_and_b32 v1, s71, v172
v_lshlrev_b32 v2, 16, v173
v_and_b32 v3, s71, v173
v_lshlrev_b32 v4, 16, v174
v_and_b32 v5, s71, v174
v_lshlrev_b32 v6, 16, v175
v_and_b32_e64 v7, s71, v175
v_pk_mul_f32 v[0:1], v[0:1], s[14:15]
v_pk_mul_f32 v[2:3], v[2:3], s[14:15]
v_pk_mul_f32 v[4:5], v[4:5], s[14:15]
v_pk_mul_f32 v[6:7], v[6:7], s[14:15]
CV 172,0,1
CV 173,2,3
CV 174,4,5
CV 175,6,7
s_waitcnt lgkmcnt(15)
PZ 128,64,32
ds_write_b128 v15, v[172:175] offset:1696
PZ 132,68,32
s_waitcnt lgkmcnt(14)
RK 144,14,0
RK 148,14,64
PZ 136,72,32
s_waitcnt lgkmcnt(14)
RK 152,14,128
v_mov_b32 v42, v40
PZ 140,76,32
s_waitcnt lgkmcnt(13)
RK 156,14,192
v_mov_b32 v43, v40
PZ 144,80,32
s_waitcnt lgkmcnt(12)
PZ 148,84,32
s_waitcnt lgkmcnt(10)
PZ 152,88,32
s_waitcnt lgkmcnt(8)
PZ 156,92,32
s_waitcnt lgkmcnt(3)
QZ 24,0,144
s_waitcnt lgkmcnt(2)
QK 24,4,148,24
s_waitcnt lgkmcnt(1)
QK 24,8,152,24
s_waitcnt lgkmcnt(0)
QK 24,12,156,24
v_mov_b32 v38, 0
v_mov_b32 v39, 0
s_nop 5
v_max3_f32 v10, v24, v25, v26
v_max_f32 v10, v10, v27
v_mov_b32 v11, v10
s_nop 1
v_permlane32_swap_b32 v10, v11
v_max_f32 v10, v10, v11
v_mov_b32 v11, v10
s_nop 1
v_permlane16_swap_b32 v10, v11
v_min_f32_e64 v44, -v10, -v11
v_add_f32 v10, v44, v12
v_add_f32 v11, v44, v13
v_add_f32 v24, v10, v24
v_add_f32 v25, v10, v25
v_add_f32 v26, v11, v26
v_add_f32 v27, v11, v27
EX 24
EX 25
EX 26
EX 27
CV 36,24,25
CV 37,26,27
v_mov_b32 v45, v44
s_waitcnt vmcnt(7)
buffer_load_dwordx4 v66, s[16:19], s40 offen lds
v_lshlrev_b32 v0, 16, v192
v_and_b32 v1, s71, v192
v_lshlrev_b32 v2, 16, v193
v_and_b32 v3, s71, v193
v_lshlrev_b32 v4, 16, v194
v_and_b32 v5, s71, v194
v_lshlrev_b32 v6, 16, v195
v_and_b32 v7, s71, v195
buffer_load_dwordx4 v67, s[16:19], s40 offen offset:1024 lds
s_add_u32 m0, s47, 0x12000
v_pk_mul_f32 v[0:1], v[0:1], s[14:15]
v_pk_mul_f32 v[2:3], v[2:3], s[14:15]
v_pk_mul_f32 v[4:5], v[4:5], s[14:15]
v_pk_mul_f32 v[6:7], v[6:7], s[14:15]
CV 192,0,1
CV 193,2,3
CV 194,4,5
CV 195,6,7
ds_write_b128 v15, v[192:195] offset:0
buffer_load_dwordx4 v68, s[20:23], s40 offen lds
s_waitcnt vmcnt(9)
v_lshlrev_b32 v0, 16, v196
v_and_b32 v1, s71, v196
v_lshlrev_b32 v2, 16, v197
v_and_b32 v3, s71, v197
v_lshlrev_b32 v4, 16, v198
v_and_b32 v5, s71, v198
v_lshlrev_b32 v6, 16, v199
v_and_b32_e64 v7, s71, v199
v_pk_mul_f32 v[0:1], v[0:1], s[14:15]
v_pk_mul_f32 v[2:3], v[2:3], s[14:15]
buffer_load_dwordx4 v69, s[20:23], s40 offen offset:1024 lds
s_mov_b32 s40, 0x7b7000
s_add_u32 m0, s47, 0x4000
v_pk_mul_f32 v[4:5], v[4:5], s[14:15]
v_pk_mul_f32 v[6:7], v[6:7], s[14:15]
CV 196,0,1
CV 197,2,3
CV 198,4,5
CV 199,6,7
ds_write_b128 v15, v[196:199] offset:544
s_waitcnt vmcnt(9)
v_lshlrev_b32 v0, 16, v200
v_and_b32 v1, s71, v200
v_lshlrev_b32 v2, 16, v201
v_and_b32 v3, s71, v201
v_lshlrev_b32 v4, 16, v202
v_and_b32 v5, s71, v202
v_lshlrev_b32 v6, 16, v203
v_and_b32_e64 v7, s71, v203
v_pk_mul_f32 v[0:1], v[0:1], s[14:15]
v_pk_mul_f32 v[2:3], v[2:3], s[14:15]
v_pk_mul_f32 v[4:5], v[4:5], s[14:15]
v_pk_mul_f32 v[6:7], v[6:7], s[14:15]
CV 200,0,1
CV 201,2,3
CV 202,4,5
CV 203,6,7
ds_write_b128 v15, v[200:203] offset:1152
s_waitcnt vmcnt(8)
v_lshlrev_b32 v0, 16, v204
v_and_b32 v1, s71, v204
v_lshlrev_b32 v2, 16, v205
v_and_b32 v3, s71, v205
v_lshlrev_b32 v4, 16, v206
v_and_b32 v5, s71, v206
v_lshlrev_b32 v6, 16, v207
v_and_b32_e64 v7, s71, v207
v_pk_mul_f32 v[0:1], v[0:1], s[14:15]
v_pk_mul_f32 v[2:3], v[2:3], s[14:15]
v_pk_mul_f32 v[4:5], v[4:5], s[14:15]
v_pk_mul_f32 v[6:7], v[6:7], s[14:15]
CV 204,0,1
CV 205,2,3
CV 206,4,5
CV 207,6,7
PZ 160,64,36
ds_write_b128 v15, v[204:207] offset:1696
PZ 164,68,36
RK 160,14,0
RK 164,14,64
PZ 168,72,36
RK 168,14,128
v_mov_b32 v46, v44
PZ 172,76,36
RK 172,14,192
v_mov_b32 v47, v44
PZ 176,80,36
PZ 180,84,36
PZ 184,88,36
PZ 188,92,36
v_smfmac_f32_16x16x64_bf16 a[240:243], v[56:59], v[32:39], v71
s_waitcnt lgkmcnt(3)
QZ 16,0,160
s_waitcnt lgkmcnt(2)
QK 16,4,164,16
s_waitcnt lgkmcnt(1)
QK 16,8,168,16
s_waitcnt lgkmcnt(0)
QK 16,12,172,16
v_mov_b32 v34, 0
v_mov_b32 v35, 0
s_nop 5
v_max3_f32 v8, v16, v17, v18
v_max_f32 v8, v8, v19
v_mov_b32 v9, v8
s_nop 1
v_permlane32_swap_b32 v8, v9
v_max_f32 v8, v8, v9
v_mov_b32 v9, v8
s_nop 1
v_permlane16_swap_b32 v8, v9
v_min_f32_e64 v48, -v8, -v9
v_add_f32 v8, v48, v12
v_add_f32 v9, v48, v13
v_add_f32 v16, v8, v16
v_add_f32 v17, v8, v17
v_add_f32 v18, v9, v18
v_add_f32 v19, v9, v19
EX 16
EX 17
EX 18
EX 19
CV 32,16,17
CV 33,18,19
v_mov_b32 v49, v48
s_waitcnt vmcnt(7)
buffer_load_dwordx4 v66, s[16:19], s40 offen lds
v_lshlrev_b32 v0, 16, v224
v_and_b32 v1, s71, v224
v_lshlrev_b32 v2, 16, v225
v_and_b32 v3, s71, v225
v_lshlrev_b32 v4, 16, v226
v_and_b32 v5, s71, v226
v_lshlrev_b32 v6, 16, v227
v_and_b32_e64 v7, s71, v227
buffer_load_dwordx4 v67, s[16:19], s40 offen offset:1024 lds
s_add_u32 m0, s47, 0x14000
v_pk_mul_f32 v[0:1], v[0:1], s[14:15]
v_pk_mul_f32 v[2:3], v[2:3], s[14:15]
v_pk_mul_f32 v[4:5], v[4:5], s[14:15]
v_pk_mul_f32 v[6:7], v[6:7], s[14:15]
CV 224,0,1
CV 225,2,3
CV 226,4,5
CV 227,6,7
ds_write_b128 v15, v[224:227] offset:0
buffer_load_dwordx4 v68, s[20:23], s40 offen lds
s_waitcnt vmcnt(9)
v_lshlrev_b32 v0, 16, v228
v_and_b32 v1, s71, v228
v_lshlrev_b32 v2, 16, v229
v_and_b32 v3, s71, v229
v_lshlrev_b32 v4, 16, v230
v_and_b32 v5, s71, v230
v_lshlrev_b32 v6, 16, v231
v_and_b32_e64 v7, s71, v231
v_pk_mul_f32 v[0:1], v[0:1], s[14:15]
v_pk_mul_f32 v[2:3], v[2:3], s[14:15]
buffer_load_dwordx4 v69, s[20:23], s40 offen offset:1024 lds
v_pk_mul_f32 v[4:5], v[4:5], s[14:15]
v_pk_mul_f32 v[6:7], v[6:7], s[14:15]
CV 228,0,1
CV 229,2,3
CV 230,4,5
CV 231,6,7
ds_write_b128 v15, v[228:231] offset:544
s_waitcnt vmcnt(9)
v_lshlrev_b32 v0, 16, v232
v_and_b32 v1, s71, v232
v_lshlrev_b32 v2, 16, v233
v_and_b32 v3, s71, v233
v_lshlrev_b32 v4, 16, v234
v_and_b32 v5, s71, v234
v_lshlrev_b32 v6, 16, v235
v_and_b32_e64 v7, s71, v235
v_pk_mul_f32 v[0:1], v[0:1], s[14:15]
v_pk_mul_f32 v[2:3], v[2:3], s[14:15]
v_pk_mul_f32 v[4:5], v[4:5], s[14:15]
v_pk_mul_f32 v[6:7], v[6:7], s[14:15]
CV 232,0,1
CV 233,2,3
CV 234,4,5
CV 235,6,7
ds_write_b128 v15, v[232:235] offset:1152
s_waitcnt vmcnt(8)
v_lshlrev_b32 v0, 16, v236
v_and_b32 v1, s71, v236
v_lshlrev_b32 v2, 16, v237
v_and_b32 v3, s71, v237
v_lshlrev_b32 v4, 16, v238
v_and_b32 v5, s71, v238
v_lshlrev_b32 v6, 16, v239
v_and_b32_e64 v7, s71, v239
v_pk_mul_f32 v[0:1], v[0:1], s[14:15]
v_pk_mul_f32 v[2:3], v[2:3], s[14:15]
v_pk_mul_f32 v[4:5], v[4:5], s[14:15]
v_pk_mul_f32 v[6:7], v[6:7], s[14:15]
CV 236,0,1
CV 237,2,3
CV 238,4,5
CV 239,6,7
PZ 192,64,32
s_mov_b32 s40, 0x7d7000
ds_write_b128 v15, v[236:239] offset:1696
PZ 196,68,32
s_add_u32 m0, s47, 0x6000
RK 176,14,0
RK 180,14,64
PZ 200,72,32
RK 184,14,128
v_mov_b32 v50, v48
PZ 204,76,32
s_waitcnt vmcnt(6)
s_barrier
PZ 208,80,32
RK 188,14,192
RK 32,60,8192
PZ 212,84,32
buffer_load_dwordx4 v66, s[16:19], s40 offen lds
PZ 216,88,32
RK 36,61,8192
RK 40,62,8192
PZ 220,92,32
s_waitcnt lgkmcnt(6)
RK 44,63,8192
v_mov_b32 v51, v48
QZ 24,0,176
s_waitcnt lgkmcnt(6)
RK 48,60,12288
v_xor_b32 v60, s43, v60
QK 24,4,180,24
s_waitcnt lgkmcnt(6)
buffer_load_dwordx4 v67, s[16:19], s40 offen offset:1024 lds
QK 24,8,184,24
s_waitcnt lgkmcnt(5)
s_add_u32 m0, s47, 0x16000
RK 52,61,12288
RK 56,62,12288
QK 24,12,188,24
s_waitcnt lgkmcnt(6)
RK 60,63,12288
v_xor_b32 v61, s43, v61
QK 16,32,128,40
s_waitcnt lgkmcnt(6)
v_mov_b32 v38, 0
v_mov_b32 v39, 0
QK 16,36,132,16
s_waitcnt lgkmcnt(5)
buffer_load_dwordx4 v68, s[20:23], s40 offen lds
QK 16,40,136,16
s_waitcnt vmcnt(7) lgkmcnt(4)
s_barrier
QK 16,44,140,16
s_waitcnt lgkmcnt(3)
RV 96,64,8192
v_max3_f32 v10, v24, v25, v26
QK 20,48,128,40
s_waitcnt lgkmcnt(3)
RV 98,64,12288
v_max_f32 v10, v10, v27
QK 20,52,132,20
s_waitcnt lgkmcnt(2)
RV 100,65,8192
v_mov_b32 v11, v10
QK 20,56,136,20
s_xor_b32 s41, s41, s43
v_permlane32_swap_b32 v10, v11
QK 20,60,140,20
buffer_load_dwordx4 v69, s[20:23], s40 offen offset:1024 lds
RV 102,65,12288
RV 104,64,8448
v_max_f32 v10, v10, v11
EX 16
v_mov_b32 v11, v10
EX 17
EX 18
v_permlane16_swap_b32 v10, v11
v_min_f32_e64 v52, -v10, -v11
EX 19
v_add_f32 v10, v52, v12
v_add_f32 v11, v52, v13
v_add_f32 v24, v10, v24
v_add_f32 v25, v10, v25
v_add_f32 v26, v11, v26
v_add_f32 v27, v11, v27
EX 24
EX 25
EX 26
EX 27
CV 36,24,25
CV 37,26,27
QK 24,32,144,44
s_xor_b32 s42, s41, 0xc000
RV 106,64,12544
RV 108,65,8448
QK 24,36,148,24
s_mov_b32 s40, 0x7f7000
RV 110,65,12544
v_mov_b32 v53, v52
QK 24,40,152,24
s_add_u32 m0, s47, 0xc000
RV 112,64,8704
RV 114,64,12800
QK 24,44,156,24
RV 116,65,8704
v_mov_b32 v54, v52
v_smfmac_f32_16x16x64_bf16 a[244:247], v[56:59], v[32:39], v71
CV 32,16,17
QK 28,48,144,44
buffer_load_dwordx4 v66, s[16:19], s40 offen lds
QK 28,52,148,28
RV 118,65,12800
CV 33,18,19
QK 28,56,152,28
RV 120,64,8960
RV 122,64,13056
QK 28,60,156,28
RV 124,65,8960
v_mov_b32 v55, v52
PZ 224,64,36
RV 126,65,13056
v_xor_b32 v62, s43, v62
PZ 228,68,36
EX 20
PZ 232,72,36
buffer_load_dwordx4 v67, s[16:19], s40 offen offset:1024 lds
PZ 236,76,36
EX 21
PZ 240,80,36
EX 22
PZ 244,84,36
EX 23
PZ 248,88,36
CV 34,20,21
CV 35,22,23
PZ 252,92,36
EX 24
QK 16,32,160,48
s_add_u32 m0, s47, 0x1c000
EX 25
QK 16,36,164,16
L_t3_pad1:
s_cbranch_execz L_t3_pad5
EX 26
QK 16,40,168,16
buffer_load_dwordx4 v68, s[20:23], s40 offen lds
QK 16,44,172,16
EX 27
QK 20,48,160,48
CV 36,24,25
CV 37,26,27
QK 20,52,164,20
EX 28
QK 20,56,168,20
s_waitcnt lgkmcnt(0)
EX 29
QK 20,60,172,20
EX 30
PV 128,96,32
EX 31
PV 132,100,32
buffer_load_dwordx4 v69, s[20:23], s40 offen offset:1024 lds
PV 136,104,32
CV 38,28,29
CV 39,30,31
PV 140,108,32
v_xor_b32 v63, s43, v63
v_xor_b32 v64, s43, v64
PV 144,112,32
EX 16
PV 148,116,32
s_mov_b32 s40, 0x817000
EX 17
PV 152,120,32
s_add_u32 m0, s47, 0xe000
EX 18
PV 156,124,32
EX 19
QK 24,32,176,52
buffer_load_dwordx4 v66, s[16:19], s40 offen lds
QK 24,36,180,24
EX 20
QK 24,40,184,24
EX 21
QK 24,44,188,24
v_xor_b32 v65, s43, v65
v_subrev_u32 v12, 0x30000, v71
v_smfmac_f32_16x16x64_bf16 a[240:243], v[56:59], v[32:39], v71
s_waitcnt vmcnt(11)
s_barrier
QK 28,48,176,52
s_xor_b32 s43, s43, 0xc000
RK 0,60,0
RK 4,61,0
QK 28,52,180,28
RK 8,62,0
CV 32,16,17
QK 28,56,184,28
buffer_load_dwordx4 v67, s[16:19], s40 offen offset:1024 lds
QK 28,60,188,28
RK 12,63,0
RK 16,60,4096
PV 160,96,36
RK 20,61,4096
CV 33,18,19
PV 164,100,36
RK 24,62,4096
CV 34,20,21
PV 168,104,36
RK 28,63,4096
v_subrev_u32 v13, 0x20000, v71
PV 172,108,36
EX 22
PV 176,112,36
s_add_u32 m0, s47, 0x1e000
EX 23
PV 180,116,36
CV 35,22,23
v_ashrrev_i32 v12, 31, v12
PV 184,120,36
buffer_load_dwordx4 v68, s[20:23], s40 offen lds
PV 188,124,36
s_waitcnt lgkmcnt(7)
EX 24
QK 16,0,128,40
s_waitcnt lgkmcnt(0)
EX 25
QK 16,4,132,16
EX 26
QK 16,8,136,16
EX 27
QK 16,12,140,16
CV 36,24,25
CV 37,26,27
QK 20,16,128,40
EX 28
QK 20,20,132,20
buffer_load_dwordx4 v69, s[20:23], s40 offen offset:1024 lds
QK 20,24,136,20
EX 29
QK 20,28,140,20
EX 30
PV 192,96,32
EX 31
PV 196,100,32
CV 38,28,29
CV 39,30,31
PV 200,104,32
s_waitcnt vmcnt(12)
s_barrier
PV 204,108,32
EX 16
PV 208,112,32
EX 17
PV 212,116,32
EX 18
PV 216,120,32
EX 19
PV 220,124,32
s_mov_b32 s40, 0x837000
RV 64,64,0
RV 66,64,4096
QK 24,0,144,44
s_add_u32 m0, s47, 0x8000
RV 68,65,0
v_ashrrev_i32 v13, 31, v13
QK 24,4,148,24
RV 70,65,4096
RV 72,64,256
QK 24,8,152,24
buffer_load_dwordx4 v66, s[16:19], s40 offen lds
QK 24,12,156,24
RV 74,64,4352
RV 76,65,256
v_smfmac_f32_16x16x64_bf16 a[244:247], v[56:59], v[32:39], v71
CV 32,16,17
QK 28,16,144,44
RV 78,65,4352
CV 33,18,19
QK 28,20,148,28
RV 80,64,512
RV 82,64,4608
QK 28,24,152,28
RV 84,65,512
v_not_b32 v12, v12
QK 28,28,156,28
RV 86,65,4608
RV 88,64,768
PV 224,96,36
RV 90,64,4864
v_not_b32 v13, v13
PV 228,100,36
buffer_load_dwordx4 v67, s[16:19], s40 offen offset:1024 lds
PV 232,104,36
RV 92,65,768
RV 94,65,4864
PV 236,108,36
s_waitcnt vmcnt(10)
s_barrier
PV 240,112,36
RK 32,60,8192
RK 36,61,8192
PV 244,116,36
RK 40,62,8192
v_and_b32 v12, 0xff800000, v12
PV 248,120,36
RK 44,63,8192
v_and_b32 v13, 0xff800000, v13
PV 252,124,36
s_add_u32 m0, s47, 0x18000
EX 20
QK 16,0,160,48
RK 48,60,12288
RK 52,61,12288
QK 16,4,164,16
RK 56,62,12288
v_xor_b32 v60, s43, v60
QK 16,8,168,16
RK 60,63,12288
v_xor_b32 v61, s43, v61
QK 16,12,172,16
buffer_load_dwordx4 v68, s[20:23], s40 offen lds
RV 96,64,8192
EX 21
EX 22
EX 23
CV 34,20,21
CV 35,22,23
QK 20,16,160,48
RV 98,64,12288
RV 100,65,8192
QK 20,20,164,20
EX 24
QK 20,24,168,20
s_waitcnt lgkmcnt(11)
RV 102,65,12288
v_xor_b32 v62, s43, v62
QK 20,28,172,20
EX 25
PV 128,64,32
EX 26
PV 132,68,32
buffer_load_dwordx4 v69, s[20:23], s40 offen offset:1024 lds
PV 136,72,32
RV 104,64,8448
CV 36,24,25
PV 140,76,32
RV 106,64,12544
v_xor_b32 v63, s43, v63
PV 144,80,32
EX 27
PV 148,84,32
RV 108,65,8448
CV 37,26,27
PV 152,88,32
EX 28
PV 156,92,32
EX 29
QK 24,0,176,52
EX 30
QK 24,4,180,24
EX 31
QK 24,8,184,24
RV 110,65,12544
CV 38,28,29
QK 24,12,188,24
RV 112,64,8704
CV 39,30,31
EX 16
s_nop 0
v_smfmac_f32_16x16x64_bf16 a[240:243], v[56:59], v[32:39], v71
RV 114,64,12800
QK 28,16,176,52
EX 17
QK 28,20,180,28
EX 18
QK 28,24,184,28
RV 116,65,8704
CV 32,16,17
QK 28,28,188,28
EX 19
PV 160,64,36
RV 118,65,12800
CV 33,18,19
PV 164,68,36
EX 20
PV 168,72,36
EX 21
PV 172,76,36
RV 120,64,8960
CV 34,20,21
PV 176,80,36
EX 22
PV 180,84,36
EX 23
PV 184,88,36
RV 122,64,13056
CV 35,22,23
PV 188,92,36
s_waitcnt lgkmcnt(14)
RV 124,65,8960
v_xor_b32 v64, s43, v64
QK 16,32,128,40
EX 24
QK 16,36,132,16
EX 25
QK 16,40,136,16
RV 126,65,13056
CV 36,24,25
QK 16,44,140,16
EX 26
QK 20,48,128,40
EX 27
QK 20,52,132,20
CV 37,26,27
v_xor_b32 v65, s43, v65
QK 20,56,136,20
EX 28
QK 20,60,140,20
EX 29
PV 192,64,32
EX 30
PV 196,68,32
EX 31
PV 200,72,32
CV 38,28,29
CV 39,30,31
PV 204,76,32
EX 16
PV 208,80,32
s_waitcnt vmcnt(8) lgkmcnt(0)
s_barrier
PV 212,84,32
EX 17
PV 216,88,32
s_xor_b32 s41, s41, s43
EX 18
PV 220,92,32
s_xor_b32 s42, s41, 0xc000
EX 19
QK 24,32,144,44
s_xor_b32 s43, s43, 0xc000
RK 0,60,0
RK 4,61,0
QK 24,36,148,24
s_mov_b32 s40, 0x857000
EX 20
QK 24,40,152,24
s_add_u32 m0, s47, 0xa000
EX 21
QK 24,44,156,24
RK 8,62,0
v_smfmac_f32_16x16x64_bf16 a[244:247], v[56:59], v[32:39], v71
CV 32,16,17
QK 28,48,144,44
buffer_load_dwordx4 v66, s[16:19], s40 offen lds
QK 28,52,148,28
RK 12,63,0
CV 33,18,19
QK 28,56,152,28
RK 16,60,4096
CV 34,20,21
QK 28,60,156,28
EX 22
PV 224,64,36
EX 23
PV 228,68,36
RK 20,61,4096
CV 35,22,23
PV 232,72,36
buffer_load_dwordx4 v67, s[16:19], s40 offen offset:1024 lds
PV 236,76,36
EX 24
PV 240,80,36
EX 25
PV 244,84,36
RK 24,62,4096
RK 28,63,4096
PV 248,88,36
EX 26
PV 252,92,36
RV 64,64,0
CV 36,24,25
QK 16,32,160,48
s_add_u32 m0, s47, 0x1a000
EX 27
QK 16,36,164,16
EX 28
QK 16,40,168,16
buffer_load_dwordx4 v68, s[20:23], s40 offen lds
QK 16,44,172,16
RV 66,64,4096
CV 37,26,27
QK 20,48,160,48
EX 29
QK 20,52,164,20
RV 68,65,0
CV 38,28,29
QK 20,56,168,20
EX 30
QK 20,60,172,20
EX 31
PV 128,96,32
RV 70,65,4096
CV 39,30,31
PV 132,100,32
buffer_load_dwordx4 v69, s[20:23], s40 offen offset:1024 lds
PV 136,104,32
EX 16
PV 140,108,32
RV 72,64,256
RV 74,64,4352
PV 144,112,32
EX 17
PV 148,116,32
s_mov_b32 s40, 0x877000
EX 18
PV 152,120,32
s_add_u32 m0, s47, 0x0
EX 19
PV 156,124,32
RV 76,65,256
QK 24,32,176,52
buffer_load_dwordx4 v66, s[16:19], s40 offen lds
QK 24,36,180,24
EX 20
QK 24,40,184,24
RV 78,65,4352
RV 80,64,512
QK 24,44,188,24
EX 21
v_smfmac_f32_16x16x64_bf16 a[240:243], v[56:59], v[32:39], v71
RV 82,64,4608
QK 28,48,176,52
CV 32,16,17
CV 33,18,19
QK 28,52,180,28
EX 22
QK 28,56,184,28
buffer_load_dwordx4 v67, s[16:19], s40 offen offset:1024 lds
QK 28,60,188,28
RV 84,65,512
CV 34,20,21
PV 160,96,36
EX 23
PV 164,100,36
RV 86,65,4608
CV 35,22,23
PV 168,104,36
EX 24
PV 172,108,36
EX 25
PV 176,112,36
s_add_u32 m0, s47, 0x10000
EX 26
PV 180,116,36
RV 88,64,768
RV 90,64,4864
PV 184,120,36
buffer_load_dwordx4 v68, s[20:23], s40 offen lds
PV 188,124,36
s_waitcnt lgkmcnt(14)
RV 92,65,768
CV 36,24,25
QK 16,0,128,40
EX 27
QK 16,4,132,16
RV 94,65,4864
CV 37,26,27
QK 16,8,136,16
EX 28
QK 16,12,140,16
EX 29
QK 20,16,128,40
EX 30
QK 20,20,132,20
buffer_load_dwordx4 v69, s[20:23], s40 offen offset:1024 lds
QK 20,24,136,20
EX 31
QK 20,28,140,20
CV 38,28,29
CV 39,30,31
PV 192,96,32
EX 16
PV 196,100,32
PV 200,104,32
EX 17
PV 204,108,32
PV 208,112,32
s_waitcnt vmcnt(12) lgkmcnt(0)
s_barrier
PV 212,116,32
s_add_u32 s40, s40, s58
EX 18
PV 216,120,32
s_add_u32 m0, s42, 0x2000
EX 19
PV 220,124,32
s_mov_b32 s58, s59
RK 32,60,8192
QK 24,0,144,44
s_mov_b32 s59, 0x20000
EX 20
QK 24,4,148,24
RK 36,61,8192
QK 24,8,152,24
buffer_load_dwordx4 v66, s[16:19], s40 offen lds
QK 24,12,156,24
EX 21
v_smfmac_f32_16x16x64_bf16 a[244:247], v[56:59], v[32:39], v71
s_sub_u32 s57, s57, 1
s_cselect_b64 s[58:59], s[60:61], s[58:59]
RK 40,62,8192
QK 28,16,144,44
RK 44,63,8192
CV 32,16,17
QK 28,20,148,28
CV 33,18,19
CV 34,20,21
QK 28,24,152,28
EX 22
QK 28,28,156,28
EX 23
PV 224,96,36
RK 48,60,12288
RK 52,61,12288
PV 228,100,36
buffer_load_dwordx4 v67, s[16:19], s40 offen offset:1024 lds
PV 232,104,36
CV 35,22,23
v_xor_b32 v60, s43, v60
PV 236,108,36
RK 56,62,12288
v_xor_b32 v61, s43, v61
PV 240,112,36
EX 24
PV 244,116,36
s_add_u32 m0, s42, 0x12000
RK 60,63,12288
v_xor_b32 v62, s43, v62
PV 248,120,36
EX 25
PV 252,124,36
RV 96,64,8192
CV 36,24,25
QK 16,0,160,48
EX 26
QK 16,4,164,16
buffer_load_dwordx4 v68, s[20:23], s40 offen lds
QK 16,8,168,16
RV 98,64,12288
v_xor_b32 v63, s43, v63
QK 16,12,172,16
EX 27
QK 20,16,160,48
RV 100,65,8192
CV 37,26,27
QK 20,20,164,20
EX 28
QK 20,24,168,20
EX 29
QK 20,28,172,20
RV 102,65,12288
CV 38,28,29
PV 128,64,32
EX 30
PV 132,68,32
buffer_load_dwordx4 v69, s[20:23], s40 offen offset:1024 lds
PV 136,72,32
EX 31
PV 140,76,32
RV 104,64,8448
RV 106,64,12544
PV 144,80,32
EX 16
PV 148,84,32
RV 108,65,8448
CV 39,30,31
PV 152,88,32
EX 17
PV 156,92,32
EX 18
QK 24,0,176,52
EX 19
QK 24,4,180,24
EX 20
QK 24,8,184,24
RV 110,65,12544
RV 112,64,8704
QK 24,12,188,24
EX 21
v_smfmac_f32_16x16x64_bf16 a[240:243], v[56:59], v[32:39], v71
RV 114,64,12800
QK 28,16,176,52
CV 32,16,17
CV 33,18,19
QK 28,20,180,28
EX 22
QK 28,24,184,28
RV 116,65,8704
CV 34,20,21
QK 28,28,188,28
EX 23
PV 160,64,36
RV 118,65,12800
CV 35,22,23
PV 164,68,36
EX 24
PV 168,72,36
EX 25
PV 172,76,36
RV 120,64,8960
PV 176,80,36
EX 26
PV 180,84,36
RV 122,64,13056
v_xor_b32 v64, s43, v64
PV 184,88,36
EX 27
PV 188,92,36
s_waitcnt lgkmcnt(14)
RV 124,65,8960
CV 36,24,25
QK 16,32,128,40
EX 28
QK 16,36,132,16
RV 126,65,13056
CV 37,26,27
QK 16,40,136,16
EX 29
QK 16,44,140,16
L_t3_pad2:
s_cbranch_execz L_t3_pad6
CV 38,28,29
v_xor_b32_e64 v65, s43, v65
QK 20,48,128,40
v_exp_f32_e64 v30, v30
QK 20,52,132,20
QK 20,56,136,20
v_exp_f32_e64 v31, v31
QK 20,60,140,20
CV 39,30,31
PV 192,64,32
v_exp_f32_e64 v16, v16
PV 196,68,32
PV 200,72,32
v_exp_f32_e64 v17, v17
PV 204,76,32
PV 208,80,32
s_waitcnt vmcnt(8) lgkmcnt(0)
s_barrier
PV 212,84,32
s_mov_b32 s56, 4
L_t3_loop0:
PV 216,88,32
s_xor_b32 s41, s41, s43
EX 18
PV 220,92,32
s_xor_b32 s42, s41, 0xc000
RK 0,60,0
QK 24,32,144,44
s_add_u32 s40, s40, s58
EX 19
QK 24,36,148,24
s_add_u32 m0, s42, 0x0
RK 4,61,0
QK 24,40,152,24
buffer_load_dwordx4 v66, s[16:19], s40 offen lds
QK 24,44,156,24
s_mov_b32 s58, s59
RK 8,62,0
v_smfmac_f32_16x16x64_bf16 a[244:247], v[56:59], v[32:39], v71
s_mov_b32 s59, 0x20000
s_xor_b32 s43, s43, 0xc000
CV 32,16,17
QK 28,48,144,44
RK 12,63,0
CV 33,18,19
QK 28,52,148,28
EX 20
QK 28,56,152,28
EX 21
QK 28,60,156,28
RK 16,60,4096
CV 34,20,21
PV 224,64,36
EX 22
PV 228,68,36
buffer_load_dwordx4 v67, s[16:19], s40 offen offset:1024 lds
PV 232,72,36
RK 20,61,4096
PV 236,76,36
EX 23
PV 240,80,36
RK 24,62,4096
CV 35,22,23
PV 244,84,36
s_add_u32 m0, s42, 0x10000
EX 24
PV 248,88,36
RK 28,63,4096
PV 252,92,36
EX 25
QK 16,32,160,48
RV 64,64,0
CV 36,24,25
QK 16,36,164,16
buffer_load_dwordx4 v68, s[20:23], s40 offen lds
QK 16,40,168,16
EX 26
QK 16,44,172,16
RV 66,64,4096
QK 20,48,160,48
EX 27
QK 20,52,164,20
RV 68,65,0
CV 37,26,27
QK 20,56,168,20
EX 28
QK 20,60,172,20
RV 70,65,4096
PV 128,96,32
EX 29
PV 132,100,32
buffer_load_dwordx4 v69, s[20:23], s40 offen offset:1024 lds
PV 136,104,32
RV 72,64,256
CV 38,28,29
PV 140,108,32
EX 30
PV 144,112,32
RV 74,64,4352
PV 148,116,32
EX 31
PV 152,120,32
RV 76,65,256
CV 39,30,31
PV 156,124,32
EX 16
QK 24,32,176,52
EX 17
QK 24,36,180,24
RV 78,65,4352
QK 24,40,184,24
EX 18
QK 24,44,188,24
RV 80,64,512
v_smfmac_f32_16x16x64_bf16 a[240:243], v[56:59], v[32:39], v71
s_sub_u32 s57, s57, 1
s_cselect_b64 s[58:59], s[60:61], s[58:59]
RV 82,64,4608
QK 28,48,176,52
EX 19
QK 28,52,180,28
CV 32,16,17
CV 33,18,19
QK 28,56,184,28
EX 20
QK 28,60,188,28
RV 84,65,512
PV 160,96,36
EX 21
PV 164,100,36
RV 86,65,4608
CV 34,20,21
PV 168,104,36
EX 22
PV 172,108,36
RV 88,64,768
PV 176,112,36
EX 23
PV 180,116,36
RV 90,64,4864
CV 35,22,23
PV 184,120,36
EX 24
PV 188,124,36
s_waitcnt lgkmcnt(14)
EX 25
QK 16,0,128,40
RV 92,65,768
CV 36,24,25
QK 16,4,132,16
EX 26
QK 16,8,136,16
RV 94,65,4864
QK 16,12,140,16
EX 27
QK 20,16,128,40
EX 28
QK 20,20,132,20
EX 29
QK 20,24,136,20
CV 37,26,27
CV 38,28,29
QK 20,28,140,20
EX 30
PV 192,96,32
EX 31
PV 196,100,32
EX 16
PV 200,104,32
EX 17
PV 204,108,32
CV 39,30,31
PV 208,112,32
s_waitcnt lgkmcnt(0)
EX 18
PV 212,116,32
s_add_u32 s40, s40, s58
PV 216,120,32
s_add_u32 m0, s42, 0x2000
EX 19
PV 220,124,32
s_mov_b32 s58, s59
RK 32,60,8192
QK 24,0,144,44
s_mov_b32 s59, 0x20000
EX 20
QK 24,4,148,24
RK 36,61,8192
QK 24,8,152,24
buffer_load_dwordx4 v66, s[16:19], s40 offen lds
QK 24,12,156,24
RK 40,62,8192
v_smfmac_f32_16x16x64_bf16 a[244:247], v[56:59], v[32:39], v71
s_sub_u32 s57, s57, 1
s_cselect_b64 s[58:59], s[60:61], s[58:59]
CV 32,16,17
QK 28,16,144,44
RK 44,63,8192
CV 33,18,19
QK 28,20,148,28
EX 21
QK 28,24,152,28
RK 48,60,12288
CV 34,20,21
QK 28,28,156,28
EX 22
PV 224,96,36
RK 52,61,12288
v_xor_b32 v60, s43, v60
PV 228,100,36
buffer_load_dwordx4 v67, s[16:19], s40 offen offset:1024 lds
PV 232,104,36
EX 23
PV 236,108,36
RK 56,62,12288
CV 35,22,23
PV 240,112,36
EX 24
PV 244,116,36
s_add_u32 m0, s42, 0x12000
RK 60,63,12288
v_xor_b32 v61, s43, v61
PV 248,120,36
EX 25
PV 252,124,36
RV 96,64,8192
CV 36,24,25
QK 16,0,160,48
EX 26
QK 16,4,164,16
buffer_load_dwordx4 v68, s[20:23], s40 offen lds
QK 16,8,168,16
RV 98,64,12288
v_xor_b32 v62, s43, v62
QK 16,12,172,16
EX 27
QK 20,16,160,48
RV 100,65,8192
CV 37,26,27
QK 20,20,164,20
EX 28
QK 20,24,168,20
RV 102,65,12288
v_xor_b32 v63, s43, v63
QK 20,28,172,20
EX 29
PV 128,64,32
EX 30
PV 132,68,32
buffer_load_dwordx4 v69, s[20:23], s40 offen offset:1024 lds
PV 136,72,32
RV 104,64,8448
CV 38,28,29
PV 140,76,32
EX 31
PV 144,80,32
RV 106,64,12544
CV 39,30,31
PV 148,84,32
EX 16
PV 152,88,32
RV 108,65,8448
PV 156,92,32
EX 17
QK 24,0,176,52
EX 18
QK 24,4,180,24
RV 110,65,12544
QK 24,8,184,24
EX 19
QK 24,12,188,24
RV 112,64,8704
v_smfmac_f32_16x16x64_bf16 a[240:243], v[56:59], v[32:39], v71
RV 114,64,12800
QK 28,16,176,52
CV 32,16,17
CV 33,18,19
QK 28,20,180,28
EX 20
QK 28,24,184,28
EX 21
QK 28,28,188,28
RV 116,65,8704
CV 34,20,21
PV 160,64,36
EX 22
PV 164,68,36
RV 118,65,12800
PV 168,72,36
EX 23
PV 172,76,36
RV 120,64,8960
CV 35,22,23
PV 176,80,36
EX 24
PV 180,84,36
EX 25
PV 184,88,36
RV 122,64,13056
v_xor_b32 v64, s43, v64
PV 188,92,36
s_waitcnt lgkmcnt(14)
RV 124,65,8960
CV 36,24,25
QK 16,32,128,40
EX 26
QK 16,36,132,16
EX 27
QK 16,40,136,16
RV 126,65,13056
CV 37,26,27
QK 16,44,140,16
EX 28
QK 20,48,128,40
EX 29
QK 20,52,132,20
EX 30
QK 20,56,136,20
EX 31
QK 20,60,140,20
CV 38,28,29
CV 39,30,31
PV 192,64,32
EX 16
PV 196,68,32
v_xor_b32 v65, s43, v65
PV 200,72,32
EX 17
PV 204,76,32
PV 208,80,32
s_waitcnt vmcnt(8) lgkmcnt(0)
s_barrier
PV 212,84,32
s_sub_u32 s56, s56, 1
s_cbranch_scc0 L_t3_loop0
PV 216,88,32
s_xor_b32 s41, s41, s43
EX 18
PV 220,92,32
s_xor_b32 s42, s41, 0xc000
EX 19
QK 24,32,144,44
s_add_u32 s40, s40, s58
RK 0,60,0
RK 4,61,0
QK 24,36,148,24
s_add_u32 m0, s42, 0x0
EX 20
QK 24,40,152,24
buffer_load_dwordx4 v66, s[16:19], s40 offen lds
QK 24,44,156,24
s_add_u32 s52, s45, 0x0
EX 21
v_smfmac_f32_16x16x64_bf16 a[244:247], v[56:59], v[32:39], v71
s_mov_b32 s58, s59
s_mov_b32 s59, 0x20000
RK 8,62,0
QK 28,48,144,44
buffer_load_dwordx4 v[80:83], v72, s[32:35], s52 offen nt
QK 28,52,148,28
s_xor_b32 s43, s43, 0xc000
RK 12,63,0
CV 32,16,17
QK 28,56,152,28
RK 16,60,4096
CV 33,18,19
QK 28,60,156,28
EX 22
PV 224,64,36
RK 20,61,4096
CV 34,20,21
PV 228,68,36
buffer_load_dwordx4 v67, s[16:19], s40 offen offset:1024 lds
PV 232,72,36
EX 23
PV 236,76,36
RK 24,62,4096
CV 35,22,23
PV 240,80,36
EX 24
PV 244,84,36
s_add_u32 m0, s42, 0x10000
EX 25
PV 248,88,36
EX 26
PV 252,92,36
RK 28,63,4096
RV 64,64,0
QK 16,32,160,48
EX 27
QK 16,36,164,16
buffer_load_dwordx4 v68, s[20:23], s40 offen lds
QK 16,40,168,16
RV 66,64,4096
CV 36,24,25
QK 16,44,172,16
EX 28
QK 20,48,160,48
RV 68,65,0
CV 37,26,27
QK 20,52,164,20
EX 29
QK 20,56,168,20
RV 70,65,4096
CV 38,28,29
QK 20,60,172,20
EX 30
PV 128,96,32
EX 31
PV 132,100,32
buffer_load_dwordx4 v69, s[20:23], s40 offen offset:1024 lds
PV 136,104,32
RV 72,64,256
CV 39,30,31
PV 140,108,32
EX 16
PV 144,112,32
EX 17
PV 148,116,32
RV 74,64,4352
RV 76,65,256
PV 152,120,32
EX 18
PV 156,124,32
EX 19
QK 24,32,176,52
EX 20
QK 24,36,180,24
RV 78,65,4352
QK 24,40,184,24
EX 21
QK 24,44,188,24
RV 80,64,512
v_smfmac_f32_16x16x64_bf16 a[240:243], v[56:59], v[32:39], v71
s_sub_u32 s57, s57, 1
s_cselect_b64 s[58:59], s[60:61], s[58:59]
RV 82,64,4608
QK 28,48,176,52
CV 32,16,17
CV 33,18,19
QK 28,52,180,28
EX 22
QK 28,56,184,28
buffer_load_dwordx4 v[84:87], v73, s[32:35], s52 offen nt
QK 28,60,188,28
RV 84,65,512
CV 34,20,21
PV 160,96,36
EX 23
PV 164,100,36
RV 86,65,4608
CV 35,22,23
PV 168,104,36
EX 24
PV 172,108,36
EX 25
PV 176,112,36
EX 26
PV 180,116,36
RV 88,64,768
RV 90,64,4864
PV 184,120,36
EX 27
PV 188,124,36
s_waitcnt lgkmcnt(14)
RV 92,65,768
CV 36,24,25
QK 16,0,128,40
EX 28
QK 16,4,132,16
RV 94,65,4864
CV 37,26,27
QK 16,8,136,16
EX 29
QK 16,12,140,16
CV 38,28,29
QK 20,16,128,40
EX 30
QK 20,20,132,20
QK 20,24,136,20
EX 31
QK 20,28,140,20
CV 39,30,31
PV 192,96,32
EX 16
PV 196,100,32
PV 200,104,32
EX 17
PV 204,108,32
PV 208,112,32
s_waitcnt lgkmcnt(0)
EX 18
PV 212,116,32
s_add_u32 s40, s40, s58
PV 216,120,32
s_add_u32 m0, s42, 0x2000
EX 19
PV 220,124,32
s_mov_b32 s58, s59
RK 32,60,8192
QK 24,0,144,44
s_mov_b32 s59, 0x20000
EX 20
QK 24,4,148,24
RK 36,61,8192
QK 24,8,152,24
buffer_load_dwordx4 v66, s[16:19], s40 offen lds
QK 24,12,156,24
EX 21
v_smfmac_f32_16x16x64_bf16 a[244:247], v[56:59], v[32:39], v71
s_sub_u32 s57, s57, 1
s_cselect_b64 s[58:59], s[60:61], s[58:59]
RK 40,62,8192
QK 28,16,144,44
RK 44,63,8192
CV 32,16,17
QK 28,20,148,28
CV 33,18,19
CV 34,20,21
QK 28,24,152,28
EX 22
QK 28,28,156,28
EX 23
PV 224,96,36
RK 48,60,12288
RK 52,61,12288
PV 228,100,36
buffer_load_dwordx4 v67, s[16:19], s40 offen offset:1024 lds
PV 232,104,36
CV 35,22,23
v_xor_b32 v60, s43, v60
PV 236,108,36
RK 56,62,12288
v_xor_b32 v61, s43, v61
PV 240,112,36
EX 24
PV 244,116,36
buffer_load_dwordx4 v[88:91], v74, s[32:35], s52 offen nt
PV 248,120,36
s_add_u32 m0, s42, 0x12000
RK 60,63,12288
v_xor_b32 v62, s43, v62
PV 252,124,36
RV 96,64,8192
v_xor_b32 v63, s43, v63
QK 16,0,160,48
EX 25
QK 16,4,164,16
buffer_load_dwordx4 v68, s[20:23], s40 offen lds
QK 16,8,168,16
RV 98,64,12288
CV 36,24,25
QK 16,12,172,16
EX 26
QK 20,16,160,48
EX 27
QK 20,20,164,20
RV 100,65,8192
CV 37,26,27
QK 20,24,168,20
EX 28
QK 20,28,172,20
EX 29
PV 128,64,32
RV 102,65,12288
CV 38,28,29
PV 132,68,32
buffer_load_dwordx4 v69, s[20:23], s40 offen offset:1024 lds
PV 136,72,32
EX 30
PV 140,76,32
RV 104,64,8448
RV 106,64,12544
PV 144,80,32
EX 31
PV 148,84,32
RV 108,65,8448
CV 39,30,31
PV 152,88,32
EX 16
PV 156,92,32
EX 17
QK 24,0,176,52
EX 18
QK 24,4,180,24
EX 19
QK 24,8,184,24
RV 110,65,12544
RV 112,64,8704
QK 24,12,188,24
L_t3_pad3:
s_cbranch_execz L_t3_go
EX 20
v_smfmac_f32_16x16x64_bf16 a[240:243], v[56:59], v[32:39], v71
RV 114,64,12800
QK 28,16,176,52
CV 32,16,17
CV 33,18,19
QK 28,20,180,28
EX 21
QK 28,24,184,28
RV 116,65,8704
CV 34,20,21
QK 28,28,188,28
EX 22
PV 160,64,36
EX 23
PV 164,68,36
RV 118,65,12800
CV 35,22,23
PV 168,72,36
EX 24
PV 172,76,36
EX 25
PV 176,80,36
EX 26
PV 180,84,36
RV 120,64,8960
RV 122,64,13056
PV 184,88,36
buffer_load_dwordx4 v[92:95], v75, s[32:35], s52 offen nt
PV 188,92,36
s_waitcnt lgkmcnt(14)
RV 124,65,8960
CV 36,24,25
QK 16,32,128,40
s_sub_u32 s52, s34, s45
EX 27
QK 16,36,132,16
s_ashr_i32 s52, s52, 8
RV 126,65,13056
CV 37,26,27
QK 16,40,136,16
s_sub_u32 s52, s52, 0
EX 28
QK 16,44,140,16
EX 29
QK 20,48,128,40
EX 30
QK 20,52,132,20
CV 38,28,29
v_xor_b32 v64, s43, v64
QK 20,56,136,20
EX 31
QK 20,60,140,20
CV 39,30,31
v_xor_b32 v65, s43, v65
PV 192,64,32
EX 16
PV 196,68,32
PV 200,72,32
EX 17
PV 204,76,32
PV 208,80,32
s_waitcnt vmcnt(12) lgkmcnt(0)
s_barrier
PV 212,84,32
s_add_u32 s40, s40, s58
EX 18
PV 216,88,32
s_xor_b32 s41, s41, s43
EX 19
PV 220,92,32
s_xor_b32 s42, s41, 0xc000
RK 0,60,0
QK 24,32,144,44
s_add_u32 m0, s42, 0x0
EX 20
QK 24,36,148,24
s_mov_b32 s58, s59
RK 4,61,0
QK 24,40,152,24
buffer_load_dwordx4 v66, s[16:19], s40 offen lds
QK 24,44,156,24
s_mov_b32 s59, 0x20000
EX 21
v_smfmac_f32_16x16x64_bf16 a[244:247], v[56:59], v[32:39], v71
s_sub_u32 s57, s57, 1
s_cselect_b64 s[58:59], s[60:61], s[58:59]
RK 8,62,0
QK 28,48,144,44
s_xor_b32 s43, s43, 0xc000
RK 12,63,0
CV 32,16,17
QK 28,52,148,28
CV 33,18,19
CV 34,20,21
QK 28,56,152,28
EX 22
QK 28,60,156,28
EX 23
PV 224,64,36
RK 16,60,4096
RK 20,61,4096
PV 228,68,36
buffer_load_dwordx4 v67, s[16:19], s40 offen offset:1024 lds
PV 232,72,36
EX 24
PV 236,76,36
RK 24,62,4096
CV 35,22,23
PV 240,80,36
EX 25
PV 244,84,36
s_add_u32 m0, s42, 0x10000
EX 26
PV 248,88,36
EX 27
PV 252,92,36
RK 28,63,4096
RV 64,64,0
QK 16,32,160,48
s_add_u32 s53, s45, 0x10000
CV 36,24,25
CV 37,26,27
QK 16,36,164,16
buffer_load_dwordx4 v68, s[20:23], s40 offen lds
QK 16,40,168,16
EX 28
QK 16,44,172,16
EX 29
QK 20,48,160,48
RV 66,64,4096
RV 68,65,0
QK 20,52,164,20
buffer_load_dwordx4 v[96:99], v72, s[32:35], s53 offen nt
QK 20,56,168,20
RV 70,65,4096
CV 38,28,29
QK 20,60,172,20
EX 30
PV 128,96,32
EX 31
PV 132,100,32
buffer_load_dwordx4 v69, s[20:23], s40 offen offset:1024 lds
PV 136,104,32
RV 72,64,256
CV 39,30,31
PV 140,108,32
EX 16
PV 144,112,32
EX 17
PV 148,116,32
RV 74,64,4352
RV 76,65,256
PV 152,120,32
EX 18
PV 156,124,32
EX 19
QK 24,32,176,52
EX 20
QK 24,36,180,24
RV 78,65,4352
QK 24,40,184,24
EX 21
QK 24,44,188,24
RV 80,64,512
v_smfmac_f32_16x16x64_bf16 a[240:243], v[56:59], v[32:39], v71
RV 82,64,4608
QK 28,48,176,52
CV 32,16,17
CV 33,18,19
QK 28,52,180,28
EX 22
QK 28,56,184,28
RV 84,65,512
CV 34,20,21
QK 28,60,188,28
EX 23
PV 160,96,36
RV 86,65,4608
CV 35,22,23
PV 164,100,36
EX 24
PV 168,104,36
EX 25
PV 172,108,36
RV 88,64,768
PV 176,112,36
EX 26
PV 180,116,36
RV 90,64,4864
PV 184,120,36
EX 27
PV 188,124,36
s_waitcnt lgkmcnt(14)
RV 92,65,768
CV 36,24,25
QK 16,0,128,40
EX 28
QK 16,4,132,16
RV 94,65,4864
CV 37,26,27
QK 16,8,136,16
EX 29
QK 16,12,140,16
CV 38,28,29
QK 20,16,128,40
EX 30
QK 20,20,132,20
QK 20,24,136,20
buffer_load_dwordx4 v[100:103], v73, s[32:35], s53 offen nt
QK 20,28,140,20
EX 31
PV 192,96,32
EX 16
PV 196,100,32
CV 39,30,31
PV 200,104,32
EX 17
PV 204,108,32
PV 208,112,32
s_waitcnt lgkmcnt(0)
EX 18
PV 212,116,32
s_add_u32 s40, s40, s58
PV 216,120,32
s_add_u32 m0, s42, 0x2000
EX 19
PV 220,124,32
s_mov_b32 s58, s59
RK 32,60,8192
QK 24,0,144,44
s_mov_b32 s59, 0x20000
EX 20
QK 24,4,148,24
RK 36,61,8192
QK 24,8,152,24
buffer_load_dwordx4 v66, s[16:19], s40 offen lds
QK 24,12,156,24
EX 21
v_smfmac_f32_16x16x64_bf16 a[244:247], v[56:59], v[32:39], v71
s_sub_u32 s57, s57, 1
s_cselect_b64 s[58:59], s[60:61], s[58:59]
RK 40,62,8192
QK 28,16,144,44
RK 44,63,8192
CV 32,16,17
QK 28,20,148,28
CV 33,18,19
CV 34,20,21
QK 28,24,152,28
EX 22
QK 28,28,156,28
EX 23
PV 224,96,36
RK 48,60,12288
RK 52,61,12288
PV 228,100,36
buffer_load_dwordx4 v67, s[16:19], s40 offen offset:1024 lds
PV 232,104,36
CV 35,22,23
v_xor_b32 v60, s43, v60
PV 236,108,36
RK 56,62,12288
v_xor_b32 v61, s43, v61
PV 240,112,36
EX 24
PV 244,116,36
s_add_u32 m0, s42, 0x12000
RK 60,63,12288
v_xor_b32 v62, s43, v62
PV 248,120,36
EX 25
PV 252,124,36
RV 96,64,8192
CV 36,24,25
QK 16,0,160,48
EX 26
QK 16,4,164,16
buffer_load_dwordx4 v68, s[20:23], s40 offen lds
QK 16,8,168,16
RV 98,64,12288
v_xor_b32 v63, s43, v63
QK 16,12,172,16
EX 27
QK 20,16,160,48
RV 100,65,8192
CV 37,26,27
QK 20,20,164,20
EX 28
QK 20,24,168,20
EX 29
QK 20,28,172,20
RV 102,65,12288
CV 38,28,29
PV 128,64,32
EX 30
PV 132,68,32
buffer_load_dwordx4 v69, s[20:23], s40 offen offset:1024 lds
PV 136,72,32
EX 31
PV 140,76,32
RV 104,64,8448
RV 106,64,12544
PV 144,80,32
EX 16
PV 148,84,32
buffer_load_dwordx4 v[104:107], v74, s[32:35], s53 offen nt
PV 152,88,32
RV 108,65,8448
CV 39,30,31
PV 156,92,32
EX 17
QK 24,0,176,52
EX 18
QK 24,4,180,24
EX 19
QK 24,8,184,24
RV 110,65,12544
RV 112,64,8704
QK 24,12,188,24
EX 20
v_smfmac_f32_16x16x64_bf16 a[240:243], v[56:59], v[32:39], v71
RV 114,64,12800
QK 28,16,176,52
CV 32,16,17
CV 33,18,19
QK 28,20,180,28
EX 21
QK 28,24,184,28
RV 116,65,8704
CV 34,20,21
QK 28,28,188,28
EX 22
PV 160,64,36
EX 23
PV 164,68,36
RV 118,65,12800
CV 35,22,23
PV 168,72,36
EX 24
PV 172,76,36
EX 25
PV 176,80,36
EX 26
PV 180,84,36
RV 120,64,8960
RV 122,64,13056
PV 184,88,36
EX 27
PV 188,92,36
s_waitcnt lgkmcnt(14)
RV 124,65,8960
CV 36,24,25
QK 16,32,128,40
CV 37,26,27
v_xor_b32 v64, s43, v64
QK 16,36,132,16
EX 28
QK 16,40,136,16
EX 29
QK 16,44,140,16
RV 126,65,13056
CV 38,28,29
QK 20,48,128,40
EX 30
QK 20,52,132,20
v_xor_b32 v65, s43, v65
QK 20,56,136,20
EX 31
QK 20,60,140,20
CV 39,30,31
PV 192,64,32
EX 16
PV 196,68,32
PV 200,72,32
EX 17
PV 204,76,32
PV 208,80,32
s_waitcnt vmcnt(12) lgkmcnt(0)
s_barrier
PV 212,84,32
s_add_u32 s40, s40, s58
EX 18
PV 216,88,32
buffer_load_dwordx4 v[108:111], v75, s[32:35], s53 offen nt
PV 220,92,32
s_xor_b32 s41, s41, s43
EX 19
QK 24,32,144,44
s_xor_b32 s42, s41, 0xc000
RK 0,60,0
RK 4,61,0
QK 24,36,148,24
s_add_u32 m0, s42, 0x0
EX 20
QK 24,40,152,24
buffer_load_dwordx4 v66, s[16:19], s40 offen lds
QK 24,44,156,24
s_mov_b32 s58, s59
EX 21
v_smfmac_f32_16x16x64_bf16 a[244:247], v[56:59], v[32:39], v71
s_mov_b32 s59, 0x20000
s_xor_b32 s43, s43, 0xc000
RK 8,62,0
QK 28,48,144,44
s_sub_u32 s53, s34, s45
RK 12,63,0
CV 32,16,17
QK 28,52,148,28
s_ashr_i32 s53, s53, 8
CV 33,18,19
CV 34,20,21
QK 28,56,152,28
s_sub_u32 s53, s53, 256
EX 22
QK 28,60,156,28
EX 23
PV 224,64,36
RK 16,60,4096
RK 20,61,4096
PV 228,68,36
buffer_load_dwordx4 v67, s[16:19], s40 offen offset:1024 lds
PV 232,72,36
EX 24
PV 236,76,36
RK 24,62,4096
CV 35,22,23
PV 240,80,36
EX 25
PV 244,84,36
s_add_u32 m0, s42, 0x10000
EX 26
PV 248,88,36
EX 27
PV 252,92,36
RK 28,63,4096
RV 64,64,0
QK 16,32,160,48
CV 36,24,25
CV 37,26,27
QK 16,36,164,16
buffer_load_dwordx4 v68, s[20:23], s40 offen lds
QK 16,40,168,16
EX 28
QK 16,44,172,16
EX 29
QK 20,48,160,48
RV 66,64,4096
RV 68,65,0
QK 20,52,164,20
EX 30
QK 20,56,168,20
RV 70,65,4096
CV 38,28,29
QK 20,60,172,20
EX 31
PV 128,96,32
EX 16
PV 132,100,32
buffer_load_dwordx4 v69, s[20:23], s40 offen offset:1024 lds
PV 136,104,32
RV 72,64,256
CV 39,30,31
PV 140,108,32
EX 17
PV 144,112,32
EX 18
PV 148,116,32
RV 74,64,4352
RV 76,65,256
PV 152,120,32
EX 19
PV 156,124,32
QK 24,32,176,52
EX 20
QK 24,36,180,24
RV 78,65,4352
QK 24,40,184,24
EX 21
QK 24,44,188,24
RV 80,64,512
v_smfmac_f32_16x16x64_bf16 a[240:243], v[56:59], v[32:39], v71
s_sub_u32 s57, s57, 1
s_cselect_b64 s[58:59], s[60:61], s[58:59]
RV 82,64,4608
QK 28,48,176,52
CV 32,16,17
CV 33,18,19
QK 28,52,180,28
EX 22
QK 28,56,184,28
RV 84,65,512
CV 34,20,21
QK 28,60,188,28
EX 23
PV 160,96,36
RV 86,65,4608
CV 35,22,23
PV 164,100,36
EX 24
PV 168,104,36
EX 25
PV 172,108,36
RV 88,64,768
PV 176,112,36
EX 26
PV 180,116,36
RV 90,64,4864
PV 184,120,36
EX 27
PV 188,124,36
s_waitcnt lgkmcnt(14)
RV 92,65,768
CV 36,24,25
QK 16,0,128,40
EX 28
QK 16,4,132,16
RV 94,65,4864
CV 37,26,27
QK 16,8,136,16
EX 29
QK 16,12,140,16
CV 38,28,29
QK 20,16,128,40
EX 30
QK 20,20,132,20
s_nop 0
v_and_b32 v41, 0xf0, v72
QK 20,24,136,20
EX 31
QK 20,28,140,20
CV 39,30,31
v_sub_u32 v41, s52, v41
PV 192,96,32
EX 16
PV 196,100,32
EX 17
PV 200,104,32
EX 18
PV 204,108,32
EX 19
PV 208,112,32
s_waitcnt lgkmcnt(0)
EX 20
PV 212,116,32
s_add_u32 s40, s40, s58
EX 21
PV 216,120,32
s_add_u32 m0, s42, 0x2000
RK 32,60,8192
RK 36,61,8192
PV 220,124,32
s_mov_b32 s58, s59
RK 40,62,8192
v_xor_b32 v60, s43, v60
QK 24,0,144,44
s_mov_b32 s59, 0x20000
RK 44,63,8192
v_xor_b32 v61, s43, v61
QK 24,4,148,24
EX 22
QK 24,8,152,24
buffer_load_dwordx4 v66, s[16:19], s40 offen lds
QK 24,12,156,24
EX 23
v_smfmac_f32_16x16x64_bf16 a[244:247], v[56:59], v[32:39], v71
CV 32,16,17
QK 28,16,144,44
CV 33,18,19
CV 34,20,21
QK 28,20,148,28
CV 35,22,23
v_xor_b32 v62, s43, v62
QK 28,24,152,28
EX 24
QK 28,28,156,28
EX 25
PV 224,96,36
RV 96,64,8192
RV 98,64,12288
PV 228,100,36
RV 100,65,8192
v_xor_b32 v63, s43, v63
PV 232,104,36
RV 102,65,12288
RV 104,64,8448
PV 236,108,36
RV 106,64,12544
v_ashrrev_i32 v41, 31, v41
PV 240,112,36
RV 108,65,8448
RV 110,65,12544
PV 244,116,36
RV 112,64,8704
v_and_b32 v45, 0xf0, v72
PV 248,120,36
L_t3_pad4:
s_cbranch_execz L_t3_go
RV 114,64,12800
RV 116,65,8704
PV 252,124,36
RV 118,65,12800
CV 36,24,25
QK 16,0,160,48
buffer_load_dwordx4 v67, s[16:19], s40 offen offset:1024 lds
RV 120,64,8960
RV 122,64,13056
v_lshlrev_b32 v0, 16, v80
v_and_b32 v1, s71, v80
v_lshlrev_b32 v2, 16, v81
v_and_b32 v3, s71, v81
v_pk_mul_f32 v[0:1], v[0:1], s[14:15]
v_pk_mul_f32 v[2:3], v[2:3], s[14:15]
QK 16,4,164,16
s_add_u32 m0, s42, 0x12000
RV 124,65,8960
RV 126,65,13056
v_lshlrev_b32 v4, 16, v82
v_and_b32 v5, s71, v82
v_lshlrev_b32 v6, 16, v83
v_and_b32 v7, s71, v83
v_pk_mul_f32 v[4:5], v[4:5], s[14:15]
v_pk_mul_f32 v[6:7], v[6:7], s[14:15]
CV 80,0,1
CV 81,2,3
QK 16,8,168,16
buffer_load_dwordx4 v68, s[20:23], s40 offen lds
CV 82,4,5
CV 83,6,7
v_lshlrev_b32 v0, 16, v84
v_and_b32 v1, s71, v84
v_lshlrev_b32 v2, 16, v85
v_and_b32 v3, s71, v85
v_pk_mul_f32 v[0:1], v[0:1], s[14:15]
v_pk_mul_f32 v[2:3], v[2:3], s[14:15]
QK 16,12,172,16
ds_write_b128 v15, v[80:83] offset:0
v_lshlrev_b32 v4, 16, v86
v_and_b32 v5, s71, v86
v_lshlrev_b32 v6, 16, v87
v_and_b32 v7, s71, v87
v_pk_mul_f32 v[4:5], v[4:5], s[14:15]
v_pk_mul_f32 v[6:7], v[6:7], s[14:15]
CV 84,0,1
CV 85,2,3
QK 20,16,160,48
CV 86,4,5
CV 87,6,7
v_lshlrev_b32 v0, 16, v88
v_and_b32 v1, s71, v88
v_lshlrev_b32 v2, 16, v89
v_and_b32 v3, s71, v89
v_pk_mul_f32 v[0:1], v[0:1], s[14:15]
v_pk_mul_f32 v[2:3], v[2:3], s[14:15]
QK 20,20,164,20
ds_write_b128 v15, v[84:87] offset:544
v_lshlrev_b32 v4, 16, v90
v_and_b32 v5, s71, v90
v_lshlrev_b32 v6, 16, v91
v_and_b32 v7, s71, v91
v_pk_mul_f32 v[4:5], v[4:5], s[14:15]
v_pk_mul_f32 v[6:7], v[6:7], s[14:15]
CV 88,0,1
CV 89,2,3
QK 20,24,168,20
s_waitcnt vmcnt(19)
CV 90,4,5
CV 91,6,7
v_lshlrev_b32 v0, 16, v92
v_and_b32 v1, s71, v92
v_lshlrev_b32 v2, 16, v93
v_and_b32 v3, s71, v93
v_pk_mul_f32 v[0:1], v[0:1], s[14:15]
v_pk_mul_f32 v[2:3], v[2:3], s[14:15]
QK 20,28,172,20
ds_write_b128 v15, v[88:91] offset:1152
v_lshlrev_b32 v4, 16, v94
v_and_b32 v5, s71, v94
v_lshlrev_b32 v6, 16, v95
v_and_b32_e64 v7, s71, v95
v_pk_mul_f32 v[4:5], v[4:5], s[14:15]
v_pk_mul_f32 v[6:7], v[6:7], s[14:15]
CV 92,0,1
CV 93,2,3
EX 26
EX 27
EX 28
EX 29
EX 30
EX 31
CV 37,26,27
CV 38,28,29
CV 39,30,31
v_xor_b32 v64, s43, v64
v_xor_b32 v65, s43, v65
v_smfmac_f32_16x16x64_bf16 a[240:243], v[56:59], v[32:39], v71
s_add_u32 s48, s44, 0x0
CV 94,4,5
CV 95,6,7
PV 128,64,32
buffer_load_dwordx4 v69, s[20:23], s40 offen offset:1024 lds
PV 132,68,32
ds_write_b128 v15, v[92:95] offset:1696
PV 136,72,32
RK 192,14,0
RK 196,14,64
PV 140,76,32
RK 200,14,128
v_accvgpr_read_b32 v76, a240
v_accvgpr_read_b32 v40, a241
RK 204,14,192
v_add_f32 v76, v76, v40
v_accvgpr_read_b32 v77, a242
v_cmp_nge_f32 s[4:5], s55, v76
v_rcp_f32 v76, v76
v_accvgpr_read_b32 v44, a243
PM 128,76,0
v_add_f32 v77, v77, v44
PM 130,76,0
PV 144,80,32
v_cmp_nge_f32 s[6:7], s55, v77
v_rcp_f32_e64 v77, v77
CV 128,128,129
CV 129,130,131
PM 132,76,0
PM 134,76,0
PV 148,84,32
ds_write_b64 v70, v[128:129] offset:0
CV 132,132,133
CV 133,134,135
PM 136,76,0
PM 138,76,0
PV 152,88,32
ds_write_b64 v70, v[132:133] offset:32
CV 136,136,137
CV 137,138,139
PM 140,76,0
PM 142,76,0
PV 156,92,32
ds_write_b64 v70, v[136:137] offset:64
CV 140,140,141
CV 141,142,143
PM 144,76,0
PM 146,76,0
QK 24,0,176,52
ds_write_b64 v70, v[140:141] offset:96
CV 144,144,145
CV 145,146,147
PM 148,76,0
PM 150,76,0
s_waitcnt vmcnt(16)
v_lshlrev_b32 v0, 16, v96
v_and_b32 v1, s71, v96
v_lshlrev_b32 v2, 16, v97
v_and_b32_e64 v3, s71, v97
v_pk_mul_f32 v[0:1], v[0:1], s[14:15]
v_pk_mul_f32 v[2:3], v[2:3], s[14:15]
QK 24,4,180,24
ds_write_b64 v70, v[144:145] offset:128
CV 148,148,149
CV 149,150,151
PM 152,76,0
PM 154,76,0
v_lshlrev_b32 v4, 16, v98
v_and_b32 v5, s71, v98
v_lshlrev_b32 v6, 16, v99
v_and_b32 v7, s71, v99
v_pk_mul_f32 v[4:5], v[4:5], s[14:15]
v_pk_mul_f32 v[6:7], v[6:7], s[14:15]
CV 96,0,1
CV 97,2,3
QK 24,8,184,24
ds_write_b64 v70, v[148:149] offset:160
CV 152,152,153
CV 153,154,155
PM 156,76,0
PM 158,76,0
CV 98,4,5
CV 99,6,7
s_waitcnt vmcnt(14)
v_lshlrev_b32 v0, 16, v100
v_and_b32 v1, s71, v100
v_lshlrev_b32 v2, 16, v101
v_and_b32 v3, s71, v101
v_pk_mul_f32 v[0:1], v[0:1], s[14:15]
v_pk_mul_f32 v[2:3], v[2:3], s[14:15]
QK 24,12,188,24
ds_write_b64 v70, v[152:153] offset:192
CV 156,156,157
CV 157,158,159
v_lshlrev_b32 v4, 16, v102
v_and_b32 v5, s71, v102
v_lshlrev_b32 v6, 16, v103
v_and_b32_e64 v7, s71, v103
v_pk_mul_f32 v[4:5], v[4:5], s[14:15]
v_pk_mul_f32 v[6:7], v[6:7], s[14:15]
CV 100,0,1
CV 101,2,3
QK 28,16,176,52
ds_write_b64 v70, v[156:157] offset:224
RK 128,15,0
RK 132,15,528
CV 102,4,5
RK 136,15,1056
CV 103,6,7
RK 140,15,1584
ds_write_b128 v15, v[96:99] offset:0
s_waitcnt vmcnt(9)
v_lshlrev_b32 v0, 16, v104
v_and_b32 v1, s71, v104
v_lshlrev_b32 v2, 16, v105
v_and_b32 v3, s71, v105
v_pk_mul_f32 v[0:1], v[0:1], s[14:15]
v_pk_mul_f32 v[2:3], v[2:3], s[14:15]
QK 28,20,180,28
s_waitcnt lgkmcnt(4)
buffer_store_dwordx4 a[128:131], v72, s[28:31], s48 offen nt
ds_write_b128 v15, v[100:103] offset:544
v_lshlrev_b32 v4, 16, v106
v_and_b32 v5, s71, v106
v_lshlrev_b32 v6, 16, v107
v_and_b32 v7, s71, v107
v_pk_mul_f32 v[4:5], v[4:5], s[14:15]
v_pk_mul_f32 v[6:7], v[6:7], s[14:15]
CV 104,0,1
CV 105,2,3
QK 28,24,184,28
s_waitcnt vmcnt(9) lgkmcnt(4)
buffer_store_dwordx4 a[132:135], v73, s[28:31], s48 offen nt
CV 106,4,5
CV 107,6,7
v_lshlrev_b32 v0, 16, v108
v_and_b32 v1, s71, v108
v_lshlrev_b32 v2, 16, v109
v_and_b32 v3, s71, v109
v_pk_mul_f32 v[0:1], v[0:1], s[14:15]
v_pk_mul_f32 v[2:3], v[2:3], s[14:15]
QK 28,28,188,28
s_add_u32 s49, s44, 0x10000
ds_write_b128 v15, v[104:107] offset:1152
s_waitcnt lgkmcnt(4)
buffer_store_dwordx4 a[136:139], v74, s[28:31], s48 offen nt
v_lshlrev_b32 v4, 16, v110
v_and_b32 v5, s71, v110
v_lshlrev_b32 v6, 16, v111
v_and_b32 v7, s71, v111
v_pk_mul_f32 v[4:5], v[4:5], s[14:15]
v_pk_mul_f32 v[6:7], v[6:7], s[14:15]
CV 108,0,1
CV 109,2,3
PV 160,64,36
CV 110,4,5
CV 111,6,7
PV 164,68,36
s_waitcnt lgkmcnt(3)
buffer_store_dwordx4 a[140:143], v75, s[28:31], s48 offen nt
PV 168,72,36
ds_write_b128 v15, v[108:111] offset:1696
PV 172,76,36
RK 208,14,0
RK 212,14,64
EX 16
RK 216,14,128
PM 160,76,1
RK 220,14,192
PM 162,76,1
PV 176,80,36
CV 160,160,161
CV 161,162,163
EX 17
EX 18
PM 164,76,1
PM 166,76,1
PV 180,84,36
ds_write_b64 v70, v[160:161] offset:0
CV 164,164,165
CV 165,166,167
PM 168,76,1
PM 170,76,1
PV 184,88,36
ds_write_b64 v70, v[164:165] offset:32
CV 168,168,169
CV 169,170,171
PM 172,76,1
PM 174,76,1
PV 188,92,36
ds_write_b64 v70, v[168:169] offset:64
CV 172,172,173
CV 173,174,175
PM 176,76,1
PM 178,76,1
v_exp_f32_e64 v19, v19
CV 32,16,17
CV 33,18,19
QZ 16,32,192
ds_write_b64 v70, v[172:173] offset:96
CV 176,176,177
CV 177,178,179
PM 180,76,1
PM 182,76,1
QK 16,36,196,16
ds_write_b64 v70, v[176:177] offset:128
CV 180,180,181
CV 181,182,183
PM 184,76,1
PM 186,76,1
QK 16,40,200,16
ds_write_b64 v70, v[180:181] offset:160
CV 184,184,185
CV 185,186,187
PM 188,76,1
PM 190,76,1
QK 16,44,204,16
ds_write_b64 v70, v[184:185] offset:192
CV 188,188,189
CV 189,190,191
EX 20
EX 21
EX 22
EX 23
EX 24
v_max3_f32 v8, v16, v17, v18
EX 25
v_max_f32 v8, v8, v19
EX 26
v_mov_b32 v9, v8
EX 27
EX 28
v_permlane32_swap_b32 v8, v9
v_max_f32 v8, v8, v9
EX 29
v_mov_b32 v9, v8
EX 30
EX 31
v_permlane16_swap_b32 v8, v9
v_min_f32_e64 v40, -v8, -v9
CV 34,20,21
CV 35,22,23
CV 36,24,25
CV 37,26,27
CV 38,28,29
CV 39,30,31
v_add_f32 v8, v40, v12
v_add_f32 v9, v40, v13
v_smfmac_f32_16x16x64_bf16 a[244:247], v[56:59], v[32:39], v71
s_add_u32 s50, s44, 0x20000
v_add_f32 v16, v8, v16
ds_write_b64 v70, v[188:189] offset:224
PV 192,64,32
RK 144,15,0
RK 148,15,528
PV 196,68,32
RK 152,15,1056
v_add_f32 v17, v8, v17
PV 200,72,32
RK 156,15,1584
v_add_f32 v18, v8, v18
PV 204,76,32
v_accvgpr_read_b32 v78, a244
v_accvgpr_read_b32 v48, a245
v_accvgpr_read_b32 v79, a246
v_add_f32 v78, v78, v48
v_accvgpr_read_b32 v52, a247
v_cmp_nge_f32 s[8:9], s55, v78
v_rcp_f32 v78, v78
v_add_f32 v79, v79, v52
PM 192,78,0
v_cmp_nge_f32 s[10:11], s55, v79
v_rcp_f32_e64 v79, v79
PM 194,78,0
PV 208,80,32
s_waitcnt vmcnt(63) lgkmcnt(0)
s_barrier
buffer_store_dwordx4 a[144:147], v72, s[28:31], s49 offen nt
CV 192,192,193
CV 193,194,195
PM 196,78,0
PM 198,78,0
PV 212,84,32
s_add_u32 s40, s40, 0x20000
ds_write_b64 v70, v[192:193] offset:0
CV 196,196,197
CV 197,198,199
PM 200,78,0
PM 202,78,0
PV 216,88,32
buffer_store_dwordx4 a[148:151], v73, s[28:31], s49 offen nt
ds_write_b64 v70, v[196:197] offset:32
RK 0,60,0
RK 4,61,0
CV 200,200,201
CV 201,202,203
PM 204,78,0
PM 206,78,0
PV 220,92,32
s_xor_b32 s41, s41, s43
ds_write_b64 v70, v[200:201] offset:64
RK 8,62,0
RK 12,63,0
buffer_store_dwordx4 a[152:155], v74, s[28:31], s49 offen nt
CV 204,204,205
CV 205,206,207
PM 208,78,0
PM 210,78,0
QZ 24,32,208
s_xor_b32 s42, s41, 0xc000
ds_write_b64 v70, v[204:205] offset:96
RK 16,60,4096
RK 20,61,4096
CV 208,208,209
CV 209,210,211
PM 212,78,0
PM 214,78,0
QK 24,36,212,24
buffer_store_dwordx4 a[156:159], v75, s[28:31], s49 offen nt
ds_write_b64 v70, v[208:209] offset:128
RK 24,62,4096
RK 28,63,4096
CV 212,212,213
CV 213,214,215
PM 216,78,0
PM 218,78,0
QK 24,40,216,24
s_add_u32 m0, s42, 0x0
ds_write_b64 v70, v[212:213] offset:160
CV 216,216,217
CV 217,218,219
PM 220,78,0
PM 222,78,0
QK 24,44,220,24
buffer_load_dwordx4 v66, s[16:19], s40 offen lds
ds_write_b64 v70, v[216:217] offset:192
CV 220,220,221
CV 221,222,223
PV 224,64,36
s_add_u32 s51, s44, 0x30000
RV 64,64,0
RV 66,64,4096
ds_write_b64 v70, v[220:221] offset:224
PV 228,68,36
s_xor_b32 s43, s43, 0xc000
RK 160,15,0
RK 164,15,528
PV 232,72,36
RK 168,15,1056
v_max3_f32 v10, v24, v25, v26
PV 236,76,36
RK 172,15,1584
v_max_f32 v10, v10, v27
v_add_f32 v19, v9, v19
v_mov_b32 v11, v10
v_bfi_b32 v40, v41, s70, v40
PM 224,78,1
v_permlane32_swap_b32 v10, v11
v_max_f32 v10, v10, v11
PM 226,78,1
PV 240,80,36
RV 68,65,0
RV 70,65,4096
v_mov_b32 v11, v10
CV 224,224,225
CV 225,226,227
v_permlane16_swap_b32 v10, v11
v_min_f32_e64 v44, -v10, -v11
PM 228,78,1
PM 230,78,1
PV 244,84,36
s_waitcnt lgkmcnt(5)
buffer_store_dwordx4 a[160:163], v72, s[28:31], s50 offen nt
ds_write_b64 v70, v[224:225] offset:0
RV 72,64,256
RV 74,64,4352
CV 228,228,229
CV 229,230,231
PM 232,78,1
PM 234,78,1
PV 248,88,36
s_waitcnt lgkmcnt(7)
buffer_store_dwordx4 a[164:167], v73, s[28:31], s50 offen nt
ds_write_b64 v70, v[228:229] offset:32
RV 76,65,256
RV 78,65,4352
CV 232,232,233
CV 233,234,235
PM 236,78,1
PM 238,78,1
PV 252,92,36
ds_write_b64 v70, v[232:233] offset:64
RV 80,64,512
RV 82,64,4608
s_waitcnt lgkmcnt(12)
buffer_store_dwordx4 a[168:171], v74, s[28:31], s50 offen nt
CV 236,236,237
CV 237,238,239
PM 240,78,1
PM 242,78,1
EX 16
EX 17
EX 18
EX 19
v_mov_b32 v41, v40
v_mov_b32 v42, v40
v_mov_b32_e64 v43, v40
CV 32,16,17
CV 33,18,19
QK 16,0,192,40
buffer_load_dwordx4 v67, s[16:19], s40 offen offset:1024 lds
ds_write_b64 v70, v[236:237] offset:96
RV 84,65,512
RV 86,65,4608
CV 240,240,241
CV 241,242,243
PM 244,78,1
PM 246,78,1
QK 16,4,196,16
ds_write_b64 v70, v[240:241] offset:128
RV 88,64,768
RV 90,64,4864
s_waitcnt lgkmcnt(15)
buffer_store_dwordx4 a[172:175], v75, s[28:31], s50 offen nt
CV 244,244,245
CV 245,246,247
PM 248,78,1
PM 250,78,1
QK 16,8,200,16
s_add_u32 m0, s42, 0x10000
ds_write_b64 v70, v[244:245] offset:160
RV 92,65,768
RV 94,65,4864
CV 248,248,249
CV 249,250,251
PM 252,78,1
PM 254,78,1
QK 16,12,204,16
ds_write_b64 v70, v[248:249] offset:192
CV 252,252,253
CV 253,254,255
QK 20,16,192,40
v_mov_b32 v34, 0
v_mov_b32 v35, 0
ds_write_b64 v70, v[252:253] offset:224
QK 20,20,196,20
RK 176,15,0
RK 180,15,528
QK 20,24,200,20
RK 184,15,1056
v_sub_u32 v45, s53, v45
QK 20,28,204,20
RK 188,15,1584
v_add_f32 v10, v44, v12
PZ 128,96,32
buffer_load_dwordx4 v68, s[20:23], s40 offen lds
PZ 132,100,32
v_add_f32 v11, v44, v13
v_ashrrev_i32 v45, 31, v45
PZ 136,104,32
v_add_f32 v24, v10, v24
v_add_f32 v25, v10, v25
PZ 140,108,32
s_waitcnt lgkmcnt(3)
buffer_store_dwordx4 a[176:179], v72, s[28:31], s51 offen nt
PZ 144,112,32
v_add_f32 v26, v10, v26
v_add_f32 v27, v11, v27
PZ 148,116,32
v_bfi_b32 v44, v45, s70, v44
v_mov_b32 v38, 0
PZ 152,120,32
EX 24
PZ 156,124,32
s_waitcnt lgkmcnt(2)
buffer_store_dwordx4 a[180:183], v73, s[28:31], s51 offen nt
RK 32,60,8192
RK 36,61,8192
EX 25
EX 26
EX 27
v_mov_b32 v45, v44
v_mov_b32 v46, v44
v_mov_b32 v47, v44
CV 36,24,25
CV 37,26,27
QK 24,0,208,44
s_waitcnt lgkmcnt(3)
buffer_store_dwordx4 a[184:187], v74, s[28:31], s51 offen nt
QK 24,4,212,24
L_t3_pad5:
s_cbranch_execz L_t3_go
RK 40,62,8192
RK 44,63,8192
QK 24,8,216,24
RK 48,60,12288
v_mov_b32 v39, 0
QK 24,12,220,24
RK 52,61,12288
v_xor_b32 v60, s43, v60
v_smfmac_f32_16x16x64_bf16 a[248:251], v[56:59], v[32:39], v71
RK 56,62,12288
QK 28,16,208,44
s_waitcnt lgkmcnt(7)
buffer_store_dwordx4 a[188:191], v75, s[28:31], s51 offen nt
QK 28,20,212,28
RK 60,63,12288
v_xor_b32 v61, s43, v61
QK 28,24,216,28
EX 16
QK 28,28,220,28
EX 17
PZ 160,96,36
buffer_load_dwordx4 v69, s[20:23], s40 offen offset:1024 lds
PZ 164,100,36
s_add_u32 s40, s40, 0x20000
RV 96,64,8192
s_add_u32 m0, s42, 0x2000
PZ 168,104,36
RV 98,64,12288
RV 100,65,8192
PZ 172,108,36
RV 102,65,12288
CV 32,16,17
PZ 176,112,36
buffer_load_dwordx4 v66, s[16:19], s40 offen lds
PZ 180,116,36
RV 104,64,8448
RV 106,64,12544
PZ 184,120,36
RV 108,65,8448
v_xor_b32 v62, s43, v62
PZ 188,124,36
s_waitcnt lgkmcnt(7)
RV 110,65,12544
RV 112,64,8704
EX 18
EX 19
EX 20
CV 33,18,19
QK 16,32,192,40
buffer_load_dwordx4 v67, s[16:19], s40 offen offset:1024 lds
QK 16,36,196,16
s_add_u32 m0, s42, 0x12000
RV 114,64,12800
RV 116,65,8704
QK 16,40,200,16
RV 118,65,12800
v_xor_b32 v63, s43, v63
QK 16,44,204,16
RV 120,64,8960
RV 122,64,13056
EX 21
EX 22
EX 23
CV 34,20,21
CV 35,22,23
QK 20,48,192,40
RV 124,65,8960
RV 126,65,13056
QK 20,52,196,20
buffer_load_dwordx4 v68, s[20:23], s40 offen lds
QK 20,56,200,20
EX 24
QK 20,60,204,20
EX 25
PV 128,64,32
EX 26
PV 132,68,32
v_exp_f32_e64 v27, v27
PV 136,72,32
CV 36,24,25
CV 37,26,27
PV 140,76,32
PV 144,80,32
s_waitcnt vmcnt(23) lgkmcnt(0)
s_barrier
PV 148,84,32
buffer_load_dwordx4 v69, s[20:23], s40 offen offset:1024 lds
s_mov_b32 s56, 3
L_t3_loop1:
PV 152,88,32
s_xor_b32 s41, s41, s43
RK 0,60,0
RK 4,61,0
PV 156,92,32
s_xor_b32 s42, s41, 0xc000
RK 8,62,0
v_xor_b32 v64, s43, v64
QK 24,32,208,44
s_add_u32 s40, s40, 0x20000
EX 28
QK 24,36,212,24
s_add_u32 m0, s42, 0x0
EX 29
QK 24,40,216,24
buffer_load_dwordx4 v66, s[16:19], s40 offen lds
QK 24,44,220,24
EX 30
EX 31
CV 38,28,29
CV 39,30,31
v_xor_b32 v65, s43, v65
s_xor_b32 s43, s43, 0xc000
v_smfmac_f32_16x16x64_bf16 a[248:251], v[56:59], v[32:39], v71
RK 12,63,0
QK 28,48,208,44
RK 16,60,4096
RK 20,61,4096
QK 28,52,212,28
EX 16
QK 28,56,216,28
RK 24,62,4096
RK 28,63,4096
QK 28,60,220,28
EX 17
PV 160,64,36
RV 64,64,0
RV 66,64,4096
PV 164,68,36
RV 68,65,0
CV 32,16,17
PV 168,72,36
buffer_load_dwordx4 v67, s[16:19], s40 offen offset:1024 lds
PV 172,76,36
RV 70,65,4096
RV 72,64,256
PV 176,80,36
RV 74,64,4352
PV 180,84,36
s_add_u32 m0, s42, 0x10000
RV 76,65,256
RV 78,65,4352
PV 184,88,36
RV 80,64,512
PV 188,92,36
s_waitcnt lgkmcnt(9)
EX 18
EX 19
EX 20
CV 33,18,19
QK 16,0,192,40
RV 82,64,4608
RV 84,65,512
QK 16,4,196,16
buffer_load_dwordx4 v68, s[20:23], s40 offen lds
QK 16,8,200,16
RV 86,65,4608
RV 88,64,768
QK 16,12,204,16
EX 21
EX 22
EX 23
CV 34,20,21
CV 35,22,23
QK 20,16,192,40
RV 90,64,4864
RV 92,65,768
QK 20,20,196,20
RV 94,65,4864
QK 20,24,200,20
EX 24
QK 20,28,204,20
EX 25
PV 128,96,32
EX 26
PV 132,100,32
buffer_load_dwordx4 v69, s[20:23], s40 offen offset:1024 lds
PV 136,104,32
EX 27
PV 140,108,32
s_add_u32 s40, s40, 0x20000
CV 36,24,25
CV 37,26,27
PV 144,112,32
s_waitcnt lgkmcnt(0)
EX 28
PV 148,116,32
s_add_u32 m0, s42, 0x2000
EX 29
PV 152,120,32
RK 32,60,8192
RK 36,61,8192
PV 156,124,32
RK 40,62,8192
CV 38,28,29
QK 24,0,208,44
EX 30
QK 24,4,212,24
buffer_load_dwordx4 v66, s[16:19], s40 offen lds
QK 24,8,216,24
EX 31
QK 24,12,220,24
RK 44,63,8192
CV 39,30,31
EX 16
s_nop 0
v_smfmac_f32_16x16x64_bf16 a[248:251], v[56:59], v[32:39], v71
RK 48,60,12288
QK 28,16,208,44
RK 52,61,12288
RK 56,62,12288
QK 28,20,212,28
EX 17
QK 28,24,216,28
RK 60,63,12288
CV 32,16,17
QK 28,28,220,28
EX 18
PV 160,96,36
RV 96,64,8192
RV 98,64,12288
PV 164,100,36
buffer_load_dwordx4 v67, s[16:19], s40 offen offset:1024 lds
PV 168,104,36
RV 100,65,8192
RV 102,65,12288
PV 172,108,36
RV 104,64,8448
v_xor_b32 v60, s43, v60
PV 176,112,36
s_add_u32 m0, s42, 0x12000
RV 106,64,12544
RV 108,65,8448
PV 180,116,36
RV 110,65,12544
v_xor_b32 v61, s43, v61
PV 184,120,36
RV 112,64,8704
RV 114,64,12800
PV 188,124,36
s_waitcnt lgkmcnt(10)
EX 19
EX 20
CV 33,18,19
QK 16,32,192,40
buffer_load_dwordx4 v68, s[20:23], s40 offen lds
QK 16,36,196,16
RV 116,65,8704
RV 118,65,12800
QK 16,40,200,16
RV 120,64,8960
v_xor_b32 v62, s43, v62
QK 16,44,204,16
EX 21
EX 22
EX 23
CV 34,20,21
CV 35,22,23
QK 20,48,192,40
RV 122,64,13056
RV 124,65,8960
QK 20,52,196,20
RV 126,65,13056
v_xor_b32 v63, s43, v63
QK 20,56,200,20
EX 24
QK 20,60,204,20
EX 25
PV 128,64,32
buffer_load_dwordx4 v69, s[20:23], s40 offen offset:1024 lds
PV 132,68,32
EX 26
PV 136,72,32
EX 27
PV 140,76,32
CV 36,24,25
CV 37,26,27
PV 144,80,32
s_waitcnt vmcnt(8) lgkmcnt(0)
s_barrier
PV 148,84,32
s_sub_u32 s56, s56, 1
s_cbranch_scc0 L_t3_loop1
PV 152,88,32
s_xor_b32 s41, s41, s43
RK 0,60,0
RK 4,61,0
PV 156,92,32
s_xor_b32 s42, s41, 0xc000
RK 8,62,0
v_xor_b32 v64, s43, v64
QK 24,32,208,44
EX 28
QK 24,36,212,24
EX 29
QK 24,40,216,24
EX 30
QK 24,44,220,24
RK 12,63,0
RK 16,60,4096
EX 31
CV 38,28,29
CV 39,30,31
v_xor_b32 v65, s43, v65
s_xor_b32 s43, s43, 0xc000
v_smfmac_f32_16x16x64_bf16 a[248:251], v[56:59], v[32:39], v71
RK 20,61,4096
QK 28,48,208,44
RK 24,62,4096
RK 28,63,4096
QK 28,52,212,28
EX 16
QK 28,56,216,28
EX 17
QK 28,60,220,28
EX 18
PV 160,64,36
RV 64,64,0
RV 66,64,4096
PV 164,68,36
RV 68,65,0
CV 32,16,17
PV 168,72,36
RV 70,65,4096
RV 72,64,256
PV 172,76,36
EX 19
PV 176,80,36
RV 74,64,4352
RV 76,65,256
PV 180,84,36
RV 78,65,4352
CV 33,18,19
PV 184,88,36
RV 80,64,512
RV 82,64,4608
PV 188,92,36
s_waitcnt lgkmcnt(10)
EX 20
QK 16,0,192,40
RV 84,65,512
RV 86,65,4608
QK 16,4,196,16
EX 21
QK 16,8,200,16
RV 88,64,768
RV 90,64,4864
QK 16,12,204,16
RV 92,65,768
EX 22
EX 23
CV 34,20,21
CV 35,22,23
QK 20,16,192,40
EX 24
QK 20,20,196,20
RV 94,65,4864
QK 20,24,200,20
EX 25
QK 20,28,204,20
EX 26
PV 128,96,32
EX 27
PV 132,100,32
CV 36,24,25
CV 37,26,27
PV 136,104,32
EX 28
PV 140,108,32
EX 29
PV 144,112,32
s_waitcnt lgkmcnt(0)
EX 30
PV 148,116,32
EX 31
PV 152,120,32
RK 32,60,8192
RK 36,61,8192
PV 156,124,32
RK 40,62,8192
CV 38,28,29
QK 24,0,208,44
RK 44,63,8192
CV 39,30,31
QK 24,4,212,24
EX 16
QK 24,8,216,24
RK 48,60,12288
RK 52,61,12288
QK 24,12,220,24
RK 56,62,12288
v_xor_b32 v60, s43, v60
v_smfmac_f32_16x16x64_bf16 a[248:251], v[56:59], v[32:39], v71
RK 60,63,12288
QK 28,16,208,44
EX 17
QK 28,20,212,28
EX 18
QK 28,24,216,28
EX 19
QK 28,28,220,28
CV 32,16,17
CV 33,18,19
PV 160,96,36
RV 96,64,8192
RV 98,64,12288
PV 164,100,36
RV 100,65,8192
v_xor_b32 v61, s43, v61
PV 168,104,36
RV 102,65,12288
RV 104,64,8448
PV 172,108,36
RV 106,64,12544
v_xor_b32 v62, s43, v62
PV 176,112,36
RV 108,65,8448
RV 110,65,12544
PV 180,116,36
RV 112,64,8704
v_xor_b32 v63, s43, v63
PV 184,120,36
RV 114,64,12800
RV 116,65,8704
PV 188,124,36
s_waitcnt lgkmcnt(11)
EX 20
QK 16,32,192,40
RV 118,65,12800
RV 120,64,8960
QK 16,36,196,16
EX 21
QK 16,40,200,16
EX 22
QK 16,44,204,16
RV 122,64,13056
RV 124,65,8960
EX 23
CV 34,20,21
CV 35,22,23
QK 20,48,192,40
RV 126,65,13056
v_xor_b32 v64, s43, v64
QK 20,52,196,20
EX 24
QK 20,56,200,20
EX 25
QK 20,60,204,20
EX 26
PV 128,64,32
EX 27
PV 132,68,32
CV 36,24,25
CV 37,26,27
PV 136,72,32
EX 28
PV 140,76,32
EX 29
PV 144,80,32
s_waitcnt vmcnt(0) lgkmcnt(0)
s_barrier
PV 148,84,32
EX 30
PV 152,88,32
s_xor_b32 s41, s41, s43
RK 0,60,0
RK 4,61,0
PV 156,92,32
s_xor_b32 s42, s41, 0xc000
RK 8,62,0
CV 38,28,29
QK 24,32,208,44
EX 31
QK 24,36,212,24
RK 12,63,0
CV 39,30,31
QK 24,40,216,24
RK 16,60,4096
RK 20,61,4096
QK 24,44,220,24
RK 24,62,4096
v_xor_b32 v65, s43, v65
v_smfmac_f32_16x16x64_bf16 a[248:251], v[56:59], v[32:39], v71
s_xor_b32 s43, s43, 0xc000
RK 28,63,4096
QK 28,48,208,44
EX 16
QK 28,52,212,28
EX 17
QK 28,56,216,28
EX 18
QK 28,60,220,28
EX 19
PV 160,64,36
RV 64,64,0
RV 66,64,4096
PV 164,68,36
RV 68,65,0
CV 32,16,17
PV 168,72,36
RV 70,65,4096
RV 72,64,256
PV 172,76,36
RV 74,64,4352
CV 33,18,19
PV 176,80,36
RV 76,65,256
RV 78,65,4352
PV 180,84,36
EX 20
PV 184,88,36
RV 80,64,512
RV 82,64,4608
PV 188,92,36
s_waitcnt lgkmcnt(10)
EX 21
QK 16,0,192,40
RV 84,65,512
RV 86,65,4608
QK 16,4,196,16
RV 88,64,768
CV 34,20,21
QK 16,8,200,16
EX 22
QK 16,12,204,16
EX 23
EX 24
CV 35,22,23
QK 20,16,192,40
RV 90,64,4864
RV 92,65,768
QK 20,20,196,20
RV 94,65,4864
QK 20,24,200,20
EX 25
QK 20,28,204,20
EX 26
PV 128,96,32
EX 27
PV 132,100,32
CV 36,24,25
CV 37,26,27
PV 136,104,32
EX 28
PV 140,108,32
EX 29
PV 144,112,32
s_waitcnt lgkmcnt(0)
EX 30
PV 148,116,32
EX 31
PV 152,120,32
RK 32,60,8192
RK 36,61,8192
PV 156,124,32
RK 40,62,8192
CV 38,28,29
QK 24,0,208,44
RK 44,63,8192
CV 39,30,31
QK 24,4,212,24
EX 16
QK 24,8,216,24
RK 48,60,12288
RK 52,61,12288
QK 24,12,220,24
EX 17
v_smfmac_f32_16x16x64_bf16 a[248:251], v[56:59], v[32:39], v71
RK 56,62,12288
QK 28,16,208,44
RK 60,63,12288
CV 32,16,17
QK 28,20,212,28
EX 18
QK 28,24,216,28
EX 19
QK 28,28,220,28
EX 20
PV 160,96,36
RV 96,64,8192
RV 98,64,12288
PV 164,100,36
RV 100,65,8192
CV 33,18,19
PV 168,104,36
L_t3_pad6:
s_cbranch_execz L_t3_go
RV 102,65,12288
RV 104,64,8448
PV 172,108,36
EX 21
PV 176,112,36
RV 106,64,12544
RV 108,65,8448
PV 180,116,36
RV 110,65,12544
CV 34,20,21
PV 184,120,36
RV 112,64,8704
RV 114,64,12800
PV 188,124,36
s_waitcnt lgkmcnt(10)
EX 22
QK 16,32,192,40
RV 116,65,8704
RV 118,65,12800
QK 16,36,196,16
EX 23
QK 16,40,200,16
RV 120,64,8960
RV 122,64,13056
QK 16,44,204,16
RV 124,65,8960
CV 35,22,23
QK 20,48,192,40
EX 24
QK 20,52,196,20
RV 126,65,13056
QK 20,56,200,20
EX 25
QK 20,60,204,20
EX 26
PV 128,64,32
EX 27
PV 132,68,32
CV 36,24,25
CV 37,26,27
PV 136,72,32
EX 28
PV 140,76,32
EX 29
PV 144,80,32
s_waitcnt lgkmcnt(0)
EX 30
PV 148,84,32
EX 31
PV 152,88,32
CV 38,28,29
CV 39,30,31
PV 156,92,32
EX 16
QK 24,32,208,44
EX 17
QK 24,36,212,24
EX 18
QK 24,40,216,24
EX 19
QK 24,44,220,24
EX 20
v_smfmac_f32_16x16x64_bf16 a[248:251], v[56:59], v[32:39], v71
CV 32,16,17
QK 28,48,208,44
EX 21
QK 28,52,212,28
EX 22
QK 28,56,216,28
EX 23
QK 28,60,220,28
EX 24
PV 160,64,36
EX 25
PV 164,68,36
EX 26
PV 168,72,36
EX 27
PV 172,76,36
EX 28
PV 176,80,36
EX 29
PV 180,84,36
EX 30
PV 184,88,36
EX 31
PV 188,92,36
CV 33,18,19
CV 34,20,21
CV 35,22,23
CV 36,24,25
CV 37,26,27
CV 38,28,29
CV 39,30,31
s_nop 1
v_smfmac_f32_16x16x64_bf16 a[248:251], v[56:59], v[32:39], v71
s_add_u32 s48, s45, 0x0
s_nop 0
PV 128,96,32
s_nop 2
PV 132,100,32
s_nop 2
PV 136,104,32
s_nop 0
v_accvgpr_read_b32 v76, a248
PV 140,108,32
v_accvgpr_read_b32 v40, a249
v_accvgpr_read_b32 v77, a250
v_add_f32 v76, v76, v40
v_accvgpr_read_b32 v44, a251
v_cmp_nge_f32 s[96:97], s55, v76
v_rcp_f32 v76, v76
v_add_f32 v77, v77, v44
PM 128,76,0
v_cmp_nge_f32 s[98:99], s55, v77
v_rcp_f32 v77, v77
PM 130,76,0
PV 144,112,32
CV 128,128,129
CV 129,130,131
PM 132,76,0
PM 134,76,0
PV 148,116,32
ds_write_b64 v70, v[128:129] offset:0
CV 132,132,133
CV 133,134,135
PM 136,76,0
PM 138,76,0
PV 152,120,32
ds_write_b64 v70, v[132:133] offset:32
CV 136,136,137
CV 137,138,139
PM 140,76,0
PM 142,76,0
PV 156,124,32
s_add_u32 s49, s45, 0x10000
ds_write_b64 v70, v[136:137] offset:64
CV 140,140,141
CV 141,142,143
PM 144,76,0
PM 146,76,0
PV 160,96,36
ds_write_b64 v70, v[140:141] offset:96
CV 144,144,145
CV 145,146,147
PM 148,76,0
PM 150,76,0
PV 164,100,36
ds_write_b64 v70, v[144:145] offset:128
CV 148,148,149
CV 149,150,151
PM 152,76,0
PM 154,76,0
PV 168,104,36
ds_write_b64 v70, v[148:149] offset:160
CV 152,152,153
CV 153,154,155
PM 156,76,0
PM 158,76,0
PV 172,108,36
ds_write_b64 v70, v[152:153] offset:192
CV 156,156,157
CV 157,158,159
PM 160,76,1
PM 162,76,1
PV 176,112,36
ds_write_b64 v70, v[156:157] offset:224
RK 192,15,0
RK 196,15,528
CV 160,160,161
RK 200,15,1056
CV 161,162,163
RK 204,15,1584
PM 164,76,1
PM 166,76,1
PV 180,116,36
ds_write_b64 v70, v[160:161] offset:0
CV 164,164,165
CV 165,166,167
PM 168,76,1
PM 170,76,1
PV 184,120,36
s_waitcnt lgkmcnt(4)
buffer_store_dwordx4 a[192:195], v72, s[36:39], s48 offen nt
ds_write_b64 v70, v[164:165] offset:32
CV 168,168,169
CV 169,170,171
PM 172,76,1
PM 174,76,1
PV 188,124,36
s_waitcnt lgkmcnt(4)
ds_write_b64 v70, v[168:169] offset:64
buffer_store_dwordx4 a[196:199], v73, s[36:39], s48 offen nt
CV 172,172,173
CV 173,174,175
ds_write_b64 v70, v[172:173] offset:96
PM 176,76,1
PM 178,76,1
CV 176,176,177
CV 177,178,179
ds_write_b64 v70, v[176:177] offset:128
s_waitcnt lgkmcnt(6)
buffer_store_dwordx4 a[200:203], v74, s[36:39], s48 offen nt
PM 180,76,1
PM 182,76,1
CV 180,180,181
CV 181,182,183
ds_write_b64 v70, v[180:181] offset:160
PM 184,76,1
PM 186,76,1
CV 184,184,185
CV 185,186,187
ds_write_b64 v70, v[184:185] offset:192
s_waitcnt lgkmcnt(7)
buffer_store_dwordx4 a[204:207], v75, s[36:39], s48 offen nt
PM 188,76,1
PM 190,76,1
CV 188,188,189
CV 189,190,191
ds_write_b64 v70, v[188:189] offset:224
RK 208,15,0
RK 212,15,528
RK 216,15,1056
RK 220,15,1584
s_waitcnt lgkmcnt(3)
buffer_store_dwordx4 a[208:211], v72, s[36:39], s49 offen nt
s_waitcnt lgkmcnt(2)
buffer_store_dwordx4 a[212:215], v73, s[36:39], s49 offen nt
s_waitcnt lgkmcnt(1)
buffer_store_dwordx4 a[216:219], v74, s[36:39], s49 offen nt
s_waitcnt lgkmcnt(0)
buffer_store_dwordx4 a[220:223], v75, s[36:39], s49 offen nt
s_cmp_lg_u64 s[4:5], 0
s_cselect_b32 s62, 1, 0
s_or_b32 s54, s54, s62
s_cmp_lg_u64 s[6:7], 0
s_cselect_b32 s62, 2, 0
s_or_b32 s54, s54, s62
s_cmp_lg_u64 s[8:9], 0
s_cselect_b32 s62, 4, 0
s_or_b32 s54, s54, s62
s_cmp_lg_u64 s[10:11], 0
s_cselect_b32 s62, 8, 0
s_or_b32 s54, s54, s62
s_cmp_lg_u64 s[96:97], 0
s_cselect_b32 s62, 16, 0
s_or_b32 s54, s54, s62
s_cmp_lg_u64 s[98:99], 0
s_cselect_b32 s62, 32, 0
s_or_b32 s54, s54, s62
s_cbranch_scc0 L_done3
s_mov_b32 s4, 0x78d000
s_mov_b32 s5, 650
s_mov_b32 s6, 0x3e0000
s_mov_b32 s7, 459
s_getpc_b64 s[62:63]
L_fpc3:
s_add_u32 s62, s62, L_fallback-L_fpc3
s_addc_u32 s63, s63, 0
s_setpc_b64 s[62:63]
L_done3:
s_endpgm
L_end3:
.p2align 12
L_type4:
s_mov_b64 exec, 0
s_cmp_eq_u32 s12, 0
s_cbranch_scc1 L_t4_pad1
s_cmp_eq_u32 s12, 1
s_cbranch_scc1 L_t4_pad2
s_cmp_eq_u32 s12, 2
s_cbranch_scc1 L_t4_pad3
s_branch L_t4_go
L_t4_go:
s_mov_b64 exec, -1
s_add_u32 s50, s44, 0x20000
s_add_u32 s51, s44, 0x30000
s_mov_b32 s40, 0x20000
s_add_u32 m0, s47, 0x4000
s_waitcnt vmcnt(9)
buffer_load_dwordx4 v[192:195], v72, s[24:27], s50 offen nt
s_barrier
v_lshlrev_b32 v0, 16, v128
RK 0,60,8192
RK 4,61,8192
v_and_b32 v1, s71, v128
RK 8,62,8192
v_lshlrev_b32 v2, 16, v129
buffer_load_dwordx4 v[196:199], v73, s[24:27], s50 offen nt
RK 12,63,8192
RK 16,60,12288
v_and_b32 v3, s71, v129
RK 20,61,12288
v_lshlrev_b32 v4, 16, v130
RK 24,62,12288
v_and_b32 v5, s71, v130
buffer_load_dwordx4 v[200:203], v74, s[24:27], s50 offen nt
RK 28,63,12288
v_lshlrev_b32 v6, 16, v131
v_and_b32_e64 v7, s71, v131
v_pk_mul_f32 v[0:1], v[0:1], s[14:15]
v_pk_mul_f32 v[2:3], v[2:3], s[14:15]
v_pk_mul_f32 v[4:5], v[4:5], s[14:15]
v_pk_mul_f32 v[6:7], v[6:7], s[14:15]
CV 128,0,1
CV 129,2,3
CV 130,4,5
buffer_load_dwordx4 v[204:207], v75, s[24:27], s50 offen nt
CV 131,6,7
ds_write_b128 v15, v[128:131] offset:0
s_waitcnt vmcnt(12)
v_lshlrev_b32 v0, 16, v132
v_and_b32 v1, s71, v132
v_lshlrev_b32 v2, 16, v133
v_and_b32 v3, s71, v133
v_lshlrev_b32 v4, 16, v134
v_and_b32 v5, s71, v134
v_lshlrev_b32 v6, 16, v135
v_and_b32_e64 v7, s71, v135
v_pk_mul_f32 v[0:1], v[0:1], s[14:15]
v_pk_mul_f32 v[2:3], v[2:3], s[14:15]
v_pk_mul_f32 v[4:5], v[4:5], s[14:15]
v_pk_mul_f32 v[6:7], v[6:7], s[14:15]
CV 132,0,1
CV 133,2,3
CV 134,4,5
CV 135,6,7
ds_write_b128 v15, v[132:135] offset:544
s_waitcnt vmcnt(11)
v_lshlrev_b32 v0, 16, v136
v_and_b32 v1, s71, v136
v_lshlrev_b32 v2, 16, v137
v_and_b32 v3, s71, v137
v_lshlrev_b32 v4, 16, v138
v_and_b32 v5, s71, v138
v_lshlrev_b32 v6, 16, v139
v_and_b32_e64 v7, s71, v139
v_pk_mul_f32 v[0:1], v[0:1], s[14:15]
v_pk_mul_f32 v[2:3], v[2:3], s[14:15]
v_pk_mul_f32 v[4:5], v[4:5], s[14:15]
v_pk_mul_f32 v[6:7], v[6:7], s[14:15]
CV 136,0,1
CV 137,2,3
CV 138,4,5
CV 139,6,7
ds_write_b128 v15, v[136:139] offset:1152
s_waitcnt vmcnt(10)
v_lshlrev_b32 v0, 16, v140
v_and_b32 v1, s71, v140
v_lshlrev_b32 v2, 16, v141
v_and_b32 v3, s71, v141
v_lshlrev_b32 v4, 16, v142
v_and_b32 v5, s71, v142
v_lshlrev_b32 v6, 16, v143
v_and_b32_e64 v7, s71, v143
v_pk_mul_f32 v[0:1], v[0:1], s[14:15]
v_pk_mul_f32 v[2:3], v[2:3], s[14:15]
v_pk_mul_f32 v[4:5], v[4:5], s[14:15]
v_pk_mul_f32 v[6:7], v[6:7], s[14:15]
CV 140,0,1
CV 141,2,3
CV 142,4,5
CV 143,6,7
ds_write_b128 v15, v[140:143] offset:1696
RK 128,14,0
RK 132,14,64
v_accvgpr_write_b32 a240, 0
v_accvgpr_write_b32 a241, 0
RK 136,14,128
v_accvgpr_write_b32 a242, 0
RK 140,14,192
v_accvgpr_write_b32 a243, 0
v_xor_b32 v60, s43, v60
v_xor_b32 v61, s43, v61
v_xor_b32 v62, s43, v62
v_xor_b32 v63, s43, v63
v_accvgpr_write_b32 a244, 0
v_accvgpr_write_b32 a245, 0
v_accvgpr_write_b32 a246, 0
v_accvgpr_write_b32 a247, 0
s_sub_u32 s52, s26, s44
s_ashr_i32 s52, s52, 8
s_waitcnt lgkmcnt(3)
QZ 16,0,128
s_waitcnt lgkmcnt(2)
s_sub_u32 s52, s52, 512
v_and_b32 v49, 0xf0, v72
v_and_b32 v53, 0xf0, v72
QK 16,4,132,16
s_waitcnt lgkmcnt(1)
s_sub_u32 s53, s26, s44
v_sub_u32 v49, s52, v49
QK 16,8,136,16
s_waitcnt lgkmcnt(0)
s_ashr_i32 s53, s53, 8
v_ashrrev_i32 v49, 31, v49
QK 16,12,140,16
s_sub_u32 s53, s53, 768
v_sub_u32 v53, s53, v53
s_nop 0
QZ 20,16,128
v_ashrrev_i32 v53, 31, v53
s_nop 0
QK 20,20,132,20
s_nop 0
v_max3_f32 v8, v16, v17, v18
QK 20,24,136,20
s_xor_b32 s41, s41, s43
QK 20,28,140,20
s_xor_b32 s42, s41, 0xc000
s_nop 6
v_max3_f32 v9, v20, v21, v22
v_max3_f32 v8, v8, v19, v23
v_max_f32 v8, v8, v9
v_mov_b32 v9, v8
s_nop 1
v_permlane32_swap_b32 v8, v9
v_max_f32 v8, v8, v9
v_mov_b32 v9, v8
s_nop 1
v_permlane16_swap_b32 v8, v9
v_min_f32_e64 v40, -v8, -v9
v_add_f32 v16, v40, v16
v_add_f32 v17, v40, v17
v_add_f32 v18, v40, v18
v_add_f32 v19, v40, v19
v_add_f32 v20, v40, v20
v_add_f32 v21, v40, v21
v_add_f32 v22, v40, v22
v_add_f32 v23, v40, v23
EX 16
EX 17
EX 18
EX 19
EX 20
EX 21
EX 22
v_exp_f32_e64 v23, v23
CV 32,16,17
CV 33,18,19
CV 34,20,21
CV 35,22,23
v_mov_b32 v41, v40
s_waitcnt vmcnt(7)
buffer_load_dwordx4 v[224:227], v72, s[24:27], s51 offen nt
s_barrier
v_lshlrev_b32 v0, 16, v160
RV 64,64,8192
RV 66,64,12288
v_and_b32_e64 v1, s71, v160
RV 68,65,8192
buffer_load_dwordx4 v[228:231], v73, s[24:27], s51 offen nt
RV 70,65,12288
RV 72,64,8448
v_lshlrev_b32 v2, 16, v161
RV 74,64,12544
RV 76,65,8448
v_and_b32 v3, s71, v161
RV 78,65,12544
v_lshlrev_b32 v4, 16, v162
buffer_load_dwordx4 v[232:235], v74, s[24:27], s51 offen nt
RV 80,64,8704
RV 82,64,12800
v_and_b32 v5, s71, v162
RV 84,65,8704
RV 86,65,12800
v_lshlrev_b32_e64 v6, 16, v163
RV 88,64,8960
RV 90,64,13056
buffer_load_dwordx4 v[236:239], v75, s[24:27], s51 offen nt
RV 92,65,8960
v_and_b32_e64 v7, s71, v163
RV 94,65,13056
v_pk_mul_f32 v[0:1], v[0:1], s[14:15]
v_pk_mul_f32 v[2:3], v[2:3], s[14:15]
v_pk_mul_f32 v[4:5], v[4:5], s[14:15]
v_pk_mul_f32 v[6:7], v[6:7], s[14:15]
CV 160,0,1
CV 161,2,3
CV 162,4,5
CV 163,6,7
ds_write_b128 v15, v[160:163] offset:0
s_waitcnt vmcnt(10)
v_lshlrev_b32 v0, 16, v164
v_and_b32 v1, s71, v164
v_lshlrev_b32 v2, 16, v165
v_and_b32 v3, s71, v165
v_lshlrev_b32 v4, 16, v166
v_and_b32 v5, s71, v166
v_lshlrev_b32 v6, 16, v167
v_and_b32_e64 v7, s71, v167
v_pk_mul_f32 v[0:1], v[0:1], s[14:15]
v_pk_mul_f32 v[2:3], v[2:3], s[14:15]
v_pk_mul_f32 v[4:5], v[4:5], s[14:15]
v_pk_mul_f32 v[6:7], v[6:7], s[14:15]
CV 164,0,1
CV 165,2,3
CV 166,4,5
CV 167,6,7
ds_write_b128 v15, v[164:167] offset:544
s_waitcnt vmcnt(9)
v_lshlrev_b32 v0, 16, v168
v_and_b32 v1, s71, v168
v_lshlrev_b32 v2, 16, v169
v_and_b32 v3, s71, v169
v_lshlrev_b32 v4, 16, v170
v_and_b32 v5, s71, v170
v_lshlrev_b32 v6, 16, v171
v_and_b32_e64 v7, s71, v171
v_pk_mul_f32 v[0:1], v[0:1], s[14:15]
v_pk_mul_f32 v[2:3], v[2:3], s[14:15]
v_pk_mul_f32 v[4:5], v[4:5], s[14:15]
v_pk_mul_f32 v[6:7], v[6:7], s[14:15]
CV 168,0,1
CV 169,2,3
CV 170,4,5
CV 171,6,7
ds_write_b128 v15, v[168:171] offset:1152
s_waitcnt vmcnt(8)
v_lshlrev_b32 v0, 16, v172
v_and_b32 v1, s71, v172
v_lshlrev_b32 v2, 16, v173
v_and_b32 v3, s71, v173
v_lshlrev_b32 v4, 16, v174
v_and_b32 v5, s71, v174
v_lshlrev_b32 v6, 16, v175
v_and_b32_e64 v7, s71, v175
v_pk_mul_f32 v[0:1], v[0:1], s[14:15]
v_pk_mul_f32 v[2:3], v[2:3], s[14:15]
v_pk_mul_f32 v[4:5], v[4:5], s[14:15]
v_pk_mul_f32 v[6:7], v[6:7], s[14:15]
CV 172,0,1
CV 173,2,3
CV 174,4,5
CV 175,6,7
s_waitcnt lgkmcnt(15)
PZ 128,64,32
ds_write_b128 v15, v[172:175] offset:1696
PZ 132,68,32
s_waitcnt lgkmcnt(14)
RK 144,14,0
RK 148,14,64
PZ 136,72,32
s_waitcnt lgkmcnt(14)
RK 152,14,128
v_mov_b32 v42, v40
PZ 140,76,32
s_waitcnt lgkmcnt(13)
RK 156,14,192
v_mov_b32 v43, v40
PZ 144,80,32
s_waitcnt lgkmcnt(12)
v_xor_b32 v64, s43, v64
v_xor_b32 v65, s43, v65
PZ 148,84,32
s_waitcnt lgkmcnt(10)
s_xor_b32 s43, s43, 0xc000
PZ 152,88,32
s_waitcnt lgkmcnt(8)
PZ 156,92,32
s_waitcnt lgkmcnt(3)
QZ 24,0,144
s_waitcnt lgkmcnt(2)
QK 24,4,148,24
s_waitcnt lgkmcnt(1)
QK 24,8,152,24
s_waitcnt lgkmcnt(0)
QK 24,12,156,24
s_nop 2
QZ 28,16,144
s_nop 2
QK 28,20,148,28
v_max3_f32 v10, v24, v25, v26
QK 28,24,152,28
QK 28,28,156,28
s_nop 7
v_max3_f32 v11, v28, v29, v30
v_max3_f32 v10, v10, v27, v31
v_max_f32 v10, v10, v11
v_mov_b32 v11, v10
s_nop 1
v_permlane32_swap_b32 v10, v11
v_max_f32 v10, v10, v11
v_mov_b32 v11, v10
s_nop 1
v_permlane16_swap_b32 v10, v11
v_min_f32_e64 v44, -v10, -v11
v_add_f32 v24, v44, v24
v_add_f32 v25, v44, v25
v_add_f32 v26, v44, v26
v_add_f32 v27, v44, v27
v_add_f32 v28, v44, v28
v_add_f32 v29, v44, v29
v_add_f32 v30, v44, v30
v_add_f32 v31, v44, v31
EX 24
EX 25
EX 26
EX 27
EX 28
EX 29
EX 30
EX 31
CV 36,24,25
CV 37,26,27
CV 38,28,29
CV 39,30,31
v_mov_b32 v45, v44
s_waitcnt vmcnt(7)
buffer_load_dwordx4 v66, s[16:19], s40 offen lds
v_lshlrev_b32 v0, 16, v192
v_and_b32 v1, s71, v192
v_lshlrev_b32 v2, 16, v193
v_and_b32 v3, s71, v193
v_lshlrev_b32 v4, 16, v194
v_and_b32 v5, s71, v194
v_lshlrev_b32 v6, 16, v195
v_and_b32 v7, s71, v195
buffer_load_dwordx4 v67, s[16:19], s40 offen offset:1024 lds
s_add_u32 m0, s47, 0x14000
v_pk_mul_f32 v[0:1], v[0:1], s[14:15]
v_pk_mul_f32 v[2:3], v[2:3], s[14:15]
v_pk_mul_f32 v[4:5], v[4:5], s[14:15]
v_pk_mul_f32 v[6:7], v[6:7], s[14:15]
CV 192,0,1
CV 193,2,3
CV 194,4,5
CV 195,6,7
ds_write_b128 v15, v[192:195] offset:0
buffer_load_dwordx4 v68, s[20:23], s40 offen lds
s_waitcnt vmcnt(9)
v_lshlrev_b32 v0, 16, v196
v_and_b32 v1, s71, v196
v_lshlrev_b32 v2, 16, v197
v_and_b32 v3, s71, v197
v_lshlrev_b32 v4, 16, v198
v_and_b32 v5, s71, v198
v_lshlrev_b32 v6, 16, v199
v_and_b32_e64 v7, s71, v199
v_pk_mul_f32 v[0:1], v[0:1], s[14:15]
v_pk_mul_f32 v[2:3], v[2:3], s[14:15]
buffer_load_dwordx4 v69, s[20:23], s40 offen offset:1024 lds
s_mov_b32 s40, 0x40000
s_add_u32 m0, s47, 0x6000
v_pk_mul_f32 v[4:5], v[4:5], s[14:15]
v_pk_mul_f32 v[6:7], v[6:7], s[14:15]
CV 196,0,1
CV 197,2,3
CV 198,4,5
CV 199,6,7
ds_write_b128 v15, v[196:199] offset:544
s_waitcnt vmcnt(9)
v_lshlrev_b32 v0, 16, v200
v_and_b32 v1, s71, v200
v_lshlrev_b32 v2, 16, v201
v_and_b32 v3, s71, v201
v_lshlrev_b32 v4, 16, v202
v_and_b32 v5, s71, v202
v_lshlrev_b32 v6, 16, v203
v_and_b32_e64 v7, s71, v203
v_pk_mul_f32 v[0:1], v[0:1], s[14:15]
v_pk_mul_f32 v[2:3], v[2:3], s[14:15]
v_pk_mul_f32 v[4:5], v[4:5], s[14:15]
v_pk_mul_f32 v[6:7], v[6:7], s[14:15]
CV 200,0,1
CV 201,2,3
CV 202,4,5
CV 203,6,7
ds_write_b128 v15, v[200:203] offset:1152
s_waitcnt vmcnt(8)
v_lshlrev_b32 v0, 16, v204
v_and_b32 v1, s71, v204
v_lshlrev_b32 v2, 16, v205
v_and_b32 v3, s71, v205
v_lshlrev_b32 v4, 16, v206
v_and_b32 v5, s71, v206
v_lshlrev_b32 v6, 16, v207
v_and_b32_e64 v7, s71, v207
v_pk_mul_f32 v[0:1], v[0:1], s[14:15]
v_pk_mul_f32 v[2:3], v[2:3], s[14:15]
v_pk_mul_f32 v[4:5], v[4:5], s[14:15]
v_pk_mul_f32 v[6:7], v[6:7], s[14:15]
CV 204,0,1
CV 205,2,3
CV 206,4,5
CV 207,6,7
PZ 160,64,36
ds_write_b128 v15, v[204:207] offset:1696
PZ 164,68,36
RK 160,14,0
RK 164,14,64
PZ 168,72,36
RK 168,14,128
v_mov_b32 v46, v44
PZ 172,76,36
RK 172,14,192
v_mov_b32 v47, v44
PZ 176,80,36
PZ 180,84,36
PZ 184,88,36
PZ 188,92,36
v_smfmac_f32_16x16x64_bf16 a[240:243], v[56:59], v[32:39], v71
s_waitcnt lgkmcnt(3)
QZ 16,0,160
s_waitcnt lgkmcnt(2)
QK 16,4,164,16
s_waitcnt lgkmcnt(1)
QK 16,8,168,16
s_waitcnt lgkmcnt(0)
QK 16,12,172,16
s_nop 2
QZ 20,16,160
s_nop 2
QK 20,20,164,20
v_max3_f32 v8, v16, v17, v18
QK 20,24,168,20
QK 20,28,172,20
s_nop 7
v_max3_f32 v9, v20, v21, v22
v_max3_f32 v8, v8, v19, v23
v_max_f32 v8, v8, v9
v_mov_b32 v9, v8
s_nop 1
v_permlane32_swap_b32 v8, v9
v_max_f32 v8, v8, v9
v_mov_b32 v9, v8
s_nop 1
v_permlane16_swap_b32 v8, v9
v_min_f32_e64 v48, -v8, -v9
v_add_f32 v16, v48, v16
v_add_f32 v17, v48, v17
v_add_f32 v18, v48, v18
v_add_f32 v19, v48, v19
v_add_f32 v20, v48, v20
v_add_f32 v21, v48, v21
v_add_f32 v22, v48, v22
v_add_f32 v23, v48, v23
EX 16
EX 17
EX 18
EX 19
EX 20
EX 21
EX 22
v_exp_f32_e64 v23, v23
CV 32,16,17
CV 33,18,19
CV 34,20,21
CV 35,22,23
v_bfi_b32 v48, v49, s70, v48
s_waitcnt vmcnt(7)
buffer_load_dwordx4 v66, s[16:19], s40 offen lds
v_lshlrev_b32 v0, 16, v224
v_and_b32 v1, s71, v224
v_lshlrev_b32 v2, 16, v225
v_and_b32 v3, s71, v225
v_lshlrev_b32 v4, 16, v226
v_and_b32 v5, s71, v226
v_lshlrev_b32 v6, 16, v227
v_and_b32_e64 v7, s71, v227
buffer_load_dwordx4 v67, s[16:19], s40 offen offset:1024 lds
s_add_u32 m0, s47, 0x16000
v_pk_mul_f32 v[0:1], v[0:1], s[14:15]
v_pk_mul_f32 v[2:3], v[2:3], s[14:15]
v_pk_mul_f32 v[4:5], v[4:5], s[14:15]
v_pk_mul_f32 v[6:7], v[6:7], s[14:15]
CV 224,0,1
CV 225,2,3
CV 226,4,5
CV 227,6,7
ds_write_b128 v15, v[224:227] offset:0
buffer_load_dwordx4 v68, s[20:23], s40 offen lds
s_waitcnt vmcnt(9)
v_lshlrev_b32 v0, 16, v228
v_and_b32 v1, s71, v228
v_lshlrev_b32 v2, 16, v229
v_and_b32 v3, s71, v229
v_lshlrev_b32 v4, 16, v230
v_and_b32 v5, s71, v230
v_lshlrev_b32 v6, 16, v231
v_and_b32_e64 v7, s71, v231
v_pk_mul_f32 v[0:1], v[0:1], s[14:15]
v_pk_mul_f32 v[2:3], v[2:3], s[14:15]
buffer_load_dwordx4 v69, s[20:23], s40 offen offset:1024 lds
v_pk_mul_f32 v[4:5], v[4:5], s[14:15]
v_pk_mul_f32 v[6:7], v[6:7], s[14:15]
CV 228,0,1
CV 229,2,3
CV 230,4,5
CV 231,6,7
ds_write_b128 v15, v[228:231] offset:544
s_waitcnt vmcnt(9)
v_lshlrev_b32 v0, 16, v232
v_and_b32 v1, s71, v232
v_lshlrev_b32 v2, 16, v233
v_and_b32 v3, s71, v233
v_lshlrev_b32 v4, 16, v234
v_and_b32 v5, s71, v234
v_lshlrev_b32 v6, 16, v235
v_and_b32_e64 v7, s71, v235
v_pk_mul_f32 v[0:1], v[0:1], s[14:15]
v_pk_mul_f32 v[2:3], v[2:3], s[14:15]
v_pk_mul_f32 v[4:5], v[4:5], s[14:15]
v_pk_mul_f32 v[6:7], v[6:7], s[14:15]
CV 232,0,1
CV 233,2,3
CV 234,4,5
CV 235,6,7
ds_write_b128 v15, v[232:235] offset:1152
s_waitcnt vmcnt(8)
v_lshlrev_b32 v0, 16, v236
v_and_b32 v1, s71, v236
v_lshlrev_b32 v2, 16, v237
v_and_b32 v3, s71, v237
v_lshlrev_b32 v4, 16, v238
v_and_b32 v5, s71, v238
v_lshlrev_b32 v6, 16, v239
v_and_b32_e64 v7, s71, v239
v_pk_mul_f32 v[0:1], v[0:1], s[14:15]
v_pk_mul_f32 v[2:3], v[2:3], s[14:15]
v_pk_mul_f32 v[4:5], v[4:5], s[14:15]
v_pk_mul_f32 v[6:7], v[6:7], s[14:15]
CV 236,0,1
CV 237,2,3
CV 238,4,5
CV 239,6,7
PZ 192,64,32
s_mov_b32 s40, 0x60000
ds_write_b128 v15, v[236:239] offset:1696
PZ 196,68,32
s_add_u32 m0, s47, 0xc000
RK 176,14,0
RK 180,14,64
PZ 200,72,32
RK 184,14,128
v_mov_b32 v49, v48
PZ 204,76,32
s_waitcnt vmcnt(6)
s_barrier
PZ 208,80,32
RK 188,14,192
RK 32,60,0
PZ 212,84,32
buffer_load_dwordx4 v66, s[16:19], s40 offen lds
PZ 216,88,32
RK 36,61,0
RK 40,62,0
PZ 220,92,32
s_waitcnt lgkmcnt(6)
RK 44,63,0
v_mov_b32 v50, v48
QZ 24,0,176
s_waitcnt lgkmcnt(6)
RK 48,60,4096
v_mov_b32 v51, v48
QK 24,4,180,24
s_waitcnt lgkmcnt(6)
buffer_load_dwordx4 v67, s[16:19], s40 offen offset:1024 lds
QK 24,8,184,24
s_waitcnt lgkmcnt(5)
s_add_u32 m0, s47, 0x1c000
RK 52,61,4096
RK 56,62,4096
QK 24,12,188,24
RK 60,63,4096
s_nop 0
QZ 28,16,176
s_nop 2
QK 28,20,180,28
buffer_load_dwordx4 v68, s[20:23], s40 offen lds
QK 28,24,184,28
v_max3_f32 v10, v24, v25, v26
QK 28,28,188,28
s_waitcnt lgkmcnt(7)
s_nop 2
QK 16,32,128,40
s_waitcnt lgkmcnt(6)
s_nop 2
QK 16,36,132,16
s_waitcnt lgkmcnt(0)
v_max3_f32 v11, v28, v29, v30
v_max3_f32 v10, v10, v27, v31
QK 16,40,136,16
s_waitcnt vmcnt(7)
s_barrier
QK 16,44,140,16
RV 96,64,0
v_max_f32 v10, v10, v11
QK 20,48,128,40
RV 98,64,4096
v_mov_b32 v11, v10
QK 20,52,132,20
RV 100,65,0
RV 102,65,4096
QK 20,56,136,20
v_permlane32_swap_b32 v10, v11
QK 20,60,140,20
buffer_load_dwordx4 v69, s[20:23], s40 offen offset:1024 lds
RV 104,64,256
RV 106,64,4352
v_max_f32 v10, v10, v11
EX 16
v_mov_b32 v11, v10
EX 17
EX 18
v_permlane16_swap_b32 v10, v11
v_min_f32_e64 v52, -v10, -v11
EX 19
v_add_f32 v24, v52, v24
v_add_f32 v25, v52, v25
v_add_f32 v26, v52, v26
v_add_f32 v27, v52, v27
EX 24
EX 25
EX 26
EX 27
CV 36,24,25
CV 37,26,27
QK 24,32,144,44
v_add_f32 v28, v52, v28
v_add_f32 v29, v52, v29
QK 24,36,148,24
s_mov_b32 s40, 0x80000
v_add_f32 v30, v52, v30
v_add_f32 v31, v52, v31
QK 24,40,152,24
s_add_u32 m0, s47, 0xe000
EX 28
QK 24,44,156,24
L_t4_pad1:
s_cbranch_execz L_t4_go
RV 108,65,256
RV 110,65,4352
EX 29
EX 30
EX 31
CV 38,28,29
CV 39,30,31
v_bfi_b32 v52, v53, s70, v52
s_nop 0
v_smfmac_f32_16x16x64_bf16 a[244:247], v[56:59], v[32:39], v71
CV 32,16,17
QK 28,48,144,44
buffer_load_dwordx4 v66, s[16:19], s40 offen lds
QK 28,52,148,28
RV 112,64,512
CV 33,18,19
QK 28,56,152,28
RV 114,64,4608
RV 116,65,512
QK 28,60,156,28
RV 118,65,4608
v_mov_b32 v53, v52
PZ 224,64,36
RV 120,64,768
RV 122,64,4864
PZ 228,68,36
RV 124,65,768
v_mov_b32 v54, v52
PZ 232,72,36
buffer_load_dwordx4 v67, s[16:19], s40 offen offset:1024 lds
PZ 236,76,36
RV 126,65,4864
v_mov_b32 v55, v52
PZ 240,80,36
EX 20
PZ 244,84,36
EX 21
PZ 248,88,36
EX 22
PZ 252,92,36
EX 23
QK 16,32,160,48
s_add_u32 m0, s47, 0x1e000
CV 34,20,21
CV 35,22,23
QK 16,36,164,16
EX 24
QK 16,40,168,16
buffer_load_dwordx4 v68, s[20:23], s40 offen lds
QK 16,44,172,16
EX 25
QK 20,48,160,48
EX 26
QK 20,52,164,20
EX 27
QK 20,56,168,20
s_waitcnt lgkmcnt(0)
CV 36,24,25
CV 37,26,27
QK 20,60,172,20
EX 28
PV 128,96,32
EX 29
PV 132,100,32
buffer_load_dwordx4 v69, s[20:23], s40 offen offset:1024 lds
PV 136,104,32
EX 30
PV 140,108,32
EX 31
PV 144,112,32
CV 38,28,29
CV 39,30,31
PV 148,116,32
s_mov_b32 s40, 0xa0000
EX 16
PV 152,120,32
s_add_u32 m0, s47, 0x8000
EX 17
PV 156,124,32
EX 18
QK 24,32,176,52
buffer_load_dwordx4 v66, s[16:19], s40 offen lds
QK 24,36,180,24
EX 19
QK 24,40,184,24
EX 20
QK 24,44,188,24
EX 21
v_smfmac_f32_16x16x64_bf16 a[240:243], v[56:59], v[32:39], v71
s_waitcnt vmcnt(11)
s_barrier
QK 28,48,176,52
RK 0,60,8192
RK 4,61,8192
QK 28,52,180,28
RK 8,62,8192
CV 32,16,17
QK 28,56,184,28
buffer_load_dwordx4 v67, s[16:19], s40 offen offset:1024 lds
QK 28,60,188,28
RK 12,63,8192
RK 16,60,12288
PV 160,96,36
RK 20,61,12288
CV 33,18,19
PV 164,100,36
RK 24,62,12288
CV 34,20,21
PV 168,104,36
RK 28,63,12288
v_xor_b32 v60, s43, v60
PV 172,108,36
EX 22
PV 176,112,36
s_add_u32 m0, s47, 0x18000
EX 23
PV 180,116,36
CV 35,22,23
v_xor_b32 v61, s43, v61
PV 184,120,36
buffer_load_dwordx4 v68, s[20:23], s40 offen lds
PV 188,124,36
s_waitcnt lgkmcnt(7)
EX 24
QK 16,0,128,40
s_waitcnt lgkmcnt(0)
EX 25
QK 16,4,132,16
EX 26
QK 16,8,136,16
EX 27
QK 16,12,140,16
CV 36,24,25
CV 37,26,27
QK 20,16,128,40
EX 28
QK 20,20,132,20
buffer_load_dwordx4 v69, s[20:23], s40 offen offset:1024 lds
QK 20,24,136,20
EX 29
QK 20,28,140,20
EX 30
PV 192,96,32
EX 31
PV 196,100,32
CV 38,28,29
CV 39,30,31
PV 200,104,32
s_waitcnt vmcnt(12)
s_barrier
PV 204,108,32
RV 64,64,8192
RV 66,64,12288
PV 208,112,32
RV 68,65,8192
v_xor_b32 v62, s43, v62
PV 212,116,32
RV 70,65,12288
RV 72,64,8448
PV 216,120,32
s_xor_b32 s41, s41, s43
RV 74,64,12544
v_xor_b32 v63, s43, v63
PV 220,124,32
s_mov_b32 s40, 0xc0000
RV 76,65,8448
RV 78,65,12544
QK 24,0,144,44
s_add_u32 m0, s47, 0xa000
EX 16
QK 24,4,148,24
s_xor_b32 s42, s41, 0xc000
RV 80,64,8704
RV 82,64,12800
QK 24,8,152,24
EX 17
QK 24,12,156,24
RV 84,65,8704
RV 86,65,12800
v_smfmac_f32_16x16x64_bf16 a[244:247], v[56:59], v[32:39], v71
RV 88,64,8960
QK 28,16,144,44
RV 90,64,13056
RV 92,65,8960
QK 28,20,148,28
RV 94,65,13056
CV 32,16,17
QK 28,24,152,28
buffer_load_dwordx4 v66, s[16:19], s40 offen lds
QK 28,28,156,28
EX 18
PV 224,96,36
EX 19
PV 228,100,36
buffer_load_dwordx4 v67, s[16:19], s40 offen offset:1024 lds
PV 232,104,36
CV 33,18,19
v_xor_b32 v64, s43, v64
PV 236,108,36
s_waitcnt vmcnt(10) lgkmcnt(0)
s_barrier
PV 240,112,36
RK 32,60,0
RK 36,61,0
PV 244,116,36
RK 40,62,0
v_xor_b32 v65, s43, v65
PV 248,120,36
s_xor_b32 s43, s43, 0xc000
EX 20
PV 252,124,36
s_add_u32 m0, s47, 0x1a000
RK 44,63,0
RK 48,60,4096
QK 16,0,160,48
EX 21
QK 16,4,164,16
RK 52,61,4096
RK 56,62,4096
QK 16,8,168,16
RK 60,63,4096
CV 34,20,21
QK 16,12,172,16
buffer_load_dwordx4 v68, s[20:23], s40 offen lds
RV 96,64,0
EX 22
EX 23
EX 24
CV 35,22,23
QK 20,16,160,48
RV 98,64,4096
RV 100,65,0
QK 20,20,164,20
EX 25
QK 20,24,168,20
RV 102,65,4096
CV 36,24,25
QK 20,28,172,20
EX 26
PV 128,64,32
EX 27
PV 132,68,32
buffer_load_dwordx4 v69, s[20:23], s40 offen offset:1024 lds
PV 136,72,32
RV 104,64,256
CV 37,26,27
PV 140,76,32
EX 28
PV 144,80,32
EX 29
PV 148,84,32
RV 106,64,4352
RV 108,65,256
PV 152,88,32
EX 30
PV 156,92,32
EX 31
QK 24,0,176,52
RV 110,65,4352
CV 38,28,29
QK 24,4,180,24
EX 16
QK 24,8,184,24
RV 112,64,512
CV 39,30,31
QK 24,12,188,24
EX 17
v_smfmac_f32_16x16x64_bf16 a[240:243], v[56:59], v[32:39], v71
RV 114,64,4608
QK 28,16,176,52
EX 18
QK 28,20,180,28
EX 19
QK 28,24,184,28
RV 116,65,512
CV 32,16,17
QK 28,28,188,28
EX 20
PV 160,64,36
RV 118,65,4608
CV 33,18,19
PV 164,68,36
EX 21
PV 168,72,36
RV 120,64,768
CV 34,20,21
PV 172,76,36
EX 22
PV 176,80,36
EX 23
PV 180,84,36
RV 122,64,4864
CV 35,22,23
PV 184,88,36
EX 24
PV 188,92,36
s_waitcnt lgkmcnt(14)
EX 25
QK 16,32,128,40
RV 124,65,768
CV 36,24,25
QK 16,36,132,16
EX 26
QK 16,40,136,16
EX 27
QK 16,44,140,16
RV 126,65,4864
CV 37,26,27
QK 20,48,128,40
EX 28
QK 20,52,132,20
EX 29
QK 20,56,136,20
EX 30
QK 20,60,140,20
EX 31
PV 192,64,32
CV 38,28,29
CV 39,30,31
PV 196,68,32
EX 16
PV 200,72,32
EX 17
PV 204,76,32
PV 208,80,32
s_waitcnt vmcnt(8) lgkmcnt(0)
s_barrier
PV 212,84,32
EX 18
PV 216,88,32
EX 19
PV 220,92,32
RK 0,60,8192
QK 24,32,144,44
EX 20
QK 24,36,148,24
s_mov_b32 s40, 0xe0000
RK 4,61,8192
QK 24,40,152,24
s_add_u32 m0, s47, 0x0
EX 21
QK 24,44,156,24
RK 8,62,8192
v_smfmac_f32_16x16x64_bf16 a[244:247], v[56:59], v[32:39], v71
CV 32,16,17
QK 28,48,144,44
buffer_load_dwordx4 v66, s[16:19], s40 offen lds
QK 28,52,148,28
RK 12,63,8192
CV 33,18,19
QK 28,56,152,28
RK 16,60,12288
CV 34,20,21
QK 28,60,156,28
EX 22
PV 224,64,36
RK 20,61,12288
v_xor_b32 v60, s43, v60
PV 228,68,36
EX 23
PV 232,72,36
buffer_load_dwordx4 v67, s[16:19], s40 offen offset:1024 lds
PV 236,76,36
RK 24,62,12288
CV 35,22,23
PV 240,80,36
EX 24
PV 244,84,36
RK 28,63,12288
v_xor_b32 v61, s43, v61
PV 248,88,36
EX 25
PV 252,92,36
RV 64,64,8192
CV 36,24,25
QK 16,32,160,48
s_add_u32 m0, s47, 0x10000
EX 26
QK 16,36,164,16
EX 27
QK 16,40,168,16
buffer_load_dwordx4 v68, s[20:23], s40 offen lds
QK 16,44,172,16
RV 66,64,12288
CV 37,26,27
QK 20,48,160,48
RV 68,65,8192
v_xor_b32 v62, s43, v62
QK 20,52,164,20
EX 28
QK 20,56,168,20
RV 70,65,12288
v_xor_b32 v63, s43, v63
QK 20,60,172,20
EX 29
PV 128,96,32
EX 30
PV 132,100,32
buffer_load_dwordx4 v69, s[20:23], s40 offen offset:1024 lds
PV 136,104,32
RV 72,64,8448
CV 38,28,29
PV 140,108,32
v_exp_f32_e64 v31, v31
PV 144,112,32
RV 74,64,12544
CV 39,30,31
PV 148,116,32
s_mov_b32 s40, 0x100000
EX 16
PV 152,120,32
s_add_u32 m0, s47, 0x2000
v_exp_f32_e64 v17, v17
PV 156,124,32
EX 18
QK 24,32,176,52
RV 76,65,8448
RV 78,65,12544
QK 24,36,180,24
buffer_load_dwordx4 v66, s[16:19], s40 offen lds
QK 24,40,184,24
v_exp_f32_e64 v19, v19
QK 24,44,188,24
EX 20
v_smfmac_f32_16x16x64_bf16 a[240:243], v[56:59], v[32:39], v71
RV 80,64,8704
QK 28,48,176,52
RV 82,64,12800
CV 32,16,17
QK 28,52,180,28
v_exp_f32_e64 v21, v21
QK 28,56,184,28
buffer_load_dwordx4 v67, s[16:19], s40 offen offset:1024 lds
QK 28,60,188,28
RV 84,65,8704
CV 33,18,19
PV 160,96,36
RV 86,65,12800
CV 34,20,21
PV 164,100,36
EX 22
PV 168,104,36
v_exp_f32_e64 v23, v23
PV 172,108,36
RV 88,64,8960
CV 35,22,23
PV 176,112,36
s_add_u32 m0, s47, 0x12000
EX 24
PV 180,116,36
v_exp_f32_e64 v25, v25
PV 184,120,36
buffer_load_dwordx4 v68, s[20:23], s40 offen lds
PV 188,124,36
s_waitcnt lgkmcnt(13)
RV 90,64,13056
RV 92,65,8960
QK 16,0,128,40
EX 26
QK 16,4,132,16
RV 94,65,13056
CV 36,24,25
QK 16,8,136,16
v_exp_f32_e64 v27, v27
QK 16,12,140,16
EX 28
QK 20,16,128,40
v_exp_f32_e64 v29, v29
QK 20,20,132,20
buffer_load_dwordx4 v69, s[20:23], s40 offen offset:1024 lds
QK 20,24,136,20
EX 30
QK 20,28,140,20
v_exp_f32_e64 v31, v31
PV 192,96,32
EX 16
PV 196,100,32
CV 37,26,27
CV 38,28,29
PV 200,104,32
v_exp_f32_e64 v17, v17
PV 204,108,32
CV 39,30,31
v_xor_b32 v64, s43, v64
PV 208,112,32
s_waitcnt vmcnt(8) lgkmcnt(0)
s_barrier
PV 212,116,32
v_xor_b32_e64 v65, s43, v65
s_mov_b32 s56, 10
L_t4_loop0:
PV 216,120,32
s_xor_b32 s41, s41, s43
EX 18
PV 220,124,32
s_xor_b32 s42, s41, 0xc000
RK 32,60,0
QK 24,0,144,44
s_add_u32 s40, s40, 0x20000
EX 19
QK 24,4,148,24
s_add_u32 m0, s42, 0x0
RK 36,61,0
QK 24,8,152,24
buffer_load_dwordx4 v66, s[16:19], s40 offen lds
QK 24,12,156,24
s_xor_b32 s43, s43, 0xc000
RK 40,62,0
v_smfmac_f32_16x16x64_bf16 a[244:247], v[56:59], v[32:39], v71
CV 32,16,17
QK 28,16,144,44
RK 44,63,0
CV 33,18,19
QK 28,20,148,28
EX 20
QK 28,24,152,28
EX 21
QK 28,28,156,28
RK 48,60,4096
CV 34,20,21
PV 224,96,36
EX 22
PV 228,100,36
buffer_load_dwordx4 v67, s[16:19], s40 offen offset:1024 lds
PV 232,104,36
RK 52,61,4096
PV 236,108,36
EX 23
PV 240,112,36
RK 56,62,4096
CV 35,22,23
PV 244,116,36
s_add_u32 m0, s42, 0x10000
EX 24
PV 248,120,36
RK 60,63,4096
PV 252,124,36
EX 25
QK 16,0,160,48
RV 96,64,0
CV 36,24,25
QK 16,4,164,16
buffer_load_dwordx4 v68, s[20:23], s40 offen lds
QK 16,8,168,16
EX 26
QK 16,12,172,16
RV 98,64,4096
QK 20,16,160,48
EX 27
QK 20,20,164,20
RV 100,65,0
CV 37,26,27
QK 20,24,168,20
EX 28
QK 20,28,172,20
RV 102,65,4096
PV 128,64,32
EX 29
PV 132,68,32
buffer_load_dwordx4 v69, s[20:23], s40 offen offset:1024 lds
PV 136,72,32
RV 104,64,256
CV 38,28,29
PV 140,76,32
EX 30
PV 144,80,32
RV 106,64,4352
PV 148,84,32
EX 31
PV 152,88,32
RV 108,65,256
CV 39,30,31
PV 156,92,32
EX 16
QK 24,0,176,52
EX 17
QK 24,4,180,24
RV 110,65,4352
QK 24,8,184,24
EX 18
QK 24,12,188,24
L_t4_pad2:
s_cbranch_execz L_t4_go
RV 112,64,512
v_smfmac_f32_16x16x64_bf16 a[240:243], v[56:59], v[32:39], v71
RV 114,64,4608
QK 28,16,176,52
EX 19
QK 28,20,180,28
CV 32,16,17
CV 33,18,19
QK 28,24,184,28
EX 20
QK 28,28,188,28
RV 116,65,512
PV 160,64,36
EX 21
PV 164,68,36
RV 118,65,4608
CV 34,20,21
PV 168,72,36
EX 22
PV 172,76,36
RV 120,64,768
PV 176,80,36
EX 23
PV 180,84,36
RV 122,64,4864
CV 35,22,23
PV 184,88,36
EX 24
PV 188,92,36
s_waitcnt lgkmcnt(14)
EX 25
QK 16,32,128,40
RV 124,65,768
CV 36,24,25
QK 16,36,132,16
EX 26
QK 16,40,136,16
RV 126,65,4864
QK 16,44,140,16
EX 27
QK 20,48,128,40
EX 28
QK 20,52,132,20
EX 29
QK 20,56,136,20
CV 37,26,27
CV 38,28,29
QK 20,60,140,20
EX 30
PV 192,64,32
EX 31
PV 196,68,32
EX 16
PV 200,72,32
EX 17
PV 204,76,32
CV 39,30,31
PV 208,80,32
s_waitcnt lgkmcnt(0)
EX 18
PV 212,84,32
s_add_u32 s40, s40, 0x20000
PV 216,88,32
s_add_u32 m0, s42, 0x2000
EX 19
PV 220,92,32
RK 0,60,8192
QK 24,32,144,44
EX 20
QK 24,36,148,24
RK 4,61,8192
QK 24,40,152,24
buffer_load_dwordx4 v66, s[16:19], s40 offen lds
QK 24,44,156,24
RK 8,62,8192
v_smfmac_f32_16x16x64_bf16 a[244:247], v[56:59], v[32:39], v71
CV 32,16,17
QK 28,48,144,44
RK 12,63,8192
CV 33,18,19
QK 28,52,148,28
EX 21
QK 28,56,152,28
RK 16,60,12288
CV 34,20,21
QK 28,60,156,28
EX 22
PV 224,64,36
RK 20,61,12288
v_xor_b32 v60, s43, v60
PV 228,68,36
buffer_load_dwordx4 v67, s[16:19], s40 offen offset:1024 lds
PV 232,72,36
EX 23
PV 236,76,36
RK 24,62,12288
CV 35,22,23
PV 240,80,36
EX 24
PV 244,84,36
s_add_u32 m0, s42, 0x12000
RK 28,63,12288
v_xor_b32 v61, s43, v61
PV 248,88,36
EX 25
PV 252,92,36
RV 64,64,8192
CV 36,24,25
QK 16,32,160,48
EX 26
QK 16,36,164,16
buffer_load_dwordx4 v68, s[20:23], s40 offen lds
QK 16,40,168,16
RV 66,64,12288
v_xor_b32 v62, s43, v62
QK 16,44,172,16
EX 27
QK 20,48,160,48
RV 68,65,8192
CV 37,26,27
QK 20,52,164,20
EX 28
QK 20,56,168,20
RV 70,65,12288
v_xor_b32 v63, s43, v63
QK 20,60,172,20
EX 29
PV 128,96,32
EX 30
PV 132,100,32
buffer_load_dwordx4 v69, s[20:23], s40 offen offset:1024 lds
PV 136,104,32
RV 72,64,8448
CV 38,28,29
PV 140,108,32
EX 31
PV 144,112,32
RV 74,64,12544
CV 39,30,31
PV 148,116,32
EX 16
PV 152,120,32
RV 76,65,8448
PV 156,124,32
EX 17
QK 24,32,176,52
EX 18
QK 24,36,180,24
RV 78,65,12544
QK 24,40,184,24
EX 19
QK 24,44,188,24
RV 80,64,8704
v_smfmac_f32_16x16x64_bf16 a[240:243], v[56:59], v[32:39], v71
RV 82,64,12800
QK 28,48,176,52
CV 32,16,17
CV 33,18,19
QK 28,52,180,28
EX 20
QK 28,56,184,28
EX 21
QK 28,60,188,28
RV 84,65,8704
CV 34,20,21
PV 160,96,36
EX 22
PV 164,100,36
RV 86,65,12800
PV 168,104,36
EX 23
PV 172,108,36
RV 88,64,8960
CV 35,22,23
PV 176,112,36
EX 24
PV 180,116,36
EX 25
PV 184,120,36
RV 90,64,13056
v_xor_b32 v64, s43, v64
PV 188,124,36
s_waitcnt lgkmcnt(14)
RV 92,65,8960
CV 36,24,25
QK 16,0,128,40
EX 26
QK 16,4,132,16
EX 27
QK 16,8,136,16
RV 94,65,13056
CV 37,26,27
QK 16,12,140,16
EX 28
QK 20,16,128,40
EX 29
QK 20,20,132,20
EX 30
QK 20,24,136,20
EX 31
QK 20,28,140,20
CV 38,28,29
CV 39,30,31
PV 192,96,32
EX 16
PV 196,100,32
v_xor_b32 v65, s43, v65
PV 200,104,32
EX 17
PV 204,108,32
PV 208,112,32
s_waitcnt vmcnt(8) lgkmcnt(0)
s_barrier
PV 212,116,32
s_sub_u32 s56, s56, 1
s_cbranch_scc0 L_t4_loop0
PV 216,120,32
s_xor_b32 s41, s41, s43
EX 18
PV 220,124,32
s_xor_b32 s43, s43, 0xc000
EX 19
QK 24,0,144,44
s_xor_b32 s42, s41, 0xc000
RK 32,60,0
RK 36,61,0
QK 24,4,148,24
EX 20
QK 24,8,152,24
EX 21
QK 24,12,156,24
RK 40,62,0
v_smfmac_f32_16x16x64_bf16 a[244:247], v[56:59], v[32:39], v71
CV 32,16,17
QK 28,16,144,44
RK 44,63,0
CV 33,18,19
QK 28,20,148,28
EX 22
QK 28,24,152,28
RK 48,60,4096
CV 34,20,21
QK 28,28,156,28
EX 23
PV 224,96,36
RK 52,61,4096
CV 35,22,23
PV 228,100,36
EX 24
PV 232,104,36
EX 25
PV 236,108,36
RK 56,62,4096
PV 240,112,36
EX 26
PV 244,116,36
RK 60,63,4096
PV 248,120,36
EX 27
PV 252,124,36
RV 96,64,0
CV 36,24,25
QK 16,0,160,48
EX 28
QK 16,4,164,16
CV 37,26,27
QK 16,8,168,16
EX 29
QK 16,12,172,16
RV 98,64,4096
CV 38,28,29
QK 20,16,160,48
EX 30
QK 20,20,164,20
RV 100,65,0
QK 20,24,168,20
EX 31
QK 20,28,172,20
RV 102,65,4096
CV 39,30,31
PV 128,64,32
EX 16
PV 132,68,32
RV 104,64,256
PV 136,72,32
EX 17
PV 140,76,32
RV 106,64,4352
PV 144,80,32
EX 18
PV 148,84,32
RV 108,65,256
PV 152,88,32
EX 19
PV 156,92,32
QK 24,0,176,52
EX 20
QK 24,4,180,24
RV 110,65,4352
QK 24,8,184,24
EX 21
QK 24,12,188,24
RV 112,64,512
v_smfmac_f32_16x16x64_bf16 a[240:243], v[56:59], v[32:39], v71
RV 114,64,4608
QK 28,16,176,52
CV 32,16,17
CV 33,18,19
QK 28,20,180,28
EX 22
QK 28,24,184,28
RV 116,65,512
CV 34,20,21
QK 28,28,188,28
EX 23
PV 160,64,36
RV 118,65,4608
CV 35,22,23
PV 164,68,36
EX 24
PV 168,72,36
EX 25
PV 172,76,36
RV 120,64,768
PV 176,80,36
EX 26
PV 180,84,36
RV 122,64,4864
PV 184,88,36
EX 27
PV 188,92,36
s_waitcnt lgkmcnt(14)
RV 124,65,768
CV 36,24,25
QK 16,32,128,40
EX 28
QK 16,36,132,16
RV 126,65,4864
CV 37,26,27
QK 16,40,136,16
EX 29
QK 16,44,140,16
CV 38,28,29
QK 20,48,128,40
EX 30
QK 20,52,132,20
QK 20,56,136,20
EX 31
QK 20,60,140,20
CV 39,30,31
PV 192,64,32
EX 16
PV 196,68,32
PV 200,72,32
EX 17
PV 204,76,32
PV 208,80,32
s_waitcnt lgkmcnt(0)
EX 18
PV 212,84,32
PV 216,88,32
EX 19
PV 220,92,32
RK 0,60,8192
QK 24,32,144,44
EX 20
QK 24,36,148,24
RK 4,61,8192
QK 24,40,152,24
EX 21
QK 24,44,156,24
RK 8,62,8192
v_smfmac_f32_16x16x64_bf16 a[244:247], v[56:59], v[32:39], v71
CV 32,16,17
QK 28,48,144,44
RK 12,63,8192
CV 33,18,19
QK 28,52,148,28
EX 22
QK 28,56,152,28
RK 16,60,12288
CV 34,20,21
QK 28,60,156,28
EX 23
PV 224,64,36
RK 20,61,12288
CV 35,22,23
PV 228,68,36
EX 24
PV 232,72,36
EX 25
PV 236,76,36
RK 24,62,12288
v_xor_b32 v60, s43, v60
PV 240,80,36
EX 26
PV 244,84,36
RK 28,63,12288
v_xor_b32 v61, s43, v61
PV 248,88,36
EX 27
PV 252,92,36
RV 64,64,8192
CV 36,24,25
QK 16,32,160,48
CV 37,26,27
v_xor_b32 v62, s43, v62
QK 16,36,164,16
EX 28
QK 16,40,168,16
RV 66,64,12288
v_xor_b32 v63, s43, v63
QK 16,44,172,16
EX 29
QK 20,48,160,48
RV 68,65,8192
CV 38,28,29
QK 20,52,164,20
EX 30
QK 20,56,168,20
EX 31
QK 20,60,172,20
RV 70,65,12288
CV 39,30,31
PV 128,96,32
EX 16
PV 132,100,32
RV 72,64,8448
PV 136,104,32
EX 17
PV 140,108,32
RV 74,64,12544
PV 144,112,32
EX 18
PV 148,116,32
RV 76,65,8448
PV 152,120,32
EX 19
PV 156,124,32
QK 24,32,176,52
EX 20
QK 24,36,180,24
RV 78,65,12544
QK 24,40,184,24
EX 21
QK 24,44,188,24
RV 80,64,8704
v_smfmac_f32_16x16x64_bf16 a[240:243], v[56:59], v[32:39], v71
RV 82,64,12800
QK 28,48,176,52
CV 32,16,17
CV 33,18,19
QK 28,52,180,28
EX 22
QK 28,56,184,28
RV 84,65,8704
CV 34,20,21
QK 28,60,188,28
EX 23
PV 160,96,36
RV 86,65,12800
CV 35,22,23
PV 164,100,36
EX 24
PV 168,104,36
EX 25
PV 172,108,36
RV 88,64,8960
PV 176,112,36
EX 26
PV 180,116,36
RV 90,64,13056
v_xor_b32 v64, s43, v64
PV 184,120,36
EX 27
PV 188,124,36
s_waitcnt lgkmcnt(14)
RV 92,65,8960
CV 36,24,25
QK 16,0,128,40
EX 28
QK 16,4,132,16
RV 94,65,13056
CV 37,26,27
QK 16,8,136,16
EX 29
QK 16,12,140,16
CV 38,28,29
v_xor_b32 v65, s43, v65
QK 20,16,128,40
EX 30
QK 20,20,132,20
QK 20,24,136,20
EX 31
QK 20,28,140,20
CV 39,30,31
PV 192,96,32
EX 16
PV 196,100,32
PV 200,104,32
EX 17
PV 204,108,32
PV 208,112,32
s_waitcnt vmcnt(0) lgkmcnt(0)
s_barrier
PV 212,116,32
EX 18
PV 216,120,32
s_xor_b32 s41, s41, s43
EX 19
PV 220,124,32
s_xor_b32 s42, s41, 0xc000
RK 32,60,0
QK 24,0,144,44
s_xor_b32 s43, s43, 0xc000
EX 20
QK 24,4,148,24
RK 36,61,0
QK 24,8,152,24
EX 21
QK 24,12,156,24
RK 40,62,0
v_smfmac_f32_16x16x64_bf16 a[244:247], v[56:59], v[32:39], v71
CV 32,16,17
QK 28,16,144,44
RK 44,63,0
CV 33,18,19
QK 28,20,148,28
EX 22
QK 28,24,152,28
RK 48,60,4096
CV 34,20,21
QK 28,28,156,28
EX 23
PV 224,96,36
RK 52,61,4096
CV 35,22,23
PV 228,100,36
EX 24
PV 232,104,36
EX 25
PV 236,108,36
RK 56,62,4096
PV 240,112,36
EX 26
PV 244,116,36
RK 60,63,4096
PV 248,120,36
EX 27
PV 252,124,36
RV 96,64,0
CV 36,24,25
QK 16,0,160,48
EX 28
QK 16,4,164,16
CV 37,26,27
QK 16,8,168,16
EX 29
QK 16,12,172,16
RV 98,64,4096
CV 38,28,29
QK 20,16,160,48
EX 30
QK 20,20,164,20
RV 100,65,0
QK 20,24,168,20
EX 31
QK 20,28,172,20
RV 102,65,4096
CV 39,30,31
PV 128,64,32
EX 16
PV 132,68,32
RV 104,64,256
PV 136,72,32
EX 17
PV 140,76,32
RV 106,64,4352
PV 144,80,32
EX 18
PV 148,84,32
RV 108,65,256
PV 152,88,32
EX 19
PV 156,92,32
QK 24,0,176,52
EX 20
QK 24,4,180,24
RV 110,65,4352
QK 24,8,184,24
L_t4_pad3:
s_cbranch_execz L_t4_go
EX 21
QK 24,12,188,24
RV 112,64,512
v_smfmac_f32_16x16x64_bf16 a[240:243], v[56:59], v[32:39], v71
RV 114,64,4608
QK 28,16,176,52
CV 32,16,17
CV 33,18,19
QK 28,20,180,28
EX 22
QK 28,24,184,28
RV 116,65,512
CV 34,20,21
QK 28,28,188,28
EX 23
PV 160,64,36
RV 118,65,4608
CV 35,22,23
PV 164,68,36
EX 24
PV 168,72,36
EX 25
PV 172,76,36
RV 120,64,768
PV 176,80,36
EX 26
PV 180,84,36
RV 122,64,4864
PV 184,88,36
EX 27
PV 188,92,36
s_waitcnt lgkmcnt(14)
RV 124,65,768
CV 36,24,25
QK 16,32,128,40
EX 28
QK 16,36,132,16
RV 126,65,4864
CV 37,26,27
QK 16,40,136,16
EX 29
QK 16,44,140,16
CV 38,28,29
QK 20,48,128,40
EX 30
QK 20,52,132,20
QK 20,56,136,20
EX 31
QK 20,60,140,20
CV 39,30,31
PV 192,64,32
EX 16
PV 196,68,32
PV 200,72,32
EX 17
PV 204,76,32
PV 208,80,32
s_waitcnt lgkmcnt(0)
EX 18
PV 212,84,32
PV 216,88,32
EX 19
PV 220,92,32
RK 0,60,8192
QK 24,32,144,44
EX 20
QK 24,36,148,24
RK 4,61,8192
QK 24,40,152,24
EX 21
QK 24,44,156,24
RK 8,62,8192
v_smfmac_f32_16x16x64_bf16 a[244:247], v[56:59], v[32:39], v71
CV 32,16,17
QK 28,48,144,44
RK 12,63,8192
CV 33,18,19
QK 28,52,148,28
EX 22
QK 28,56,152,28
RK 16,60,12288
CV 34,20,21
QK 28,60,156,28
EX 23
PV 224,64,36
RK 20,61,12288
CV 35,22,23
PV 228,68,36
EX 24
PV 232,72,36
EX 25
PV 236,76,36
RK 24,62,12288
PV 240,80,36
EX 26
PV 244,84,36
RK 28,63,12288
PV 248,88,36
EX 27
PV 252,92,36
RV 64,64,8192
CV 36,24,25
QK 16,32,160,48
EX 28
QK 16,36,164,16
CV 37,26,27
QK 16,40,168,16
EX 29
QK 16,44,172,16
RV 66,64,12288
CV 38,28,29
QK 20,48,160,48
EX 30
QK 20,52,164,20
RV 68,65,8192
QK 20,56,168,20
EX 31
QK 20,60,172,20
RV 70,65,12288
CV 39,30,31
PV 128,96,32
EX 16
PV 132,100,32
RV 72,64,8448
PV 136,104,32
EX 17
PV 140,108,32
RV 74,64,12544
PV 144,112,32
EX 18
PV 148,116,32
RV 76,65,8448
PV 152,120,32
EX 19
PV 156,124,32
QK 24,32,176,52
EX 20
QK 24,36,180,24
RV 78,65,12544
QK 24,40,184,24
EX 21
QK 24,44,188,24
RV 80,64,8704
v_smfmac_f32_16x16x64_bf16 a[240:243], v[56:59], v[32:39], v71
RV 82,64,12800
QK 28,48,176,52
CV 32,16,17
CV 33,18,19
QK 28,52,180,28
EX 22
QK 28,56,184,28
RV 84,65,8704
CV 34,20,21
QK 28,60,188,28
EX 23
PV 160,96,36
RV 86,65,12800
CV 35,22,23
PV 164,100,36
EX 24
PV 168,104,36
EX 25
PV 172,108,36
RV 88,64,8960
PV 176,112,36
EX 26
PV 180,116,36
RV 90,64,13056
PV 184,120,36
EX 27
PV 188,124,36
s_waitcnt lgkmcnt(14)
RV 92,65,8960
CV 36,24,25
QK 16,0,128,40
EX 28
QK 16,4,132,16
RV 94,65,13056
CV 37,26,27
QK 16,8,136,16
EX 29
QK 16,12,140,16
CV 38,28,29
QK 20,16,128,40
EX 30
QK 20,20,132,20
QK 20,24,136,20
EX 31
QK 20,28,140,20
CV 39,30,31
PV 192,96,32
EX 16
PV 196,100,32
EX 17
PV 200,104,32
EX 18
PV 204,108,32
EX 19
PV 208,112,32
s_waitcnt lgkmcnt(0)
EX 20
PV 212,116,32
EX 21
PV 216,120,32
EX 22
PV 220,124,32
EX 23
QK 24,0,144,44
QK 24,4,148,24
QK 24,8,152,24
QK 24,12,156,24
v_smfmac_f32_16x16x64_bf16 a[244:247], v[56:59], v[32:39], v71
CV 32,16,17
QK 28,16,144,44
CV 33,18,19
CV 34,20,21
QK 28,20,148,28
CV 35,22,23
QK 28,24,152,28
EX 24
QK 28,28,156,28
EX 25
PV 224,96,36
EX 26
PV 228,100,36
EX 27
PV 232,104,36
PV 236,108,36
PV 240,112,36
EX 28
PV 244,116,36
EX 29
PV 248,120,36
EX 30
PV 252,124,36
EX 31
QK 16,0,160,48
CV 36,24,25
CV 37,26,27
QK 16,4,164,16
CV 38,28,29
CV 39,30,31
QK 16,8,168,16
QK 16,12,172,16
QK 20,16,160,48
QK 20,20,164,20
QK 20,24,168,20
QK 20,28,172,20
v_smfmac_f32_16x16x64_bf16 a[240:243], v[56:59], v[32:39], v71
s_add_u32 s48, s44, 0x0
s_nop 0
PV 128,64,32
EX 16
PV 132,68,32
EX 17
PV 136,72,32
EX 18
PV 140,76,32
EX 19
EX 20
EX 21
v_accvgpr_read_b32 v76, a240
v_accvgpr_read_b32 v40, a241
v_accvgpr_read_b32 v77, a242
v_add_f32 v76, v76, v40
v_accvgpr_read_b32 v44, a243
v_cmp_nge_f32 s[4:5], s55, v76
v_rcp_f32 v76, v76
v_add_f32 v77, v77, v44
PM 128,76,0
v_cmp_nge_f32 s[6:7], s55, v77
v_rcp_f32 v77, v77
PM 130,76,0
PV 144,80,32
CV 128,128,129
CV 129,130,131
EX 22
EX 23
PM 132,76,0
PM 134,76,0
PV 148,84,32
ds_write_b64 v70, v[128:129] offset:0
CV 132,132,133
CV 133,134,135
PM 136,76,0
PM 138,76,0
PV 152,88,32
ds_write_b64 v70, v[132:133] offset:32
CV 136,136,137
CV 137,138,139
PM 140,76,0
PM 142,76,0
PV 156,92,32
ds_write_b64 v70, v[136:137] offset:64
CV 140,140,141
CV 141,142,143
PM 144,76,0
PM 146,76,0
QK 24,0,176,52
ds_write_b64 v70, v[140:141] offset:96
CV 144,144,145
CV 145,146,147
PM 148,76,0
PM 150,76,0
QK 24,4,180,24
ds_write_b64 v70, v[144:145] offset:128
CV 148,148,149
CV 149,150,151
PM 152,76,0
PM 154,76,0
QK 24,8,184,24
ds_write_b64 v70, v[148:149] offset:160
CV 152,152,153
CV 153,154,155
PM 156,76,0
PM 158,76,0
QK 24,12,188,24
ds_write_b64 v70, v[152:153] offset:192
CV 156,156,157
CV 157,158,159
QK 28,16,176,52
CV 32,16,17
CV 33,18,19
ds_write_b64 v70, v[156:157] offset:224
QK 28,20,180,28
RK 128,15,0
RK 132,15,528
QK 28,24,184,28
RK 136,15,1056
CV 34,20,21
QK 28,28,188,28
s_add_u32 s49, s44, 0x10000
RK 140,15,1584
CV 35,22,23
PV 160,64,36
EX 24
PV 164,68,36
EX 25
PV 168,72,36
EX 26
PV 172,76,36
s_waitcnt lgkmcnt(3)
buffer_store_dwordx4 a[128:131], v72, s[28:31], s48 offen nt
EX 27
PM 160,76,1
PM 162,76,1
PV 176,80,36
s_waitcnt lgkmcnt(2)
CV 160,160,161
CV 161,162,163
buffer_store_dwordx4 a[132:135], v73, s[28:31], s48 offen nt
PM 164,76,1
PM 166,76,1
PV 180,84,36
ds_write_b64 v70, v[160:161] offset:0
CV 164,164,165
CV 165,166,167
PM 168,76,1
PM 170,76,1
PV 184,88,36
s_waitcnt lgkmcnt(2)
buffer_store_dwordx4 a[136:139], v74, s[28:31], s48 offen nt
ds_write_b64 v70, v[164:165] offset:32
CV 168,168,169
CV 169,170,171
PM 172,76,1
PM 174,76,1
PV 188,92,36
s_waitcnt lgkmcnt(2)
ds_write_b64 v70, v[168:169] offset:64
buffer_store_dwordx4 a[140:143], v75, s[28:31], s48 offen nt
CV 172,172,173
CV 173,174,175
PM 176,76,1
PM 178,76,1
EX 28
EX 29
EX 30
EX 31
CV 36,24,25
CV 37,26,27
CV 38,28,29
CV 39,30,31
CV 176,176,177
CV 177,178,179
v_smfmac_f32_16x16x64_bf16 a[244:247], v[56:59], v[32:39], v71
s_add_u32 s50, s44, 0x20000
ds_write_b64 v70, v[172:173] offset:96
PM 180,76,1
PM 182,76,1
PV 192,64,32
ds_write_b64 v70, v[176:177] offset:128
CV 180,180,181
CV 181,182,183
PM 184,76,1
PM 186,76,1
PV 196,68,32
ds_write_b64 v70, v[180:181] offset:160
v_accvgpr_read_b32 v78, a244
v_accvgpr_read_b32 v48, a245
v_accvgpr_read_b32 v79, a246
v_add_f32 v78, v78, v48
v_accvgpr_read_b32 v52, a247
v_cmp_nge_f32 s[8:9], s55, v78
v_rcp_f32 v78, v78
v_add_f32 v79, v79, v52
CV 184,184,185
v_cmp_nge_f32 s[10:11], s55, v79
v_rcp_f32 v79, v79
CV 185,186,187
PM 188,76,1
PM 190,76,1
PV 200,72,32
ds_write_b64 v70, v[184:185] offset:192
CV 188,188,189
CV 189,190,191
PV 204,76,32
ds_write_b64 v70, v[188:189] offset:224
RK 144,15,0
RK 148,15,528
PM 192,78,0
RK 152,15,1056
PM 194,78,0
PV 208,80,32
RK 156,15,1584
CV 192,192,193
CV 193,194,195
PM 196,78,0
PM 198,78,0
PV 212,84,32
ds_write_b64 v70, v[192:193] offset:0
CV 196,196,197
CV 197,198,199
PM 200,78,0
PM 202,78,0
PV 216,88,32
s_waitcnt lgkmcnt(4)
buffer_store_dwordx4 a[144:147], v72, s[28:31], s49 offen nt
ds_write_b64 v70, v[196:197] offset:32
CV 200,200,201
CV 201,202,203
PM 204,78,0
PM 206,78,0
PV 220,92,32
s_waitcnt lgkmcnt(4)
s_add_u32 s51, s44, 0x30000
ds_write_b64 v70, v[200:201] offset:64
buffer_store_dwordx4 a[148:151], v73, s[28:31], s49 offen nt
CV 204,204,205
CV 205,206,207
PM 208,78,0
PM 210,78,0
PV 224,64,36
ds_write_b64 v70, v[204:205] offset:96
CV 208,208,209
CV 209,210,211
PM 212,78,0
PM 214,78,0
PV 228,68,36
s_waitcnt lgkmcnt(5)
buffer_store_dwordx4 a[152:155], v74, s[28:31], s49 offen nt
ds_write_b64 v70, v[208:209] offset:128
CV 212,212,213
CV 213,214,215
PM 216,78,0
PM 218,78,0
PV 232,72,36
s_waitcnt lgkmcnt(5)
ds_write_b64 v70, v[212:213] offset:160
buffer_store_dwordx4 a[156:159], v75, s[28:31], s49 offen nt
CV 216,216,217
CV 217,218,219
PM 220,78,0
PM 222,78,0
PV 236,76,36
ds_write_b64 v70, v[216:217] offset:192
CV 220,220,221
CV 221,222,223
PM 224,78,1
PM 226,78,1
PV 240,80,36
ds_write_b64 v70, v[220:221] offset:224
RK 160,15,0
RK 164,15,528
CV 224,224,225
RK 168,15,1056
CV 225,226,227
RK 172,15,1584
PM 228,78,1
PM 230,78,1
PV 244,84,36
ds_write_b64 v70, v[224:225] offset:0
CV 228,228,229
CV 229,230,231
PM 232,78,1
PM 234,78,1
PV 248,88,36
s_waitcnt lgkmcnt(4)
buffer_store_dwordx4 a[160:163], v72, s[28:31], s50 offen nt
ds_write_b64 v70, v[228:229] offset:32
CV 232,232,233
CV 233,234,235
PM 236,78,1
PM 238,78,1
PV 252,92,36
s_waitcnt lgkmcnt(4)
ds_write_b64 v70, v[232:233] offset:64
buffer_store_dwordx4 a[164:167], v73, s[28:31], s50 offen nt
CV 236,236,237
CV 237,238,239
ds_write_b64 v70, v[236:237] offset:96
PM 240,78,1
PM 242,78,1
CV 240,240,241
CV 241,242,243
ds_write_b64 v70, v[240:241] offset:128
s_waitcnt lgkmcnt(6)
buffer_store_dwordx4 a[168:171], v74, s[28:31], s50 offen nt
PM 244,78,1
PM 246,78,1
CV 244,244,245
CV 245,246,247
ds_write_b64 v70, v[244:245] offset:160
PM 248,78,1
PM 250,78,1
CV 248,248,249
CV 249,250,251
ds_write_b64 v70, v[248:249] offset:192
s_waitcnt lgkmcnt(7)
buffer_store_dwordx4 a[172:175], v75, s[28:31], s50 offen nt
PM 252,78,1
PM 254,78,1
CV 252,252,253
CV 253,254,255
ds_write_b64 v70, v[252:253] offset:224
RK 176,15,0
RK 180,15,528
RK 184,15,1056
RK 188,15,1584
s_waitcnt lgkmcnt(3)
buffer_store_dwordx4 a[176:179], v72, s[28:31], s51 offen nt
s_waitcnt lgkmcnt(2)
buffer_store_dwordx4 a[180:183], v73, s[28:31], s51 offen nt
s_waitcnt lgkmcnt(1)
buffer_store_dwordx4 a[184:187], v74, s[28:31], s51 offen nt
s_waitcnt lgkmcnt(0)
buffer_store_dwordx4 a[188:191], v75, s[28:31], s51 offen nt
s_cmp_lg_u64 s[4:5], 0
s_cselect_b32 s62, 1, 0
s_or_b32 s54, s54, s62
s_cmp_lg_u64 s[6:7], 0
s_cselect_b32 s62, 2, 0
s_or_b32 s54, s54, s62
s_cmp_lg_u64 s[8:9], 0
s_cselect_b32 s62, 4, 0
s_or_b32 s54, s54, s62
s_cmp_lg_u64 s[10:11], 0
s_cselect_b32 s62, 8, 0
s_or_b32 s54, s54, s62
s_cbranch_scc0 L_done4
s_mov_b32 s4, 0x0
s_mov_b32 s5, 992
s_mov_b32 s6, 0x0
s_mov_b32 s7, 992
s_mov_b32 s45, s44
s_getpc_b64 s[62:63]
L_fpc4:
s_add_u32 s62, s62, L_fallback-L_fpc4
s_addc_u32 s63, s63, 0
s_setpc_b64 s[62:63]
L_done4:
s_endpgm
L_end4:
.p2align 12
L_type5:
s_mov_b64 exec, 0
s_cmp_eq_u32 s12, 0
s_cbranch_scc1 L_t5_pad1
s_cmp_eq_u32 s12, 1
s_cbranch_scc1 L_t5_pad2
s_cmp_eq_u32 s12, 2
s_cbranch_scc1 L_t5_pad3
s_branch L_t5_pad4
L_t5_go:
s_mov_b64 exec, -1
s_add_u32 s51, s44, 0x20000
s_mov_b32 s40, 0xa35000
s_add_u32 m0, s47, 0x4000
s_waitcnt vmcnt(9)
buffer_load_dwordx4 v[192:195], v72, s[24:27], s51 offen nt
s_barrier
v_lshlrev_b32 v0, 16, v128
RK 0,60,8192
RK 4,61,8192
v_and_b32 v1, s71, v128
RK 8,62,8192
v_lshlrev_b32 v2, 16, v129
buffer_load_dwordx4 v[196:199], v73, s[24:27], s51 offen nt
RK 12,63,8192
RK 16,60,12288
v_and_b32 v3, s71, v129
RK 20,61,12288
v_lshlrev_b32 v4, 16, v130
RK 24,62,12288
v_and_b32 v5, s71, v130
buffer_load_dwordx4 v[200:203], v74, s[24:27], s51 offen nt
RK 28,63,12288
v_lshlrev_b32 v6, 16, v131
v_and_b32_e64 v7, s71, v131
v_pk_mul_f32 v[0:1], v[0:1], s[14:15]
v_pk_mul_f32 v[2:3], v[2:3], s[14:15]
v_pk_mul_f32 v[4:5], v[4:5], s[14:15]
v_pk_mul_f32 v[6:7], v[6:7], s[14:15]
CV 128,0,1
CV 129,2,3
CV 130,4,5
buffer_load_dwordx4 v[204:207], v75, s[24:27], s51 offen nt
CV 131,6,7
ds_write_b128 v15, v[128:131] offset:0
s_waitcnt vmcnt(12)
v_lshlrev_b32 v0, 16, v132
v_and_b32 v1, s71, v132
v_lshlrev_b32 v2, 16, v133
v_and_b32 v3, s71, v133
v_lshlrev_b32 v4, 16, v134
v_and_b32 v5, s71, v134
v_lshlrev_b32 v6, 16, v135
v_and_b32_e64 v7, s71, v135
v_pk_mul_f32 v[0:1], v[0:1], s[14:15]
v_pk_mul_f32 v[2:3], v[2:3], s[14:15]
v_pk_mul_f32 v[4:5], v[4:5], s[14:15]
v_pk_mul_f32 v[6:7], v[6:7], s[14:15]
CV 132,0,1
CV 133,2,3
CV 134,4,5
CV 135,6,7
ds_write_b128 v15, v[132:135] offset:544
s_waitcnt vmcnt(11)
v_lshlrev_b32 v0, 16, v136
v_and_b32 v1, s71, v136
v_lshlrev_b32 v2, 16, v137
v_and_b32 v3, s71, v137
v_lshlrev_b32 v4, 16, v138
v_and_b32 v5, s71, v138
v_lshlrev_b32 v6, 16, v139
v_and_b32_e64 v7, s71, v139
v_pk_mul_f32 v[0:1], v[0:1], s[14:15]
v_pk_mul_f32 v[2:3], v[2:3], s[14:15]
v_pk_mul_f32 v[4:5], v[4:5], s[14:15]
v_pk_mul_f32 v[6:7], v[6:7], s[14:15]
CV 136,0,1
CV 137,2,3
CV 138,4,5
CV 139,6,7
ds_write_b128 v15, v[136:139] offset:1152
s_waitcnt vmcnt(10)
v_lshlrev_b32 v0, 16, v140
v_and_b32 v1, s71, v140
v_lshlrev_b32 v2, 16, v141
v_and_b32 v3, s71, v141
v_lshlrev_b32 v4, 16, v142
v_and_b32 v5, s71, v142
v_lshlrev_b32 v6, 16, v143
v_and_b32_e64 v7, s71, v143
v_pk_mul_f32 v[0:1], v[0:1], s[14:15]
v_pk_mul_f32 v[2:3], v[2:3], s[14:15]
v_pk_mul_f32 v[4:5], v[4:5], s[14:15]
v_pk_mul_f32 v[6:7], v[6:7], s[14:15]
CV 140,0,1
CV 141,2,3
CV 142,4,5
CV 143,6,7
ds_write_b128 v15, v[140:143] offset:1696
RK 128,14,0
v_subrev_u32 v13, 0x30000, v71
RK 132,14,64
v_ashrrev_i32 v13, 31, v13
RK 136,14,128
v_not_b32 v13, v13
RK 140,14,192
v_and_b32 v13, 0xff800000, v13
v_mov_b32 v36, 0
v_mov_b32 v37, 0
v_mov_b32 v38, 0
v_mov_b32 v39, 0
v_accvgpr_write_b32 a240, 0
v_accvgpr_write_b32 a241, 0
v_xor_b32 v60, s43, v60
v_xor_b32 v61, s43, v61
v_xor_b32 v62, s43, v62
v_xor_b32 v63, s43, v63
s_sub_u32 s52, s26, s44
s_ashr_i32 s52, s52, 8
v_and_b32 v45, 0xf0, v72
s_waitcnt lgkmcnt(3)
QZ 16,0,128
s_waitcnt lgkmcnt(2)
s_sub_u32 s52, s52, 256
v_sub_u32 v45, s52, v45
v_accvgpr_write_b32 a244, 0
QK 16,4,132,16
s_waitcnt lgkmcnt(1)
s_sub_u32 s53, s26, s44
v_ashrrev_i32 v45, 31, v45
v_accvgpr_write_b32 a245, 0
QK 16,8,136,16
s_waitcnt lgkmcnt(0)
s_ashr_i32 s53, s53, 8
v_accvgpr_write_b32 a246, 0
v_accvgpr_write_b32 a247, 0
QK 16,12,140,16
s_sub_u32 s53, s53, 512
v_and_b32 v49, 0xf0, v72
v_accvgpr_write_b32 a248, 0
QZ 20,16,128
s_mov_b32 s57, 6
v_sub_u32 v49, s53, v49
v_accvgpr_write_b32 a249, 0
QK 20,20,132,20
s_mov_b32 s58, 0x20000
v_max3_f32 v8, v16, v17, v18
v_ashrrev_i32 v49, 31, v49
QK 20,24,136,20
s_xor_b32 s41, s41, s43
v_accvgpr_write_b32 a250, 0
v_accvgpr_write_b32 a251, 0
QK 20,28,140,20
s_xor_b32 s42, s41, 0xc000
s_mov_b32 s60, 0x54b000
s_mov_b32 s59, 0x20000
s_mov_b32 s61, 0x1a000
s_sub_u32 s57, s57, 1
s_cselect_b64 s[58:59], s[60:61], s[58:59]
s_mul_i32 s45, s12, 0x30000
s_mul_i32 s50, s46, 0xc0000
s_add_u32 s45, s45, s50
v_max3_f32 v9, v20, v21, v22
v_max3_f32 v8, v8, v19, v23
s_add_u32 s45, s45, 0x11a0000
v_max_f32 v8, v8, v9
s_mov_b64 s[32:33], s[24:25]
v_mov_b32 v9, v8
s_mov_b32 s34, 0x13d9100
s_mov_b32 s35, 0x20000
v_permlane32_swap_b32 v8, v9
v_max_f32 v8, v8, v9
v_accvgpr_write_b32 a252, 0
v_mov_b32 v9, v8
v_accvgpr_write_b32 a253, 0
v_accvgpr_write_b32 a254, 0
v_permlane16_swap_b32 v8, v9
v_min_f32_e64 v40, -v8, -v9
v_accvgpr_write_b32 a255, 0
v_add_f32 v9, v40, v13
v_add_f32 v16, v40, v16
v_add_f32 v17, v40, v17
v_add_f32 v18, v40, v18
v_add_f32 v19, v40, v19
v_add_f32 v20, v40, v20
v_add_f32 v21, v40, v21
v_add_f32 v22, v9, v22
v_add_f32 v23, v9, v23
EX 16
EX 17
EX 18
EX 19
EX 20
EX 21
EX 22
v_exp_f32_e64 v23, v23
CV 32,16,17
CV 33,18,19
CV 34,20,21
CV 35,22,23
v_mov_b32 v41, v40
s_waitcnt vmcnt(7)
s_barrier
buffer_load_dwordx4 v66, s[16:19], s40 offen lds
RV 64,64,8192
RV 66,64,12288
v_lshlrev_b32 v0, 16, v160
RV 68,65,8192
RV 70,65,12288
v_and_b32_e64 v1, s71, v160
RV 72,64,8448
RV 74,64,12544
buffer_load_dwordx4 v67, s[16:19], s40 offen offset:1024 lds
RV 76,65,8448
s_add_u32 m0, s47, 0x14000
v_lshlrev_b32 v2, 16, v161
RV 78,65,12544
RV 80,64,8704
v_and_b32 v3, s71, v161
RV 82,64,12800
RV 84,65,8704
buffer_load_dwordx4 v68, s[20:23], s40 offen lds
RV 86,65,12800
v_lshlrev_b32 v4, 16, v162
RV 88,64,8960
RV 90,64,13056
v_and_b32 v5, s71, v162
RV 92,65,8960
v_lshlrev_b32_e64 v6, 16, v163
buffer_load_dwordx4 v69, s[20:23], s40 offen offset:1024 lds
s_mov_b32 s40, 0xa55000
s_add_u32 m0, s47, 0x6000
RV 94,65,13056
v_and_b32_e64 v7, s71, v163
v_pk_mul_f32 v[0:1], v[0:1], s[14:15]
v_pk_mul_f32 v[2:3], v[2:3], s[14:15]
v_pk_mul_f32 v[4:5], v[4:5], s[14:15]
v_pk_mul_f32 v[6:7], v[6:7], s[14:15]
CV 160,0,1
CV 161,2,3
CV 162,4,5
CV 163,6,7
ds_write_b128 v15, v[160:163] offset:0
s_waitcnt vmcnt(10)
v_lshlrev_b32 v0, 16, v164
v_and_b32 v1, s71, v164
v_lshlrev_b32 v2, 16, v165
v_and_b32 v3, s71, v165
v_lshlrev_b32 v4, 16, v166
v_and_b32 v5, s71, v166
v_lshlrev_b32 v6, 16, v167
v_and_b32_e64 v7, s71, v167
v_pk_mul_f32 v[0:1], v[0:1], s[14:15]
v_pk_mul_f32 v[2:3], v[2:3], s[14:15]
v_pk_mul_f32 v[4:5], v[4:5], s[14:15]
v_pk_mul_f32 v[6:7], v[6:7], s[14:15]
CV 164,0,1
CV 165,2,3
CV 166,4,5
CV 167,6,7
ds_write_b128 v15, v[164:167] offset:544
s_waitcnt vmcnt(9)
v_lshlrev_b32 v0, 16, v168
v_and_b32 v1, s71, v168
v_lshlrev_b32 v2, 16, v169
v_and_b32 v3, s71, v169
v_lshlrev_b32 v4, 16, v170
v_and_b32 v5, s71, v170
v_lshlrev_b32 v6, 16, v171
v_and_b32_e64 v7, s71, v171
v_pk_mul_f32 v[0:1], v[0:1], s[14:15]
v_pk_mul_f32 v[2:3], v[2:3], s[14:15]
v_pk_mul_f32 v[4:5], v[4:5], s[14:15]
v_pk_mul_f32 v[6:7], v[6:7], s[14:15]
CV 168,0,1
CV 169,2,3
CV 170,4,5
CV 171,6,7
ds_write_b128 v15, v[168:171] offset:1152
s_waitcnt vmcnt(8)
v_lshlrev_b32 v0, 16, v172
v_and_b32 v1, s71, v172
v_lshlrev_b32 v2, 16, v173
v_and_b32 v3, s71, v173
v_lshlrev_b32 v4, 16, v174
v_and_b32 v5, s71, v174
v_lshlrev_b32 v6, 16, v175
v_and_b32_e64 v7, s71, v175
v_pk_mul_f32 v[0:1], v[0:1], s[14:15]
v_pk_mul_f32 v[2:3], v[2:3], s[14:15]
v_pk_mul_f32 v[4:5], v[4:5], s[14:15]
v_pk_mul_f32 v[6:7], v[6:7], s[14:15]
CV 172,0,1
CV 173,2,3
CV 174,4,5
CV 175,6,7
s_waitcnt lgkmcnt(15)
PZ 128,64,32
s_mov_b64 s[36:37], s[28:29]
ds_write_b128 v15, v[172:175] offset:1696
PZ 132,68,32
s_waitcnt lgkmcnt(14)
s_mov_b32 s38, 0x13d9100
RK 144,14,0
RK 148,14,64
PZ 136,72,32
s_waitcnt lgkmcnt(14)
s_mov_b32 s39, 0x20000
RK 152,14,128
v_mov_b32 v42, v40
PZ 140,76,32
s_waitcnt lgkmcnt(13)
RK 156,14,192
v_mov_b32 v43, v40
PZ 144,80,32
s_waitcnt lgkmcnt(12)
v_xor_b32 v64, s43, v64
v_xor_b32 v65, s43, v65
PZ 148,84,32
s_waitcnt lgkmcnt(10)
s_xor_b32 s43, s43, 0xc000
PZ 152,88,32
s_waitcnt lgkmcnt(8)
PZ 156,92,32
v_smfmac_f32_16x16x64_bf16 a[240:243], v[56:59], v[32:39], v71
s_waitcnt lgkmcnt(3)
QZ 24,0,144
s_waitcnt lgkmcnt(2)
QK 24,4,148,24
s_waitcnt lgkmcnt(1)
QK 24,8,152,24
s_waitcnt lgkmcnt(0)
QK 24,12,156,24
s_nop 2
QZ 28,16,144
s_nop 2
QK 28,20,148,28
v_max3_f32 v10, v24, v25, v26
v_accvgpr_write_b32 a242, 0
QK 28,24,152,28
v_accvgpr_write_b32 a243, 0
QK 28,28,156,28
s_nop 7
v_max3_f32 v11, v28, v29, v30
v_max3_f32 v10, v10, v27, v31
v_max_f32 v10, v10, v11
v_mov_b32 v11, v10
s_nop 1
v_permlane32_swap_b32 v10, v11
v_max_f32 v10, v10, v11
v_mov_b32 v11, v10
s_nop 1
v_permlane16_swap_b32 v10, v11
v_min_f32_e64 v44, -v10, -v11
v_add_f32 v11, v44, v13
v_add_f32 v24, v44, v24
v_add_f32 v25, v44, v25
v_add_f32 v26, v44, v26
v_add_f32 v27, v44, v27
v_add_f32 v28, v44, v28
v_add_f32 v29, v44, v29
v_add_f32 v30, v11, v30
v_add_f32 v31, v11, v31
EX 24
EX 25
EX 26
EX 27
EX 28
EX 29
EX 30
EX 31
CV 36,24,25
CV 37,26,27
CV 38,28,29
CV 39,30,31
v_bfi_b32 v44, v45, s70, v44
s_waitcnt vmcnt(7)
buffer_load_dwordx4 v66, s[16:19], s40 offen lds
v_lshlrev_b32 v0, 16, v192
v_and_b32 v1, s71, v192
v_lshlrev_b32 v2, 16, v193
v_and_b32 v3, s71, v193
v_lshlrev_b32 v4, 16, v194
v_and_b32 v5, s71, v194
v_lshlrev_b32 v6, 16, v195
v_and_b32_e64 v7, s71, v195
buffer_load_dwordx4 v67, s[16:19], s40 offen offset:1024 lds
s_add_u32 m0, s47, 0x16000
v_pk_mul_f32 v[0:1], v[0:1], s[14:15]
v_pk_mul_f32 v[2:3], v[2:3], s[14:15]
v_pk_mul_f32 v[4:5], v[4:5], s[14:15]
v_pk_mul_f32 v[6:7], v[6:7], s[14:15]
CV 192,0,1
CV 193,2,3
CV 194,4,5
CV 195,6,7
ds_write_b128 v15, v[192:195] offset:0
buffer_load_dwordx4 v68, s[20:23], s40 offen lds
s_waitcnt vmcnt(9)
v_lshlrev_b32 v0, 16, v196
v_and_b32 v1, s71, v196
v_lshlrev_b32 v2, 16, v197
v_and_b32 v3, s71, v197
v_lshlrev_b32 v4, 16, v198
v_and_b32 v5, s71, v198
v_lshlrev_b32 v6, 16, v199
v_and_b32_e64 v7, s71, v199
v_pk_mul_f32 v[0:1], v[0:1], s[14:15]
v_pk_mul_f32 v[2:3], v[2:3], s[14:15]
buffer_load_dwordx4 v69, s[20:23], s40 offen offset:1024 lds
v_pk_mul_f32 v[4:5], v[4:5], s[14:15]
v_pk_mul_f32 v[6:7], v[6:7], s[14:15]
CV 196,0,1
CV 197,2,3
CV 198,4,5
CV 199,6,7
ds_write_b128 v15, v[196:199] offset:544
s_waitcnt vmcnt(9)
v_lshlrev_b32 v0, 16, v200
v_and_b32 v1, s71, v200
v_lshlrev_b32 v2, 16, v201
v_and_b32 v3, s71, v201
v_lshlrev_b32 v4, 16, v202
v_and_b32 v5, s71, v202
v_lshlrev_b32 v6, 16, v203
v_and_b32_e64 v7, s71, v203
v_pk_mul_f32 v[0:1], v[0:1], s[14:15]
v_pk_mul_f32 v[2:3], v[2:3], s[14:15]
v_pk_mul_f32 v[4:5], v[4:5], s[14:15]
v_pk_mul_f32 v[6:7], v[6:7], s[14:15]
CV 200,0,1
CV 201,2,3
CV 202,4,5
CV 203,6,7
ds_write_b128 v15, v[200:203] offset:1152
s_waitcnt vmcnt(8)
v_lshlrev_b32 v0, 16, v204
v_and_b32 v1, s71, v204
v_lshlrev_b32 v2, 16, v205
v_and_b32 v3, s71, v205
v_lshlrev_b32 v4, 16, v206
v_and_b32 v5, s71, v206
v_lshlrev_b32 v6, 16, v207
v_and_b32_e64 v7, s71, v207
v_pk_mul_f32 v[0:1], v[0:1], s[14:15]
v_pk_mul_f32 v[2:3], v[2:3], s[14:15]
v_pk_mul_f32 v[4:5], v[4:5], s[14:15]
v_pk_mul_f32 v[6:7], v[6:7], s[14:15]
CV 204,0,1
CV 205,2,3
CV 206,4,5
CV 207,6,7
PZ 160,64,36
s_mov_b32 s40, 0xa75000
ds_write_b128 v15, v[204:207] offset:1696
PZ 164,68,36
s_add_u32 m0, s47, 0xc000
RK 160,14,0
RK 164,14,64
PZ 168,72,36
RK 168,14,128
v_mov_b32 v45, v44
PZ 172,76,36
s_waitcnt vmcnt(6)
s_barrier
PZ 176,80,36
RK 172,14,192
RK 32,60,0
PZ 180,84,36
buffer_load_dwordx4 v66, s[16:19], s40 offen lds
PZ 184,88,36
RK 36,61,0
RK 40,62,0
PZ 188,92,36
s_waitcnt lgkmcnt(6)
RK 44,63,0
v_mov_b32 v46, v44
QZ 16,0,160
s_waitcnt lgkmcnt(6)
RK 48,60,4096
v_mov_b32 v47, v44
QK 16,4,164,16
s_waitcnt lgkmcnt(6)
buffer_load_dwordx4 v67, s[16:19], s40 offen offset:1024 lds
QK 16,8,168,16
s_waitcnt lgkmcnt(5)
s_add_u32 m0, s47, 0x1c000
RK 52,61,4096
RK 56,62,4096
QK 16,12,172,16
RK 60,63,4096
s_nop 0
QZ 20,16,160
s_nop 2
QK 20,20,164,20
s_nop 0
v_max3_f32 v8, v16, v17, v18
QK 20,24,168,20
buffer_load_dwordx4 v68, s[20:23], s40 offen lds
QK 20,28,172,20
s_waitcnt lgkmcnt(7)
s_nop 2
QK 24,32,128,40
s_waitcnt lgkmcnt(6)
s_nop 2
QK 24,36,132,24
s_waitcnt lgkmcnt(0)
v_max3_f32 v9, v20, v21, v22
v_max3_f32 v8, v8, v19, v23
QK 24,40,136,24
v_max_f32 v8, v8, v9
QK 24,44,140,24
s_waitcnt vmcnt(7)
s_barrier
QK 28,48,128,40
RV 96,64,0
v_mov_b32 v9, v8
QK 28,52,132,28
RV 98,64,4096
RV 100,65,0
QK 28,56,136,28
v_permlane32_swap_b32 v8, v9
QK 28,60,140,28
buffer_load_dwordx4 v69, s[20:23], s40 offen offset:1024 lds
RV 102,65,4096
RV 104,64,256
v_max_f32 v8, v8, v9
EX 24
v_mov_b32 v9, v8
EX 25
EX 26
v_permlane16_swap_b32 v8, v9
v_min_f32_e64 v48, -v8, -v9
EX 27
v_add_f32 v9, v48, v13
v_add_f32 v16, v48, v16
v_add_f32 v17, v48, v17
v_add_f32 v18, v48, v18
v_add_f32 v19, v48, v19
v_add_f32 v20, v48, v20
v_add_f32 v21, v48, v21
v_add_f32 v22, v9, v22
v_add_f32 v23, v9, v23
EX 16
EX 17
EX 18
EX 19
EX 20
EX 21
EX 22
EX 23
CV 32,16,17
CV 33,18,19
CV 34,20,21
CV 35,22,23
v_bfi_b32 v48, v49, s70, v48
s_nop 0
v_smfmac_f32_16x16x64_bf16 a[244:247], v[56:59], v[32:39], v71
s_mov_b32 s40, 0xa95000
v_mov_b32 v49, v48
QK 16,32,144,44
s_add_u32 m0, s47, 0xe000
v_mov_b32 v50, v48
v_mov_b32 v51, v48
QK 16,36,148,16
CV 36,24,25
CV 37,26,27
QK 16,40,152,16
buffer_load_dwordx4 v66, s[16:19], s40 offen lds
QK 16,44,156,16
RV 106,64,4352
RV 108,65,256
QK 20,48,144,44
RV 110,65,4352
v_subrev_u32 v12, 0x30000, v71
QK 20,52,148,20
RV 112,64,512
RV 114,64,4608
QK 20,56,152,20
RV 116,65,512
v_ashrrev_i32 v12, 31, v12
QK 20,60,156,20
RV 118,65,4608
RV 120,64,768
PZ 192,64,32
RV 122,64,4864
v_subrev_u32 v13, 0x20000, v71
PZ 196,68,32
RV 124,65,768
RV 126,65,4864
PZ 200,72,32
EX 28
PZ 204,76,32
buffer_load_dwordx4 v67, s[16:19], s40 offen offset:1024 lds
PZ 208,80,32
EX 29
PZ 212,84,32
EX 30
PZ 216,88,32
EX 31
PZ 220,92,32
CV 38,28,29
CV 39,30,31
QK 24,32,160,48
EX 16
QK 24,36,164,24
EX 17
QK 24,40,168,24
s_add_u32 m0, s47, 0x1e000
EX 18
QK 24,44,172,24
EX 19
QK 28,48,160,48
s_waitcnt vmcnt(8)
s_barrier
QK 28,52,164,28
buffer_load_dwordx4 v68, s[20:23], s40 offen lds
QK 28,56,168,28
s_waitcnt lgkmcnt(0)
RK 0,60,8192
RK 4,61,8192
QK 28,60,172,28
RK 8,62,8192
CV 32,16,17
PV 128,96,36
RK 12,63,8192
CV 33,18,19
PV 132,100,36
RK 16,60,12288
v_not_b32 v12, v12
PV 136,104,36
RK 20,61,12288
v_xor_b32 v60, s43, v60
PV 140,108,36
RK 24,62,12288
v_xor_b32 v61, s43, v61
PV 144,112,36
RK 28,63,12288
v_xor_b32 v62, s43, v62
PV 148,116,36
buffer_load_dwordx4 v69, s[20:23], s40 offen offset:1024 lds
PV 152,120,36
EX 20
PV 156,124,36
EX 21
EX 22
EX 23
CV 34,20,21
CV 35,22,23
v_xor_b32 v63, s43, v63
v_ashrrev_i32 v13, 31, v13
v_smfmac_f32_16x16x64_bf16 a[248:251], v[56:59], v[32:39], v71
s_waitcnt lgkmcnt(0)
v_and_b32 v12, 0xff800000, v12
QK 16,0,128,40
L_t5_pad1:
s_cbranch_execz L_t5_pad5
EX 24
QK 16,4,132,16
EX 25
QK 16,8,136,16
EX 26
QK 16,12,140,16
EX 27
QK 20,16,128,40
CV 36,24,25
CV 37,26,27
QK 20,20,132,20
EX 28
QK 20,24,136,20
EX 29
QK 20,28,140,20
EX 30
PV 160,96,32
EX 31
PV 164,100,32
CV 38,28,29
CV 39,30,31
PV 168,104,32
s_waitcnt vmcnt(8)
s_barrier
PV 172,108,32
EX 16
PV 176,112,32
EX 17
PV 180,116,32
EX 18
PV 184,120,32
s_xor_b32 s41, s41, s43
EX 19
PV 188,124,32
s_mov_b32 s40, 0xab5000
CV 32,16,17
CV 33,18,19
QK 24,0,144,44
s_add_u32 m0, s47, 0x8000
EX 20
QK 24,4,148,24
s_xor_b32 s42, s41, 0xc000
RV 64,64,8192
RV 66,64,12288
QK 24,8,152,24
buffer_load_dwordx4 v66, s[16:19], s40 offen lds
QK 24,12,156,24
EX 21
QK 28,16,144,44
EX 22
QK 28,20,148,28
RV 68,65,8192
CV 34,20,21
QK 28,24,152,28
EX 23
QK 28,28,156,28
RV 70,65,12288
CV 35,22,23
PV 192,96,36
RV 72,64,8448
RV 74,64,12544
PV 196,100,36
RV 76,65,8448
v_not_b32 v13, v13
PV 200,104,36
RV 78,65,12544
RV 80,64,8704
PV 204,108,36
buffer_load_dwordx4 v67, s[16:19], s40 offen offset:1024 lds
PV 208,112,36
RV 82,64,12800
RV 84,65,8704
PV 212,116,36
RV 86,65,12800
v_and_b32 v13, 0xff800000, v13
PV 216,120,36
RV 88,64,8960
RV 90,64,13056
PV 220,124,36
RV 92,65,8960
v_xor_b32 v64, s43, v64
v_smfmac_f32_16x16x64_bf16 a[240:243], v[56:59], v[32:39], v71
RV 94,65,13056
QK 16,0,160,48
EX 24
QK 16,4,164,16
s_add_u32 m0, s47, 0x18000
EX 25
QK 16,8,168,16
EX 26
QK 16,12,172,16
s_waitcnt vmcnt(8)
s_barrier
QK 20,16,160,48
buffer_load_dwordx4 v68, s[20:23], s40 offen lds
QK 20,20,164,20
RK 32,60,0
RK 36,61,0
QK 20,24,168,20
s_waitcnt lgkmcnt(2)
RK 40,62,0
CV 36,24,25
QK 20,28,172,20
RK 44,63,0
v_xor_b32 v65, s43, v65
PV 128,64,32
s_xor_b32 s43, s43, 0xc000
RK 48,60,4096
PV 132,68,32
RK 52,61,4096
PV 136,72,32
RK 56,62,4096
PV 140,76,32
RK 60,63,4096
PV 144,80,32
buffer_load_dwordx4 v69, s[20:23], s40 offen offset:1024 lds
PV 148,84,32
EX 27
PV 152,88,32
CV 37,26,27
PV 156,92,32
s_waitcnt lgkmcnt(7)
EX 28
QK 24,32,128,40
s_waitcnt lgkmcnt(6)
EX 29
QK 24,36,132,24
s_waitcnt lgkmcnt(0)
EX 30
QK 24,40,136,24
EX 31
QK 24,44,140,24
CV 38,28,29
CV 39,30,31
QK 28,48,128,40
EX 16
QK 28,52,132,28
EX 17
QK 28,56,136,28
EX 18
QK 28,60,140,28
EX 19
PV 160,64,36
EX 20
PV 164,68,36
EX 21
PV 168,72,36
EX 22
PV 172,76,36
s_waitcnt vmcnt(8)
s_barrier
PV 176,80,36
EX 23
PV 180,84,36
CV 32,16,17
CV 33,18,19
PV 184,88,36
CV 34,20,21
CV 35,22,23
PV 188,92,36
EX 24
v_smfmac_f32_16x16x64_bf16 a[244:247], v[56:59], v[32:39], v71
RV 96,64,0
QK 16,32,144,44
s_mov_b32 s40, 0xad5000
EX 25
QK 16,36,148,16
s_add_u32 m0, s47, 0xa000
EX 26
QK 16,40,152,16
EX 27
QK 16,44,156,16
buffer_load_dwordx4 v66, s[16:19], s40 offen lds
QK 20,48,144,44
CV 36,24,25
CV 37,26,27
QK 20,52,148,20
RV 98,64,4096
RV 100,65,0
QK 20,56,152,20
EX 28
QK 20,60,156,20
RV 102,65,4096
RV 104,64,256
PV 192,64,32
buffer_load_dwordx4 v67, s[16:19], s40 offen offset:1024 lds
PV 196,68,32
RV 106,64,4352
RV 108,65,256
PV 200,72,32
EX 29
PV 204,76,32
s_add_u32 m0, s47, 0x1a000
RV 110,65,4352
RV 112,64,512
PV 208,80,32
RV 114,64,4608
CV 38,28,29
PV 212,84,32
buffer_load_dwordx4 v68, s[20:23], s40 offen lds
PV 216,88,32
RV 116,65,512
RV 118,65,4608
PV 220,92,32
RV 120,64,768
QK 24,32,160,48
RV 122,64,4864
RV 124,65,768
QK 24,36,164,24
RV 126,65,4864
QK 24,40,168,24
buffer_load_dwordx4 v69, s[20:23], s40 offen offset:1024 lds
QK 24,44,172,24
EX 30
EX 31
EX 16
CV 39,30,31
QK 28,48,160,48
s_waitcnt vmcnt(10)
s_barrier
QK 28,52,164,28
s_mov_b32 s40, 0xaf5000
RK 0,60,8192
RK 4,61,8192
QK 28,56,168,28
s_waitcnt lgkmcnt(2)
RK 8,62,8192
s_add_u32 m0, s47, 0x0
QK 28,60,172,28
EX 17
PV 128,96,36
buffer_load_dwordx4 v66, s[16:19], s40 offen lds
PV 132,100,36
RK 12,63,8192
RK 16,60,12288
PV 136,104,36
RK 20,61,12288
CV 32,16,17
PV 140,108,36
RK 24,62,12288
v_xor_b32 v60, s43, v60
PV 144,112,36
RK 28,63,12288
v_xor_b32 v61, s43, v61
PV 148,116,36
buffer_load_dwordx4 v67, s[16:19], s40 offen offset:1024 lds
PV 152,120,36
EX 18
PV 156,124,36
EX 19
EX 20
EX 21
EX 22
EX 23
CV 33,18,19
CV 34,20,21
CV 35,22,23
v_xor_b32 v62, s43, v62
v_xor_b32 v63, s43, v63
v_smfmac_f32_16x16x64_bf16 a[248:251], v[56:59], v[32:39], v71
s_waitcnt lgkmcnt(0)
s_add_u32 m0, s47, 0x10000
QK 16,0,128,40
EX 24
QK 16,4,132,16
buffer_load_dwordx4 v68, s[20:23], s40 offen lds
QK 16,8,136,16
EX 25
QK 16,12,140,16
EX 26
QK 20,16,128,40
EX 27
QK 20,20,132,20
CV 36,24,25
CV 37,26,27
QK 20,24,136,20
buffer_load_dwordx4 v69, s[20:23], s40 offen offset:1024 lds
QK 20,28,140,20
EX 28
PV 160,96,32
EX 29
PV 164,100,32
EX 30
PV 168,104,32
s_waitcnt vmcnt(12)
s_barrier
PV 172,108,32
RV 64,64,8192
RV 66,64,12288
PV 176,112,32
RV 68,65,8192
CV 38,28,29
PV 180,116,32
RV 70,65,12288
RV 72,64,8448
PV 184,120,32
s_xor_b32 s41, s41, s43
EX 31
PV 188,124,32
s_mov_b32 s40, 0xb15000
RV 74,64,12544
RV 76,65,8448
QK 24,0,144,44
s_add_u32 m0, s47, 0x2000
RV 78,65,12544
CV 39,30,31
QK 24,4,148,24
s_xor_b32 s42, s41, 0xc000
RV 80,64,8704
RV 82,64,12800
QK 24,8,152,24
EX 16
QK 24,12,156,24
RV 84,65,8704
RV 86,65,12800
QK 28,16,144,44
EX 17
QK 28,20,148,28
RV 88,64,8960
RV 90,64,13056
QK 28,24,152,28
RV 92,65,8960
v_xor_b32 v64, s43, v64
QK 28,28,156,28
RV 94,65,13056
CV 32,16,17
PV 192,96,36
buffer_load_dwordx4 v66, s[16:19], s40 offen lds
PV 196,100,36
EX 18
PV 200,104,36
EX 19
PV 204,108,36
buffer_load_dwordx4 v67, s[16:19], s40 offen offset:1024 lds
PV 208,112,36
EX 20
PV 212,116,36
s_waitcnt vmcnt(10) lgkmcnt(0)
s_barrier
PV 216,120,36
RK 32,60,0
RK 36,61,0
PV 220,124,36
RK 40,62,0
EX 21
EX 22
EX 23
CV 33,18,19
CV 34,20,21
CV 35,22,23
v_xor_b32 v65, s43, v65
s_xor_b32 s43, s43, 0xc000
v_smfmac_f32_16x16x64_bf16 a[240:243], v[56:59], v[32:39], v71
RK 44,63,0
QK 16,0,160,48
RK 48,60,4096
RK 52,61,4096
QK 16,4,164,16
s_add_u32 m0, s47, 0x12000
EX 24
QK 16,8,168,16
RK 56,62,4096
RK 60,63,4096
QK 16,12,172,16
buffer_load_dwordx4 v68, s[20:23], s40 offen lds
QK 20,16,160,48
RV 96,64,0
RV 98,64,4096
QK 20,20,164,20
EX 25
QK 20,24,168,20
RV 100,65,0
RV 102,65,4096
QK 20,28,172,20
RV 104,64,256
CV 36,24,25
PV 128,64,32
RV 106,64,4352
RV 108,65,256
PV 132,68,32
EX 26
PV 136,72,32
RV 110,65,4352
RV 112,64,512
PV 140,76,32
EX 27
PV 144,80,32
RV 114,64,4608
RV 116,65,512
PV 148,84,32
buffer_load_dwordx4 v69, s[20:23], s40 offen offset:1024 lds
PV 152,88,32
RV 118,65,4608
CV 37,26,27
PV 156,92,32
s_waitcnt lgkmcnt(12)
EX 28
QK 24,32,128,40
RV 120,64,768
RV 122,64,4864
QK 24,36,132,24
EX 29
QK 24,40,136,24
EX 30
QK 24,44,140,24
RV 124,65,768
RV 126,65,4864
EX 31
CV 38,28,29
CV 39,30,31
QK 28,48,128,40
EX 16
QK 28,52,132,28
EX 17
QK 28,56,136,28
EX 18
QK 28,60,140,28
EX 19
PV 160,64,36
EX 20
PV 164,68,36
EX 21
PV 168,72,36
EX 22
PV 172,76,36
EX 23
PV 176,80,36
CV 32,16,17
CV 33,18,19
PV 180,84,36
s_waitcnt vmcnt(8) lgkmcnt(0)
s_barrier
PV 184,88,36
CV 34,20,21
CV 35,22,23
PV 188,92,36
EX 24
v_smfmac_f32_16x16x64_bf16 a[244:247], v[56:59], v[32:39], v71
s_mov_b32 s40, 0xb35000
RK 0,60,8192
QK 16,32,144,44
s_add_u32 m0, s47, 0x4000
EX 25
QK 16,36,148,16
RK 4,61,8192
RK 8,62,8192
QK 16,40,152,16
buffer_load_dwordx4 v66, s[16:19], s40 offen lds
QK 16,44,156,16
RK 12,63,8192
CV 36,24,25
QK 20,48,144,44
EX 26
QK 20,52,148,20
EX 27
QK 20,56,152,20
RK 16,60,12288
RK 20,61,12288
QK 20,60,156,20
RK 24,62,12288
CV 37,26,27
PV 192,64,32
EX 28
PV 196,68,32
RK 28,63,12288
v_xor_b32 v60, s43, v60
PV 200,72,32
EX 29
PV 204,76,32
buffer_load_dwordx4 v67, s[16:19], s40 offen offset:1024 lds
PV 208,80,32
RV 64,64,8192
RV 66,64,12288
PV 212,84,32
EX 30
PV 216,88,32
RV 68,65,8192
CV 38,28,29
PV 220,92,32
RV 70,65,12288
v_xor_b32 v61, s43, v61
QK 24,32,160,48
EX 31
QK 24,36,164,24
RV 72,64,8448
CV 39,30,31
QK 24,40,168,24
s_add_u32 m0, s47, 0x14000
EX 16
QK 24,44,172,24
RV 74,64,12544
v_xor_b32 v62, s43, v62
QK 28,48,160,48
buffer_load_dwordx4 v68, s[20:23], s40 offen lds
QK 28,52,164,28
RV 76,65,8448
v_xor_b32 v63, s43, v63
QK 28,56,168,28
EX 17
QK 28,60,172,28
RV 78,65,12544
CV 32,16,17
PV 128,96,36
EX 18
PV 132,100,36
RV 80,64,8704
RV 82,64,12800
PV 136,104,36
EX 19
PV 140,108,36
RV 84,65,8704
CV 33,18,19
PV 144,112,36
EX 20
PV 148,116,36
buffer_load_dwordx4 v69, s[20:23], s40 offen offset:1024 lds
PV 152,120,36
EX 21
PV 156,124,36
RV 86,65,12800
RV 88,64,8960
EX 22
EX 23
CV 34,20,21
CV 35,22,23
EX 24
s_nop 0
v_smfmac_f32_16x16x64_bf16 a[248:251], v[56:59], v[32:39], v71
s_waitcnt lgkmcnt(13)
RV 90,64,13056
QK 16,0,128,40
RV 92,65,8960
v_xor_b32 v64, s43, v64
QK 16,4,132,16
EX 25
QK 16,8,136,16
RV 94,65,13056
CV 36,24,25
QK 16,12,140,16
EX 26
QK 20,16,128,40
EX 27
QK 20,20,132,20
CV 37,26,27
v_xor_b32 v65, s43, v65
QK 20,24,136,20
EX 28
QK 20,28,140,20
EX 29
PV 160,96,32
EX 30
PV 164,100,32
EX 31
PV 168,104,32
CV 38,28,29
CV 39,30,31
PV 172,108,32
EX 16
PV 176,112,32
s_waitcnt vmcnt(8) lgkmcnt(0)
s_barrier
PV 180,116,32
EX 17
PV 184,120,32
s_xor_b32 s41, s41, s43
EX 18
PV 188,124,32
s_mov_b32 s40, 0xb55000
RK 32,60,0
RK 36,61,0
QK 24,0,144,44
s_add_u32 m0, s47, 0x6000
EX 19
QK 24,4,148,24
s_xor_b32 s43, s43, 0xc000
RK 40,62,0
CV 32,16,17
QK 24,8,152,24
buffer_load_dwordx4 v66, s[16:19], s40 offen lds
QK 24,12,156,24
s_xor_b32 s42, s41, 0xc000
RK 44,63,0
CV 33,18,19
QK 28,16,144,44
L_t5_pad2:
s_cbranch_execz L_t5_pad6
EX 20
QK 28,20,148,28
EX 21
QK 28,24,152,28
RK 48,60,4096
RK 52,61,4096
QK 28,28,156,28
EX 22
PV 192,96,36
RK 56,62,4096
CV 34,20,21
PV 196,100,36
EX 23
PV 200,104,36
RK 60,63,4096
CV 35,22,23
PV 204,108,36
buffer_load_dwordx4 v67, s[16:19], s40 offen offset:1024 lds
PV 208,112,36
EX 24
PV 212,116,36
RV 96,64,0
RV 98,64,4096
PV 216,120,36
EX 25
PV 220,124,36
EX 26
v_smfmac_f32_16x16x64_bf16 a[240:243], v[56:59], v[32:39], v71
RV 100,65,0
QK 16,0,160,48
RV 102,65,4096
CV 36,24,25
QK 16,4,164,16
s_add_u32 m0, s47, 0x16000
EX 27
QK 16,8,168,16
RV 104,64,256
RV 106,64,4352
QK 16,12,172,16
buffer_load_dwordx4 v68, s[20:23], s40 offen lds
QK 20,16,160,48
RV 108,65,256
CV 37,26,27
QK 20,20,164,20
EX 28
QK 20,24,168,20
EX 29
QK 20,28,172,20
RV 110,65,4352
RV 112,64,512
PV 128,64,32
EX 30
PV 132,68,32
RV 114,64,4608
CV 38,28,29
PV 136,72,32
EX 31
PV 140,76,32
RV 116,65,512
CV 39,30,31
PV 144,80,32
buffer_load_dwordx4 v69, s[20:23], s40 offen offset:1024 lds
PV 148,84,32
EX 16
PV 152,88,32
RV 118,65,4608
RV 120,64,768
PV 156,92,32
s_waitcnt lgkmcnt(13)
EX 17
QK 24,32,128,40
RV 122,64,4864
CV 32,16,17
QK 24,36,132,24
EX 18
QK 24,40,136,24
EX 19
QK 24,44,140,24
RV 124,65,768
RV 126,65,4864
QK 28,48,128,40
EX 20
QK 28,52,132,28
EX 21
QK 28,56,136,28
EX 22
QK 28,60,140,28
EX 23
PV 160,64,36
CV 33,18,19
CV 34,20,21
PV 164,68,36
EX 24
PV 168,72,36
CV 35,22,23
PV 172,76,36
EX 25
PV 176,80,36
PV 180,84,36
s_waitcnt vmcnt(8) lgkmcnt(0)
s_barrier
PV 184,88,36
EX 26
PV 188,92,36
EX 27
v_smfmac_f32_16x16x64_bf16 a[244:247], v[56:59], v[32:39], v71
RK 0,60,8192
QK 16,32,144,44
s_mov_b32 s40, 0xb75000
RK 4,61,8192
CV 36,24,25
QK 16,36,148,16
s_add_u32 m0, s47, 0xc000
RK 8,62,8192
CV 37,26,27
QK 16,40,152,16
EX 28
QK 16,44,156,16
buffer_load_dwordx4 v66, s[16:19], s40 offen lds
QK 20,48,144,44
RK 12,63,8192
RK 16,60,12288
QK 20,52,148,20
EX 29
QK 20,56,152,20
RK 20,61,12288
CV 38,28,29
QK 20,60,156,20
RK 24,62,12288
v_xor_b32 v60, s43, v60
PV 192,64,32
buffer_load_dwordx4 v67, s[16:19], s40 offen offset:1024 lds
PV 196,68,32
RK 28,63,12288
v_xor_b32 v61, s43, v61
PV 200,72,32
EX 30
PV 204,76,32
s_add_u32 m0, s47, 0x1c000
RV 64,64,8192
v_xor_b32 v62, s43, v62
PV 208,80,32
RV 66,64,12288
v_xor_b32 v63, s43, v63
PV 212,84,32
buffer_load_dwordx4 v68, s[20:23], s40 offen lds
PV 216,88,32
EX 31
PV 220,92,32
RV 68,65,8192
RV 70,65,12288
QK 24,32,160,48
EX 16
QK 24,36,164,24
RV 72,64,8448
CV 39,30,31
QK 24,40,168,24
buffer_load_dwordx4 v69, s[20:23], s40 offen offset:1024 lds
QK 24,44,172,24
EX 17
QK 28,48,160,48
RV 74,64,12544
RV 76,65,8448
QK 28,52,164,28
s_mov_b32 s40, 0xb95000
EX 18
QK 28,56,168,28
s_add_u32 m0, s47, 0xe000
RV 78,65,12544
CV 32,16,17
QK 28,60,172,28
EX 19
PV 128,96,36
buffer_load_dwordx4 v66, s[16:19], s40 offen lds
PV 132,100,36
RV 80,64,8704
RV 82,64,12800
PV 136,104,36
EX 20
PV 140,108,36
RV 84,65,8704
CV 33,18,19
PV 144,112,36
EX 21
PV 148,116,36
buffer_load_dwordx4 v67, s[16:19], s40 offen offset:1024 lds
PV 152,120,36
EX 22
PV 156,124,36
RV 86,65,12800
RV 88,64,8960
EX 23
CV 34,20,21
CV 35,22,23
EX 24
s_nop 0
v_smfmac_f32_16x16x64_bf16 a[248:251], v[56:59], v[32:39], v71
s_waitcnt lgkmcnt(13)
s_add_u32 m0, s47, 0x1e000
QK 16,0,128,40
RV 90,64,13056
RV 92,65,8960
QK 16,4,132,16
buffer_load_dwordx4 v68, s[20:23], s40 offen lds
QK 16,8,136,16
RV 94,65,13056
v_xor_b32 v64, s43, v64
QK 16,12,140,16
EX 25
QK 20,16,128,40
EX 26
QK 20,20,132,20
EX 27
QK 20,24,136,20
buffer_load_dwordx4 v69, s[20:23], s40 offen offset:1024 lds
QK 20,28,140,20
CV 36,24,25
CV 37,26,27
PV 160,96,32
EX 28
PV 164,100,32
EX 29
PV 168,104,32
EX 30
PV 172,108,32
EX 31
PV 176,112,32
s_waitcnt vmcnt(8) lgkmcnt(0)
s_barrier
PV 180,116,32
s_add_u32 s40, s40, s58
CV 38,28,29
CV 39,30,31
PV 184,120,32
s_xor_b32 s41, s41, s43
RK 32,60,0
v_xor_b32 v65, s43, v65
PV 188,124,32
s_xor_b32 s42, s41, 0xc000
EX 16
QK 24,0,144,44
s_add_u32 m0, s42, 0x0
EX 17
QK 24,4,148,24
s_mov_b32 s58, s59
RK 36,61,0
RK 40,62,0
QK 24,8,152,24
buffer_load_dwordx4 v66, s[16:19], s40 offen lds
QK 24,12,156,24
s_mov_b32 s59, 0x20000
RK 44,63,0
CV 32,16,17
QK 28,16,144,44
s_xor_b32 s43, s43, 0xc000
EX 18
QK 28,20,148,28
EX 19
QK 28,24,152,28
RK 48,60,4096
RK 52,61,4096
QK 28,28,156,28
EX 20
PV 192,96,36
RK 56,62,4096
CV 33,18,19
PV 196,100,36
EX 21
PV 200,104,36
RK 60,63,4096
CV 34,20,21
PV 204,108,36
buffer_load_dwordx4 v67, s[16:19], s40 offen offset:1024 lds
PV 208,112,36
EX 22
PV 212,116,36
RV 96,64,0
RV 98,64,4096
PV 216,120,36
EX 23
PV 220,124,36
RV 100,65,0
CV 35,22,23
EX 24
s_nop 0
v_smfmac_f32_16x16x64_bf16 a[240:243], v[56:59], v[32:39], v71
s_sub_u32 s57, s57, 1
s_cselect_b64 s[58:59], s[60:61], s[58:59]
RV 102,65,4096
QK 16,0,160,48
s_add_u32 m0, s42, 0x10000
EX 25
QK 16,4,164,16
RV 104,64,256
CV 36,24,25
QK 16,8,168,16
EX 26
QK 16,12,172,16
buffer_load_dwordx4 v68, s[20:23], s40 offen lds
QK 20,16,160,48
RV 106,64,4352
RV 108,65,256
QK 20,20,164,20
EX 27
QK 20,24,168,20
RV 110,65,4352
CV 37,26,27
QK 20,28,172,20
EX 28
PV 128,64,32
EX 29
PV 132,68,32
RV 112,64,512
RV 114,64,4608
PV 136,72,32
EX 30
PV 140,76,32
RV 116,65,512
CV 38,28,29
PV 144,80,32
buffer_load_dwordx4 v69, s[20:23], s40 offen offset:1024 lds
PV 148,84,32
EX 31
PV 152,88,32
RV 118,65,4608
RV 120,64,768
PV 156,92,32
s_waitcnt lgkmcnt(13)
EX 16
QK 24,32,128,40
RV 122,64,4864
CV 39,30,31
QK 24,36,132,24
EX 17
QK 24,40,136,24
RV 124,65,768
CV 32,16,17
QK 24,44,140,24
EX 18
QK 28,48,128,40
EX 19
QK 28,52,132,28
RV 126,65,4864
CV 33,18,19
QK 28,56,136,28
EX 20
QK 28,60,140,28
EX 21
PV 160,64,36
EX 22
PV 164,68,36
EX 23
PV 168,72,36
CV 34,20,21
CV 35,22,23
PV 172,76,36
EX 24
PV 176,80,36
EX 25
PV 180,84,36
s_waitcnt lgkmcnt(0)
EX 26
PV 184,88,36
s_add_u32 s40, s40, s58
PV 188,92,36
s_add_u32 m0, s42, 0x2000
EX 27
v_smfmac_f32_16x16x64_bf16 a[244:247], v[56:59], v[32:39], v71
s_mov_b32 s58, s59
s_mov_b32 s59, 0x20000
RK 0,60,8192
QK 16,32,144,44
RK 4,61,8192
CV 36,24,25
QK 16,36,148,16
RK 8,62,8192
CV 37,26,27
QK 16,40,152,16
buffer_load_dwordx4 v66, s[16:19], s40 offen lds
QK 16,44,156,16
EX 28
QK 20,48,144,44
RK 12,63,8192
RK 16,60,12288
QK 20,52,148,20
EX 29
QK 20,56,152,20
RK 20,61,12288
CV 38,28,29
QK 20,60,156,20
RK 24,62,12288
v_xor_b32 v60, s43, v60
PV 192,64,32
EX 30
PV 196,68,32
RK 28,63,12288
v_xor_b32 v61, s43, v61
PV 200,72,32
EX 31
PV 204,76,32
buffer_load_dwordx4 v67, s[16:19], s40 offen offset:1024 lds
PV 208,80,32
RV 64,64,8192
RV 66,64,12288
PV 212,84,32
CV 39,30,31
v_xor_b32 v62, s43, v62
PV 216,88,32
RV 68,65,8192
v_xor_b32 v63, s43, v63
PV 220,92,32
EX 16
QK 24,32,160,48
s_add_u32 m0, s42, 0x12000
EX 17
QK 24,36,164,24
RV 70,65,12288
RV 72,64,8448
QK 24,40,168,24
EX 18
QK 24,44,172,24
RV 74,64,12544
CV 32,16,17
QK 28,48,160,48
buffer_load_dwordx4 v68, s[20:23], s40 offen lds
QK 28,52,164,28
EX 19
QK 28,56,168,28
RV 76,65,8448
RV 78,65,12544
QK 28,60,172,28
EX 20
PV 128,96,36
RV 80,64,8704
CV 33,18,19
PV 132,100,36
EX 21
PV 136,104,36
RV 82,64,12800
CV 34,20,21
PV 140,108,36
EX 22
PV 144,112,36
RV 84,65,8704
RV 86,65,12800
PV 148,116,36
buffer_load_dwordx4 v69, s[20:23], s40 offen offset:1024 lds
PV 152,120,36
EX 23
PV 156,124,36
RV 88,64,8960
CV 35,22,23
EX 24
s_nop 0
v_smfmac_f32_16x16x64_bf16 a[248:251], v[56:59], v[32:39], v71
s_waitcnt lgkmcnt(13)
RV 90,64,13056
QK 16,0,128,40
RV 92,65,8960
v_xor_b32 v64, s43, v64
QK 16,4,132,16
EX 25
QK 16,8,136,16
RV 94,65,13056
CV 36,24,25
QK 16,12,140,16
EX 26
QK 20,16,128,40
EX 27
QK 20,20,132,20
CV 37,26,27
v_xor_b32 v65, s43, v65
QK 20,24,136,20
EX 28
QK 20,28,140,20
EX 29
PV 160,96,32
EX 30
PV 164,100,32
EX 31
PV 168,104,32
CV 38,28,29
CV 39,30,31
PV 172,108,32
EX 16
PV 176,112,32
s_waitcnt vmcnt(8) lgkmcnt(0)
s_barrier
PV 180,116,32
EX 17
PV 184,120,32
s_xor_b32 s41, s41, s43
EX 18
PV 188,124,32
s_xor_b32 s42, s41, 0xc000
RK 32,60,0
RK 36,61,0
QK 24,0,144,44
s_sub_u32 s57, s57, 1
s_cselect_b64 s[58:59], s[60:61], s[58:59]
CV 32,16,17
QK 24,4,148,24
s_add_u32 s40, s40, s58
RK 40,62,0
s_add_u32 m0, s42, 0x0
QK 24,8,152,24
buffer_load_dwordx4 v66, s[16:19], s40 offen lds
QK 24,12,156,24
s_add_u32 s48, s45, 0x0
EX 19
QK 28,16,144,44
s_mov_b32 s58, s59
RK 44,63,0
RK 48,60,4096
QK 28,20,148,28
s_mov_b32 s59, 0x20000
EX 20
QK 28,24,152,28
buffer_load_dwordx4 v[80:83], v72, s[32:35], s48 offen nt
QK 28,28,156,28
s_xor_b32 s43, s43, 0xc000
RK 52,61,4096
CV 33,18,19
PV 192,96,36
EX 21
PV 196,100,36
RK 56,62,4096
RK 60,63,4096
PV 200,104,36
EX 22
PV 204,108,36
buffer_load_dwordx4 v67, s[16:19], s40 offen offset:1024 lds
PV 208,112,36
RV 96,64,0
CV 34,20,21
PV 212,116,36
EX 23
PV 216,120,36
RV 98,64,4096
CV 35,22,23
PV 220,124,36
EX 24
v_smfmac_f32_16x16x64_bf16 a[240:243], v[56:59], v[32:39], v71
s_sub_u32 s57, s57, 1
s_cselect_b64 s[58:59], s[60:61], s[58:59]
RV 100,65,0
QK 16,0,160,48
s_add_u32 m0, s42, 0x10000
EX 25
QK 16,4,164,16
RV 102,65,4096
RV 104,64,256
QK 16,8,168,16
RV 106,64,4352
CV 36,24,25
QK 16,12,172,16
buffer_load_dwordx4 v68, s[20:23], s40 offen lds
QK 20,16,160,48
EX 26
QK 20,20,164,20
EX 27
QK 20,24,168,20
RV 108,65,256
RV 110,65,4352
QK 20,28,172,20
RV 112,64,512
CV 37,26,27
PV 128,64,32
EX 28
PV 132,68,32
EX 29
PV 136,72,32
RV 114,64,4608
CV 38,28,29
PV 140,76,32
EX 30
PV 144,80,32
buffer_load_dwordx4 v69, s[20:23], s40 offen offset:1024 lds
PV 148,84,32
RV 116,65,512
RV 118,65,4608
PV 152,88,32
EX 31
PV 156,92,32
s_waitcnt lgkmcnt(12)
RV 120,64,768
CV 39,30,31
QK 24,32,128,40
L_t5_pad3:
s_cbranch_execz L_t5_pad7
EX 16
QK 24,36,132,24
buffer_load_dwordx4 v[84:87], v73, s[32:35], s48 offen nt
QK 24,40,136,24
RV 122,64,4864
RV 124,65,768
QK 24,44,140,24
EX 17
QK 28,48,128,40
RV 126,65,4864
CV 32,16,17
QK 28,52,132,28
EX 18
QK 28,56,136,28
EX 19
QK 28,60,140,28
EX 20
PV 160,64,36
EX 21
PV 164,68,36
EX 22
PV 168,72,36
EX 23
PV 172,76,36
CV 33,18,19
CV 34,20,21
PV 176,80,36
EX 24
PV 180,84,36
s_waitcnt lgkmcnt(0)
EX 25
PV 184,88,36
s_add_u32 s40, s40, s58
CV 35,22,23
PV 188,92,36
s_add_u32 m0, s42, 0x2000
EX 26
v_smfmac_f32_16x16x64_bf16 a[244:247], v[56:59], v[32:39], v71
s_mov_b32 s58, s59
s_mov_b32 s59, 0x20000
RK 0,60,8192
QK 16,32,144,44
RK 4,61,8192
CV 36,24,25
QK 16,36,148,16
EX 27
QK 16,40,152,16
buffer_load_dwordx4 v66, s[16:19], s40 offen lds
QK 16,44,156,16
RK 8,62,8192
RK 12,63,8192
QK 20,48,144,44
RK 16,60,12288
CV 37,26,27
QK 20,52,148,20
EX 28
QK 20,56,152,20
RK 20,61,12288
v_xor_b32 v60, s43, v60
QK 20,60,156,20
RK 24,62,12288
v_xor_b32 v61, s43, v61
PV 192,64,32
EX 29
PV 196,68,32
RK 28,63,12288
CV 38,28,29
PV 200,72,32
EX 30
PV 204,76,32
buffer_load_dwordx4 v67, s[16:19], s40 offen offset:1024 lds
PV 208,80,32
RV 64,64,8192
RV 66,64,12288
PV 212,84,32
EX 31
PV 216,88,32
RV 68,65,8192
CV 39,30,31
PV 220,92,32
buffer_load_dwordx4 v[88:91], v74, s[32:35], s48 offen nt
QK 24,32,160,48
s_add_u32 m0, s42, 0x12000
RV 70,65,12288
v_xor_b32 v62, s43, v62
QK 24,36,164,24
RV 72,64,8448
v_xor_b32 v63, s43, v63
QK 24,40,168,24
EX 16
QK 24,44,172,24
EX 17
QK 28,48,160,48
buffer_load_dwordx4 v68, s[20:23], s40 offen lds
QK 28,52,164,28
RV 74,64,12544
RV 76,65,8448
QK 28,56,168,28
RV 78,65,12544
CV 32,16,17
QK 28,60,172,28
EX 18
PV 128,96,36
EX 19
PV 132,100,36
RV 80,64,8704
RV 82,64,12800
PV 136,104,36
EX 20
PV 140,108,36
RV 84,65,8704
CV 33,18,19
PV 144,112,36
EX 21
PV 148,116,36
buffer_load_dwordx4 v69, s[20:23], s40 offen offset:1024 lds
PV 152,120,36
EX 22
PV 156,124,36
RV 86,65,12800
RV 88,64,8960
EX 23
CV 34,20,21
CV 35,22,23
EX 24
s_nop 0
v_smfmac_f32_16x16x64_bf16 a[248:251], v[56:59], v[32:39], v71
s_waitcnt lgkmcnt(13)
RV 90,64,13056
QK 16,0,128,40
RV 92,65,8960
v_xor_b32 v64, s43, v64
QK 16,4,132,16
EX 25
QK 16,8,136,16
RV 94,65,13056
CV 36,24,25
QK 16,12,140,16
EX 26
QK 20,16,128,40
EX 27
QK 20,20,132,20
CV 37,26,27
v_xor_b32 v65, s43, v65
QK 20,24,136,20
EX 28
QK 20,28,140,20
EX 29
PV 160,96,32
EX 30
PV 164,100,32
EX 31
PV 168,104,32
CV 38,28,29
CV 39,30,31
PV 172,108,32
EX 16
PV 176,112,32
s_waitcnt vmcnt(11) lgkmcnt(0)
s_barrier
PV 180,116,32
buffer_load_dwordx4 v[92:95], v75, s[32:35], s48 offen nt
PV 184,120,32
s_xor_b32 s41, s41, s43
EX 17
PV 188,124,32
s_xor_b32 s42, s41, 0xc000
RK 32,60,0
RK 36,61,0
QK 24,0,144,44
s_sub_u32 s57, s57, 1
s_cselect_b64 s[58:59], s[60:61], s[58:59]
CV 32,16,17
QK 24,4,148,24
s_add_u32 s40, s40, s58
RK 40,62,0
s_add_u32 m0, s42, 0x0
QK 24,8,152,24
buffer_load_dwordx4 v66, s[16:19], s40 offen lds
QK 24,12,156,24
s_mov_b32 s58, s59
EX 18
QK 28,16,144,44
s_mov_b32 s59, 0x20000
RK 44,63,0
RK 48,60,4096
QK 28,20,148,28
s_xor_b32 s43, s43, 0xc000
EX 19
QK 28,24,152,28
RK 52,61,4096
CV 33,18,19
QK 28,28,156,28
EX 20
PV 192,96,36
EX 21
PV 196,100,36
RK 56,62,4096
RK 60,63,4096
PV 200,104,36
EX 22
PV 204,108,36
buffer_load_dwordx4 v67, s[16:19], s40 offen offset:1024 lds
PV 208,112,36
RV 96,64,0
CV 34,20,21
PV 212,116,36
EX 23
PV 216,120,36
RV 98,64,4096
CV 35,22,23
PV 220,124,36
EX 24
v_smfmac_f32_16x16x64_bf16 a[240:243], v[56:59], v[32:39], v71
s_sub_u32 s57, s57, 1
s_cselect_b64 s[58:59], s[60:61], s[58:59]
RV 100,65,0
QK 16,0,160,48
s_add_u32 m0, s42, 0x10000
EX 25
QK 16,4,164,16
RV 102,65,4096
RV 104,64,256
QK 16,8,168,16
RV 106,64,4352
CV 36,24,25
QK 16,12,172,16
buffer_load_dwordx4 v68, s[20:23], s40 offen lds
QK 20,16,160,48
EX 26
QK 20,20,164,20
EX 27
QK 20,24,168,20
RV 108,65,256
RV 110,65,4352
QK 20,28,172,20
RV 112,64,512
CV 37,26,27
PV 128,64,32
EX 28
PV 132,68,32
EX 29
PV 136,72,32
s_add_u32 s49, s45, 0x10000
RV 114,64,4608
CV 38,28,29
PV 140,76,32
EX 30
PV 144,80,32
buffer_load_dwordx4 v[96:99], v72, s[32:35], s49 offen nt
PV 148,84,32
RV 116,65,512
RV 118,65,4608
PV 152,88,32
EX 31
PV 156,92,32
s_waitcnt lgkmcnt(12)
RV 120,64,768
CV 39,30,31
QK 24,32,128,40
buffer_load_dwordx4 v69, s[20:23], s40 offen offset:1024 lds
QK 24,36,132,24
RV 122,64,4864
RV 124,65,768
QK 24,40,136,24
EX 16
QK 24,44,140,24
EX 17
QK 28,48,128,40
RV 126,65,4864
CV 32,16,17
QK 28,52,132,28
EX 18
QK 28,56,136,28
EX 19
QK 28,60,140,28
EX 20
PV 160,64,36
EX 21
PV 164,68,36
EX 22
PV 168,72,36
EX 23
PV 172,76,36
CV 33,18,19
CV 34,20,21
PV 176,80,36
EX 24
PV 180,84,36
s_waitcnt lgkmcnt(0)
EX 25
PV 184,88,36
s_add_u32 s40, s40, s58
CV 35,22,23
PV 188,92,36
s_add_u32 m0, s42, 0x2000
EX 26
v_smfmac_f32_16x16x64_bf16 a[244:247], v[56:59], v[32:39], v71
s_mov_b32 s58, s59
s_mov_b32 s59, 0x20000
RK 0,60,8192
QK 16,32,144,44
RK 4,61,8192
CV 36,24,25
QK 16,36,148,16
EX 27
QK 16,40,152,16
buffer_load_dwordx4 v66, s[16:19], s40 offen lds
QK 16,44,156,16
RK 8,62,8192
RK 12,63,8192
QK 20,48,144,44
RK 16,60,12288
CV 37,26,27
QK 20,52,148,20
EX 28
QK 20,56,152,20
RK 20,61,12288
v_xor_b32 v60, s43, v60
QK 20,60,156,20
RK 24,62,12288
v_xor_b32 v61, s43, v61
PV 192,64,32
EX 29
PV 196,68,32
RK 28,63,12288
CV 38,28,29
PV 200,72,32
buffer_load_dwordx4 v[100:103], v73, s[32:35], s49 offen nt
PV 204,76,32
RV 64,64,8192
v_xor_b32 v62, s43, v62
PV 208,80,32
RV 66,64,12288
v_xor_b32 v63, s43, v63
PV 212,84,32
EX 30
PV 216,88,32
buffer_load_dwordx4 v67, s[16:19], s40 offen offset:1024 lds
PV 220,92,32
RV 68,65,8192
RV 70,65,12288
QK 24,32,160,48
s_add_u32 m0, s42, 0x12000
EX 31
QK 24,36,164,24
RV 72,64,8448
CV 39,30,31
QK 24,40,168,24
EX 16
QK 24,44,172,24
EX 17
QK 28,48,160,48
buffer_load_dwordx4 v68, s[20:23], s40 offen lds
QK 28,52,164,28
RV 74,64,12544
RV 76,65,8448
QK 28,56,168,28
RV 78,65,12544
CV 32,16,17
QK 28,60,172,28
EX 18
PV 128,96,36
EX 19
PV 132,100,36
RV 80,64,8704
RV 82,64,12800
PV 136,104,36
EX 20
PV 140,108,36
RV 84,65,8704
CV 33,18,19
PV 144,112,36
EX 21
PV 148,116,36
buffer_load_dwordx4 v69, s[20:23], s40 offen offset:1024 lds
PV 152,120,36
EX 22
PV 156,124,36
RV 86,65,12800
RV 88,64,8960
EX 23
CV 34,20,21
CV 35,22,23
EX 24
s_nop 0
v_smfmac_f32_16x16x64_bf16 a[248:251], v[56:59], v[32:39], v71
s_waitcnt lgkmcnt(13)
RV 90,64,13056
QK 16,0,128,40
RV 92,65,8960
v_xor_b32 v64, s43, v64
QK 16,4,132,16
EX 25
QK 16,8,136,16
RV 94,65,13056
CV 36,24,25
QK 16,12,140,16
EX 26
QK 20,16,128,40
EX 27
QK 20,20,132,20
CV 37,26,27
v_xor_b32 v65, s43, v65
QK 20,24,136,20
EX 28
QK 20,28,140,20
EX 29
PV 160,96,32
buffer_load_dwordx4 v[104:107], v74, s[32:35], s49 offen nt
PV 164,100,32
EX 30
PV 168,104,32
EX 31
PV 172,108,32
CV 38,28,29
CV 39,30,31
PV 176,112,32
s_waitcnt vmcnt(12) lgkmcnt(0)
s_barrier
PV 180,116,32
EX 16
PV 184,120,32
s_xor_b32 s41, s41, s43
EX 17
PV 188,124,32
s_xor_b32 s42, s41, 0xc000
RK 32,60,0
RK 36,61,0
QK 24,0,144,44
s_sub_u32 s57, s57, 1
s_cselect_b64 s[58:59], s[60:61], s[58:59]
CV 32,16,17
QK 24,4,148,24
s_add_u32 s40, s40, s58
RK 40,62,0
s_add_u32 m0, s42, 0x0
QK 24,8,152,24
buffer_load_dwordx4 v66, s[16:19], s40 offen lds
QK 24,12,156,24
s_mov_b32 s58, s59
EX 18
QK 28,16,144,44
s_mov_b32 s59, 0x20000
RK 44,63,0
RK 48,60,4096
QK 28,20,148,28
s_xor_b32 s43, s43, 0xc000
EX 19
QK 28,24,152,28
RK 52,61,4096
CV 33,18,19
QK 28,28,156,28
EX 20
PV 192,96,36
EX 21
PV 196,100,36
RK 56,62,4096
RK 60,63,4096
PV 200,104,36
EX 22
PV 204,108,36
buffer_load_dwordx4 v67, s[16:19], s40 offen offset:1024 lds
PV 208,112,36
RV 96,64,0
CV 34,20,21
PV 212,116,36
EX 23
PV 216,120,36
RV 98,64,4096
CV 35,22,23
PV 220,124,36
EX 24
v_smfmac_f32_16x16x64_bf16 a[240:243], v[56:59], v[32:39], v71
s_sub_u32 s57, s57, 1
s_cselect_b64 s[58:59], s[60:61], s[58:59]
RV 100,65,0
QK 16,0,160,48
s_add_u32 m0, s42, 0x10000
EX 25
QK 16,4,164,16
RV 102,65,4096
RV 104,64,256
QK 16,8,168,16
RV 106,64,4352
CV 36,24,25
QK 16,12,172,16
buffer_load_dwordx4 v68, s[20:23], s40 offen lds
QK 20,16,160,48
EX 26
QK 20,20,164,20
EX 27
QK 20,24,168,20
RV 108,65,256
RV 110,65,4352
QK 20,28,172,20
buffer_load_dwordx4 v[108:111], v75, s[32:35], s49 offen nt
PV 128,64,32
RV 112,64,512
CV 37,26,27
PV 132,68,32
EX 28
PV 136,72,32
EX 29
PV 140,76,32
RV 114,64,4608
RV 116,65,512
PV 144,80,32
buffer_load_dwordx4 v69, s[20:23], s40 offen offset:1024 lds
PV 148,84,32
RV 118,65,4608
CV 38,28,29
PV 152,88,32
EX 30
PV 156,92,32
s_waitcnt lgkmcnt(12)
EX 31
QK 24,32,128,40
RV 120,64,768
RV 122,64,4864
QK 24,36,132,24
RV 124,65,768
CV 39,30,31
QK 24,40,136,24
EX 16
QK 24,44,140,24
EX 17
QK 28,48,128,40
RV 126,65,4864
CV 32,16,17
QK 28,52,132,28
EX 18
QK 28,56,136,28
EX 19
QK 28,60,140,28
EX 20
PV 160,64,36
EX 21
PV 164,68,36
EX 22
PV 168,72,36
EX 23
PV 172,76,36
CV 33,18,19
CV 34,20,21
PV 176,80,36
EX 24
PV 180,84,36
s_waitcnt lgkmcnt(0)
EX 25
PV 184,88,36
s_add_u32 s40, s40, s58
CV 35,22,23
PV 188,92,36
s_add_u32 m0, s42, 0x2000
EX 26
v_smfmac_f32_16x16x64_bf16 a[244:247], v[56:59], v[32:39], v71
s_mov_b32 s58, s59
s_mov_b32 s59, 0x20000
RK 0,60,8192
QK 16,32,144,44
RK 4,61,8192
CV 36,24,25
QK 16,36,148,16
EX 27
QK 16,40,152,16
buffer_load_dwordx4 v66, s[16:19], s40 offen lds
QK 16,44,156,16
s_add_u32 s50, s45, 0x20000
RK 8,62,8192
RK 12,63,8192
QK 20,48,144,44
RK 16,60,12288
CV 37,26,27
QK 20,52,148,20
buffer_load_dwordx4 v[112:115], v72, s[32:35], s50 offen nt
QK 20,56,152,20
RK 20,61,12288
v_xor_b32 v60, s43, v60
QK 20,60,156,20
RK 24,62,12288
v_xor_b32 v61, s43, v61
PV 192,64,32
EX 28
PV 196,68,32
RK 28,63,12288
v_xor_b32 v62, s43, v62
PV 200,72,32
EX 29
PV 204,76,32
buffer_load_dwordx4 v67, s[16:19], s40 offen offset:1024 lds
PV 208,80,32
L_t5_pad4:
s_cbranch_execz L_t5_go
RV 64,64,8192
RV 66,64,12288
PV 212,84,32
EX 30
PV 216,88,32
RV 68,65,8192
CV 38,28,29
PV 220,92,32
RV 70,65,12288
v_xor_b32 v63, s43, v63
QK 24,32,160,48
s_add_u32 m0, s42, 0x12000
EX 31
QK 24,36,164,24
RV 72,64,8448
CV 39,30,31
QK 24,40,168,24
EX 16
QK 24,44,172,24
EX 17
QK 28,48,160,48
buffer_load_dwordx4 v68, s[20:23], s40 offen lds
QK 28,52,164,28
RV 74,64,12544
RV 76,65,8448
QK 28,56,168,28
RV 78,65,12544
CV 32,16,17
QK 28,60,172,28
EX 18
PV 128,96,36
EX 19
PV 132,100,36
RV 80,64,8704
RV 82,64,12800
PV 136,104,36
EX 20
PV 140,108,36
RV 84,65,8704
CV 33,18,19
PV 144,112,36
EX 21
PV 148,116,36
buffer_load_dwordx4 v69, s[20:23], s40 offen offset:1024 lds
PV 152,120,36
EX 22
PV 156,124,36
RV 86,65,12800
RV 88,64,8960
EX 23
CV 34,20,21
CV 35,22,23
EX 24
s_nop 0
v_smfmac_f32_16x16x64_bf16 a[248:251], v[56:59], v[32:39], v71
s_waitcnt lgkmcnt(13)
RV 90,64,13056
QK 16,0,128,40
RV 92,65,8960
v_xor_b32 v64, s43, v64
QK 16,4,132,16
EX 25
QK 16,8,136,16
RV 94,65,13056
CV 36,24,25
QK 16,12,140,16
buffer_load_dwordx4 v[116:119], v73, s[32:35], s50 offen nt
QK 20,16,128,40
EX 26
QK 20,20,132,20
EX 27
QK 20,24,136,20
CV 37,26,27
v_xor_b32 v65, s43, v65
QK 20,28,140,20
EX 28
PV 160,96,32
EX 29
PV 164,100,32
EX 30
PV 168,104,32
EX 31
PV 172,108,32
CV 38,28,29
CV 39,30,31
PV 176,112,32
s_waitcnt vmcnt(12) lgkmcnt(0)
s_barrier
PV 180,116,32
EX 16
PV 184,120,32
s_xor_b32 s41, s41, s43
EX 17
PV 188,124,32
s_xor_b32 s42, s41, 0xc000
RK 32,60,0
RK 36,61,0
QK 24,0,144,44
s_sub_u32 s57, s57, 1
s_cselect_b64 s[58:59], s[60:61], s[58:59]
CV 32,16,17
QK 24,4,148,24
s_add_u32 s40, s40, s58
RK 40,62,0
s_add_u32 m0, s42, 0x0
QK 24,8,152,24
buffer_load_dwordx4 v66, s[16:19], s40 offen lds
QK 24,12,156,24
s_mov_b32 s58, s59
EX 18
QK 28,16,144,44
s_mov_b32 s59, 0x20000
RK 44,63,0
RK 48,60,4096
QK 28,20,148,28
s_xor_b32 s43, s43, 0xc000
EX 19
QK 28,24,152,28
RK 52,61,4096
CV 33,18,19
QK 28,28,156,28
EX 20
PV 192,96,36
EX 21
PV 196,100,36
RK 56,62,4096
RK 60,63,4096
PV 200,104,36
EX 22
PV 204,108,36
buffer_load_dwordx4 v67, s[16:19], s40 offen offset:1024 lds
PV 208,112,36
RV 96,64,0
CV 34,20,21
PV 212,116,36
EX 23
PV 216,120,36
RV 98,64,4096
CV 35,22,23
PV 220,124,36
EX 24
v_smfmac_f32_16x16x64_bf16 a[240:243], v[56:59], v[32:39], v71
s_sub_u32 s57, s57, 1
s_cselect_b64 s[58:59], s[60:61], s[58:59]
RV 100,65,0
QK 16,0,160,48
s_add_u32 m0, s42, 0x10000
EX 25
QK 16,4,164,16
buffer_load_dwordx4 v[120:123], v74, s[32:35], s50 offen nt
QK 16,8,168,16
RV 102,65,4096
RV 104,64,256
QK 16,12,172,16
RV 106,64,4352
CV 36,24,25
QK 20,16,160,48
EX 26
QK 20,20,164,20
buffer_load_dwordx4 v68, s[20:23], s40 offen lds
QK 20,24,168,20
RV 108,65,256
RV 110,65,4352
QK 20,28,172,20
EX 27
PV 128,64,32
RV 112,64,512
CV 37,26,27
PV 132,68,32
EX 28
PV 136,72,32
EX 29
PV 140,76,32
RV 114,64,4608
RV 116,65,512
PV 144,80,32
buffer_load_dwordx4 v69, s[20:23], s40 offen offset:1024 lds
PV 148,84,32
RV 118,65,4608
CV 38,28,29
PV 152,88,32
EX 30
PV 156,92,32
s_waitcnt lgkmcnt(12)
EX 31
QK 24,32,128,40
RV 120,64,768
RV 122,64,4864
QK 24,36,132,24
RV 124,65,768
CV 39,30,31
QK 24,40,136,24
EX 16
QK 24,44,140,24
EX 17
QK 28,48,128,40
RV 126,65,4864
CV 32,16,17
QK 28,52,132,28
EX 18
QK 28,56,136,28
EX 19
QK 28,60,140,28
EX 20
PV 160,64,36
EX 21
PV 164,68,36
EX 22
PV 168,72,36
EX 23
PV 172,76,36
CV 33,18,19
CV 34,20,21
PV 176,80,36
EX 24
PV 180,84,36
s_waitcnt lgkmcnt(0)
EX 25
PV 184,88,36
s_add_u32 s40, s40, s58
CV 35,22,23
PV 188,92,36
s_add_u32 m0, s42, 0x2000
EX 26
v_smfmac_f32_16x16x64_bf16 a[244:247], v[56:59], v[32:39], v71
s_mov_b32 s58, s59
s_mov_b32 s59, 0x20000
RK 0,60,8192
QK 16,32,144,44
buffer_load_dwordx4 v[124:127], v75, s[32:35], s50 offen nt
QK 16,36,148,16
RK 4,61,8192
RK 8,62,8192
QK 16,40,152,16
RK 12,63,8192
CV 36,24,25
QK 16,44,156,16
EX 27
QK 20,48,144,44
buffer_load_dwordx4 v66, s[16:19], s40 offen lds
QK 20,52,148,20
RK 16,60,12288
CV 37,26,27
QK 20,56,152,20
RK 20,61,12288
v_xor_b32 v60, s43, v60
QK 20,60,156,20
RK 24,62,12288
v_xor_b32 v61, s43, v61
PV 192,64,32
EX 28
PV 196,68,32
RK 28,63,12288
v_xor_b32 v62, s43, v62
PV 200,72,32
EX 29
PV 204,76,32
buffer_load_dwordx4 v67, s[16:19], s40 offen offset:1024 lds
PV 208,80,32
RV 64,64,8192
RV 66,64,12288
PV 212,84,32
EX 30
PV 216,88,32
RV 68,65,8192
CV 38,28,29
PV 220,92,32
RV 70,65,12288
v_xor_b32 v63, s43, v63
QK 24,32,160,48
s_add_u32 m0, s42, 0x12000
EX 31
QK 24,36,164,24
RV 72,64,8448
CV 39,30,31
QK 24,40,168,24
EX 16
QK 24,44,172,24
EX 17
QK 28,48,160,48
buffer_load_dwordx4 v68, s[20:23], s40 offen lds
QK 28,52,164,28
RV 74,64,12544
RV 76,65,8448
QK 28,56,168,28
RV 78,65,12544
CV 32,16,17
QK 28,60,172,28
EX 18
PV 128,96,36
EX 19
PV 132,100,36
RV 80,64,8704
RV 82,64,12800
PV 136,104,36
EX 20
PV 140,108,36
RV 84,65,8704
CV 33,18,19
PV 144,112,36
EX 21
PV 148,116,36
buffer_load_dwordx4 v69, s[20:23], s40 offen offset:1024 lds
PV 152,120,36
EX 22
PV 156,124,36
RV 86,65,12800
RV 88,64,8960
EX 23
CV 34,20,21
CV 35,22,23
EX 24
s_nop 0
v_smfmac_f32_16x16x64_bf16 a[248:251], v[56:59], v[32:39], v71
s_waitcnt lgkmcnt(13)
RV 90,64,13056
QK 16,0,128,40
RV 92,65,8960
v_xor_b32 v64, s43, v64
QK 16,4,132,16
EX 25
QK 16,8,136,16
RV 94,65,13056
CV 36,24,25
QK 16,12,140,16
EX 26
QK 20,16,128,40
v_accvgpr_read_b32 v76, a250
v_accvgpr_read_b32 v77, a248
QK 20,20,132,20
v_accvgpr_read_b32 v40, a251
v_xor_b32 v65, s43, v65
QK 20,24,136,20
EX 27
QK 20,28,140,20
v_add_f32 v76, v76, v40
CV 37,26,27
PV 160,96,32
EX 28
PV 164,100,32
EX 29
PV 168,104,32
EX 30
PV 172,108,32
EX 31
PV 176,112,32
s_waitcnt vmcnt(11) lgkmcnt(0)
s_barrier
PV 180,116,32
CV 38,28,29
CV 39,30,31
PV 184,120,32
s_xor_b32 s41, s41, s43
RK 32,60,0
RK 36,61,0
PV 188,124,32
s_xor_b32 s42, s41, 0xc000
EX 16
QK 24,0,144,44
s_sub_u32 s57, s57, 1
s_cselect_b64 s[58:59], s[60:61], s[58:59]
RK 40,62,0
QK 24,4,148,24
s_add_u32 s40, s40, s58
RK 44,63,0
s_add_u32 m0, s42, 0x0
QK 24,8,152,24
buffer_load_dwordx4 v66, s[16:19], s40 offen lds
QK 24,12,156,24
s_xor_b32 s43, s43, 0xc000
RK 48,60,4096
RK 52,61,4096
QK 28,16,144,44
s_mov_b32 s58, s59
EX 17
QK 28,20,148,28
s_mov_b32 s59, 0x20000
RK 56,62,4096
v_accvgpr_read_b32 v44, a249
QK 28,24,152,28
RK 60,63,4096
v_add_f32 v77, v77, v44
QK 28,28,156,28
EX 18
PV 192,96,36
RV 96,64,0
RV 98,64,4096
PV 196,100,36
RV 100,65,0
CV 32,16,17
PV 200,104,36
RV 102,65,4096
RV 104,64,256
PV 204,108,36
EX 19
PV 208,112,36
RV 106,64,4352
RV 108,65,256
PV 212,116,36
RV 110,65,4352
CV 33,18,19
PV 216,120,36
RV 112,64,512
RV 114,64,4608
PV 220,124,36
buffer_load_dwordx4 v67, s[16:19], s40 offen offset:1024 lds
RV 116,65,512
RV 118,65,4608
EX 20
EX 21
EX 22
EX 23
CV 34,20,21
CV 35,22,23
EX 24
s_nop 0
v_smfmac_f32_16x16x64_bf16 a[240:243], v[56:59], v[32:39], v71
s_add_u32 m0, s42, 0x10000
RV 120,64,768
QK 16,0,160,48
RV 122,64,4864
RV 124,65,768
v_lshlrev_b32 v0, 16, v80
v_and_b32 v1, s71, v80
v_lshlrev_b32 v2, 16, v81
v_and_b32 v3, s71, v81
v_pk_mul_f32 v[0:1], v[0:1], s[14:15]
v_pk_mul_f32 v[2:3], v[2:3], s[14:15]
QK 16,4,164,16
RV 126,65,4864
v_accvgpr_read_b32 v41, a240
v_accvgpr_read_b32 v42, a241
v_add_f32 v76, v76, v41
v_accvgpr_read_b32 v78, a242
v_add_f32 v76, v76, v42
v_lshlrev_b32 v4, 16, v82
v_cmp_nge_f32 s[4:5], s55, v76
v_rcp_f32 v76, v76
v_and_b32 v5, s71, v82
v_lshlrev_b32 v6, 16, v83
v_and_b32_e64 v7, s71, v83
v_pk_mul_f32 v[4:5], v[4:5], s[14:15]
v_pk_mul_f32 v[6:7], v[6:7], s[14:15]
CV 80,0,1
CV 81,2,3
QK 16,8,168,16
CV 82,4,5
CV 83,6,7
v_lshlrev_b32 v0, 16, v84
v_and_b32 v1, s71, v84
v_lshlrev_b32 v2, 16, v85
v_and_b32 v3, s71, v85
v_pk_mul_f32 v[0:1], v[0:1], s[14:15]
v_pk_mul_f32 v[2:3], v[2:3], s[14:15]
QK 16,12,172,16
buffer_load_dwordx4 v68, s[20:23], s40 offen lds
ds_write_b128 v15, v[80:83] offset:0
v_lshlrev_b32 v4, 16, v86
v_and_b32 v5, s71, v86
v_lshlrev_b32 v6, 16, v87
v_and_b32 v7, s71, v87
v_pk_mul_f32 v[4:5], v[4:5], s[14:15]
v_pk_mul_f32 v[6:7], v[6:7], s[14:15]
CV 84,0,1
CV 85,2,3
QK 20,16,160,48
CV 86,4,5
CV 87,6,7
v_lshlrev_b32 v0, 16, v88
v_accvgpr_read_b32 v48, a243
v_and_b32 v1, s71, v88
v_add_f32 v78, v78, v48
v_lshlrev_b32 v2, 16, v89
v_and_b32 v3, s71, v89
v_pk_mul_f32 v[0:1], v[0:1], s[14:15]
v_pk_mul_f32 v[2:3], v[2:3], s[14:15]
QK 20,20,164,20
ds_write_b128 v15, v[84:87] offset:544
v_lshlrev_b32 v4, 16, v90
v_and_b32 v5, s71, v90
v_lshlrev_b32 v6, 16, v91
v_and_b32_e64 v7, s71, v91
v_pk_mul_f32 v[4:5], v[4:5], s[14:15]
v_pk_mul_f32 v[6:7], v[6:7], s[14:15]
CV 88,0,1
CV 89,2,3
QK 20,24,168,20
CV 90,4,5
CV 91,6,7
v_lshlrev_b32 v0, 16, v92
v_and_b32 v1, s71, v92
v_lshlrev_b32 v2, 16, v93
v_and_b32 v3, s71, v93
v_pk_mul_f32 v[0:1], v[0:1], s[14:15]
v_pk_mul_f32 v[2:3], v[2:3], s[14:15]
QK 20,28,172,20
s_add_u32 s51, s44, 0x0
ds_write_b128 v15, v[88:91] offset:1152
v_lshlrev_b32 v4, 16, v94
v_and_b32 v5, s71, v94
v_lshlrev_b32 v6, 16, v95
v_and_b32_e64 v7, s71, v95
v_pk_mul_f32 v[4:5], v[4:5], s[14:15]
v_pk_mul_f32 v[6:7], v[6:7], s[14:15]
CV 92,0,1
CV 93,2,3
PV 128,64,32
CV 94,4,5
CV 95,6,7
PV 132,68,32
ds_write_b128 v15, v[92:95] offset:1696
PV 136,72,32
RK 176,14,0
RK 180,14,64
PV 140,76,32
RK 184,14,128
v_accvgpr_write_b32 a240, 0
RK 188,14,192
PM 128,76,0
PM 130,76,0
PV 144,80,32
buffer_load_dwordx4 v69, s[20:23], s40 offen offset:1024 lds
CV 128,128,129
CV 129,130,131
PM 132,76,0
PM 134,76,0
PV 148,84,32
ds_write_b64 v70, v[128:129] offset:0
CV 132,132,133
CV 133,134,135
PM 136,76,0
PM 138,76,0
PV 152,88,32
ds_write_b64 v70, v[132:133] offset:32
CV 136,136,137
CV 137,138,139
PM 140,76,0
PM 142,76,0
PV 156,92,32
s_waitcnt lgkmcnt(15)
ds_write_b64 v70, v[136:137] offset:64
CV 140,140,141
CV 141,142,143
PM 144,76,0
PM 146,76,0
EX 25
EX 26
EX 27
CV 36,24,25
CV 37,26,27
s_waitcnt lgkmcnt(6)
QZ 24,32,176
ds_write_b64 v70, v[140:141] offset:96
CV 144,144,145
CV 145,146,147
PM 148,76,0
PM 150,76,0
v_lshlrev_b32 v0, 16, v96
v_and_b32 v1, s71, v96
v_lshlrev_b32 v2, 16, v97
v_and_b32 v3, s71, v97
v_pk_mul_f32 v[0:1], v[0:1], s[14:15]
v_pk_mul_f32 v[2:3], v[2:3], s[14:15]
s_waitcnt lgkmcnt(6)
QK 24,36,180,24
ds_write_b64 v70, v[144:145] offset:128
CV 148,148,149
CV 149,150,151
PM 152,76,0
PM 154,76,0
v_lshlrev_b32 v4, 16, v98
v_and_b32 v5, s71, v98
v_lshlrev_b32 v6, 16, v99
v_and_b32 v7, s71, v99
v_pk_mul_f32 v[4:5], v[4:5], s[14:15]
v_pk_mul_f32 v[6:7], v[6:7], s[14:15]
CV 96,0,1
CV 97,2,3
s_waitcnt lgkmcnt(6)
QK 24,40,184,24
ds_write_b64 v70, v[148:149] offset:160
CV 152,152,153
CV 153,154,155
PM 156,76,0
PM 158,76,0
CV 98,4,5
CV 99,6,7
v_lshlrev_b32 v0, 16, v100
v_and_b32 v1, s71, v100
v_lshlrev_b32 v2, 16, v101
v_and_b32 v3, s71, v101
v_pk_mul_f32 v[0:1], v[0:1], s[14:15]
v_pk_mul_f32 v[2:3], v[2:3], s[14:15]
s_waitcnt lgkmcnt(6)
QK 24,44,188,24
L_t5_pad5:
s_cbranch_execz L_t5_go
ds_write_b64 v70, v[152:153] offset:192
CV 156,156,157
CV 157,158,159
v_lshlrev_b32 v4, 16, v102
v_and_b32 v5, s71, v102
v_lshlrev_b32 v6, 16, v103
v_and_b32_e64 v7, s71, v103
v_pk_mul_f32 v[4:5], v[4:5], s[14:15]
v_max3_f32 v10, v24, v25, v26
v_pk_mul_f32 v[6:7], v[6:7], s[14:15]
CV 100,0,1
CV 101,2,3
EX 28
EX 29
EX 30
EX 31
CV 38,28,29
CV 39,30,31
QZ 28,48,176
ds_write_b64 v70, v[156:157] offset:224
RK 128,15,0
RK 132,15,528
CV 102,4,5
RK 136,15,1056
CV 103,6,7
RK 140,15,1584
ds_write_b128 v15, v[96:99] offset:0
v_lshlrev_b32 v0, 16, v104
v_and_b32 v1, s71, v104
v_lshlrev_b32 v2, 16, v105
v_and_b32 v3, s71, v105
v_pk_mul_f32 v[0:1], v[0:1], s[14:15]
v_pk_mul_f32 v[2:3], v[2:3], s[14:15]
QK 28,52,180,28
ds_write_b128 v15, v[100:103] offset:544
s_waitcnt lgkmcnt(5)
buffer_store_dwordx4 a[128:131], v72, s[28:31], s51 offen nt
v_lshlrev_b32 v4, 16, v106
v_and_b32 v5, s71, v106
v_lshlrev_b32 v6, 16, v107
v_and_b32_e64 v7, s71, v107
v_pk_mul_f32 v[4:5], v[4:5], s[14:15]
v_pk_mul_f32 v[6:7], v[6:7], s[14:15]
CV 104,0,1
CV 105,2,3
QK 28,56,184,28
CV 106,4,5
CV 107,6,7
v_lshlrev_b32 v0, 16, v108
v_and_b32 v1, s71, v108
v_lshlrev_b32 v2, 16, v109
v_and_b32 v3, s71, v109
v_pk_mul_f32 v[0:1], v[0:1], s[14:15]
v_pk_mul_f32 v[2:3], v[2:3], s[14:15]
QK 28,60,188,28
s_waitcnt lgkmcnt(4)
buffer_store_dwordx4 a[132:135], v73, s[28:31], s51 offen nt
ds_write_b128 v15, v[104:107] offset:1152
v_lshlrev_b32 v4, 16, v110
v_and_b32 v5, s71, v110
v_lshlrev_b32 v6, 16, v111
v_and_b32_e64 v7, s71, v111
v_pk_mul_f32 v[4:5], v[4:5], s[14:15]
v_pk_mul_f32 v[6:7], v[6:7], s[14:15]
v_max3_f32 v11, v28, v29, v30
v_max3_f32 v10, v10, v27, v31
CV 108,0,1
v_max_f32 v10, v10, v11
CV 109,2,3
v_mov_b32 v11, v10
EX 16
EX 17
v_permlane32_swap_b32 v10, v11
v_max_f32 v10, v10, v11
EX 18
v_mov_b32 v11, v10
EX 19
EX 20
v_permlane16_swap_b32 v10, v11
v_min_f32_e64 v52, -v10, -v11
EX 21
EX 22
EX 23
CV 32,16,17
CV 33,18,19
CV 34,20,21
CV 35,22,23
v_add_f32 v24, v52, v24
v_add_f32 v25, v52, v25
v_smfmac_f32_16x16x64_bf16 a[244:247], v[56:59], v[32:39], v71
s_add_u32 s52, s44, 0x10000
CV 110,4,5
CV 111,6,7
PV 160,64,36
s_waitcnt lgkmcnt(4)
buffer_store_dwordx4 a[136:139], v74, s[28:31], s51 offen nt
PV 164,68,36
ds_write_b128 v15, v[108:111] offset:1696
PV 168,72,36
RK 192,14,0
RK 196,14,64
PV 172,76,36
s_waitcnt lgkmcnt(6)
buffer_store_dwordx4 a[140:143], v75, s[28:31], s51 offen nt
RK 200,14,128
v_accvgpr_read_b32 v45, a246
v_accvgpr_read_b32 v46, a247
v_add_f32 v77, v77, v45
RK 204,14,192
v_add_f32 v77, v77, v46
v_accvgpr_read_b32 v49, a244
v_cmp_nge_f32 s[6:7], s55, v77
v_rcp_f32 v77, v77
v_add_f32 v78, v78, v49
v_accvgpr_read_b32 v50, a245
PM 160,76,1
v_add_f32 v78, v78, v50
PM 162,76,1
PV 176,80,36
v_cmp_nge_f32 s[8:9], s55, v78
v_rcp_f32 v78, v78
CV 160,160,161
CV 161,162,163
PM 164,76,1
PM 166,76,1
PV 180,84,36
s_add_u32 s40, s40, 0x20000
ds_write_b64 v70, v[160:161] offset:0
CV 164,164,165
CV 165,166,167
PM 168,76,1
PM 170,76,1
PV 184,88,36
s_add_u32 m0, s42, 0x2000
ds_write_b64 v70, v[164:165] offset:32
RK 0,60,8192
RK 4,61,8192
CV 168,168,169
CV 169,170,171
PM 172,76,1
PM 174,76,1
PV 188,92,36
ds_write_b64 v70, v[168:169] offset:64
RK 8,62,8192
RK 12,63,8192
CV 172,172,173
CV 173,174,175
PM 176,76,1
PM 178,76,1
s_waitcnt lgkmcnt(10)
QZ 16,32,192
s_bfe_u32 s48, s2, 0x10003
ds_write_b64 v70, v[172:173] offset:96
RK 16,60,12288
RK 20,61,12288
CV 176,176,177
CV 177,178,179
PM 180,76,1
PM 182,76,1
v_lshlrev_b32 v0, 16, v112
v_and_b32 v1, s71, v112
v_lshlrev_b32 v2, 16, v113
v_and_b32_e64 v3, s71, v113
v_pk_mul_f32 v[0:1], v[0:1], s[14:15]
v_pk_mul_f32 v[2:3], v[2:3], s[14:15]
s_waitcnt lgkmcnt(12)
QK 16,36,196,16
s_lshl1_add_u32 s48, s46, s48
ds_write_b64 v70, v[176:177] offset:128
RK 24,62,12288
RK 28,63,12288
CV 180,180,181
CV 181,182,183
PM 184,76,1
PM 186,76,1
v_lshlrev_b32 v4, 16, v114
v_and_b32 v5, s71, v114
v_lshlrev_b32 v6, 16, v115
v_and_b32 v7, s71, v115
v_pk_mul_f32 v[4:5], v[4:5], s[14:15]
v_pk_mul_f32 v[6:7], v[6:7], s[14:15]
CV 112,0,1
CV 113,2,3
s_waitcnt lgkmcnt(14)
QK 16,40,200,16
buffer_load_dwordx4 v66, s[16:19], s40 offen lds
ds_write_b64 v70, v[180:181] offset:160
CV 184,184,185
CV 185,186,187
PM 188,76,1
PM 190,76,1
CV 114,4,5
CV 115,6,7
s_waitcnt vmcnt(19)
v_lshlrev_b32 v0, 16, v116
v_and_b32 v1, s71, v116
v_lshlrev_b32 v2, 16, v117
v_and_b32 v3, s71, v117
v_pk_mul_f32 v[0:1], v[0:1], s[14:15]
v_pk_mul_f32 v[2:3], v[2:3], s[14:15]
s_waitcnt lgkmcnt(14)
QK 16,44,204,16
s_lshl2_add_u32 s48, s48, s12
ds_write_b64 v70, v[184:185] offset:192
CV 188,188,189
CV 189,190,191
v_lshlrev_b32 v4, 16, v118
v_and_b32 v5, s71, v118
v_lshlrev_b32 v6, 16, v119
v_and_b32 v7, s71, v119
v_max3_f32 v8, v16, v17, v18
v_pk_mul_f32 v[4:5], v[4:5], s[14:15]
v_pk_mul_f32 v[6:7], v[6:7], s[14:15]
CV 116,0,1
CV 117,2,3
QZ 20,48,192
s_add_u32 s48, s48, 0
ds_write_b64 v70, v[188:189] offset:224
RK 144,15,0
RK 148,15,528
CV 118,4,5
RK 152,15,1056
CV 119,6,7
RK 156,15,1584
ds_write_b128 v15, v[112:115] offset:0
s_waitcnt vmcnt(16)
v_lshlrev_b32 v0, 16, v120
v_and_b32 v1, s71, v120
v_lshlrev_b32 v2, 16, v121
v_and_b32 v3, s71, v121
v_pk_mul_f32 v[0:1], v[0:1], s[14:15]
v_pk_mul_f32 v[2:3], v[2:3], s[14:15]
QK 20,52,196,20
s_lshl_b32 s48, s48, 13
ds_write_b128 v15, v[116:119] offset:544
s_waitcnt lgkmcnt(5)
buffer_store_dwordx4 a[144:147], v72, s[28:31], s52 offen nt
v_lshlrev_b32 v4, 16, v122
v_and_b32 v5, s71, v122
v_lshlrev_b32 v6, 16, v123
v_and_b32 v7, s71, v123
v_pk_mul_f32 v[4:5], v[4:5], s[14:15]
v_pk_mul_f32 v[6:7], v[6:7], s[14:15]
CV 120,0,1
CV 121,2,3
QK 20,56,200,20
s_waitcnt vmcnt(14)
CV 122,4,5
CV 123,6,7
v_lshlrev_b32 v0, 16, v124
v_and_b32 v1, s71, v124
v_lshlrev_b32 v2, 16, v125
v_and_b32 v3, s71, v125
v_pk_mul_f32 v[0:1], v[0:1], s[14:15]
v_pk_mul_f32 v[2:3], v[2:3], s[14:15]
QK 20,60,204,20
s_waitcnt lgkmcnt(4)
buffer_store_dwordx4 a[148:151], v73, s[28:31], s52 offen nt
ds_write_b128 v15, v[120:123] offset:1152
v_lshlrev_b32 v4, 16, v126
v_and_b32 v5, s71, v126
v_lshlrev_b32 v6, 16, v127
v_and_b32 v7, s71, v127
v_pk_mul_f32 v[4:5], v[4:5], s[14:15]
v_pk_mul_f32 v[6:7], v[6:7], s[14:15]
v_max3_f32 v9, v20, v21, v22
v_max3_f32 v8, v8, v19, v23
CV 124,0,1
v_max_f32 v8, v8, v9
CV 125,2,3
PV 192,64,32
s_add_u32 s53, s44, 0x20000
CV 126,4,5
CV 127,6,7
PV 196,68,32
ds_write_b128 v15, v[124:127] offset:1696
PV 200,72,32
RK 208,14,0
RK 212,14,64
PV 204,76,32
RK 216,14,128
v_mov_b32 v9, v8
RK 220,14,192
s_waitcnt lgkmcnt(9)
buffer_store_dwordx4 a[152:155], v74, s[28:31], s52 offen nt
v_permlane32_swap_b32 v8, v9
v_max_f32 v8, v8, v9
PM 192,78,0
v_mov_b32 v9, v8
PM 194,78,0
PV 208,80,32
RV 64,64,8192
RV 66,64,12288
v_permlane16_swap_b32 v8, v9
v_min_f32_e64 v40, -v8, -v9
CV 192,192,193
CV 193,194,195
PM 196,78,0
PM 198,78,0
PV 212,84,32
buffer_load_dwordx4 v67, s[16:19], s40 offen offset:1024 lds
ds_write_b64 v70, v[192:193] offset:0
RV 68,65,8192
RV 70,65,12288
CV 196,196,197
CV 197,198,199
PM 200,78,0
PM 202,78,0
PV 216,88,32
ds_write_b64 v70, v[196:197] offset:32
RV 72,64,8448
RV 74,64,12544
s_waitcnt lgkmcnt(15)
buffer_store_dwordx4 a[156:159], v75, s[28:31], s52 offen nt
CV 200,200,201
CV 201,202,203
PM 204,78,0
PM 206,78,0
PV 220,92,32
ds_write_b64 v70, v[200:201] offset:64
RV 76,65,8448
RV 78,65,12544
CV 204,204,205
CV 205,206,207
PM 208,78,0
PM 210,78,0
v_add_f32 v26, v52, v26
v_add_f32 v27, v52, v27
EX 24
EX 25
EX 26
v_exp_f32_e64 v27, v27
CV 36,24,25
CV 37,26,27
s_waitcnt lgkmcnt(14)
QZ 24,32,208
s_add_u32 m0, s42, 0x12000
ds_write_b64 v70, v[204:205] offset:96
RV 80,64,8704
RV 82,64,12800
CV 208,208,209
CV 209,210,211
PM 212,78,0
PM 214,78,0
s_waitcnt lgkmcnt(15)
QK 24,36,212,24
ds_write_b64 v70, v[208:209] offset:128
RV 84,65,8704
RV 86,65,12800
CV 212,212,213
CV 213,214,215
PM 216,78,0
PM 218,78,0
QK 24,40,216,24
ds_write_b64 v70, v[212:213] offset:160
RV 88,64,8960
RV 90,64,13056
CV 216,216,217
CV 217,218,219
PM 220,78,0
PM 222,78,0
s_waitcnt lgkmcnt(15)
QK 24,44,220,24
ds_write_b64 v70, v[216:217] offset:192
RV 92,65,8960
RV 94,65,13056
CV 220,220,221
CV 221,222,223
v_add_f32 v10, v52, v12
v_add_f32 v11, v52, v13
v_add_f32 v28, v10, v28
v_add_f32 v29, v10, v29
v_max3_f32 v10, v24, v25, v26
v_add_f32 v30, v11, v30
v_add_f32 v31, v11, v31
EX 28
EX 29
EX 30
EX 31
CV 38,28,29
CV 39,30,31
QZ 28,48,208
ds_write_b64 v70, v[220:221] offset:224
QK 28,52,212,28
RK 160,15,0
RK 164,15,528
QK 28,56,216,28
RK 168,15,1056
v_mbcnt_lo_u32_b32 v80, -1, 0
QK 28,60,220,28
RK 172,15,1584
v_mbcnt_hi_u32_b32 v80, -1, v80
PZ 224,96,36
v_lshl_add_u32 v80, v80, 7, s48
v_add_f32 v8, v40, v12
PZ 228,100,36
v_min_u32 v80, L_end8-L_type0+4092, v80
v_add_f32 v9, v40, v13
PZ 232,104,36
global_load_dword v81, v80, s[68:69]
PZ 236,108,36
v_max3_f32 v11, v28, v29, v30
v_max3_f32 v10, v10, v27, v31
PZ 240,112,36
v_max_f32 v10, v10, v11
v_add_f32 v16, v40, v16
PZ 244,116,36
v_mov_b32 v11, v10
v_add_f32 v17, v40, v17
PZ 248,120,36
v_permlane32_swap_b32 v10, v11
PZ 252,124,36
buffer_load_dwordx4 v68, s[20:23], s40 offen lds
v_max_f32 v10, v10, v11
v_add_f32 v18, v40, v18
v_mov_b32 v11, v10
v_add_f32 v19, v40, v19
v_add_f32 v20, v8, v20
v_permlane16_swap_b32 v10, v11
v_min_f32_e64 v44, -v10, -v11
v_add_f32 v21, v8, v21
v_add_f32 v22, v9, v22
v_add_f32 v23, v9, v23
EX 16
EX 17
EX 18
EX 19
EX 20
EX 21
EX 22
EX 23
CV 32,16,17
CV 33,18,19
CV 34,20,21
CV 35,22,23
v_mov_b32 v53, v52
v_mov_b32 v54, v52
v_smfmac_f32_16x16x64_bf16 a[252:255], v[56:59], v[32:39], v71
v_mov_b32 v55, v52
v_add_f32 v24, v44, v24
v_add_f32 v25, v44, v25
QK 16,0,176,52
s_waitcnt lgkmcnt(3)
buffer_store_dwordx4 a[160:163], v72, s[28:31], s53 offen nt
QK 16,4,180,16
v_add_f32 v26, v44, v26
v_add_f32 v27, v44, v27
QK 16,8,184,16
EX 24
QK 16,12,188,16
s_waitcnt lgkmcnt(2)
buffer_store_dwordx4 a[164:167], v73, s[28:31], s53 offen nt
QK 20,16,176,52
EX 25
QK 20,20,180,20
EX 26
QK 20,24,184,20
EX 27
QK 20,28,188,20
s_waitcnt lgkmcnt(1)
buffer_store_dwordx4 a[168:171], v74, s[28:31], s53 offen nt
PZ 128,96,32
v_mov_b32 v41, v40
v_mov_b32 v42, v40
PZ 132,100,32
v_mov_b32 v43, v40
CV 36,24,25
PZ 136,104,32
CV 37,26,27
v_xor_b32 v60, s43, v60
PZ 140,108,32
s_waitcnt lgkmcnt(0)
buffer_store_dwordx4 a[172:175], v75, s[28:31], s53 offen nt
PZ 144,112,32
s_waitcnt vmcnt(20) lgkmcnt(0)
s_barrier
PZ 148,116,32
v_xor_b32 v61, s43, v61
v_add_f32 v10, v44, v12
PZ 152,120,32
s_xor_b32 s41, s41, s43
RK 32,60,0
v_add_f32 v11, v44, v13
PZ 156,124,32
buffer_load_dwordx4 v69, s[20:23], s40 offen offset:1024 lds
QK 24,0,192,40
s_xor_b32 s42, s41, 0xc000
RK 36,61,0
v_add_f32 v28, v10, v28
QK 24,4,196,24
s_add_u32 s40, s40, 0x20000
s_add_u32 m0, s42, 0x0
v_add_f32 v29, v10, v29
QK 24,8,200,24
v_add_f32 v30, v11, v30
v_add_f32 v31, v11, v31
QK 24,12,204,24
buffer_load_dwordx4 v66, s[16:19], s40 offen lds
EX 28
EX 29
EX 30
EX 31
CV 38,28,29
CV 39,30,31
QK 28,16,192,40
v_xor_b32 v62, s43, v62
v_xor_b32 v63, s43, v63
QK 28,20,196,28
RK 40,62,0
RK 44,63,0
QK 28,24,200,28
RK 48,60,4096
v_xor_b32 v64, s43, v64
QK 28,28,204,28
RK 52,61,4096
v_accvgpr_write_b32 a241, 0
PZ 160,96,36
RK 56,62,4096
v_accvgpr_write_b32 a242, 0
PZ 164,100,36
RK 60,63,4096
v_accvgpr_write_b32 a243, 0
PZ 168,104,36
EX 16
PZ 172,108,36
buffer_load_dwordx4 v67, s[16:19], s40 offen offset:1024 lds
PZ 176,112,36
RV 96,64,0
v_xor_b32 v65, s43, v65
PZ 180,116,36
s_xor_b32 s43, s43, 0xc000
EX 17
PZ 184,120,36
EX 18
PZ 188,124,36
RV 98,64,4096
RV 100,65,0
EX 19
EX 20
EX 21
EX 22
EX 23
CV 32,16,17
CV 33,18,19
CV 34,20,21
CV 35,22,23
v_mov_b32 v45, v44
v_mov_b32 v46, v44
v_smfmac_f32_16x16x64_bf16 a[240:243], v[56:59], v[32:39], v71
s_add_u32 m0, s42, 0x10000
v_mov_b32 v47, v44
v_accvgpr_write_b32 a244, 0
v_accvgpr_write_b32 a245, 0
QK 16,0,208,44
RV 102,65,4096
v_accvgpr_write_b32 a246, 0
QK 16,4,212,16
RV 104,64,256
v_accvgpr_write_b32 a247, 0
QK 16,8,216,16
EX 24
QK 16,12,220,16
buffer_load_dwordx4 v68, s[20:23], s40 offen lds
QK 20,16,208,44
RV 106,64,4352
RV 108,65,256
QK 20,20,212,20
EX 25
QK 20,24,216,20
RV 110,65,4352
CV 36,24,25
QK 20,28,220,20
EX 26
PV 224,64,32
EX 27
PV 228,68,32
RV 112,64,512
RV 114,64,4608
PV 232,72,32
EX 28
PV 236,76,32
RV 116,65,512
CV 37,26,27
PV 240,80,32
buffer_load_dwordx4 v69, s[20:23], s40 offen offset:1024 lds
PV 244,84,32
EX 29
PV 248,88,32
RV 118,65,4608
RV 120,64,768
PV 252,92,32
s_waitcnt lgkmcnt(13)
EX 30
QK 24,32,176,52
RV 122,64,4864
CV 38,28,29
QK 24,36,180,24
EX 31
QK 24,40,184,24
RV 124,65,768
CV 39,30,31
QK 24,44,188,24
EX 16
QK 28,48,176,52
EX 17
QK 28,52,180,28
RV 126,65,4864
CV 32,16,17
QK 28,56,184,28
EX 18
QK 28,60,188,28
L_t5_pad6:
s_cbranch_execz L_t5_go
EX 19
PV 128,64,36
EX 20
PV 132,68,36
EX 21
PV 136,72,36
EX 22
PV 140,76,36
EX 23
PV 144,80,36
CV 33,18,19
CV 34,20,21
PV 148,84,36
s_waitcnt lgkmcnt(0)
EX 24
PV 152,88,36
s_add_u32 s40, s40, 0x20000
CV 35,22,23
PV 156,92,36
s_add_u32 m0, s42, 0x2000
EX 25
v_smfmac_f32_16x16x64_bf16 a[244:247], v[56:59], v[32:39], v71
RK 0,60,8192
QK 16,32,192,40
RK 4,61,8192
CV 36,24,25
QK 16,36,196,16
EX 26
QK 16,40,200,16
buffer_load_dwordx4 v66, s[16:19], s40 offen lds
QK 16,44,204,16
RK 8,62,8192
RK 12,63,8192
QK 20,48,192,40
EX 27
QK 20,52,196,20
RK 16,60,12288
CV 37,26,27
QK 20,56,200,20
RK 20,61,12288
v_xor_b32 v60, s43, v60
QK 20,60,204,20
RK 24,62,12288
v_xor_b32 v61, s43, v61
PV 160,64,32
EX 28
PV 164,68,32
RK 28,63,12288
v_xor_b32 v62, s43, v62
PV 168,72,32
EX 29
PV 172,76,32
buffer_load_dwordx4 v67, s[16:19], s40 offen offset:1024 lds
PV 176,80,32
RV 64,64,8192
RV 66,64,12288
PV 180,84,32
EX 30
PV 184,88,32
RV 68,65,8192
CV 38,28,29
PV 188,92,32
RV 70,65,12288
v_xor_b32 v63, s43, v63
QK 24,32,208,44
s_add_u32 m0, s42, 0x12000
EX 31
QK 24,36,212,24
RV 72,64,8448
CV 39,30,31
QK 24,40,216,24
EX 16
QK 24,44,220,24
v_exp_f32_e64 v17, v17
QK 28,48,208,44
buffer_load_dwordx4 v68, s[20:23], s40 offen lds
QK 28,52,212,28
RV 74,64,12544
RV 76,65,8448
QK 28,56,216,28
RV 78,65,12544
CV 32,16,17
QK 28,60,220,28
EX 18
PV 224,96,36
v_exp_f32_e64 v19, v19
PV 228,100,36
RV 80,64,8704
RV 82,64,12800
PV 232,104,36
EX 20
PV 236,108,36
RV 84,65,8704
CV 33,18,19
PV 240,112,36
v_exp_f32_e64 v21, v21
PV 244,116,36
buffer_load_dwordx4 v69, s[20:23], s40 offen offset:1024 lds
PV 248,120,36
EX 22
PV 252,124,36
RV 86,65,12800
RV 88,64,8960
v_exp_f32_e64 v23, v23
CV 34,20,21
CV 35,22,23
EX 24
s_nop 0
v_smfmac_f32_16x16x64_bf16 a[252:255], v[56:59], v[32:39], v71
s_waitcnt lgkmcnt(13)
RV 90,64,13056
QK 16,0,176,52
RV 92,65,8960
v_xor_b32_e64 v64, s43, v64
QK 16,4,180,16
EX 25
QK 16,8,184,16
RV 94,65,13056
CV 36,24,25
QK 16,12,188,16
v_exp_f32_e64 v26, v26
QK 20,16,176,52
EX 27
QK 20,20,180,20
v_exp_f32_e64 v28, v28
QK 20,24,184,20
EX 29
QK 20,28,188,20
v_exp_f32_e64 v30, v30
PV 128,96,32
EX 31
PV 132,100,32
CV 37,26,27
CV 38,28,29
PV 136,104,32
CV 39,30,31
v_xor_b32_e64 v65, s43, v65
PV 140,108,32
PV 144,112,32
s_waitcnt vmcnt(8) lgkmcnt(0)
s_barrier
PV 148,116,32
s_mov_b32 s56, 4
L_t5_loop0:
PV 152,120,32
s_xor_b32 s41, s41, s43
EX 16
PV 156,124,32
s_xor_b32 s42, s41, 0xc000
RK 32,60,0
RK 36,61,0
QK 24,0,192,40
s_add_u32 s40, s40, 0x20000
EX 17
QK 24,4,196,24
s_add_u32 m0, s42, 0x0
RK 40,62,0
CV 32,16,17
QK 24,8,200,24
buffer_load_dwordx4 v66, s[16:19], s40 offen lds
QK 24,12,204,24
s_xor_b32 s43, s43, 0xc000
EX 18
QK 28,16,192,40
RK 44,63,0
RK 48,60,4096
QK 28,20,196,28
EX 19
QK 28,24,200,28
RK 52,61,4096
CV 33,18,19
QK 28,28,204,28
EX 20
PV 160,96,36
EX 21
PV 164,100,36
RK 56,62,4096
RK 60,63,4096
PV 168,104,36
EX 22
PV 172,108,36
buffer_load_dwordx4 v67, s[16:19], s40 offen offset:1024 lds
PV 176,112,36
EX 23
PV 180,116,36
CV 34,20,21
CV 35,22,23
PV 184,120,36
RV 96,64,0
RV 98,64,4096
PV 188,124,36
EX 24
v_smfmac_f32_16x16x64_bf16 a[240:243], v[56:59], v[32:39], v71
s_add_u32 m0, s42, 0x10000
RV 100,65,0
QK 16,0,208,44
EX 25
QK 16,4,212,16
RV 102,65,4096
RV 104,64,256
QK 16,8,216,16
RV 106,64,4352
CV 36,24,25
QK 16,12,220,16
buffer_load_dwordx4 v68, s[20:23], s40 offen lds
QK 20,16,208,44
EX 26
QK 20,20,212,20
EX 27
QK 20,24,216,20
RV 108,65,256
RV 110,65,4352
QK 20,28,220,20
RV 112,64,512
CV 37,26,27
PV 224,64,32
EX 28
PV 228,68,32
EX 29
PV 232,72,32
RV 114,64,4608
CV 38,28,29
PV 236,76,32
EX 30
PV 240,80,32
buffer_load_dwordx4 v69, s[20:23], s40 offen offset:1024 lds
PV 244,84,32
RV 116,65,512
RV 118,65,4608
PV 248,88,32
EX 31
PV 252,92,32
s_waitcnt lgkmcnt(12)
RV 120,64,768
CV 39,30,31
QK 24,32,176,52
EX 16
QK 24,36,180,24
RV 122,64,4864
RV 124,65,768
QK 24,40,184,24
EX 17
QK 24,44,188,24
RV 126,65,4864
CV 32,16,17
QK 28,48,176,52
EX 18
QK 28,52,180,28
EX 19
QK 28,56,184,28
EX 20
QK 28,60,188,28
EX 21
PV 128,64,36
EX 22
PV 132,68,36
EX 23
PV 136,72,36
CV 33,18,19
CV 34,20,21
PV 140,76,36
EX 24
PV 144,80,36
EX 25
PV 148,84,36
s_waitcnt lgkmcnt(0)
EX 26
PV 152,88,36
s_add_u32 s40, s40, 0x20000
CV 35,22,23
PV 156,92,36
s_add_u32 m0, s42, 0x2000
EX 27
v_smfmac_f32_16x16x64_bf16 a[244:247], v[56:59], v[32:39], v71
RK 0,60,8192
QK 16,32,192,40
RK 4,61,8192
CV 36,24,25
QK 16,36,196,16
RK 8,62,8192
CV 37,26,27
QK 16,40,200,16
buffer_load_dwordx4 v66, s[16:19], s40 offen lds
QK 16,44,204,16
EX 28
QK 20,48,192,40
RK 12,63,8192
RK 16,60,12288
QK 20,52,196,20
EX 29
QK 20,56,200,20
RK 20,61,12288
CV 38,28,29
QK 20,60,204,20
RK 24,62,12288
v_xor_b32 v60, s43, v60
PV 160,64,32
EX 30
PV 164,68,32
RK 28,63,12288
v_xor_b32 v61, s43, v61
PV 168,72,32
EX 31
PV 172,76,32
buffer_load_dwordx4 v67, s[16:19], s40 offen offset:1024 lds
PV 176,80,32
RV 64,64,8192
RV 66,64,12288
PV 180,84,32
CV 39,30,31
v_xor_b32 v62, s43, v62
PV 184,88,32
RV 68,65,8192
v_xor_b32 v63, s43, v63
PV 188,92,32
EX 16
QK 24,32,208,44
s_add_u32 m0, s42, 0x12000
EX 17
QK 24,36,212,24
RV 70,65,12288
RV 72,64,8448
QK 24,40,216,24
EX 18
QK 24,44,220,24
RV 74,64,12544
CV 32,16,17
QK 28,48,208,44
buffer_load_dwordx4 v68, s[20:23], s40 offen lds
QK 28,52,212,28
EX 19
QK 28,56,216,28
RV 76,65,8448
RV 78,65,12544
QK 28,60,220,28
EX 20
PV 224,96,36
RV 80,64,8704
CV 33,18,19
PV 228,100,36
EX 21
PV 232,104,36
RV 82,64,12800
CV 34,20,21
PV 236,108,36
EX 22
PV 240,112,36
EX 23
PV 244,116,36
buffer_load_dwordx4 v69, s[20:23], s40 offen offset:1024 lds
PV 248,120,36
RV 84,65,8704
CV 35,22,23
PV 252,124,36
RV 86,65,12800
RV 88,64,8960
v_smfmac_f32_16x16x64_bf16 a[252:255], v[56:59], v[32:39], v71
s_waitcnt lgkmcnt(13)
RV 90,64,13056
QK 16,0,176,52
RV 92,65,8960
v_xor_b32 v64, s43, v64
QK 16,4,180,16
EX 24
QK 16,8,184,16
EX 25
QK 16,12,188,16
RV 94,65,13056
CV 36,24,25
QK 20,16,176,52
EX 26
QK 20,20,180,20
EX 27
QK 20,24,184,20
CV 37,26,27
v_xor_b32 v65, s43, v65
QK 20,28,188,20
EX 28
PV 128,96,32
EX 29
PV 132,100,32
EX 30
PV 136,104,32
EX 31
PV 140,108,32
CV 38,28,29
CV 39,30,31
PV 144,112,32
s_waitcnt vmcnt(8) lgkmcnt(0)
s_barrier
PV 148,116,32
s_sub_u32 s56, s56, 1
s_cbranch_scc0 L_t5_loop0
PV 152,120,32
s_xor_b32 s41, s41, s43
EX 16
PV 156,124,32
s_xor_b32 s43, s43, 0xc000
RK 32,60,0
RK 36,61,0
QK 24,0,192,40
s_xor_b32 s42, s41, 0xc000
EX 17
QK 24,4,196,24
RK 40,62,0
CV 32,16,17
QK 24,8,200,24
EX 18
QK 24,12,204,24
EX 19
QK 28,16,192,40
RK 44,63,0
RK 48,60,4096
QK 28,20,196,28
EX 20
QK 28,24,200,28
RK 52,61,4096
CV 33,18,19
QK 28,28,204,28
EX 21
PV 160,96,36
RK 56,62,4096
CV 34,20,21
PV 164,100,36
EX 22
PV 168,104,36
EX 23
PV 172,108,36
RK 60,63,4096
RV 96,64,0
PV 176,112,36
EX 24
PV 180,116,36
RV 98,64,4096
CV 35,22,23
PV 184,120,36
EX 25
PV 188,124,36
EX 26
v_smfmac_f32_16x16x64_bf16 a[240:243], v[56:59], v[32:39], v71
RV 100,65,0
QK 16,0,208,44
RV 102,65,4096
CV 36,24,25
QK 16,4,212,16
EX 27
QK 16,8,216,16
RV 104,64,256
RV 106,64,4352
QK 16,12,220,16
EX 28
QK 20,16,208,44
RV 108,65,256
CV 37,26,27
QK 20,20,212,20
EX 29
QK 20,24,216,20
RV 110,65,4352
CV 38,28,29
QK 20,28,220,20
EX 30
PV 224,64,32
EX 31
PV 228,68,32
RV 112,64,512
RV 114,64,4608
PV 232,72,32
EX 16
PV 236,76,32
RV 116,65,512
CV 39,30,31
PV 240,80,32
EX 17
PV 244,84,32
EX 18
PV 248,88,32
RV 118,65,4608
RV 120,64,768
PV 252,92,32
s_waitcnt lgkmcnt(13)
EX 19
QK 24,32,176,52
RV 122,64,4864
CV 32,16,17
QK 24,36,180,24
RV 124,65,768
CV 33,18,19
QK 24,40,184,24
EX 20
QK 24,44,188,24
EX 21
QK 28,48,176,52
RV 126,65,4864
CV 34,20,21
QK 28,52,180,28
EX 22
QK 28,56,184,28
EX 23
QK 28,60,188,28
CV 35,22,23
PV 128,64,36
PV 132,68,36
EX 24
PV 136,72,36
PV 140,76,36
EX 25
PV 144,80,36
PV 148,84,36
s_waitcnt lgkmcnt(0)
EX 26
PV 152,88,36
PV 156,92,36
EX 27
v_smfmac_f32_16x16x64_bf16 a[244:247], v[56:59], v[32:39], v71
RK 0,60,8192
QK 16,32,192,40
RK 4,61,8192
CV 36,24,25
QK 16,36,196,16
RK 8,62,8192
CV 37,26,27
QK 16,40,200,16
EX 28
QK 16,44,204,16
EX 29
QK 20,48,192,40
RK 12,63,8192
RK 16,60,12288
QK 20,52,196,20
EX 30
QK 20,56,200,20
RK 20,61,12288
CV 38,28,29
QK 20,60,204,20
RK 24,62,12288
v_xor_b32 v60, s43, v60
PV 160,64,32
EX 31
PV 164,68,32
RK 28,63,12288
CV 39,30,31
PV 168,72,32
EX 16
PV 172,76,32
RV 64,64,8192
v_xor_b32 v61, s43, v61
PV 176,80,32
RV 66,64,12288
v_xor_b32 v62, s43, v62
PV 180,84,32
EX 17
PV 184,88,32
RV 68,65,8192
v_xor_b32 v63, s43, v63
PV 188,92,32
RV 70,65,12288
CV 32,16,17
QK 24,32,208,44
EX 18
QK 24,36,212,24
EX 19
QK 24,40,216,24
RV 72,64,8448
CV 33,18,19
QK 24,44,220,24
EX 20
QK 28,48,208,44
RV 74,64,12544
RV 76,65,8448
QK 28,52,212,28
EX 21
QK 28,56,216,28
RV 78,65,12544
CV 34,20,21
QK 28,60,220,28
EX 22
PV 224,96,36
EX 23
PV 228,100,36
RV 80,64,8704
RV 82,64,12800
PV 232,104,36
EX 24
PV 236,108,36
L_t5_pad7:
s_cbranch_execz L_t5_go
RV 84,65,8704
CV 35,22,23
PV 240,112,36
EX 25
PV 244,116,36
EX 26
PV 248,120,36
RV 86,65,12800
RV 88,64,8960
PV 252,124,36
EX 27
v_smfmac_f32_16x16x64_bf16 a[252:255], v[56:59], v[32:39], v71
s_waitcnt lgkmcnt(13)
RV 90,64,13056
QK 16,0,176,52
RV 92,65,8960
CV 36,24,25
QK 16,4,180,16
CV 37,26,27
v_xor_b32 v64, s43, v64
QK 16,8,184,16
EX 28
QK 16,12,188,16
EX 29
QK 20,16,176,52
RV 94,65,13056
CV 38,28,29
QK 20,20,180,20
EX 30
QK 20,24,184,20
EX 31
QK 20,28,188,20
CV 39,30,31
v_xor_b32 v65, s43, v65
PV 128,96,32
EX 16
PV 132,100,32
PV 136,104,32
EX 17
PV 140,108,32
PV 144,112,32
s_waitcnt vmcnt(0) lgkmcnt(0)
s_barrier
PV 148,116,32
EX 18
PV 152,120,32
s_xor_b32 s41, s41, s43
EX 19
PV 156,124,32
s_xor_b32 s42, s41, 0xc000
RK 32,60,0
RK 36,61,0
QK 24,0,192,40
s_xor_b32 s43, s43, 0xc000
EX 20
QK 24,4,196,24
RK 40,62,0
CV 32,16,17
QK 24,8,200,24
EX 21
QK 24,12,204,24
RK 44,63,0
CV 33,18,19
QK 28,16,192,40
RK 48,60,4096
CV 34,20,21
QK 28,20,196,28
EX 22
QK 28,24,200,28
EX 23
QK 28,28,204,28
RK 52,61,4096
CV 35,22,23
PV 160,96,36
RK 56,62,4096
PV 164,100,36
EX 24
PV 168,104,36
RK 60,63,4096
PV 172,108,36
EX 25
PV 176,112,36
RV 96,64,0
PV 180,116,36
EX 26
PV 184,120,36
RV 98,64,4096
RV 100,65,0
PV 188,124,36
EX 27
v_smfmac_f32_16x16x64_bf16 a[240:243], v[56:59], v[32:39], v71
RV 102,65,4096
QK 16,0,208,44
CV 36,24,25
CV 37,26,27
QK 16,4,212,16
EX 28
QK 16,8,216,16
RV 104,64,256
RV 106,64,4352
QK 16,12,220,16
EX 29
QK 20,16,208,44
RV 108,65,256
CV 38,28,29
QK 20,20,212,20
EX 30
QK 20,24,216,20
EX 31
QK 20,28,220,20
RV 110,65,4352
RV 112,64,512
PV 224,64,32
EX 16
PV 228,68,32
RV 114,64,4608
CV 39,30,31
PV 232,72,32
EX 17
PV 236,76,32
RV 116,65,512
PV 240,80,32
EX 18
PV 244,84,32
RV 118,65,4608
PV 248,88,32
EX 19
PV 252,92,32
s_waitcnt lgkmcnt(12)
RV 120,64,768
CV 32,16,17
QK 24,32,176,52
RV 122,64,4864
CV 33,18,19
QK 24,36,180,24
EX 20
QK 24,40,184,24
EX 21
QK 24,44,188,24
RV 124,65,768
RV 126,65,4864
QK 28,48,176,52
EX 22
QK 28,52,180,28
CV 34,20,21
QK 28,56,184,28
EX 23
QK 28,60,188,28
CV 35,22,23
PV 128,64,36
PV 132,68,36
EX 24
PV 136,72,36
PV 140,76,36
EX 25
PV 144,80,36
PV 148,84,36
s_waitcnt lgkmcnt(0)
EX 26
PV 152,88,36
PV 156,92,36
EX 27
v_smfmac_f32_16x16x64_bf16 a[244:247], v[56:59], v[32:39], v71
RK 0,60,8192
QK 16,32,192,40
RK 4,61,8192
CV 36,24,25
QK 16,36,196,16
RK 8,62,8192
CV 37,26,27
QK 16,40,200,16
EX 28
QK 16,44,204,16
EX 29
QK 20,48,192,40
RK 12,63,8192
RK 16,60,12288
QK 20,52,196,20
EX 30
QK 20,56,200,20
RK 20,61,12288
CV 38,28,29
QK 20,60,204,20
EX 31
PV 160,64,32
RK 24,62,12288
CV 39,30,31
PV 164,68,32
EX 16
PV 168,72,32
EX 17
PV 172,76,32
RK 28,63,12288
RV 64,64,8192
PV 176,80,32
EX 18
PV 180,84,32
RV 66,64,12288
PV 184,88,32
EX 19
PV 188,92,32
RV 68,65,8192
RV 70,65,12288
QK 24,32,208,44
EX 20
QK 24,36,212,24
RV 72,64,8448
CV 32,16,17
QK 24,40,216,24
EX 21
QK 24,44,220,24
RV 74,64,12544
CV 33,18,19
QK 28,48,208,44
RV 76,65,8448
CV 34,20,21
QK 28,52,212,28
EX 22
QK 28,56,216,28
EX 23
QK 28,60,220,28
RV 78,65,12544
CV 35,22,23
PV 224,96,36
RV 80,64,8704
PV 228,100,36
EX 24
PV 232,104,36
RV 82,64,12800
PV 236,108,36
EX 25
PV 240,112,36
RV 84,65,8704
RV 86,65,12800
PV 244,116,36
EX 26
PV 248,120,36
RV 88,64,8960
PV 252,124,36
EX 27
v_smfmac_f32_16x16x64_bf16 a[252:255], v[56:59], v[32:39], v71
s_waitcnt lgkmcnt(13)
RV 90,64,13056
QK 16,0,176,52
RV 92,65,8960
CV 36,24,25
QK 16,4,180,16
EX 28
QK 16,8,184,16
RV 94,65,13056
CV 37,26,27
QK 16,12,188,16
EX 29
QK 20,16,176,52
v_accvgpr_read_b32 v79, a254
v_accvgpr_read_b32 v76, a252
QK 20,20,180,20
v_accvgpr_read_b32 v52, a255
CV 38,28,29
QK 20,24,184,20
EX 30
QK 20,28,188,20
EX 31
PV 128,96,32
v_add_f32 v79, v79, v52
CV 39,30,31
PV 132,100,32
EX 16
PV 136,104,32
EX 17
PV 140,108,32
EX 18
PV 144,112,32
s_waitcnt lgkmcnt(0)
EX 19
PV 148,116,32
EX 20
PV 152,120,32
EX 21
PV 156,124,32
EX 22
QK 24,0,192,40
EX 23
QK 24,4,196,24
CV 32,16,17
CV 33,18,19
QK 24,8,200,24
CV 34,20,21
CV 35,22,23
QK 24,12,204,24
QK 28,16,192,40
QK 28,20,196,28
QK 28,24,200,28
s_nop 0
v_accvgpr_read_b32 v40, a253
QK 28,28,204,28
v_add_f32 v76, v76, v40
PV 160,96,36
PV 164,100,36
EX 24
PV 168,104,36
EX 25
PV 172,108,36
EX 26
PV 176,112,36
EX 27
PV 180,116,36
EX 28
PV 184,120,36
EX 29
PV 188,124,36
EX 30
v_smfmac_f32_16x16x64_bf16 a[240:243], v[56:59], v[32:39], v71
CV 36,24,25
QK 16,0,208,44
EX 31
QK 16,4,212,16
CV 37,26,27
CV 38,28,29
QK 16,8,216,16
CV 39,30,31
s_nop 0
QK 16,12,220,16
s_nop 0
QK 20,16,208,44
v_accvgpr_read_b32 v53, a240
v_accvgpr_read_b32 v54, a241
QK 20,20,212,20
v_add_f32 v79, v79, v53
v_accvgpr_read_b32 v77, a242
QK 20,24,216,20
v_add_f32 v79, v79, v54
v_accvgpr_read_b32 v44, a243
QK 20,28,220,20
s_add_u32 s49, s45, 0x0
v_cmp_nge_f32 s[10:11], s55, v79
v_add_f32 v77, v77, v44
PV 224,64,32
v_rcp_f32 v79, v79
PV 228,68,32
EX 16
PV 232,72,32
EX 17
PV 236,76,32
EX 18
EX 19
EX 20
PM 224,78,1
PM 226,78,1
PV 240,80,32
CV 224,224,225
CV 225,226,227
EX 21
EX 22
PM 228,78,1
PM 230,78,1
PV 244,84,32
ds_write_b64 v70, v[224:225] offset:0
CV 228,228,229
CV 229,230,231
PM 232,78,1
PM 234,78,1
PV 248,88,32
ds_write_b64 v70, v[228:229] offset:32
CV 232,232,233
CV 233,234,235
PM 236,78,1
PM 238,78,1
PV 252,92,32
ds_write_b64 v70, v[232:233] offset:64
CV 236,236,237
CV 237,238,239
PM 240,78,1
PM 242,78,1
v_exp_f32_e64 v23, v23
CV 32,16,17
CV 33,18,19
CV 34,20,21
CV 35,22,23
CV 240,240,241
CV 241,242,243
v_smfmac_f32_16x16x64_bf16 a[244:247], v[56:59], v[32:39], v71
s_add_u32 s50, s45, 0x10000
ds_write_b64 v70, v[236:237] offset:96
PM 244,78,1
PM 246,78,1
PV 128,64,36
ds_write_b64 v70, v[240:241] offset:128
CV 244,244,245
CV 245,246,247
PM 248,78,1
PM 250,78,1
PV 132,68,36
ds_write_b64 v70, v[244:245] offset:160
v_accvgpr_read_b32 v41, a246
v_accvgpr_read_b32 v42, a247
v_add_f32 v76, v76, v41
v_accvgpr_read_b32 v45, a244
v_add_f32 v76, v76, v42
v_add_f32 v77, v77, v45
v_cmp_nge_f32 s[96:97], s55, v76
v_rcp_f32 v76, v76
v_accvgpr_read_b32 v46, a245
CV 248,248,249
v_add_f32 v77, v77, v46
CV 249,250,251
v_cmp_nge_f32 s[98:99], s55, v77
v_rcp_f32 v77, v77
PM 252,78,1
PM 254,78,1
PV 136,72,36
ds_write_b64 v70, v[248:249] offset:192
CV 252,252,253
CV 253,254,255
PV 140,76,36
ds_write_b64 v70, v[252:253] offset:224
RK 176,15,0
RK 180,15,528
PM 128,76,0
RK 184,15,1056
PM 130,76,0
PV 144,80,36
RK 188,15,1584
CV 128,128,129
CV 129,130,131
PM 132,76,0
PM 134,76,0
PV 148,84,36
ds_write_b64 v70, v[128:129] offset:0
CV 132,132,133
CV 133,134,135
PM 136,76,0
PM 138,76,0
PV 152,88,36
s_waitcnt lgkmcnt(4)
ds_write_b64 v70, v[132:133] offset:32
buffer_store_dwordx4 a[176:179], v72, s[36:39], s49 offen nt
CV 136,136,137
CV 137,138,139
PM 140,76,0
PM 142,76,0
PV 156,92,36
s_add_u32 s51, s45, 0x20000
ds_write_b64 v70, v[136:137] offset:64
CV 140,140,141
CV 141,142,143
PM 144,76,0
PM 146,76,0
PV 160,64,32
s_waitcnt lgkmcnt(5)
buffer_store_dwordx4 a[180:183], v73, s[36:39], s49 offen nt
ds_write_b64 v70, v[140:141] offset:96
CV 144,144,145
CV 145,146,147
PM 148,76,0
PM 150,76,0
PV 164,68,32
s_waitcnt lgkmcnt(5)
ds_write_b64 v70, v[144:145] offset:128
buffer_store_dwordx4 a[184:187], v74, s[36:39], s49 offen nt
CV 148,148,149
CV 149,150,151
PM 152,76,0
PM 154,76,0
PV 168,72,32
ds_write_b64 v70, v[148:149] offset:160
CV 152,152,153
CV 153,154,155
PM 156,76,0
PM 158,76,0
PV 172,76,32
s_waitcnt lgkmcnt(6)
buffer_store_dwordx4 a[188:191], v75, s[36:39], s49 offen nt
ds_write_b64 v70, v[152:153] offset:192
CV 156,156,157
PM 160,76,1
CV 157,158,159
PM 162,76,1
PV 176,80,32
ds_write_b64 v70, v[156:157] offset:224
RK 192,15,0
RK 196,15,528
CV 160,160,161
RK 200,15,1056
CV 161,162,163
RK 204,15,1584
PM 164,76,1
PM 166,76,1
PV 180,84,32
ds_write_b64 v70, v[160:161] offset:0
CV 164,164,165
CV 165,166,167
PM 168,76,1
PM 170,76,1
PV 184,88,32
ds_write_b64 v70, v[164:165] offset:32
CV 168,168,169
CV 169,170,171
PM 172,76,1
PM 174,76,1
PV 188,92,32
s_waitcnt lgkmcnt(5)
ds_write_b64 v70, v[168:169] offset:64
buffer_store_dwordx4 a[192:195], v72, s[36:39], s50 offen nt
CV 172,172,173
CV 173,174,175
ds_write_b64 v70, v[172:173] offset:96
PM 176,76,1
PM 178,76,1
CV 176,176,177
CV 177,178,179
ds_write_b64 v70, v[176:177] offset:128
s_waitcnt lgkmcnt(7)
buffer_store_dwordx4 a[196:199], v73, s[36:39], s50 offen nt
PM 180,76,1
PM 182,76,1
CV 180,180,181
CV 181,182,183
ds_write_b64 v70, v[180:181] offset:160
PM 184,76,1
PM 186,76,1
CV 184,184,185
CV 185,186,187
ds_write_b64 v70, v[184:185] offset:192
s_waitcnt lgkmcnt(8)
buffer_store_dwordx4 a[200:203], v74, s[36:39], s50 offen nt
PM 188,76,1
PM 190,76,1
CV 188,188,189
CV 189,190,191
ds_write_b64 v70, v[188:189] offset:224
RK 208,15,0
RK 212,15,528
s_waitcnt lgkmcnt(10)
buffer_store_dwordx4 a[204:207], v75, s[36:39], s50 offen nt
RK 216,15,1056
RK 220,15,1584
s_waitcnt lgkmcnt(3)
buffer_store_dwordx4 a[208:211], v72, s[36:39], s51 offen nt
s_waitcnt lgkmcnt(2)
buffer_store_dwordx4 a[212:215], v73, s[36:39], s51 offen nt
s_waitcnt lgkmcnt(1)
buffer_store_dwordx4 a[216:219], v74, s[36:39], s51 offen nt
s_waitcnt lgkmcnt(0)
buffer_store_dwordx4 a[220:223], v75, s[36:39], s51 offen nt
s_cmp_lg_u64 s[4:5], 0
s_cselect_b32 s62, 1, 0
s_or_b32 s54, s54, s62
s_cmp_lg_u64 s[6:7], 0
s_cselect_b32 s62, 2, 0
s_or_b32 s54, s54, s62
s_cmp_lg_u64 s[8:9], 0
s_cselect_b32 s62, 4, 0
s_or_b32 s54, s54, s62
s_cmp_lg_u64 s[10:11], 0
s_cselect_b32 s62, 16, 0
s_or_b32 s54, s54, s62
s_cmp_lg_u64 s[96:97], 0
s_cselect_b32 s62, 32, 0
s_or_b32 s54, s54, s62
s_cmp_lg_u64 s[98:99], 0
s_cselect_b32 s62, 64, 0
s_or_b32 s54, s54, s62
s_cbranch_scc0 L_done5
s_mov_b32 s4, 0xa17000
s_mov_b32 s5, 606
s_mov_b32 s6, 0x11a0000
s_mov_b32 s7, 570
s_getpc_b64 s[62:63]
L_fpc5:
s_add_u32 s62, s62, L_fallback-L_fpc5
s_addc_u32 s63, s63, 0
s_setpc_b64 s[62:63]
L_done5:
s_endpgm
L_end5:
.p2align 12
L_type6:
s_mov_b64 exec, 0
s_cmp_eq_u32 s12, 0
s_cbranch_scc1 L_t6_pad1
s_cmp_eq_u32 s12, 1
s_cbranch_scc1 L_t6_pad2
s_cmp_eq_u32 s12, 2
s_cbranch_scc1 L_t6_pad3
s_branch L_t6_pad4
L_t6_go:
s_mov_b64 exec, -1
s_add_u32 m0, s47, 0x10000
s_add_u32 s49, s44, 0x10000
s_add_u32 s50, s44, 0x20000
s_add_u32 s51, s44, 0x30000
s_waitcnt vmcnt(3)
buffer_load_dwordx4 v68, s[20:23], s40 offen lds
s_barrier
v_lshlrev_b32 v0, 16, v128
RK 0,60,0
RK 4,61,0
v_and_b32 v1, s71, v128
RK 8,62,0
v_lshlrev_b32 v2, 16, v129
buffer_load_dwordx4 v69, s[20:23], s40 offen offset:1024 lds
RK 12,63,0
s_mov_b32 s40, 0xe00000
s_add_u32 m0, s47, 0x2000
v_and_b32 v3, s71, v129
v_lshlrev_b32 v4, 16, v130
v_and_b32 v5, s71, v130
v_lshlrev_b32 v6, 16, v131
v_and_b32_e64 v7, s71, v131
v_pk_mul_f32 v[0:1], v[0:1], s[14:15]
v_pk_mul_f32 v[2:3], v[2:3], s[14:15]
buffer_load_dwordx4 v[160:163], v72, s[24:27], s49 offen nt
v_pk_mul_f32 v[4:5], v[4:5], s[14:15]
v_pk_mul_f32 v[6:7], v[6:7], s[14:15]
CV 128,0,1
CV 129,2,3
CV 130,4,5
CV 131,6,7
ds_write_b128 v15, v[128:131] offset:0
buffer_load_dwordx4 v[164:167], v73, s[24:27], s49 offen nt
s_waitcnt vmcnt(6)
v_lshlrev_b32 v0, 16, v132
v_and_b32 v1, s71, v132
v_lshlrev_b32 v2, 16, v133
v_and_b32 v3, s71, v133
v_lshlrev_b32 v4, 16, v134
v_and_b32 v5, s71, v134
v_lshlrev_b32 v6, 16, v135
v_and_b32_e64 v7, s71, v135
v_pk_mul_f32 v[0:1], v[0:1], s[14:15]
v_pk_mul_f32 v[2:3], v[2:3], s[14:15]
buffer_load_dwordx4 v[168:171], v74, s[24:27], s49 offen nt
v_pk_mul_f32 v[4:5], v[4:5], s[14:15]
v_pk_mul_f32 v[6:7], v[6:7], s[14:15]
CV 132,0,1
CV 133,2,3
CV 134,4,5
CV 135,6,7
ds_write_b128 v15, v[132:135] offset:544
buffer_load_dwordx4 v[172:175], v75, s[24:27], s49 offen nt
s_waitcnt vmcnt(7)
v_lshlrev_b32 v0, 16, v136
v_and_b32 v1, s71, v136
v_lshlrev_b32 v2, 16, v137
v_and_b32 v3, s71, v137
v_lshlrev_b32 v4, 16, v138
v_and_b32 v5, s71, v138
v_lshlrev_b32 v6, 16, v139
v_and_b32_e64 v7, s71, v139
v_pk_mul_f32 v[0:1], v[0:1], s[14:15]
v_pk_mul_f32 v[2:3], v[2:3], s[14:15]
v_pk_mul_f32 v[4:5], v[4:5], s[14:15]
v_pk_mul_f32 v[6:7], v[6:7], s[14:15]
CV 136,0,1
CV 137,2,3
CV 138,4,5
CV 139,6,7
ds_write_b128 v15, v[136:139] offset:1152
s_waitcnt vmcnt(6)
v_lshlrev_b32 v0, 16, v140
v_and_b32 v1, s71, v140
v_lshlrev_b32 v2, 16, v141
v_and_b32 v3, s71, v141
v_lshlrev_b32 v4, 16, v142
v_and_b32 v5, s71, v142
v_lshlrev_b32 v6, 16, v143
v_and_b32_e64 v7, s71, v143
v_pk_mul_f32 v[0:1], v[0:1], s[14:15]
v_pk_mul_f32 v[2:3], v[2:3], s[14:15]
v_pk_mul_f32 v[4:5], v[4:5], s[14:15]
v_pk_mul_f32 v[6:7], v[6:7], s[14:15]
CV 140,0,1
CV 141,2,3
CV 142,4,5
CV 143,6,7
ds_write_b128 v15, v[140:143] offset:1696
RK 128,14,0
v_subrev_u32 v12, 0x20000, v71
v_subrev_u32 v13, 0x10000, v71
v_ashrrev_i32 v12, 31, v12
v_ashrrev_i32 v13, 31, v13
v_not_b32 v12, v12
v_not_b32 v13, v13
v_and_b32 v12, 0xff800000, v12
v_and_b32 v13, 0xff800000, v13
RK 132,14,64
RK 136,14,128
v_accvgpr_write_b32 a240, 0
v_accvgpr_write_b32 a241, 0
RK 140,14,192
v_accvgpr_write_b32 a242, 0
v_accvgpr_write_b32 a243, 0
v_accvgpr_write_b32 a244, 0
v_accvgpr_write_b32 a245, 0
s_waitcnt lgkmcnt(3)
QZ 16,0,128
v_accvgpr_write_b32 a246, 0
v_accvgpr_write_b32 a247, 0
s_waitcnt lgkmcnt(2)
QK 16,4,132,16
s_waitcnt lgkmcnt(1)
QK 16,8,136,16
s_waitcnt lgkmcnt(0)
QK 16,12,140,16
v_mov_b32 v34, 0
v_mov_b32 v35, 0
s_nop 5
v_max3_f32 v8, v16, v17, v18
v_max_f32 v8, v8, v19
v_mov_b32 v9, v8
s_nop 1
v_permlane32_swap_b32 v8, v9
v_max_f32 v8, v8, v9
v_mov_b32 v9, v8
s_nop 1
v_permlane16_swap_b32 v8, v9
v_min_f32_e64 v40, -v8, -v9
v_add_f32 v8, v40, v12
v_add_f32 v9, v40, v13
v_add_f32 v16, v8, v16
v_add_f32 v17, v8, v17
v_add_f32 v18, v9, v18
v_add_f32 v19, v9, v19
EX 16
EX 17
EX 18
EX 19
CV 32,16,17
CV 33,18,19
v_mov_b32 v41, v40
s_waitcnt vmcnt(3)
buffer_load_dwordx4 v[192:195], v72, s[24:27], s50 offen nt
s_barrier
v_lshlrev_b32 v0, 16, v160
RV 64,64,0
RV 66,64,4096
v_and_b32 v1, s71, v160
RV 68,65,0
buffer_load_dwordx4 v[196:199], v73, s[24:27], s50 offen nt
RV 70,65,4096
RV 72,64,256
v_lshlrev_b32 v2, 16, v161
RV 74,64,4352
RV 76,65,256
v_and_b32 v3, s71, v161
RV 78,65,4352
v_lshlrev_b32 v4, 16, v162
buffer_load_dwordx4 v[200:203], v74, s[24:27], s50 offen nt
RV 80,64,512
RV 82,64,4608
v_and_b32 v5, s71, v162
RV 84,65,512
RV 86,65,4608
v_lshlrev_b32_e64 v6, 16, v163
RV 88,64,768
RV 90,64,4864
buffer_load_dwordx4 v[204:207], v75, s[24:27], s50 offen nt
RV 92,65,768
v_and_b32_e64 v7, s71, v163
RV 94,65,4864
v_pk_mul_f32 v[0:1], v[0:1], s[14:15]
v_pk_mul_f32 v[2:3], v[2:3], s[14:15]
v_pk_mul_f32 v[4:5], v[4:5], s[14:15]
v_pk_mul_f32 v[6:7], v[6:7], s[14:15]
CV 160,0,1
CV 161,2,3
CV 162,4,5
CV 163,6,7
ds_write_b128 v15, v[160:163] offset:0
s_waitcnt vmcnt(6)
v_lshlrev_b32 v0, 16, v164
v_and_b32 v1, s71, v164
v_lshlrev_b32 v2, 16, v165
v_and_b32 v3, s71, v165
v_lshlrev_b32 v4, 16, v166
v_and_b32 v5, s71, v166
v_lshlrev_b32 v6, 16, v167
v_and_b32_e64 v7, s71, v167
v_pk_mul_f32 v[0:1], v[0:1], s[14:15]
v_pk_mul_f32 v[2:3], v[2:3], s[14:15]
v_pk_mul_f32 v[4:5], v[4:5], s[14:15]
v_pk_mul_f32 v[6:7], v[6:7], s[14:15]
CV 164,0,1
CV 165,2,3
CV 166,4,5
CV 167,6,7
ds_write_b128 v15, v[164:167] offset:544
s_waitcnt vmcnt(5)
v_lshlrev_b32 v0, 16, v168
v_and_b32 v1, s71, v168
v_lshlrev_b32 v2, 16, v169
v_and_b32 v3, s71, v169
v_lshlrev_b32 v4, 16, v170
v_and_b32 v5, s71, v170
v_lshlrev_b32 v6, 16, v171
v_and_b32_e64 v7, s71, v171
v_pk_mul_f32 v[0:1], v[0:1], s[14:15]
v_pk_mul_f32 v[2:3], v[2:3], s[14:15]
v_pk_mul_f32 v[4:5], v[4:5], s[14:15]
v_pk_mul_f32 v[6:7], v[6:7], s[14:15]
CV 168,0,1
CV 169,2,3
CV 170,4,5
CV 171,6,7
ds_write_b128 v15, v[168:171] offset:1152
s_waitcnt vmcnt(4)
v_lshlrev_b32 v0, 16, v172
v_and_b32 v1, s71, v172
v_lshlrev_b32 v2, 16, v173
v_and_b32 v3, s71, v173
v_lshlrev_b32 v4, 16, v174
v_and_b32 v5, s71, v174
v_lshlrev_b32 v6, 16, v175
v_and_b32_e64 v7, s71, v175
v_pk_mul_f32 v[0:1], v[0:1], s[14:15]
v_pk_mul_f32 v[2:3], v[2:3], s[14:15]
v_pk_mul_f32 v[4:5], v[4:5], s[14:15]
v_pk_mul_f32 v[6:7], v[6:7], s[14:15]
CV 172,0,1
CV 173,2,3
CV 174,4,5
CV 175,6,7
s_waitcnt lgkmcnt(15)
PZ 128,64,32
ds_write_b128 v15, v[172:175] offset:1696
PZ 132,68,32
s_waitcnt lgkmcnt(14)
RK 144,14,0
RK 148,14,64
PZ 136,72,32
s_waitcnt lgkmcnt(14)
RK 152,14,128
v_mov_b32 v42, v40
PZ 140,76,32
s_waitcnt lgkmcnt(13)
RK 156,14,192
v_mov_b32 v43, v40
PZ 144,80,32
s_waitcnt lgkmcnt(12)
PZ 148,84,32
s_waitcnt lgkmcnt(10)
PZ 152,88,32
s_waitcnt lgkmcnt(8)
PZ 156,92,32
s_waitcnt lgkmcnt(3)
QZ 24,0,144
s_waitcnt lgkmcnt(2)
QK 24,4,148,24
s_waitcnt lgkmcnt(1)
QK 24,8,152,24
s_waitcnt lgkmcnt(0)
QK 24,12,156,24
v_mov_b32 v38, 0
v_mov_b32 v39, 0
s_nop 5
v_max3_f32 v10, v24, v25, v26
v_max_f32 v10, v10, v27
v_mov_b32 v11, v10
s_nop 1
v_permlane32_swap_b32 v10, v11
v_max_f32 v10, v10, v11
v_mov_b32 v11, v10
s_nop 1
v_permlane16_swap_b32 v10, v11
v_min_f32_e64 v44, -v10, -v11
v_add_f32 v10, v44, v12
v_add_f32 v11, v44, v13
v_add_f32 v24, v10, v24
v_add_f32 v25, v10, v25
v_add_f32 v26, v11, v26
v_add_f32 v27, v11, v27
EX 24
EX 25
EX 26
EX 27
CV 36,24,25
CV 37,26,27
v_mov_b32 v45, v44
s_waitcnt vmcnt(3)
buffer_load_dwordx4 v[224:227], v72, s[24:27], s51 offen nt
v_lshlrev_b32 v0, 16, v192
v_and_b32 v1, s71, v192
v_lshlrev_b32 v2, 16, v193
v_and_b32 v3, s71, v193
v_lshlrev_b32 v4, 16, v194
v_and_b32 v5, s71, v194
v_lshlrev_b32 v6, 16, v195
v_and_b32 v7, s71, v195
buffer_load_dwordx4 v[228:231], v73, s[24:27], s51 offen nt
v_pk_mul_f32 v[0:1], v[0:1], s[14:15]
v_pk_mul_f32 v[2:3], v[2:3], s[14:15]
v_pk_mul_f32 v[4:5], v[4:5], s[14:15]
v_pk_mul_f32 v[6:7], v[6:7], s[14:15]
CV 192,0,1
CV 193,2,3
CV 194,4,5
CV 195,6,7
ds_write_b128 v15, v[192:195] offset:0
buffer_load_dwordx4 v[232:235], v74, s[24:27], s51 offen nt
s_waitcnt vmcnt(5)
v_lshlrev_b32 v0, 16, v196
v_and_b32 v1, s71, v196
v_lshlrev_b32 v2, 16, v197
v_and_b32 v3, s71, v197
v_lshlrev_b32 v4, 16, v198
v_and_b32 v5, s71, v198
v_lshlrev_b32 v6, 16, v199
v_and_b32_e64 v7, s71, v199
v_pk_mul_f32 v[0:1], v[0:1], s[14:15]
v_pk_mul_f32 v[2:3], v[2:3], s[14:15]
buffer_load_dwordx4 v[236:239], v75, s[24:27], s51 offen nt
v_pk_mul_f32 v[4:5], v[4:5], s[14:15]
v_pk_mul_f32 v[6:7], v[6:7], s[14:15]
CV 196,0,1
CV 197,2,3
CV 198,4,5
CV 199,6,7
ds_write_b128 v15, v[196:199] offset:544
s_waitcnt vmcnt(5)
v_lshlrev_b32 v0, 16, v200
v_and_b32 v1, s71, v200
v_lshlrev_b32 v2, 16, v201
v_and_b32 v3, s71, v201
v_lshlrev_b32 v4, 16, v202
v_and_b32 v5, s71, v202
v_lshlrev_b32 v6, 16, v203
v_and_b32_e64 v7, s71, v203
v_pk_mul_f32 v[0:1], v[0:1], s[14:15]
v_pk_mul_f32 v[2:3], v[2:3], s[14:15]
v_pk_mul_f32 v[4:5], v[4:5], s[14:15]
v_pk_mul_f32 v[6:7], v[6:7], s[14:15]
CV 200,0,1
CV 201,2,3
CV 202,4,5
CV 203,6,7
ds_write_b128 v15, v[200:203] offset:1152
s_waitcnt vmcnt(4)
v_lshlrev_b32 v0, 16, v204
v_and_b32 v1, s71, v204
v_lshlrev_b32 v2, 16, v205
v_and_b32 v3, s71, v205
v_lshlrev_b32 v4, 16, v206
v_and_b32 v5, s71, v206
v_lshlrev_b32 v6, 16, v207
v_and_b32_e64 v7, s71, v207
v_pk_mul_f32 v[0:1], v[0:1], s[14:15]
v_pk_mul_f32 v[2:3], v[2:3], s[14:15]
v_pk_mul_f32 v[4:5], v[4:5], s[14:15]
v_pk_mul_f32 v[6:7], v[6:7], s[14:15]
CV 204,0,1
CV 205,2,3
CV 206,4,5
CV 207,6,7
PZ 160,64,36
ds_write_b128 v15, v[204:207] offset:1696
PZ 164,68,36
RK 160,14,0
RK 164,14,64
PZ 168,72,36
RK 168,14,128
v_mov_b32 v46, v44
PZ 172,76,36
RK 172,14,192
v_mov_b32 v47, v44
PZ 176,80,36
PZ 180,84,36
PZ 184,88,36
PZ 188,92,36
v_smfmac_f32_16x16x64_bf16 a[240:243], v[56:59], v[32:39], v71
s_waitcnt lgkmcnt(3)
QZ 16,0,160
s_waitcnt lgkmcnt(2)
QK 16,4,164,16
s_waitcnt lgkmcnt(1)
QK 16,8,168,16
s_waitcnt lgkmcnt(0)
QK 16,12,172,16
v_mov_b32 v34, 0
v_mov_b32 v35, 0
s_nop 5
v_max3_f32 v8, v16, v17, v18
v_max_f32 v8, v8, v19
v_mov_b32 v9, v8
s_nop 1
v_permlane32_swap_b32 v8, v9
v_max_f32 v8, v8, v9
v_mov_b32 v9, v8
s_nop 1
v_permlane16_swap_b32 v8, v9
v_min_f32_e64 v48, -v8, -v9
v_add_f32 v8, v48, v12
v_add_f32 v9, v48, v13
v_add_f32 v16, v8, v16
v_add_f32 v17, v8, v17
v_add_f32 v18, v9, v18
v_add_f32 v19, v9, v19
EX 16
EX 17
EX 18
EX 19
CV 32,16,17
CV 33,18,19
v_mov_b32 v49, v48
s_waitcnt vmcnt(3)
buffer_load_dwordx4 v66, s[16:19], s40 offen lds
v_lshlrev_b32 v0, 16, v224
v_and_b32 v1, s71, v224
v_lshlrev_b32 v2, 16, v225
v_and_b32 v3, s71, v225
v_lshlrev_b32 v4, 16, v226
v_and_b32 v5, s71, v226
v_lshlrev_b32 v6, 16, v227
v_and_b32_e64 v7, s71, v227
buffer_load_dwordx4 v67, s[16:19], s40 offen offset:1024 lds
s_add_u32 m0, s47, 0x12000
v_pk_mul_f32 v[0:1], v[0:1], s[14:15]
v_pk_mul_f32 v[2:3], v[2:3], s[14:15]
v_pk_mul_f32 v[4:5], v[4:5], s[14:15]
v_pk_mul_f32 v[6:7], v[6:7], s[14:15]
CV 224,0,1
CV 225,2,3
CV 226,4,5
CV 227,6,7
ds_write_b128 v15, v[224:227] offset:0
buffer_load_dwordx4 v68, s[20:23], s40 offen lds
s_waitcnt vmcnt(5)
v_lshlrev_b32 v0, 16, v228
v_and_b32 v1, s71, v228
v_lshlrev_b32 v2, 16, v229
v_and_b32 v3, s71, v229
v_lshlrev_b32 v4, 16, v230
v_and_b32 v5, s71, v230
v_lshlrev_b32 v6, 16, v231
v_and_b32_e64 v7, s71, v231
v_pk_mul_f32 v[0:1], v[0:1], s[14:15]
v_pk_mul_f32 v[2:3], v[2:3], s[14:15]
buffer_load_dwordx4 v69, s[20:23], s40 offen offset:1024 lds
s_mov_b32 s40, 0xe20000
s_add_u32 m0, s47, 0x4000
v_pk_mul_f32 v[4:5], v[4:5], s[14:15]
v_pk_mul_f32 v[6:7], v[6:7], s[14:15]
CV 228,0,1
CV 229,2,3
CV 230,4,5
CV 231,6,7
ds_write_b128 v15, v[228:231] offset:544
s_waitcnt vmcnt(5)
v_lshlrev_b32 v0, 16, v232
v_and_b32 v1, s71, v232
v_lshlrev_b32 v2, 16, v233
v_and_b32 v3, s71, v233
v_lshlrev_b32 v4, 16, v234
v_and_b32 v5, s71, v234
v_lshlrev_b32 v6, 16, v235
v_and_b32_e64 v7, s71, v235
v_pk_mul_f32 v[0:1], v[0:1], s[14:15]
v_pk_mul_f32 v[2:3], v[2:3], s[14:15]
v_pk_mul_f32 v[4:5], v[4:5], s[14:15]
v_pk_mul_f32 v[6:7], v[6:7], s[14:15]
CV 232,0,1
CV 233,2,3
CV 234,4,5
CV 235,6,7
ds_write_b128 v15, v[232:235] offset:1152
s_waitcnt vmcnt(4)
v_lshlrev_b32 v0, 16, v236
v_and_b32 v1, s71, v236
v_lshlrev_b32 v2, 16, v237
v_and_b32 v3, s71, v237
v_lshlrev_b32 v4, 16, v238
v_and_b32 v5, s71, v238
v_lshlrev_b32 v6, 16, v239
v_and_b32_e64 v7, s71, v239
v_pk_mul_f32 v[0:1], v[0:1], s[14:15]
v_pk_mul_f32 v[2:3], v[2:3], s[14:15]
v_pk_mul_f32 v[4:5], v[4:5], s[14:15]
v_pk_mul_f32 v[6:7], v[6:7], s[14:15]
CV 236,0,1
CV 237,2,3
CV 238,4,5
CV 239,6,7
PZ 192,64,32
buffer_load_dwordx4 v66, s[16:19], s40 offen lds
PZ 196,68,32
ds_write_b128 v15, v[236:239] offset:1696
PZ 200,72,32
RK 176,14,0
RK 180,14,64
PZ 204,76,32
s_waitcnt vmcnt(3)
s_barrier
PZ 208,80,32
RK 184,14,128
RK 188,14,192
PZ 212,84,32
buffer_load_dwordx4 v67, s[16:19], s40 offen offset:1024 lds
PZ 216,88,32
s_add_u32 m0, s47, 0x14000
RK 32,60,8192
RK 36,61,8192
PZ 220,92,32
s_waitcnt lgkmcnt(5)
RK 40,62,8192
v_mov_b32 v50, v48
QZ 24,0,176
s_waitcnt lgkmcnt(5)
RK 44,63,8192
v_mov_b32 v51, v48
QK 24,4,180,24
s_waitcnt lgkmcnt(5)
buffer_load_dwordx4 v68, s[20:23], s40 offen lds
QK 24,8,184,24
s_waitcnt lgkmcnt(4)
RK 48,60,12288
RK 52,61,12288
QK 24,12,188,24
s_waitcnt lgkmcnt(5)
RK 56,62,12288
v_xor_b32 v60, s43, v60
v_xor_b32 v61, s43, v61
QK 16,32,128,40
s_waitcnt lgkmcnt(5)
RK 60,63,12288
v_mov_b32 v38, 0
QK 16,36,132,16
s_waitcnt lgkmcnt(5)
buffer_load_dwordx4 v69, s[20:23], s40 offen offset:1024 lds
QK 16,40,136,16
s_waitcnt vmcnt(4) lgkmcnt(4)
s_barrier
QK 16,44,140,16
s_waitcnt lgkmcnt(3)
s_mov_b32 s40, 0xe40000
s_add_u32 m0, s47, 0x6000
v_max3_f32 v10, v24, v25, v26
QK 20,48,128,40
s_waitcnt lgkmcnt(2)
v_max_f32 v10, v10, v27
v_mov_b32 v39, 0
QK 20,52,132,20
s_waitcnt lgkmcnt(1)
buffer_load_dwordx4 v66, s[16:19], s40 offen lds
QK 20,56,136,20
s_waitcnt lgkmcnt(0)
RV 96,64,8192
v_mov_b32 v11, v10
QK 20,60,140,20
s_xor_b32 s41, s41, s43
RV 98,64,12288
RV 100,65,8192
v_permlane32_swap_b32 v10, v11
v_max_f32 v10, v10, v11
EX 16
v_mov_b32 v11, v10
EX 17
EX 18
v_permlane16_swap_b32 v10, v11
v_min_f32_e64 v52, -v10, -v11
EX 19
v_add_f32 v10, v52, v12
v_add_f32 v11, v52, v13
v_add_f32 v24, v10, v24
v_add_f32 v25, v10, v25
v_add_f32 v26, v11, v26
v_add_f32 v27, v11, v27
EX 24
EX 25
EX 26
EX 27
CV 36,24,25
CV 37,26,27
QK 24,32,144,44
buffer_load_dwordx4 v67, s[16:19], s40 offen offset:1024 lds
QK 24,36,148,24
s_add_u32 m0, s47, 0x16000
RV 102,65,12288
RV 104,64,8448
QK 24,40,152,24
s_xor_b32 s42, s41, 0xc000
RV 106,64,12544
v_mov_b32 v53, v52
QK 24,44,156,24
buffer_load_dwordx4 v68, s[20:23], s40 offen lds
v_smfmac_f32_16x16x64_bf16 a[244:247], v[56:59], v[32:39], v71
CV 32,16,17
QK 28,48,144,44
RV 108,65,8448
CV 33,18,19
QK 28,52,148,28
RV 110,65,12544
RV 112,64,8704
QK 28,56,152,28
buffer_load_dwordx4 v69, s[20:23], s40 offen offset:1024 lds
QK 28,60,156,28
s_mov_b32 s40, 0xe60000
RV 114,64,12800
s_add_u32 m0, s47, 0xc000
PZ 224,64,36
RV 116,65,8704
RV 118,65,12800
PZ 228,68,36
RV 120,64,8960
v_mov_b32 v54, v52
PZ 232,72,36
buffer_load_dwordx4 v66, s[16:19], s40 offen lds
PZ 236,76,36
RV 122,64,13056
RV 124,65,8960
PZ 240,80,36
RV 126,65,13056
v_mov_b32 v55, v52
PZ 244,84,36
EX 20
PZ 248,88,36
buffer_load_dwordx4 v67, s[16:19], s40 offen offset:1024 lds
PZ 252,92,36
EX 21
QK 16,32,160,48
s_add_u32 m0, s47, 0x1c000
EX 22
QK 16,36,164,16
EX 23
QK 16,40,168,16
buffer_load_dwordx4 v68, s[20:23], s40 offen lds
QK 16,44,172,16
CV 34,20,21
CV 35,22,23
QK 20,48,160,48
EX 24
QK 20,52,164,20
EX 25
QK 20,56,168,20
s_waitcnt lgkmcnt(0)
EX 26
QK 20,60,172,20
L_t6_pad1:
s_cbranch_execz L_t6_go
EX 27
PV 128,96,32
CV 36,24,25
CV 37,26,27
PV 132,100,32
buffer_load_dwordx4 v69, s[20:23], s40 offen offset:1024 lds
PV 136,104,32
EX 28
PV 140,108,32
EX 29
PV 144,112,32
EX 30
PV 148,116,32
s_mov_b32 s40, 0xe80000
EX 31
PV 152,120,32
s_add_u32 m0, s47, 0xe000
CV 38,28,29
CV 39,30,31
PV 156,124,32
v_xor_b32 v62, s43, v62
v_xor_b32 v63, s43, v63
QK 24,32,176,52
buffer_load_dwordx4 v66, s[16:19], s40 offen lds
QK 24,36,180,24
EX 16
QK 24,40,184,24
EX 17
QK 24,44,188,24
EX 18
v_smfmac_f32_16x16x64_bf16 a[240:243], v[56:59], v[32:39], v71
s_waitcnt vmcnt(11)
s_barrier
QK 28,48,176,52
RK 0,60,0
RK 4,61,0
QK 28,52,180,28
RK 8,62,0
CV 32,16,17
QK 28,56,184,28
buffer_load_dwordx4 v67, s[16:19], s40 offen offset:1024 lds
QK 28,60,188,28
RK 12,63,0
RK 16,60,4096
PV 160,96,36
RK 20,61,4096
v_xor_b32 v64, s43, v64
PV 164,100,36
RK 24,62,4096
v_xor_b32 v65, s43, v65
PV 168,104,36
s_xor_b32 s43, s43, 0xc000
RK 28,63,4096
PV 172,108,36
EX 19
PV 176,112,36
s_add_u32 m0, s47, 0x1e000
EX 20
PV 180,116,36
EX 21
PV 184,120,36
buffer_load_dwordx4 v68, s[20:23], s40 offen lds
PV 188,124,36
s_waitcnt lgkmcnt(7)
CV 33,18,19
CV 34,20,21
QK 16,0,128,40
s_waitcnt lgkmcnt(0)
EX 22
QK 16,4,132,16
EX 23
QK 16,8,136,16
CV 35,22,23
QK 16,12,140,16
EX 24
QK 20,16,128,40
EX 25
QK 20,20,132,20
buffer_load_dwordx4 v69, s[20:23], s40 offen offset:1024 lds
QK 20,24,136,20
EX 26
QK 20,28,140,20
EX 27
PV 192,96,32
CV 36,24,25
CV 37,26,27
PV 196,100,32
EX 28
PV 200,104,32
s_waitcnt vmcnt(12)
s_barrier
PV 204,108,32
EX 29
PV 208,112,32
EX 30
PV 212,116,32
EX 31
PV 216,120,32
CV 38,28,29
CV 39,30,31
PV 220,124,32
s_mov_b32 s40, 0xea0000
EX 16
QK 24,0,144,44
s_add_u32 m0, s47, 0x8000
EX 17
QK 24,4,148,24
EX 18
QK 24,8,152,24
buffer_load_dwordx4 v66, s[16:19], s40 offen lds
QK 24,12,156,24
EX 19
v_smfmac_f32_16x16x64_bf16 a[244:247], v[56:59], v[32:39], v71
CV 32,16,17
QK 28,16,144,44
RV 64,64,0
CV 33,18,19
QK 28,20,148,28
RV 66,64,4096
RV 68,65,0
QK 28,24,152,28
EX 20
QK 28,28,156,28
RV 70,65,4096
RV 72,64,256
PV 224,96,36
EX 21
PV 228,100,36
buffer_load_dwordx4 v67, s[16:19], s40 offen offset:1024 lds
PV 232,104,36
RV 74,64,4352
RV 76,65,256
PV 236,108,36
s_waitcnt vmcnt(10)
s_barrier
PV 240,112,36
RK 32,60,8192
RK 36,61,8192
PV 244,116,36
RK 40,62,8192
CV 34,20,21
PV 248,120,36
EX 22
PV 252,124,36
s_add_u32 m0, s47, 0x18000
RK 44,63,8192
RK 48,60,12288
QK 16,0,160,48
RK 52,61,12288
v_xor_b32 v60, s43, v60
QK 16,4,164,16
RK 56,62,12288
v_xor_b32 v61, s43, v61
QK 16,8,168,16
RK 60,63,12288
v_xor_b32 v62, s43, v62
QK 16,12,172,16
RV 78,65,4352
v_xor_b32 v63, s43, v63
EX 23
EX 24
CV 35,22,23
QK 20,16,160,48
RV 80,64,512
RV 82,64,4608
QK 20,20,164,20
RV 84,65,512
QK 20,24,168,20
RV 86,65,4608
RV 88,64,768
QK 20,28,172,20
s_waitcnt lgkmcnt(15)
RV 90,64,4864
PV 128,64,32
RV 92,65,768
RV 94,65,4864
PV 132,68,32
buffer_load_dwordx4 v68, s[20:23], s40 offen lds
PV 136,72,32
s_waitcnt lgkmcnt(8)
RV 96,64,8192
RV 98,64,12288
PV 140,76,32
s_waitcnt lgkmcnt(8)
EX 25
PV 144,80,32
s_waitcnt lgkmcnt(6)
RV 100,65,8192
RV 102,65,12288
PV 148,84,32
s_waitcnt lgkmcnt(6)
buffer_load_dwordx4 v69, s[20:23], s40 offen offset:1024 lds
PV 152,88,32
s_waitcnt lgkmcnt(4)
RV 104,64,8448
RV 106,64,12544
PV 156,92,32
RV 108,65,8448
EX 26
EX 27
CV 36,24,25
CV 37,26,27
QK 24,0,176,52
EX 28
QK 24,4,180,24
EX 29
QK 24,8,184,24
EX 30
QK 24,12,188,24
RV 110,65,12544
RV 112,64,8704
EX 31
CV 38,28,29
CV 39,30,31
EX 16
s_nop 0
v_smfmac_f32_16x16x64_bf16 a[240:243], v[56:59], v[32:39], v71
RV 114,64,12800
QK 28,16,176,52
EX 17
QK 28,20,180,28
EX 18
QK 28,24,184,28
RV 116,65,8704
CV 32,16,17
QK 28,28,188,28
EX 19
PV 160,64,36
RV 118,65,12800
CV 33,18,19
PV 164,68,36
EX 20
PV 168,72,36
EX 21
PV 172,76,36
RV 120,64,8960
CV 34,20,21
PV 176,80,36
EX 22
PV 180,84,36
EX 23
PV 184,88,36
RV 122,64,13056
CV 35,22,23
PV 188,92,36
RV 124,65,8960
v_xor_b32 v64, s43, v64
QK 16,32,128,40
EX 24
QK 16,36,132,16
EX 25
QK 16,40,136,16
RV 126,65,13056
CV 36,24,25
QK 16,44,140,16
EX 26
QK 20,48,128,40
EX 27
QK 20,52,132,20
CV 37,26,27
v_xor_b32 v65, s43, v65
QK 20,56,136,20
EX 28
QK 20,60,140,20
EX 29
PV 192,64,32
EX 30
PV 196,68,32
EX 31
PV 200,72,32
CV 38,28,29
CV 39,30,31
PV 204,76,32
EX 16
PV 208,80,32
s_waitcnt vmcnt(8) lgkmcnt(0)
s_barrier
PV 212,84,32
EX 17
PV 216,88,32
s_xor_b32 s41, s41, s43
EX 18
PV 220,92,32
s_xor_b32 s42, s41, 0xc000
EX 19
QK 24,32,144,44
s_xor_b32 s43, s43, 0xc000
RK 0,60,0
RK 4,61,0
QK 24,36,148,24
s_mov_b32 s40, 0xec0000
EX 20
QK 24,40,152,24
s_add_u32 m0, s47, 0xa000
EX 21
QK 24,44,156,24
RK 8,62,0
v_smfmac_f32_16x16x64_bf16 a[244:247], v[56:59], v[32:39], v71
CV 32,16,17
QK 28,48,144,44
buffer_load_dwordx4 v66, s[16:19], s40 offen lds
QK 28,52,148,28
RK 12,63,0
CV 33,18,19
QK 28,56,152,28
RK 16,60,4096
CV 34,20,21
QK 28,60,156,28
EX 22
PV 224,64,36
EX 23
PV 228,68,36
RK 20,61,4096
CV 35,22,23
PV 232,72,36
buffer_load_dwordx4 v67, s[16:19], s40 offen offset:1024 lds
PV 236,76,36
EX 24
PV 240,80,36
EX 25
PV 244,84,36
RK 24,62,4096
RK 28,63,4096
PV 248,88,36
EX 26
PV 252,92,36
RV 64,64,0
CV 36,24,25
QK 16,32,160,48
s_add_u32 m0, s47, 0x1a000
EX 27
QK 16,36,164,16
EX 28
QK 16,40,168,16
buffer_load_dwordx4 v68, s[20:23], s40 offen lds
QK 16,44,172,16
RV 66,64,4096
CV 37,26,27
QK 20,48,160,48
EX 29
QK 20,52,164,20
RV 68,65,0
CV 38,28,29
QK 20,56,168,20
EX 30
QK 20,60,172,20
EX 31
PV 128,96,32
RV 70,65,4096
CV 39,30,31
PV 132,100,32
buffer_load_dwordx4 v69, s[20:23], s40 offen offset:1024 lds
PV 136,104,32
EX 16
PV 140,108,32
RV 72,64,256
RV 74,64,4352
PV 144,112,32
EX 17
PV 148,116,32
s_mov_b32 s40, 0xee0000
EX 18
PV 152,120,32
s_add_u32 m0, s47, 0x0
EX 19
PV 156,124,32
RV 76,65,256
QK 24,32,176,52
buffer_load_dwordx4 v66, s[16:19], s40 offen lds
QK 24,36,180,24
EX 20
QK 24,40,184,24
RV 78,65,4352
RV 80,64,512
QK 24,44,188,24
EX 21
v_smfmac_f32_16x16x64_bf16 a[240:243], v[56:59], v[32:39], v71
RV 82,64,4608
QK 28,48,176,52
CV 32,16,17
CV 33,18,19
QK 28,52,180,28
EX 22
QK 28,56,184,28
buffer_load_dwordx4 v67, s[16:19], s40 offen offset:1024 lds
QK 28,60,188,28
RV 84,65,512
CV 34,20,21
PV 160,96,36
EX 23
PV 164,100,36
RV 86,65,4608
CV 35,22,23
PV 168,104,36
EX 24
PV 172,108,36
EX 25
PV 176,112,36
s_add_u32 m0, s47, 0x10000
EX 26
PV 180,116,36
RV 88,64,768
RV 90,64,4864
PV 184,120,36
buffer_load_dwordx4 v68, s[20:23], s40 offen lds
PV 188,124,36
s_waitcnt lgkmcnt(14)
RV 92,65,768
CV 36,24,25
QK 16,0,128,40
EX 27
QK 16,4,132,16
RV 94,65,4864
CV 37,26,27
QK 16,8,136,16
EX 28
QK 16,12,140,16
EX 29
QK 20,16,128,40
EX 30
QK 20,20,132,20
buffer_load_dwordx4 v69, s[20:23], s40 offen offset:1024 lds
QK 20,24,136,20
EX 31
QK 20,28,140,20
CV 38,28,29
CV 39,30,31
PV 192,96,32
EX 16
PV 196,100,32
PV 200,104,32
EX 17
PV 204,108,32
PV 208,112,32
s_waitcnt vmcnt(12) lgkmcnt(0)
s_barrier
PV 212,116,32
s_add_u32 s40, s40, 0x20000
EX 18
PV 216,120,32
s_add_u32 m0, s42, 0x2000
EX 19
PV 220,124,32
RK 32,60,8192
QK 24,0,144,44
EX 20
QK 24,4,148,24
RK 36,61,8192
QK 24,8,152,24
buffer_load_dwordx4 v66, s[16:19], s40 offen lds
QK 24,12,156,24
EX 21
v_smfmac_f32_16x16x64_bf16 a[244:247], v[56:59], v[32:39], v71
RK 40,62,8192
QK 28,16,144,44
RK 44,63,8192
CV 32,16,17
QK 28,20,148,28
CV 33,18,19
CV 34,20,21
QK 28,24,152,28
EX 22
QK 28,28,156,28
EX 23
PV 224,96,36
RK 48,60,12288
RK 52,61,12288
PV 228,100,36
buffer_load_dwordx4 v67, s[16:19], s40 offen offset:1024 lds
PV 232,104,36
CV 35,22,23
v_xor_b32 v60, s43, v60
PV 236,108,36
RK 56,62,12288
v_xor_b32 v61, s43, v61
PV 240,112,36
EX 24
PV 244,116,36
s_add_u32 m0, s42, 0x12000
RK 60,63,12288
v_xor_b32 v62, s43, v62
PV 248,120,36
EX 25
PV 252,124,36
RV 96,64,8192
CV 36,24,25
QK 16,0,160,48
EX 26
QK 16,4,164,16
buffer_load_dwordx4 v68, s[20:23], s40 offen lds
QK 16,8,168,16
RV 98,64,12288
v_xor_b32 v63, s43, v63
QK 16,12,172,16
EX 27
QK 20,16,160,48
RV 100,65,8192
CV 37,26,27
QK 20,20,164,20
EX 28
QK 20,24,168,20
EX 29
QK 20,28,172,20
RV 102,65,12288
CV 38,28,29
PV 128,64,32
EX 30
PV 132,68,32
buffer_load_dwordx4 v69, s[20:23], s40 offen offset:1024 lds
PV 136,72,32
EX 31
PV 140,76,32
RV 104,64,8448
RV 106,64,12544
PV 144,80,32
EX 16
PV 148,84,32
RV 108,65,8448
CV 39,30,31
PV 152,88,32
EX 17
PV 156,92,32
EX 18
QK 24,0,176,52
EX 19
QK 24,4,180,24
EX 20
QK 24,8,184,24
RV 110,65,12544
RV 112,64,8704
QK 24,12,188,24
EX 21
v_smfmac_f32_16x16x64_bf16 a[240:243], v[56:59], v[32:39], v71
RV 114,64,12800
QK 28,16,176,52
CV 32,16,17
CV 33,18,19
QK 28,20,180,28
EX 22
QK 28,24,184,28
RV 116,65,8704
CV 34,20,21
QK 28,28,188,28
EX 23
PV 160,64,36
RV 118,65,12800
CV 35,22,23
PV 164,68,36
EX 24
PV 168,72,36
EX 25
PV 172,76,36
RV 120,64,8960
PV 176,80,36
EX 26
PV 180,84,36
RV 122,64,13056
v_xor_b32 v64, s43, v64
PV 184,88,36
EX 27
PV 188,92,36
s_waitcnt lgkmcnt(14)
RV 124,65,8960
CV 36,24,25
QK 16,32,128,40
EX 28
QK 16,36,132,16
RV 126,65,13056
CV 37,26,27
QK 16,40,136,16
EX 29
QK 16,44,140,16
CV 38,28,29
v_xor_b32 v65, s43, v65
QK 20,48,128,40
EX 30
QK 20,52,132,20
QK 20,56,136,20
EX 31
QK 20,60,140,20
CV 39,30,31
PV 192,64,32
EX 16
PV 196,68,32
PV 200,72,32
EX 17
PV 204,76,32
PV 208,80,32
s_waitcnt vmcnt(8) lgkmcnt(0)
s_barrier
PV 212,84,32
s_mov_b32 s56, 9
L_t6_pad2:
s_cbranch_execz L_t6_go
L_t6_loop0:
PV 216,88,32
s_xor_b32 s41, s41, s43
EX 18
PV 220,92,32
s_xor_b32 s42, s41, 0xc000
RK 0,60,0
QK 24,32,144,44
s_add_u32 s40, s40, 0x20000
EX 19
QK 24,36,148,24
s_add_u32 m0, s42, 0x0
RK 4,61,0
QK 24,40,152,24
buffer_load_dwordx4 v66, s[16:19], s40 offen lds
QK 24,44,156,24
s_xor_b32 s43, s43, 0xc000
RK 8,62,0
v_smfmac_f32_16x16x64_bf16 a[244:247], v[56:59], v[32:39], v71
CV 32,16,17
QK 28,48,144,44
RK 12,63,0
CV 33,18,19
QK 28,52,148,28
EX 20
QK 28,56,152,28
EX 21
QK 28,60,156,28
RK 16,60,4096
CV 34,20,21
PV 224,64,36
EX 22
PV 228,68,36
buffer_load_dwordx4 v67, s[16:19], s40 offen offset:1024 lds
PV 232,72,36
RK 20,61,4096
PV 236,76,36
EX 23
PV 240,80,36
RK 24,62,4096
CV 35,22,23
PV 244,84,36
s_add_u32 m0, s42, 0x10000
EX 24
PV 248,88,36
RK 28,63,4096
PV 252,92,36
EX 25
QK 16,32,160,48
RV 64,64,0
CV 36,24,25
QK 16,36,164,16
buffer_load_dwordx4 v68, s[20:23], s40 offen lds
QK 16,40,168,16
EX 26
QK 16,44,172,16
RV 66,64,4096
QK 20,48,160,48
EX 27
QK 20,52,164,20
RV 68,65,0
CV 37,26,27
QK 20,56,168,20
EX 28
QK 20,60,172,20
RV 70,65,4096
PV 128,96,32
EX 29
PV 132,100,32
buffer_load_dwordx4 v69, s[20:23], s40 offen offset:1024 lds
PV 136,104,32
RV 72,64,256
CV 38,28,29
PV 140,108,32
EX 30
PV 144,112,32
RV 74,64,4352
PV 148,116,32
EX 31
PV 152,120,32
RV 76,65,256
CV 39,30,31
PV 156,124,32
EX 16
QK 24,32,176,52
EX 17
QK 24,36,180,24
RV 78,65,4352
QK 24,40,184,24
EX 18
QK 24,44,188,24
RV 80,64,512
v_smfmac_f32_16x16x64_bf16 a[240:243], v[56:59], v[32:39], v71
RV 82,64,4608
QK 28,48,176,52
EX 19
QK 28,52,180,28
CV 32,16,17
CV 33,18,19
QK 28,56,184,28
EX 20
QK 28,60,188,28
RV 84,65,512
PV 160,96,36
EX 21
PV 164,100,36
RV 86,65,4608
CV 34,20,21
PV 168,104,36
EX 22
PV 172,108,36
RV 88,64,768
PV 176,112,36
EX 23
PV 180,116,36
RV 90,64,4864
CV 35,22,23
PV 184,120,36
EX 24
PV 188,124,36
s_waitcnt lgkmcnt(14)
EX 25
QK 16,0,128,40
RV 92,65,768
CV 36,24,25
QK 16,4,132,16
EX 26
QK 16,8,136,16
RV 94,65,4864
QK 16,12,140,16
EX 27
QK 20,16,128,40
EX 28
QK 20,20,132,20
EX 29
QK 20,24,136,20
CV 37,26,27
CV 38,28,29
QK 20,28,140,20
EX 30
PV 192,96,32
EX 31
PV 196,100,32
EX 16
PV 200,104,32
EX 17
PV 204,108,32
CV 39,30,31
PV 208,112,32
s_waitcnt lgkmcnt(0)
EX 18
PV 212,116,32
s_add_u32 s40, s40, 0x20000
PV 216,120,32
s_add_u32 m0, s42, 0x2000
EX 19
PV 220,124,32
RK 32,60,8192
QK 24,0,144,44
EX 20
QK 24,4,148,24
RK 36,61,8192
QK 24,8,152,24
buffer_load_dwordx4 v66, s[16:19], s40 offen lds
QK 24,12,156,24
RK 40,62,8192
v_smfmac_f32_16x16x64_bf16 a[244:247], v[56:59], v[32:39], v71
CV 32,16,17
QK 28,16,144,44
RK 44,63,8192
CV 33,18,19
QK 28,20,148,28
EX 21
QK 28,24,152,28
RK 48,60,12288
CV 34,20,21
QK 28,28,156,28
EX 22
PV 224,96,36
RK 52,61,12288
v_xor_b32 v60, s43, v60
PV 228,100,36
buffer_load_dwordx4 v67, s[16:19], s40 offen offset:1024 lds
PV 232,104,36
EX 23
PV 236,108,36
RK 56,62,12288
CV 35,22,23
PV 240,112,36
EX 24
PV 244,116,36
s_add_u32 m0, s42, 0x12000
RK 60,63,12288
v_xor_b32 v61, s43, v61
PV 248,120,36
EX 25
PV 252,124,36
RV 96,64,8192
CV 36,24,25
QK 16,0,160,48
EX 26
QK 16,4,164,16
buffer_load_dwordx4 v68, s[20:23], s40 offen lds
QK 16,8,168,16
RV 98,64,12288
v_xor_b32 v62, s43, v62
QK 16,12,172,16
EX 27
QK 20,16,160,48
RV 100,65,8192
CV 37,26,27
QK 20,20,164,20
EX 28
QK 20,24,168,20
RV 102,65,12288
v_xor_b32 v63, s43, v63
QK 20,28,172,20
EX 29
PV 128,64,32
EX 30
PV 132,68,32
buffer_load_dwordx4 v69, s[20:23], s40 offen offset:1024 lds
PV 136,72,32
RV 104,64,8448
CV 38,28,29
PV 140,76,32
EX 31
PV 144,80,32
RV 106,64,12544
CV 39,30,31
PV 148,84,32
EX 16
PV 152,88,32
RV 108,65,8448
PV 156,92,32
EX 17
QK 24,0,176,52
EX 18
QK 24,4,180,24
RV 110,65,12544
QK 24,8,184,24
EX 19
QK 24,12,188,24
RV 112,64,8704
v_smfmac_f32_16x16x64_bf16 a[240:243], v[56:59], v[32:39], v71
RV 114,64,12800
QK 28,16,176,52
CV 32,16,17
CV 33,18,19
QK 28,20,180,28
EX 20
QK 28,24,184,28
EX 21
QK 28,28,188,28
RV 116,65,8704
CV 34,20,21
PV 160,64,36
EX 22
PV 164,68,36
RV 118,65,12800
PV 168,72,36
EX 23
PV 172,76,36
RV 120,64,8960
CV 35,22,23
PV 176,80,36
EX 24
PV 180,84,36
EX 25
PV 184,88,36
RV 122,64,13056
v_xor_b32 v64, s43, v64
PV 188,92,36
s_waitcnt lgkmcnt(14)
RV 124,65,8960
CV 36,24,25
QK 16,32,128,40
EX 26
QK 16,36,132,16
EX 27
QK 16,40,136,16
RV 126,65,13056
CV 37,26,27
QK 16,44,140,16
EX 28
QK 20,48,128,40
EX 29
QK 20,52,132,20
EX 30
QK 20,56,136,20
EX 31
QK 20,60,140,20
CV 38,28,29
CV 39,30,31
PV 192,64,32
EX 16
PV 196,68,32
v_xor_b32 v65, s43, v65
PV 200,72,32
EX 17
PV 204,76,32
PV 208,80,32
s_waitcnt vmcnt(8) lgkmcnt(0)
s_barrier
PV 212,84,32
s_sub_u32 s56, s56, 1
s_cbranch_scc0 L_t6_loop0
PV 216,88,32
s_xor_b32 s41, s41, s43
EX 18
PV 220,92,32
s_xor_b32 s43, s43, 0xc000
EX 19
QK 24,32,144,44
s_xor_b32 s42, s41, 0xc000
RK 0,60,0
RK 4,61,0
QK 24,36,148,24
EX 20
QK 24,40,152,24
EX 21
QK 24,44,156,24
RK 8,62,0
v_smfmac_f32_16x16x64_bf16 a[244:247], v[56:59], v[32:39], v71
CV 32,16,17
QK 28,48,144,44
RK 12,63,0
CV 33,18,19
QK 28,52,148,28
EX 22
QK 28,56,152,28
RK 16,60,4096
CV 34,20,21
QK 28,60,156,28
EX 23
PV 224,64,36
RK 20,61,4096
CV 35,22,23
PV 228,68,36
EX 24
PV 232,72,36
EX 25
PV 236,76,36
RK 24,62,4096
PV 240,80,36
EX 26
PV 244,84,36
RK 28,63,4096
PV 248,88,36
EX 27
PV 252,92,36
RV 64,64,0
CV 36,24,25
QK 16,32,160,48
EX 28
QK 16,36,164,16
CV 37,26,27
QK 16,40,168,16
EX 29
QK 16,44,172,16
RV 66,64,4096
CV 38,28,29
QK 20,48,160,48
EX 30
QK 20,52,164,20
RV 68,65,0
QK 20,56,168,20
EX 31
QK 20,60,172,20
RV 70,65,4096
CV 39,30,31
PV 128,96,32
EX 16
PV 132,100,32
RV 72,64,256
PV 136,104,32
EX 17
PV 140,108,32
RV 74,64,4352
PV 144,112,32
EX 18
PV 148,116,32
RV 76,65,256
PV 152,120,32
EX 19
PV 156,124,32
QK 24,32,176,52
EX 20
QK 24,36,180,24
RV 78,65,4352
QK 24,40,184,24
EX 21
QK 24,44,188,24
RV 80,64,512
v_smfmac_f32_16x16x64_bf16 a[240:243], v[56:59], v[32:39], v71
RV 82,64,4608
QK 28,48,176,52
CV 32,16,17
CV 33,18,19
QK 28,52,180,28
EX 22
QK 28,56,184,28
RV 84,65,512
CV 34,20,21
QK 28,60,188,28
EX 23
PV 160,96,36
RV 86,65,4608
CV 35,22,23
PV 164,100,36
EX 24
PV 168,104,36
EX 25
PV 172,108,36
RV 88,64,768
PV 176,112,36
EX 26
PV 180,116,36
RV 90,64,4864
PV 184,120,36
EX 27
PV 188,124,36
s_waitcnt lgkmcnt(14)
RV 92,65,768
CV 36,24,25
QK 16,0,128,40
EX 28
QK 16,4,132,16
RV 94,65,4864
CV 37,26,27
QK 16,8,136,16
EX 29
QK 16,12,140,16
CV 38,28,29
QK 20,16,128,40
EX 30
QK 20,20,132,20
QK 20,24,136,20
EX 31
QK 20,28,140,20
CV 39,30,31
PV 192,96,32
EX 16
PV 196,100,32
PV 200,104,32
EX 17
PV 204,108,32
PV 208,112,32
s_waitcnt lgkmcnt(0)
EX 18
PV 212,116,32
PV 216,120,32
EX 19
PV 220,124,32
RK 32,60,8192
QK 24,0,144,44
EX 20
QK 24,4,148,24
RK 36,61,8192
QK 24,8,152,24
EX 21
QK 24,12,156,24
RK 40,62,8192
v_smfmac_f32_16x16x64_bf16 a[244:247], v[56:59], v[32:39], v71
CV 32,16,17
QK 28,16,144,44
RK 44,63,8192
CV 33,18,19
QK 28,20,148,28
EX 22
QK 28,24,152,28
RK 48,60,12288
CV 34,20,21
QK 28,28,156,28
EX 23
PV 224,96,36
RK 52,61,12288
CV 35,22,23
PV 228,100,36
EX 24
PV 232,104,36
EX 25
PV 236,108,36
RK 56,62,12288
v_xor_b32 v60, s43, v60
PV 240,112,36
EX 26
PV 244,116,36
RK 60,63,12288
v_xor_b32 v61, s43, v61
PV 248,120,36
EX 27
PV 252,124,36
RV 96,64,8192
CV 36,24,25
QK 16,0,160,48
CV 37,26,27
v_xor_b32 v62, s43, v62
QK 16,4,164,16
EX 28
QK 16,8,168,16
RV 98,64,12288
v_xor_b32 v63, s43, v63
QK 16,12,172,16
EX 29
QK 20,16,160,48
RV 100,65,8192
CV 38,28,29
QK 20,20,164,20
EX 30
QK 20,24,168,20
EX 31
QK 20,28,172,20
RV 102,65,12288
CV 39,30,31
PV 128,64,32
EX 16
PV 132,68,32
RV 104,64,8448
PV 136,72,32
EX 17
PV 140,76,32
RV 106,64,12544
PV 144,80,32
EX 18
PV 148,84,32
RV 108,65,8448
PV 152,88,32
EX 19
PV 156,92,32
QK 24,0,176,52
EX 20
QK 24,4,180,24
RV 110,65,12544
QK 24,8,184,24
EX 21
QK 24,12,188,24
RV 112,64,8704
v_smfmac_f32_16x16x64_bf16 a[240:243], v[56:59], v[32:39], v71
RV 114,64,12800
QK 28,16,176,52
CV 32,16,17
CV 33,18,19
QK 28,20,180,28
EX 22
QK 28,24,184,28
RV 116,65,8704
CV 34,20,21
QK 28,28,188,28
EX 23
PV 160,64,36
RV 118,65,12800
CV 35,22,23
PV 164,68,36
EX 24
PV 168,72,36
EX 25
PV 172,76,36
RV 120,64,8960
PV 176,80,36
EX 26
PV 180,84,36
RV 122,64,13056
v_xor_b32 v64, s43, v64
PV 184,88,36
EX 27
PV 188,92,36
s_waitcnt lgkmcnt(14)
RV 124,65,8960
CV 36,24,25
QK 16,32,128,40
EX 28
QK 16,36,132,16
RV 126,65,13056
CV 37,26,27
QK 16,40,136,16
EX 29
QK 16,44,140,16
CV 38,28,29
v_xor_b32 v65, s43, v65
QK 20,48,128,40
EX 30
QK 20,52,132,20
QK 20,56,136,20
EX 31
QK 20,60,140,20
L_t6_pad3:
s_cbranch_execz L_t6_go
CV 39,30,31
PV 192,64,32
EX 16
PV 196,68,32
PV 200,72,32
EX 17
PV 204,76,32
PV 208,80,32
s_waitcnt vmcnt(0) lgkmcnt(0)
s_barrier
PV 212,84,32
EX 18
PV 216,88,32
s_xor_b32 s41, s41, s43
EX 19
PV 220,92,32
s_xor_b32 s42, s41, 0xc000
RK 0,60,0
QK 24,32,144,44
s_xor_b32 s43, s43, 0xc000
EX 20
QK 24,36,148,24
RK 4,61,0
QK 24,40,152,24
EX 21
QK 24,44,156,24
RK 8,62,0
v_smfmac_f32_16x16x64_bf16 a[244:247], v[56:59], v[32:39], v71
CV 32,16,17
QK 28,48,144,44
RK 12,63,0
CV 33,18,19
QK 28,52,148,28
EX 22
QK 28,56,152,28
RK 16,60,4096
CV 34,20,21
QK 28,60,156,28
EX 23
PV 224,64,36
RK 20,61,4096
CV 35,22,23
PV 228,68,36
EX 24
PV 232,72,36
EX 25
PV 236,76,36
RK 24,62,4096
PV 240,80,36
EX 26
PV 244,84,36
RK 28,63,4096
PV 248,88,36
EX 27
PV 252,92,36
RV 64,64,0
CV 36,24,25
QK 16,32,160,48
EX 28
QK 16,36,164,16
CV 37,26,27
QK 16,40,168,16
EX 29
QK 16,44,172,16
RV 66,64,4096
CV 38,28,29
QK 20,48,160,48
EX 30
QK 20,52,164,20
RV 68,65,0
QK 20,56,168,20
EX 31
QK 20,60,172,20
RV 70,65,4096
CV 39,30,31
PV 128,96,32
EX 16
PV 132,100,32
RV 72,64,256
PV 136,104,32
EX 17
PV 140,108,32
RV 74,64,4352
PV 144,112,32
EX 18
PV 148,116,32
RV 76,65,256
PV 152,120,32
EX 19
PV 156,124,32
QK 24,32,176,52
EX 20
QK 24,36,180,24
RV 78,65,4352
QK 24,40,184,24
EX 21
QK 24,44,188,24
RV 80,64,512
v_smfmac_f32_16x16x64_bf16 a[240:243], v[56:59], v[32:39], v71
RV 82,64,4608
QK 28,48,176,52
CV 32,16,17
CV 33,18,19
QK 28,52,180,28
EX 22
QK 28,56,184,28
RV 84,65,512
CV 34,20,21
QK 28,60,188,28
EX 23
PV 160,96,36
RV 86,65,4608
CV 35,22,23
PV 164,100,36
EX 24
PV 168,104,36
EX 25
PV 172,108,36
RV 88,64,768
PV 176,112,36
EX 26
PV 180,116,36
RV 90,64,4864
PV 184,120,36
EX 27
PV 188,124,36
s_waitcnt lgkmcnt(14)
RV 92,65,768
CV 36,24,25
QK 16,0,128,40
EX 28
QK 16,4,132,16
RV 94,65,4864
CV 37,26,27
QK 16,8,136,16
EX 29
QK 16,12,140,16
CV 38,28,29
QK 20,16,128,40
EX 30
QK 20,20,132,20
QK 20,24,136,20
EX 31
QK 20,28,140,20
CV 39,30,31
PV 192,96,32
EX 16
PV 196,100,32
PV 200,104,32
EX 17
PV 204,108,32
PV 208,112,32
s_waitcnt lgkmcnt(0)
EX 18
PV 212,116,32
PV 216,120,32
EX 19
PV 220,124,32
RK 32,60,8192
QK 24,0,144,44
EX 20
QK 24,4,148,24
RK 36,61,8192
QK 24,8,152,24
EX 21
QK 24,12,156,24
RK 40,62,8192
v_smfmac_f32_16x16x64_bf16 a[244:247], v[56:59], v[32:39], v71
CV 32,16,17
QK 28,16,144,44
RK 44,63,8192
CV 33,18,19
QK 28,20,148,28
EX 22
QK 28,24,152,28
RK 48,60,12288
CV 34,20,21
QK 28,28,156,28
EX 23
PV 224,96,36
RK 52,61,12288
CV 35,22,23
PV 228,100,36
EX 24
PV 232,104,36
EX 25
PV 236,108,36
RK 56,62,12288
PV 240,112,36
EX 26
PV 244,116,36
RK 60,63,12288
PV 248,120,36
EX 27
PV 252,124,36
RV 96,64,8192
CV 36,24,25
QK 16,0,160,48
EX 28
QK 16,4,164,16
CV 37,26,27
QK 16,8,168,16
EX 29
QK 16,12,172,16
RV 98,64,12288
CV 38,28,29
QK 20,16,160,48
EX 30
QK 20,20,164,20
RV 100,65,8192
QK 20,24,168,20
EX 31
QK 20,28,172,20
RV 102,65,12288
CV 39,30,31
PV 128,64,32
EX 16
PV 132,68,32
RV 104,64,8448
PV 136,72,32
EX 17
PV 140,76,32
RV 106,64,12544
PV 144,80,32
EX 18
PV 148,84,32
RV 108,65,8448
PV 152,88,32
EX 19
PV 156,92,32
QK 24,0,176,52
EX 20
QK 24,4,180,24
RV 110,65,12544
QK 24,8,184,24
EX 21
QK 24,12,188,24
RV 112,64,8704
v_smfmac_f32_16x16x64_bf16 a[240:243], v[56:59], v[32:39], v71
RV 114,64,12800
QK 28,16,176,52
CV 32,16,17
CV 33,18,19
QK 28,20,180,28
EX 22
QK 28,24,184,28
RV 116,65,8704
CV 34,20,21
QK 28,28,188,28
EX 23
PV 160,64,36
RV 118,65,12800
CV 35,22,23
PV 164,68,36
EX 24
PV 168,72,36
EX 25
PV 172,76,36
RV 120,64,8960
PV 176,80,36
EX 26
PV 180,84,36
RV 122,64,13056
PV 184,88,36
EX 27
PV 188,92,36
s_waitcnt lgkmcnt(14)
RV 124,65,8960
CV 36,24,25
QK 16,32,128,40
EX 28
QK 16,36,132,16
RV 126,65,13056
CV 37,26,27
QK 16,40,136,16
EX 29
QK 16,44,140,16
CV 38,28,29
QK 20,48,128,40
EX 30
QK 20,52,132,20
QK 20,56,136,20
EX 31
QK 20,60,140,20
CV 39,30,31
PV 192,64,32
EX 16
PV 196,68,32
EX 17
PV 200,72,32
EX 18
PV 204,76,32
EX 19
PV 208,80,32
s_waitcnt lgkmcnt(0)
EX 20
PV 212,84,32
EX 21
PV 216,88,32
EX 22
PV 220,92,32
EX 23
QK 24,32,144,44
QK 24,36,148,24
QK 24,40,152,24
QK 24,44,156,24
v_smfmac_f32_16x16x64_bf16 a[244:247], v[56:59], v[32:39], v71
CV 32,16,17
QK 28,48,144,44
CV 33,18,19
CV 34,20,21
QK 28,52,148,28
CV 35,22,23
QK 28,56,152,28
EX 24
QK 28,60,156,28
EX 25
PV 224,64,36
EX 26
PV 228,68,36
EX 27
PV 232,72,36
PV 236,76,36
PV 240,80,36
EX 28
PV 244,84,36
EX 29
PV 248,88,36
EX 30
PV 252,92,36
EX 31
QK 16,32,160,48
CV 36,24,25
CV 37,26,27
QK 16,36,164,16
CV 38,28,29
CV 39,30,31
QK 16,40,168,16
QK 16,44,172,16
QK 20,48,160,48
QK 20,52,164,20
QK 20,56,168,20
QK 20,60,172,20
v_smfmac_f32_16x16x64_bf16 a[240:243], v[56:59], v[32:39], v71
s_add_u32 s52, s44, 0x0
s_nop 0
PV 128,96,32
EX 16
PV 132,100,32
EX 17
PV 136,104,32
EX 18
PV 140,108,32
EX 19
EX 20
EX 21
v_accvgpr_read_b32 v76, a240
v_accvgpr_read_b32 v40, a241
v_accvgpr_read_b32 v77, a242
v_add_f32 v76, v76, v40
v_accvgpr_read_b32 v44, a243
v_cmp_nge_f32 s[4:5], s55, v76
v_rcp_f32 v76, v76
v_add_f32 v77, v77, v44
PM 128,76,0
v_cmp_nge_f32 s[6:7], s55, v77
v_rcp_f32 v77, v77
PM 130,76,0
PV 144,112,32
CV 128,128,129
CV 129,130,131
EX 22
v_exp_f32_e64 v23, v23
PM 132,76,0
PM 134,76,0
PV 148,116,32
ds_write_b64 v70, v[128:129] offset:0
CV 132,132,133
CV 133,134,135
PM 136,76,0
PM 138,76,0
PV 152,120,32
ds_write_b64 v70, v[132:133] offset:32
CV 136,136,137
CV 137,138,139
PM 140,76,0
PM 142,76,0
PV 156,124,32
ds_write_b64 v70, v[136:137] offset:64
CV 140,140,141
CV 141,142,143
PM 144,76,0
PM 146,76,0
QK 24,32,176,52
ds_write_b64 v70, v[140:141] offset:96
CV 144,144,145
CV 145,146,147
PM 148,76,0
PM 150,76,0
QK 24,36,180,24
ds_write_b64 v70, v[144:145] offset:128
CV 148,148,149
CV 149,150,151
PM 152,76,0
PM 154,76,0
QK 24,40,184,24
ds_write_b64 v70, v[148:149] offset:160
CV 152,152,153
CV 153,154,155
PM 156,76,0
PM 158,76,0
QK 24,44,188,24
ds_write_b64 v70, v[152:153] offset:192
CV 156,156,157
CV 157,158,159
QK 28,48,176,52
CV 32,16,17
CV 33,18,19
ds_write_b64 v70, v[156:157] offset:224
QK 28,52,180,28
RK 128,15,0
RK 132,15,528
QK 28,56,184,28
RK 136,15,1056
CV 34,20,21
QK 28,60,188,28
s_add_u32 s53, s44, 0x10000
RK 140,15,1584
CV 35,22,23
PV 160,96,36
EX 24
PV 164,100,36
EX 25
PV 168,104,36
EX 26
PV 172,108,36
s_waitcnt lgkmcnt(3)
buffer_store_dwordx4 a[128:131], v72, s[28:31], s52 offen nt
EX 27
PM 160,76,1
PM 162,76,1
PV 176,112,36
s_waitcnt lgkmcnt(2)
CV 160,160,161
CV 161,162,163
buffer_store_dwordx4 a[132:135], v73, s[28:31], s52 offen nt
PM 164,76,1
PM 166,76,1
PV 180,116,36
ds_write_b64 v70, v[160:161] offset:0
CV 164,164,165
CV 165,166,167
PM 168,76,1
PM 170,76,1
PV 184,120,36
s_waitcnt lgkmcnt(2)
buffer_store_dwordx4 a[136:139], v74, s[28:31], s52 offen nt
ds_write_b64 v70, v[164:165] offset:32
CV 168,168,169
CV 169,170,171
PM 172,76,1
PM 174,76,1
PV 188,124,36
s_waitcnt lgkmcnt(2)
ds_write_b64 v70, v[168:169] offset:64
buffer_store_dwordx4 a[140:143], v75, s[28:31], s52 offen nt
CV 172,172,173
CV 173,174,175
PM 176,76,1
PM 178,76,1
EX 28
EX 29
EX 30
EX 31
CV 36,24,25
CV 37,26,27
CV 38,28,29
CV 39,30,31
CV 176,176,177
CV 177,178,179
v_smfmac_f32_16x16x64_bf16 a[244:247], v[56:59], v[32:39], v71
s_add_u32 s48, s44, 0x20000
ds_write_b64 v70, v[172:173] offset:96
PM 180,76,1
PM 182,76,1
PV 192,96,32
ds_write_b64 v70, v[176:177] offset:128
CV 180,180,181
CV 181,182,183
PM 184,76,1
PM 186,76,1
PV 196,100,32
ds_write_b64 v70, v[180:181] offset:160
v_accvgpr_read_b32 v78, a244
v_accvgpr_read_b32 v48, a245
v_accvgpr_read_b32 v79, a246
v_add_f32 v78, v78, v48
v_accvgpr_read_b32 v52, a247
v_cmp_nge_f32 s[8:9], s55, v78
v_rcp_f32 v78, v78
v_add_f32 v79, v79, v52
CV 184,184,185
v_cmp_nge_f32 s[10:11], s55, v79
v_rcp_f32 v79, v79
CV 185,186,187
PM 188,76,1
PM 190,76,1
PV 200,104,32
ds_write_b64 v70, v[184:185] offset:192
CV 188,188,189
CV 189,190,191
PV 204,108,32
ds_write_b64 v70, v[188:189] offset:224
RK 144,15,0
RK 148,15,528
PM 192,78,0
RK 152,15,1056
PM 194,78,0
PV 208,112,32
RK 156,15,1584
CV 192,192,193
CV 193,194,195
PM 196,78,0
PM 198,78,0
PV 212,116,32
ds_write_b64 v70, v[192:193] offset:0
CV 196,196,197
CV 197,198,199
PM 200,78,0
PM 202,78,0
PV 216,120,32
s_waitcnt lgkmcnt(4)
buffer_store_dwordx4 a[144:147], v72, s[28:31], s53 offen nt
ds_write_b64 v70, v[196:197] offset:32
CV 200,200,201
CV 201,202,203
PM 204,78,0
PM 206,78,0
PV 220,124,32
s_waitcnt lgkmcnt(4)
s_add_u32 s49, s44, 0x30000
ds_write_b64 v70, v[200:201] offset:64
buffer_store_dwordx4 a[148:151], v73, s[28:31], s53 offen nt
CV 204,204,205
CV 205,206,207
PM 208,78,0
PM 210,78,0
PV 224,96,36
ds_write_b64 v70, v[204:205] offset:96
CV 208,208,209
CV 209,210,211
PM 212,78,0
PM 214,78,0
PV 228,100,36
s_waitcnt lgkmcnt(5)
buffer_store_dwordx4 a[152:155], v74, s[28:31], s53 offen nt
ds_write_b64 v70, v[208:209] offset:128
CV 212,212,213
CV 213,214,215
PM 216,78,0
PM 218,78,0
PV 232,104,36
s_waitcnt lgkmcnt(5)
ds_write_b64 v70, v[212:213] offset:160
buffer_store_dwordx4 a[156:159], v75, s[28:31], s53 offen nt
CV 216,216,217
CV 217,218,219
PM 220,78,0
PM 222,78,0
PV 236,108,36
ds_write_b64 v70, v[216:217] offset:192
CV 220,220,221
CV 221,222,223
PM 224,78,1
PM 226,78,1
PV 240,112,36
L_t6_pad4:
s_cbranch_execz L_t6_go
ds_write_b64 v70, v[220:221] offset:224
RK 160,15,0
RK 164,15,528
CV 224,224,225
RK 168,15,1056
CV 225,226,227
RK 172,15,1584
PM 228,78,1
PM 230,78,1
PV 244,116,36
ds_write_b64 v70, v[224:225] offset:0
CV 228,228,229
CV 229,230,231
PM 232,78,1
PM 234,78,1
PV 248,120,36
s_waitcnt lgkmcnt(4)
buffer_store_dwordx4 a[160:163], v72, s[28:31], s48 offen nt
ds_write_b64 v70, v[228:229] offset:32
CV 232,232,233
CV 233,234,235
PM 236,78,1
PM 238,78,1
PV 252,124,36
s_waitcnt lgkmcnt(4)
ds_write_b64 v70, v[232:233] offset:64
buffer_store_dwordx4 a[164:167], v73, s[28:31], s48 offen nt
CV 236,236,237
CV 237,238,239
ds_write_b64 v70, v[236:237] offset:96
PM 240,78,1
PM 242,78,1
CV 240,240,241
CV 241,242,243
ds_write_b64 v70, v[240:241] offset:128
s_waitcnt lgkmcnt(6)
buffer_store_dwordx4 a[168:171], v74, s[28:31], s48 offen nt
PM 244,78,1
PM 246,78,1
CV 244,244,245
CV 245,246,247
ds_write_b64 v70, v[244:245] offset:160
PM 248,78,1
PM 250,78,1
CV 248,248,249
CV 249,250,251
ds_write_b64 v70, v[248:249] offset:192
s_waitcnt lgkmcnt(7)
buffer_store_dwordx4 a[172:175], v75, s[28:31], s48 offen nt
PM 252,78,1
PM 254,78,1
CV 252,252,253
CV 253,254,255
ds_write_b64 v70, v[252:253] offset:224
RK 176,15,0
RK 180,15,528
RK 184,15,1056
RK 188,15,1584
s_waitcnt lgkmcnt(3)
buffer_store_dwordx4 a[176:179], v72, s[28:31], s49 offen nt
s_waitcnt lgkmcnt(2)
buffer_store_dwordx4 a[180:183], v73, s[28:31], s49 offen nt
s_waitcnt lgkmcnt(1)
buffer_store_dwordx4 a[184:187], v74, s[28:31], s49 offen nt
s_waitcnt lgkmcnt(0)
buffer_store_dwordx4 a[188:191], v75, s[28:31], s49 offen nt
s_cmp_lg_u64 s[4:5], 0
s_cselect_b32 s62, 1, 0
s_or_b32 s54, s54, s62
s_cmp_lg_u64 s[6:7], 0
s_cselect_b32 s62, 2, 0
s_or_b32 s54, s54, s62
s_cmp_lg_u64 s[8:9], 0
s_cselect_b32 s62, 4, 0
s_or_b32 s54, s54, s62
s_cmp_lg_u64 s[10:11], 0
s_cselect_b32 s62, 8, 0
s_or_b32 s54, s54, s62
s_cbranch_scc0 L_done6
s_mov_b32 s4, 0xdfa000
s_mov_b32 s5, 934
s_mov_b32 s6, 0xdfa000
s_mov_b32 s7, 934
s_mov_b32 s45, s44
s_getpc_b64 s[62:63]
L_fpc6:
s_add_u32 s62, s62, L_fallback-L_fpc6
s_addc_u32 s63, s63, 0
s_setpc_b64 s[62:63]
L_done6:
s_endpgm
L_end6:
.p2align 12
L_type7:
s_mov_b64 exec, 0
s_cmp_eq_u32 s12, 0
s_cbranch_scc1 L_t7_pad1
s_cmp_eq_u32 s12, 1
s_cbranch_scc1 L_t7_pad2
s_cmp_eq_u32 s12, 2
s_cbranch_scc1 L_t7_pad3
s_branch L_t7_pad4
L_t7_go:
s_mov_b64 exec, -1
s_add_u32 m0, s47, 0x10000
s_add_u32 s49, s44, 0x10000
s_add_u32 s50, s44, 0x20000
s_add_u32 s51, s44, 0x30000
s_waitcnt vmcnt(3)
buffer_load_dwordx4 v68, s[20:23], s40 offen lds
s_barrier
v_lshlrev_b32 v0, 16, v128
RK 0,60,0
RK 4,61,0
v_and_b32 v1, s71, v128
RK 8,62,0
v_lshlrev_b32 v2, 16, v129
buffer_load_dwordx4 v69, s[20:23], s40 offen offset:1024 lds
RK 12,63,0
s_mov_b32 s40, 0x797000
s_add_u32 m0, s47, 0x2000
v_and_b32 v3, s71, v129
v_lshlrev_b32 v4, 16, v130
v_and_b32 v5, s71, v130
v_lshlrev_b32 v6, 16, v131
v_and_b32_e64 v7, s71, v131
v_pk_mul_f32 v[0:1], v[0:1], s[14:15]
v_pk_mul_f32 v[2:3], v[2:3], s[14:15]
buffer_load_dwordx4 v[160:163], v72, s[24:27], s49 offen nt
v_pk_mul_f32 v[4:5], v[4:5], s[14:15]
v_pk_mul_f32 v[6:7], v[6:7], s[14:15]
CV 128,0,1
CV 129,2,3
CV 130,4,5
CV 131,6,7
ds_write_b128 v15, v[128:131] offset:0
buffer_load_dwordx4 v[164:167], v73, s[24:27], s49 offen nt
s_waitcnt vmcnt(6)
v_lshlrev_b32 v0, 16, v132
v_and_b32 v1, s71, v132
v_lshlrev_b32 v2, 16, v133
v_and_b32 v3, s71, v133
v_lshlrev_b32 v4, 16, v134
v_and_b32 v5, s71, v134
v_lshlrev_b32 v6, 16, v135
v_and_b32_e64 v7, s71, v135
v_pk_mul_f32 v[0:1], v[0:1], s[14:15]
v_pk_mul_f32 v[2:3], v[2:3], s[14:15]
buffer_load_dwordx4 v[168:171], v74, s[24:27], s49 offen nt
v_pk_mul_f32 v[4:5], v[4:5], s[14:15]
v_pk_mul_f32 v[6:7], v[6:7], s[14:15]
CV 132,0,1
CV 133,2,3
CV 134,4,5
CV 135,6,7
ds_write_b128 v15, v[132:135] offset:544
buffer_load_dwordx4 v[172:175], v75, s[24:27], s49 offen nt
s_waitcnt vmcnt(7)
v_lshlrev_b32 v0, 16, v136
v_and_b32 v1, s71, v136
v_lshlrev_b32 v2, 16, v137
v_and_b32 v3, s71, v137
v_lshlrev_b32 v4, 16, v138
v_and_b32 v5, s71, v138
v_lshlrev_b32 v6, 16, v139
v_and_b32_e64 v7, s71, v139
v_pk_mul_f32 v[0:1], v[0:1], s[14:15]
v_pk_mul_f32 v[2:3], v[2:3], s[14:15]
v_pk_mul_f32 v[4:5], v[4:5], s[14:15]
v_pk_mul_f32 v[6:7], v[6:7], s[14:15]
CV 136,0,1
CV 137,2,3
CV 138,4,5
CV 139,6,7
ds_write_b128 v15, v[136:139] offset:1152
s_waitcnt vmcnt(6)
v_lshlrev_b32 v0, 16, v140
v_and_b32 v1, s71, v140
v_lshlrev_b32 v2, 16, v141
v_and_b32 v3, s71, v141
v_lshlrev_b32 v4, 16, v142
v_and_b32 v5, s71, v142
v_lshlrev_b32 v6, 16, v143
v_and_b32_e64 v7, s71, v143
v_pk_mul_f32 v[0:1], v[0:1], s[14:15]
v_pk_mul_f32 v[2:3], v[2:3], s[14:15]
v_pk_mul_f32 v[4:5], v[4:5], s[14:15]
v_pk_mul_f32 v[6:7], v[6:7], s[14:15]
CV 140,0,1
CV 141,2,3
CV 142,4,5
CV 143,6,7
ds_write_b128 v15, v[140:143] offset:1696
RK 128,14,0
v_subrev_u32 v12, 0x30000, v71
v_subrev_u32 v13, 0x20000, v71
v_ashrrev_i32 v12, 31, v12
v_ashrrev_i32 v13, 31, v13
v_not_b32 v12, v12
v_not_b32 v13, v13
v_and_b32 v12, 0xff800000, v12
v_and_b32 v13, 0xff800000, v13
RK 132,14,64
RK 136,14,128
v_accvgpr_write_b32 a240, 0
v_accvgpr_write_b32 a241, 0
RK 140,14,192
v_accvgpr_write_b32 a242, 0
v_accvgpr_write_b32 a243, 0
v_accvgpr_write_b32 a244, 0
v_accvgpr_write_b32 a245, 0
s_waitcnt lgkmcnt(3)
QZ 16,0,128
s_mov_b32 s57, 12
v_accvgpr_write_b32 a246, 0
v_accvgpr_write_b32 a247, 0
s_mov_b32 s58, 0x20000
s_mov_b32 s60, 0x27e000
s_mov_b32 s59, 0x20000
s_mov_b32 s61, 0x5000
s_mul_i32 s45, s12, 0x20000
s_add_u32 s45, s45, 0xcf5000
s_mov_b64 s[32:33], s[24:25]
s_waitcnt lgkmcnt(2)
QK 16,4,132,16
s_waitcnt lgkmcnt(1)
s_mov_b32 s34, 0xdf9100
v_accvgpr_write_b32 a248, 0
v_accvgpr_write_b32 a249, 0
QK 16,8,136,16
s_waitcnt lgkmcnt(0)
s_mov_b32 s35, 0x20000
v_accvgpr_write_b32 a250, 0
v_accvgpr_write_b32 a251, 0
QK 16,12,140,16
s_mov_b64 s[36:37], s[28:29]
v_mov_b32 v34, 0
v_mov_b32 v35, 0
s_sub_u32 s57, s57, 1
s_cselect_b64 s[58:59], s[60:61], s[58:59]
s_mov_b32 s38, 0xdf9100
s_mov_b32 s39, 0x20000
s_nop 0
v_max3_f32 v8, v16, v17, v18
v_max_f32 v8, v8, v19
v_mov_b32 v9, v8
s_nop 1
v_permlane32_swap_b32 v8, v9
v_max_f32 v8, v8, v9
v_mov_b32 v9, v8
s_nop 1
v_permlane16_swap_b32 v8, v9
v_min_f32_e64 v40, -v8, -v9
v_add_f32 v8, v40, v12
v_add_f32 v9, v40, v13
v_add_f32 v16, v8, v16
v_add_f32 v17, v8, v17
v_add_f32 v18, v9, v18
v_add_f32 v19, v9, v19
EX 16
EX 17
EX 18
EX 19
CV 32,16,17
CV 33,18,19
v_mov_b32 v41, v40
s_waitcnt vmcnt(3)
buffer_load_dwordx4 v[192:195], v72, s[24:27], s50 offen nt
s_barrier
v_lshlrev_b32 v0, 16, v160
RV 64,64,0
RV 66,64,4096
v_and_b32_e64 v1, s71, v160
RV 68,65,0
buffer_load_dwordx4 v[196:199], v73, s[24:27], s50 offen nt
RV 70,65,4096
RV 72,64,256
v_lshlrev_b32 v2, 16, v161
RV 74,64,4352
RV 76,65,256
v_and_b32 v3, s71, v161
RV 78,65,4352
v_lshlrev_b32 v4, 16, v162
buffer_load_dwordx4 v[200:203], v74, s[24:27], s50 offen nt
RV 80,64,512
RV 82,64,4608
v_and_b32 v5, s71, v162
RV 84,65,512
RV 86,65,4608
v_lshlrev_b32_e64 v6, 16, v163
RV 88,64,768
RV 90,64,4864
buffer_load_dwordx4 v[204:207], v75, s[24:27], s50 offen nt
RV 92,65,768
v_and_b32_e64 v7, s71, v163
RV 94,65,4864
v_pk_mul_f32 v[0:1], v[0:1], s[14:15]
v_pk_mul_f32 v[2:3], v[2:3], s[14:15]
v_pk_mul_f32 v[4:5], v[4:5], s[14:15]
v_pk_mul_f32 v[6:7], v[6:7], s[14:15]
CV 160,0,1
CV 161,2,3
CV 162,4,5
CV 163,6,7
ds_write_b128 v15, v[160:163] offset:0
s_waitcnt vmcnt(6)
v_lshlrev_b32 v0, 16, v164
v_and_b32 v1, s71, v164
v_lshlrev_b32 v2, 16, v165
v_and_b32 v3, s71, v165
v_lshlrev_b32 v4, 16, v166
v_and_b32 v5, s71, v166
v_lshlrev_b32 v6, 16, v167
v_and_b32_e64 v7, s71, v167
v_pk_mul_f32 v[0:1], v[0:1], s[14:15]
v_pk_mul_f32 v[2:3], v[2:3], s[14:15]
v_pk_mul_f32 v[4:5], v[4:5], s[14:15]
v_pk_mul_f32 v[6:7], v[6:7], s[14:15]
CV 164,0,1
CV 165,2,3
CV 166,4,5
CV 167,6,7
ds_write_b128 v15, v[164:167] offset:544
s_waitcnt vmcnt(5)
v_lshlrev_b32 v0, 16, v168
v_and_b32 v1, s71, v168
v_lshlrev_b32 v2, 16, v169
v_and_b32 v3, s71, v169
v_lshlrev_b32 v4, 16, v170
v_and_b32 v5, s71, v170
v_lshlrev_b32 v6, 16, v171
v_and_b32_e64 v7, s71, v171
v_pk_mul_f32 v[0:1], v[0:1], s[14:15]
v_pk_mul_f32 v[2:3], v[2:3], s[14:15]
v_pk_mul_f32 v[4:5], v[4:5], s[14:15]
v_pk_mul_f32 v[6:7], v[6:7], s[14:15]
CV 168,0,1
CV 169,2,3
CV 170,4,5
CV 171,6,7
ds_write_b128 v15, v[168:171] offset:1152
s_waitcnt vmcnt(4)
v_lshlrev_b32 v0, 16, v172
v_and_b32 v1, s71, v172
v_lshlrev_b32 v2, 16, v173
v_and_b32 v3, s71, v173
v_lshlrev_b32 v4, 16, v174
v_and_b32 v5, s71, v174
v_lshlrev_b32 v6, 16, v175
v_and_b32_e64 v7, s71, v175
v_pk_mul_f32 v[0:1], v[0:1], s[14:15]
v_pk_mul_f32 v[2:3], v[2:3], s[14:15]
v_pk_mul_f32 v[4:5], v[4:5], s[14:15]
v_pk_mul_f32 v[6:7], v[6:7], s[14:15]
CV 172,0,1
CV 173,2,3
CV 174,4,5
CV 175,6,7
s_waitcnt lgkmcnt(15)
PZ 128,64,32
ds_write_b128 v15, v[172:175] offset:1696
PZ 132,68,32
s_waitcnt lgkmcnt(14)
RK 144,14,0
RK 148,14,64
PZ 136,72,32
s_waitcnt lgkmcnt(14)
RK 152,14,128
v_mov_b32 v42, v40
PZ 140,76,32
s_waitcnt lgkmcnt(13)
RK 156,14,192
v_mov_b32 v43, v40
PZ 144,80,32
s_waitcnt lgkmcnt(12)
PZ 148,84,32
s_waitcnt lgkmcnt(10)
PZ 152,88,32
s_waitcnt lgkmcnt(8)
PZ 156,92,32
s_waitcnt lgkmcnt(3)
QZ 24,0,144
s_waitcnt lgkmcnt(2)
QK 24,4,148,24
s_waitcnt lgkmcnt(1)
QK 24,8,152,24
s_waitcnt lgkmcnt(0)
QK 24,12,156,24
v_mov_b32 v38, 0
v_mov_b32 v39, 0
s_nop 5
v_max3_f32 v10, v24, v25, v26
v_max_f32 v10, v10, v27
v_mov_b32 v11, v10
s_nop 1
v_permlane32_swap_b32 v10, v11
v_max_f32 v10, v10, v11
v_mov_b32 v11, v10
s_nop 1
v_permlane16_swap_b32 v10, v11
v_min_f32_e64 v44, -v10, -v11
v_add_f32 v10, v44, v12
v_add_f32 v11, v44, v13
v_add_f32 v24, v10, v24
v_add_f32 v25, v10, v25
v_add_f32 v26, v11, v26
v_add_f32 v27, v11, v27
EX 24
EX 25
EX 26
EX 27
CV 36,24,25
CV 37,26,27
v_mov_b32 v45, v44
s_waitcnt vmcnt(3)
buffer_load_dwordx4 v[224:227], v72, s[24:27], s51 offen nt
v_lshlrev_b32 v0, 16, v192
v_and_b32 v1, s71, v192
v_lshlrev_b32 v2, 16, v193
v_and_b32 v3, s71, v193
v_lshlrev_b32 v4, 16, v194
v_and_b32 v5, s71, v194
v_lshlrev_b32 v6, 16, v195
v_and_b32 v7, s71, v195
buffer_load_dwordx4 v[228:231], v73, s[24:27], s51 offen nt
v_pk_mul_f32 v[0:1], v[0:1], s[14:15]
v_pk_mul_f32 v[2:3], v[2:3], s[14:15]
v_pk_mul_f32 v[4:5], v[4:5], s[14:15]
v_pk_mul_f32 v[6:7], v[6:7], s[14:15]
CV 192,0,1
CV 193,2,3
CV 194,4,5
CV 195,6,7
ds_write_b128 v15, v[192:195] offset:0
buffer_load_dwordx4 v[232:235], v74, s[24:27], s51 offen nt
s_waitcnt vmcnt(5)
v_lshlrev_b32 v0, 16, v196
v_and_b32 v1, s71, v196
v_lshlrev_b32 v2, 16, v197
v_and_b32 v3, s71, v197
v_lshlrev_b32 v4, 16, v198
v_and_b32 v5, s71, v198
v_lshlrev_b32 v6, 16, v199
v_and_b32_e64 v7, s71, v199
v_pk_mul_f32 v[0:1], v[0:1], s[14:15]
v_pk_mul_f32 v[2:3], v[2:3], s[14:15]
buffer_load_dwordx4 v[236:239], v75, s[24:27], s51 offen nt
v_pk_mul_f32 v[4:5], v[4:5], s[14:15]
v_pk_mul_f32 v[6:7], v[6:7], s[14:15]
CV 196,0,1
CV 197,2,3
CV 198,4,5
CV 199,6,7
ds_write_b128 v15, v[196:199] offset:544
s_waitcnt vmcnt(5)
v_lshlrev_b32 v0, 16, v200
v_and_b32 v1, s71, v200
v_lshlrev_b32 v2, 16, v201
v_and_b32 v3, s71, v201
v_lshlrev_b32 v4, 16, v202
v_and_b32 v5, s71, v202
v_lshlrev_b32 v6, 16, v203
v_and_b32_e64 v7, s71, v203
v_pk_mul_f32 v[0:1], v[0:1], s[14:15]
v_pk_mul_f32 v[2:3], v[2:3], s[14:15]
v_pk_mul_f32 v[4:5], v[4:5], s[14:15]
v_pk_mul_f32 v[6:7], v[6:7], s[14:15]
CV 200,0,1
CV 201,2,3
CV 202,4,5
CV 203,6,7
ds_write_b128 v15, v[200:203] offset:1152
s_waitcnt vmcnt(4)
v_lshlrev_b32 v0, 16, v204
v_and_b32 v1, s71, v204
v_lshlrev_b32 v2, 16, v205
v_and_b32 v3, s71, v205
v_lshlrev_b32 v4, 16, v206
v_and_b32 v5, s71, v206
v_lshlrev_b32 v6, 16, v207
v_and_b32_e64 v7, s71, v207
v_pk_mul_f32 v[0:1], v[0:1], s[14:15]
v_pk_mul_f32 v[2:3], v[2:3], s[14:15]
v_pk_mul_f32 v[4:5], v[4:5], s[14:15]
v_pk_mul_f32 v[6:7], v[6:7], s[14:15]
CV 204,0,1
CV 205,2,3
CV 206,4,5
CV 207,6,7
PZ 160,64,36
ds_write_b128 v15, v[204:207] offset:1696
PZ 164,68,36
RK 160,14,0
RK 164,14,64
PZ 168,72,36
RK 168,14,128
v_mov_b32 v46, v44
PZ 172,76,36
RK 172,14,192
v_mov_b32 v47, v44
PZ 176,80,36
PZ 180,84,36
PZ 184,88,36
PZ 188,92,36
v_smfmac_f32_16x16x64_bf16 a[240:243], v[56:59], v[32:39], v71
s_waitcnt lgkmcnt(3)
QZ 16,0,160
s_waitcnt lgkmcnt(2)
QK 16,4,164,16
s_waitcnt lgkmcnt(1)
QK 16,8,168,16
s_waitcnt lgkmcnt(0)
QK 16,12,172,16
v_mov_b32 v34, 0
v_mov_b32 v35, 0
s_nop 5
v_max3_f32 v8, v16, v17, v18
v_max_f32 v8, v8, v19
v_mov_b32 v9, v8
s_nop 1
v_permlane32_swap_b32 v8, v9
v_max_f32 v8, v8, v9
v_mov_b32 v9, v8
s_nop 1
v_permlane16_swap_b32 v8, v9
v_min_f32_e64 v48, -v8, -v9
v_add_f32 v8, v48, v12
v_add_f32 v9, v48, v13
v_add_f32 v16, v8, v16
v_add_f32 v17, v8, v17
v_add_f32 v18, v9, v18
v_add_f32 v19, v9, v19
EX 16
EX 17
EX 18
EX 19
CV 32,16,17
CV 33,18,19
v_mov_b32 v49, v48
s_waitcnt vmcnt(3)
buffer_load_dwordx4 v66, s[16:19], s40 offen lds
v_lshlrev_b32 v0, 16, v224
v_and_b32 v1, s71, v224
v_lshlrev_b32 v2, 16, v225
v_and_b32 v3, s71, v225
v_lshlrev_b32 v4, 16, v226
v_and_b32 v5, s71, v226
v_lshlrev_b32 v6, 16, v227
v_and_b32_e64 v7, s71, v227
buffer_load_dwordx4 v67, s[16:19], s40 offen offset:1024 lds
s_add_u32 m0, s47, 0x12000
v_pk_mul_f32 v[0:1], v[0:1], s[14:15]
v_pk_mul_f32 v[2:3], v[2:3], s[14:15]
v_pk_mul_f32 v[4:5], v[4:5], s[14:15]
v_pk_mul_f32 v[6:7], v[6:7], s[14:15]
CV 224,0,1
CV 225,2,3
CV 226,4,5
CV 227,6,7
ds_write_b128 v15, v[224:227] offset:0
buffer_load_dwordx4 v68, s[20:23], s40 offen lds
s_waitcnt vmcnt(5)
v_lshlrev_b32 v0, 16, v228
v_and_b32 v1, s71, v228
v_lshlrev_b32 v2, 16, v229
v_and_b32 v3, s71, v229
v_lshlrev_b32 v4, 16, v230
v_and_b32 v5, s71, v230
v_lshlrev_b32 v6, 16, v231
v_and_b32_e64 v7, s71, v231
v_pk_mul_f32 v[0:1], v[0:1], s[14:15]
v_pk_mul_f32 v[2:3], v[2:3], s[14:15]
buffer_load_dwordx4 v69, s[20:23], s40 offen offset:1024 lds
s_mov_b32 s40, 0x7b7000
s_add_u32 m0, s47, 0x4000
v_pk_mul_f32 v[4:5], v[4:5], s[14:15]
v_pk_mul_f32 v[6:7], v[6:7], s[14:15]
CV 228,0,1
CV 229,2,3
CV 230,4,5
CV 231,6,7
ds_write_b128 v15, v[228:231] offset:544
s_waitcnt vmcnt(5)
v_lshlrev_b32 v0, 16, v232
v_and_b32 v1, s71, v232
v_lshlrev_b32 v2, 16, v233
v_and_b32 v3, s71, v233
v_lshlrev_b32 v4, 16, v234
v_and_b32 v5, s71, v234
v_lshlrev_b32 v6, 16, v235
v_and_b32_e64 v7, s71, v235
v_pk_mul_f32 v[0:1], v[0:1], s[14:15]
v_pk_mul_f32 v[2:3], v[2:3], s[14:15]
v_pk_mul_f32 v[4:5], v[4:5], s[14:15]
v_pk_mul_f32 v[6:7], v[6:7], s[14:15]
CV 232,0,1
CV 233,2,3
CV 234,4,5
CV 235,6,7
ds_write_b128 v15, v[232:235] offset:1152
s_waitcnt vmcnt(4)
v_lshlrev_b32 v0, 16, v236
v_and_b32 v1, s71, v236
v_lshlrev_b32 v2, 16, v237
v_and_b32 v3, s71, v237
v_lshlrev_b32 v4, 16, v238
v_and_b32 v5, s71, v238
v_lshlrev_b32 v6, 16, v239
v_and_b32_e64 v7, s71, v239
v_pk_mul_f32 v[0:1], v[0:1], s[14:15]
v_pk_mul_f32 v[2:3], v[2:3], s[14:15]
v_pk_mul_f32 v[4:5], v[4:5], s[14:15]
v_pk_mul_f32 v[6:7], v[6:7], s[14:15]
CV 236,0,1
CV 237,2,3
CV 238,4,5
CV 239,6,7
PZ 192,64,32
buffer_load_dwordx4 v66, s[16:19], s40 offen lds
PZ 196,68,32
ds_write_b128 v15, v[236:239] offset:1696
PZ 200,72,32
RK 176,14,0
RK 180,14,64
PZ 204,76,32
s_waitcnt vmcnt(3)
s_barrier
PZ 208,80,32
RK 184,14,128
RK 188,14,192
PZ 212,84,32
buffer_load_dwordx4 v67, s[16:19], s40 offen offset:1024 lds
PZ 216,88,32
s_add_u32 m0, s47, 0x14000
RK 32,60,8192
RK 36,61,8192
PZ 220,92,32
s_waitcnt lgkmcnt(5)
RK 40,62,8192
v_mov_b32 v50, v48
QZ 24,0,176
s_waitcnt lgkmcnt(5)
RK 44,63,8192
v_mov_b32 v51, v48
QK 24,4,180,24
s_waitcnt lgkmcnt(5)
buffer_load_dwordx4 v68, s[20:23], s40 offen lds
QK 24,8,184,24
s_waitcnt lgkmcnt(4)
RK 48,60,12288
RK 52,61,12288
QK 24,12,188,24
s_waitcnt lgkmcnt(5)
RK 56,62,12288
v_xor_b32 v60, s43, v60
v_xor_b32 v61, s43, v61
QK 16,32,128,40
s_waitcnt lgkmcnt(5)
RK 60,63,12288
v_mov_b32 v38, 0
QK 16,36,132,16
s_waitcnt lgkmcnt(5)
buffer_load_dwordx4 v69, s[20:23], s40 offen offset:1024 lds
QK 16,40,136,16
s_waitcnt vmcnt(4) lgkmcnt(4)
s_barrier
QK 16,44,140,16
s_waitcnt lgkmcnt(3)
s_mov_b32 s40, 0x7d7000
s_add_u32 m0, s47, 0x6000
v_max3_f32 v10, v24, v25, v26
QK 20,48,128,40
s_waitcnt lgkmcnt(2)
v_max_f32 v10, v10, v27
v_mov_b32 v39, 0
QK 20,52,132,20
s_waitcnt lgkmcnt(1)
buffer_load_dwordx4 v66, s[16:19], s40 offen lds
QK 20,56,136,20
s_waitcnt lgkmcnt(0)
RV 96,64,8192
v_mov_b32 v11, v10
QK 20,60,140,20
s_xor_b32 s41, s41, s43
RV 98,64,12288
RV 100,65,8192
v_permlane32_swap_b32 v10, v11
v_max_f32 v10, v10, v11
EX 16
v_mov_b32 v11, v10
EX 17
EX 18
v_permlane16_swap_b32 v10, v11
v_min_f32_e64 v52, -v10, -v11
EX 19
v_add_f32 v10, v52, v12
v_add_f32 v11, v52, v13
v_add_f32 v24, v10, v24
v_add_f32 v25, v10, v25
v_add_f32 v26, v11, v26
v_add_f32 v27, v11, v27
EX 24
EX 25
EX 26
EX 27
CV 36,24,25
CV 37,26,27
QK 24,32,144,44
buffer_load_dwordx4 v67, s[16:19], s40 offen offset:1024 lds
QK 24,36,148,24
s_add_u32 m0, s47, 0x16000
RV 102,65,12288
RV 104,64,8448
QK 24,40,152,24
s_xor_b32 s42, s41, 0xc000
RV 106,64,12544
v_mov_b32 v53, v52
QK 24,44,156,24
buffer_load_dwordx4 v68, s[20:23], s40 offen lds
v_smfmac_f32_16x16x64_bf16 a[244:247], v[56:59], v[32:39], v71
CV 32,16,17
QK 28,48,144,44
RV 108,65,8448
CV 33,18,19
QK 28,52,148,28
RV 110,65,12544
RV 112,64,8704
QK 28,56,152,28
buffer_load_dwordx4 v69, s[20:23], s40 offen offset:1024 lds
QK 28,60,156,28
s_mov_b32 s40, 0x7f7000
RV 114,64,12800
s_add_u32 m0, s47, 0xc000
PZ 224,64,36
RV 116,65,8704
RV 118,65,12800
PZ 228,68,36
RV 120,64,8960
v_mov_b32 v54, v52
PZ 232,72,36
buffer_load_dwordx4 v66, s[16:19], s40 offen lds
PZ 236,76,36
RV 122,64,13056
RV 124,65,8960
PZ 240,80,36
RV 126,65,13056
v_mov_b32 v55, v52
PZ 244,84,36
L_t7_pad1:
s_cbranch_execz L_t7_pad5
EX 20
PZ 248,88,36
buffer_load_dwordx4 v67, s[16:19], s40 offen offset:1024 lds
PZ 252,92,36
EX 21
QK 16,32,160,48
s_add_u32 m0, s47, 0x1c000
EX 22
QK 16,36,164,16
EX 23
QK 16,40,168,16
buffer_load_dwordx4 v68, s[20:23], s40 offen lds
QK 16,44,172,16
CV 34,20,21
CV 35,22,23
QK 20,48,160,48
EX 24
QK 20,52,164,20
EX 25
QK 20,56,168,20
s_waitcnt lgkmcnt(0)
EX 26
QK 20,60,172,20
EX 27
PV 128,96,32
CV 36,24,25
CV 37,26,27
PV 132,100,32
buffer_load_dwordx4 v69, s[20:23], s40 offen offset:1024 lds
PV 136,104,32
EX 28
PV 140,108,32
EX 29
PV 144,112,32
EX 30
PV 148,116,32
s_mov_b32 s40, 0x817000
EX 31
PV 152,120,32
s_add_u32 m0, s47, 0xe000
CV 38,28,29
CV 39,30,31
PV 156,124,32
v_xor_b32 v62, s43, v62
v_xor_b32 v63, s43, v63
QK 24,32,176,52
buffer_load_dwordx4 v66, s[16:19], s40 offen lds
QK 24,36,180,24
EX 16
QK 24,40,184,24
EX 17
QK 24,44,188,24
EX 18
v_smfmac_f32_16x16x64_bf16 a[240:243], v[56:59], v[32:39], v71
s_waitcnt vmcnt(11)
s_barrier
QK 28,48,176,52
RK 0,60,0
RK 4,61,0
QK 28,52,180,28
RK 8,62,0
CV 32,16,17
QK 28,56,184,28
buffer_load_dwordx4 v67, s[16:19], s40 offen offset:1024 lds
QK 28,60,188,28
RK 12,63,0
RK 16,60,4096
PV 160,96,36
RK 20,61,4096
v_xor_b32 v64, s43, v64
PV 164,100,36
RK 24,62,4096
v_xor_b32 v65, s43, v65
PV 168,104,36
s_xor_b32 s43, s43, 0xc000
RK 28,63,4096
v_subrev_u32 v12, 0x20000, v71
PV 172,108,36
EX 19
PV 176,112,36
s_add_u32 m0, s47, 0x1e000
CV 33,18,19
v_subrev_u32 v13, 0x10000, v71
PV 180,116,36
EX 20
PV 184,120,36
buffer_load_dwordx4 v68, s[20:23], s40 offen lds
PV 188,124,36
s_waitcnt lgkmcnt(7)
EX 21
QK 16,0,128,40
s_waitcnt lgkmcnt(0)
EX 22
QK 16,4,132,16
EX 23
QK 16,8,136,16
CV 34,20,21
CV 35,22,23
QK 16,12,140,16
EX 24
QK 20,16,128,40
EX 25
QK 20,20,132,20
buffer_load_dwordx4 v69, s[20:23], s40 offen offset:1024 lds
QK 20,24,136,20
EX 26
QK 20,28,140,20
EX 27
PV 192,96,32
CV 36,24,25
CV 37,26,27
PV 196,100,32
EX 28
PV 200,104,32
s_waitcnt vmcnt(12)
s_barrier
PV 204,108,32
EX 29
PV 208,112,32
EX 30
PV 212,116,32
EX 31
PV 216,120,32
CV 38,28,29
CV 39,30,31
PV 220,124,32
s_mov_b32 s40, 0x837000
EX 16
QK 24,0,144,44
s_add_u32 m0, s47, 0x8000
EX 17
QK 24,4,148,24
EX 18
QK 24,8,152,24
buffer_load_dwordx4 v66, s[16:19], s40 offen lds
QK 24,12,156,24
EX 19
v_smfmac_f32_16x16x64_bf16 a[244:247], v[56:59], v[32:39], v71
CV 32,16,17
QK 28,16,144,44
RV 64,64,0
CV 33,18,19
QK 28,20,148,28
RV 66,64,4096
RV 68,65,0
QK 28,24,152,28
RV 70,65,4096
v_ashrrev_i32 v12, 31, v12
QK 28,28,156,28
RV 72,64,256
RV 74,64,4352
PV 224,96,36
RV 76,65,256
v_ashrrev_i32 v13, 31, v13
PV 228,100,36
buffer_load_dwordx4 v67, s[16:19], s40 offen offset:1024 lds
PV 232,104,36
RV 78,65,4352
RV 80,64,512
PV 236,108,36
s_waitcnt vmcnt(10)
s_barrier
PV 240,112,36
RK 32,60,8192
RK 36,61,8192
PV 244,116,36
RK 40,62,8192
v_not_b32 v12, v12
PV 248,120,36
RK 44,63,8192
v_not_b32 v13, v13
PV 252,124,36
s_add_u32 m0, s47, 0x18000
RK 48,60,12288
v_and_b32 v12, 0xff800000, v12
QK 16,0,160,48
RK 52,61,12288
v_xor_b32 v60, s43, v60
QK 16,4,164,16
RK 56,62,12288
v_xor_b32 v61, s43, v61
QK 16,8,168,16
RK 60,63,12288
v_xor_b32 v62, s43, v62
QK 16,12,172,16
buffer_load_dwordx4 v68, s[20:23], s40 offen lds
RV 82,64,4608
EX 20
EX 21
EX 22
EX 23
CV 34,20,21
CV 35,22,23
QK 20,16,160,48
RV 84,65,512
RV 86,65,4608
QK 20,20,164,20
RV 88,64,768
v_xor_b32 v63, s43, v63
QK 20,24,168,20
RV 90,64,4864
RV 92,65,768
QK 20,28,172,20
s_waitcnt lgkmcnt(15)
RV 94,65,4864
v_and_b32 v13, 0xff800000, v13
PV 128,64,32
RV 96,64,8192
RV 98,64,12288
PV 132,68,32
EX 24
PV 136,72,32
RV 100,65,8192
RV 102,65,12288
PV 140,76,32
s_waitcnt lgkmcnt(10)
buffer_load_dwordx4 v69, s[20:23], s40 offen offset:1024 lds
PV 144,80,32
s_waitcnt lgkmcnt(8)
RV 104,64,8448
RV 106,64,12544
PV 148,84,32
s_waitcnt lgkmcnt(6)
EX 25
PV 152,88,32
EX 26
PV 156,92,32
RV 108,65,8448
EX 27
CV 36,24,25
CV 37,26,27
QK 24,0,176,52
EX 28
QK 24,4,180,24
EX 29
QK 24,8,184,24
EX 30
QK 24,12,188,24
RV 110,65,12544
RV 112,64,8704
EX 31
CV 38,28,29
CV 39,30,31
EX 16
s_nop 0
v_smfmac_f32_16x16x64_bf16 a[240:243], v[56:59], v[32:39], v71
RV 114,64,12800
QK 28,16,176,52
EX 17
QK 28,20,180,28
EX 18
QK 28,24,184,28
RV 116,65,8704
CV 32,16,17
QK 28,28,188,28
EX 19
PV 160,64,36
RV 118,65,12800
CV 33,18,19
PV 164,68,36
EX 20
PV 168,72,36
EX 21
PV 172,76,36
RV 120,64,8960
CV 34,20,21
PV 176,80,36
EX 22
PV 180,84,36
EX 23
PV 184,88,36
RV 122,64,13056
CV 35,22,23
PV 188,92,36
RV 124,65,8960
v_xor_b32 v64, s43, v64
QK 16,32,128,40
EX 24
QK 16,36,132,16
EX 25
QK 16,40,136,16
RV 126,65,13056
CV 36,24,25
QK 16,44,140,16
EX 26
QK 20,48,128,40
EX 27
QK 20,52,132,20
CV 37,26,27
v_xor_b32 v65, s43, v65
QK 20,56,136,20
EX 28
QK 20,60,140,20
EX 29
PV 192,64,32
EX 30
PV 196,68,32
EX 31
PV 200,72,32
CV 38,28,29
CV 39,30,31
PV 204,76,32
EX 16
PV 208,80,32
s_waitcnt vmcnt(8) lgkmcnt(0)
s_barrier
PV 212,84,32
EX 17
PV 216,88,32
s_xor_b32 s41, s41, s43
EX 18
PV 220,92,32
s_xor_b32 s42, s41, 0xc000
EX 19
QK 24,32,144,44
s_xor_b32 s43, s43, 0xc000
RK 0,60,0
RK 4,61,0
QK 24,36,148,24
s_mov_b32 s40, 0x857000
EX 20
QK 24,40,152,24
s_add_u32 m0, s47, 0xa000
EX 21
QK 24,44,156,24
RK 8,62,0
v_smfmac_f32_16x16x64_bf16 a[244:247], v[56:59], v[32:39], v71
CV 32,16,17
QK 28,48,144,44
buffer_load_dwordx4 v66, s[16:19], s40 offen lds
QK 28,52,148,28
RK 12,63,0
CV 33,18,19
QK 28,56,152,28
RK 16,60,4096
CV 34,20,21
QK 28,60,156,28
EX 22
PV 224,64,36
EX 23
PV 228,68,36
RK 20,61,4096
CV 35,22,23
PV 232,72,36
buffer_load_dwordx4 v67, s[16:19], s40 offen offset:1024 lds
PV 236,76,36
EX 24
PV 240,80,36
EX 25
PV 244,84,36
RK 24,62,4096
RK 28,63,4096
PV 248,88,36
EX 26
PV 252,92,36
RV 64,64,0
CV 36,24,25
QK 16,32,160,48
s_add_u32 m0, s47, 0x1a000
EX 27
QK 16,36,164,16
EX 28
QK 16,40,168,16
buffer_load_dwordx4 v68, s[20:23], s40 offen lds
QK 16,44,172,16
RV 66,64,4096
CV 37,26,27
QK 20,48,160,48
EX 29
QK 20,52,164,20
RV 68,65,0
CV 38,28,29
QK 20,56,168,20
EX 30
QK 20,60,172,20
EX 31
PV 128,96,32
RV 70,65,4096
CV 39,30,31
PV 132,100,32
buffer_load_dwordx4 v69, s[20:23], s40 offen offset:1024 lds
PV 136,104,32
EX 16
PV 140,108,32
RV 72,64,256
RV 74,64,4352
PV 144,112,32
EX 17
PV 148,116,32
s_mov_b32 s40, 0x877000
EX 18
PV 152,120,32
s_add_u32 m0, s47, 0x0
EX 19
PV 156,124,32
RV 76,65,256
QK 24,32,176,52
buffer_load_dwordx4 v66, s[16:19], s40 offen lds
QK 24,36,180,24
EX 20
QK 24,40,184,24
RV 78,65,4352
RV 80,64,512
QK 24,44,188,24
EX 21
v_smfmac_f32_16x16x64_bf16 a[240:243], v[56:59], v[32:39], v71
RV 82,64,4608
QK 28,48,176,52
CV 32,16,17
CV 33,18,19
QK 28,52,180,28
EX 22
QK 28,56,184,28
buffer_load_dwordx4 v67, s[16:19], s40 offen offset:1024 lds
QK 28,60,188,28
RV 84,65,512
CV 34,20,21
PV 160,96,36
EX 23
PV 164,100,36
RV 86,65,4608
CV 35,22,23
PV 168,104,36
EX 24
PV 172,108,36
EX 25
PV 176,112,36
s_add_u32 m0, s47, 0x10000
EX 26
PV 180,116,36
RV 88,64,768
RV 90,64,4864
PV 184,120,36
buffer_load_dwordx4 v68, s[20:23], s40 offen lds
PV 188,124,36
s_waitcnt lgkmcnt(14)
RV 92,65,768
CV 36,24,25
QK 16,0,128,40
EX 27
QK 16,4,132,16
RV 94,65,4864
CV 37,26,27
QK 16,8,136,16
EX 28
QK 16,12,140,16
EX 29
QK 20,16,128,40
EX 30
QK 20,20,132,20
buffer_load_dwordx4 v69, s[20:23], s40 offen offset:1024 lds
QK 20,24,136,20
EX 31
QK 20,28,140,20
CV 38,28,29
CV 39,30,31
PV 192,96,32
EX 16
PV 196,100,32
PV 200,104,32
EX 17
PV 204,108,32
PV 208,112,32
s_waitcnt vmcnt(12) lgkmcnt(0)
s_barrier
PV 212,116,32
s_add_u32 s40, s40, s58
EX 18
PV 216,120,32
s_add_u32 m0, s42, 0x2000
EX 19
PV 220,124,32
s_mov_b32 s58, s59
RK 32,60,8192
QK 24,0,144,44
s_mov_b32 s59, 0x20000
EX 20
QK 24,4,148,24
RK 36,61,8192
QK 24,8,152,24
buffer_load_dwordx4 v66, s[16:19], s40 offen lds
QK 24,12,156,24
EX 21
v_smfmac_f32_16x16x64_bf16 a[244:247], v[56:59], v[32:39], v71
s_sub_u32 s57, s57, 1
s_cselect_b64 s[58:59], s[60:61], s[58:59]
RK 40,62,8192
QK 28,16,144,44
RK 44,63,8192
CV 32,16,17
QK 28,20,148,28
CV 33,18,19
CV 34,20,21
QK 28,24,152,28
EX 22
QK 28,28,156,28
EX 23
PV 224,96,36
RK 48,60,12288
RK 52,61,12288
PV 228,100,36
buffer_load_dwordx4 v67, s[16:19], s40 offen offset:1024 lds
PV 232,104,36
CV 35,22,23
v_xor_b32 v60, s43, v60
PV 236,108,36
RK 56,62,12288
v_xor_b32 v61, s43, v61
PV 240,112,36
EX 24
PV 244,116,36
s_add_u32 m0, s42, 0x12000
RK 60,63,12288
v_xor_b32 v62, s43, v62
PV 248,120,36
EX 25
PV 252,124,36
RV 96,64,8192
CV 36,24,25
QK 16,0,160,48
EX 26
QK 16,4,164,16
buffer_load_dwordx4 v68, s[20:23], s40 offen lds
QK 16,8,168,16
RV 98,64,12288
v_xor_b32 v63, s43, v63
QK 16,12,172,16
EX 27
QK 20,16,160,48
RV 100,65,8192
CV 37,26,27
QK 20,20,164,20
EX 28
QK 20,24,168,20
EX 29
QK 20,28,172,20
RV 102,65,12288
CV 38,28,29
PV 128,64,32
EX 30
PV 132,68,32
buffer_load_dwordx4 v69, s[20:23], s40 offen offset:1024 lds
PV 136,72,32
EX 31
PV 140,76,32
RV 104,64,8448
RV 106,64,12544
PV 144,80,32
EX 16
PV 148,84,32
RV 108,65,8448
CV 39,30,31
PV 152,88,32
EX 17
PV 156,92,32
EX 18
QK 24,0,176,52
EX 19
QK 24,4,180,24
EX 20
QK 24,8,184,24
RV 110,65,12544
RV 112,64,8704
QK 24,12,188,24
EX 21
v_smfmac_f32_16x16x64_bf16 a[240:243], v[56:59], v[32:39], v71
RV 114,64,12800
QK 28,16,176,52
CV 32,16,17
CV 33,18,19
QK 28,20,180,28
EX 22
QK 28,24,184,28
RV 116,65,8704
CV 34,20,21
QK 28,28,188,28
EX 23
PV 160,64,36
RV 118,65,12800
CV 35,22,23
PV 164,68,36
EX 24
PV 168,72,36
EX 25
PV 172,76,36
RV 120,64,8960
PV 176,80,36
EX 26
PV 180,84,36
RV 122,64,13056
v_xor_b32 v64, s43, v64
PV 184,88,36
EX 27
PV 188,92,36
s_waitcnt lgkmcnt(14)
RV 124,65,8960
CV 36,24,25
QK 16,32,128,40
L_t7_pad2:
s_cbranch_execz L_t7_pad6
EX 28
QK 16,36,132,16
RV 126,65,13056
CV 37,26,27
QK 16,40,136,16
EX 29
QK 16,44,140,16
CV 38,28,29
v_xor_b32 v65, s43, v65
QK 20,48,128,40
EX 30
QK 20,52,132,20
QK 20,56,136,20
v_exp_f32_e64 v31, v31
QK 20,60,140,20
CV 39,30,31
PV 192,64,32
EX 16
PV 196,68,32
PV 200,72,32
v_exp_f32_e64 v17, v17
PV 204,76,32
PV 208,80,32
s_waitcnt vmcnt(8) lgkmcnt(0)
s_barrier
PV 212,84,32
s_mov_b32 s56, 4
L_t7_loop0:
PV 216,88,32
s_xor_b32 s41, s41, s43
EX 18
PV 220,92,32
s_xor_b32 s42, s41, 0xc000
RK 0,60,0
QK 24,32,144,44
s_add_u32 s40, s40, s58
EX 19
QK 24,36,148,24
s_add_u32 m0, s42, 0x0
RK 4,61,0
QK 24,40,152,24
buffer_load_dwordx4 v66, s[16:19], s40 offen lds
QK 24,44,156,24
s_mov_b32 s58, s59
RK 8,62,0
v_smfmac_f32_16x16x64_bf16 a[244:247], v[56:59], v[32:39], v71
s_mov_b32 s59, 0x20000
s_xor_b32 s43, s43, 0xc000
CV 32,16,17
QK 28,48,144,44
RK 12,63,0
CV 33,18,19
QK 28,52,148,28
EX 20
QK 28,56,152,28
EX 21
QK 28,60,156,28
RK 16,60,4096
CV 34,20,21
PV 224,64,36
EX 22
PV 228,68,36
buffer_load_dwordx4 v67, s[16:19], s40 offen offset:1024 lds
PV 232,72,36
RK 20,61,4096
PV 236,76,36
EX 23
PV 240,80,36
RK 24,62,4096
CV 35,22,23
PV 244,84,36
s_add_u32 m0, s42, 0x10000
EX 24
PV 248,88,36
RK 28,63,4096
PV 252,92,36
EX 25
QK 16,32,160,48
RV 64,64,0
CV 36,24,25
QK 16,36,164,16
buffer_load_dwordx4 v68, s[20:23], s40 offen lds
QK 16,40,168,16
EX 26
QK 16,44,172,16
RV 66,64,4096
QK 20,48,160,48
EX 27
QK 20,52,164,20
RV 68,65,0
CV 37,26,27
QK 20,56,168,20
EX 28
QK 20,60,172,20
RV 70,65,4096
PV 128,96,32
EX 29
PV 132,100,32
buffer_load_dwordx4 v69, s[20:23], s40 offen offset:1024 lds
PV 136,104,32
RV 72,64,256
CV 38,28,29
PV 140,108,32
EX 30
PV 144,112,32
RV 74,64,4352
PV 148,116,32
EX 31
PV 152,120,32
RV 76,65,256
CV 39,30,31
PV 156,124,32
EX 16
QK 24,32,176,52
EX 17
QK 24,36,180,24
RV 78,65,4352
QK 24,40,184,24
EX 18
QK 24,44,188,24
RV 80,64,512
v_smfmac_f32_16x16x64_bf16 a[240:243], v[56:59], v[32:39], v71
s_sub_u32 s57, s57, 1
s_cselect_b64 s[58:59], s[60:61], s[58:59]
RV 82,64,4608
QK 28,48,176,52
EX 19
QK 28,52,180,28
CV 32,16,17
CV 33,18,19
QK 28,56,184,28
EX 20
QK 28,60,188,28
RV 84,65,512
PV 160,96,36
EX 21
PV 164,100,36
RV 86,65,4608
CV 34,20,21
PV 168,104,36
EX 22
PV 172,108,36
RV 88,64,768
PV 176,112,36
EX 23
PV 180,116,36
RV 90,64,4864
CV 35,22,23
PV 184,120,36
EX 24
PV 188,124,36
s_waitcnt lgkmcnt(14)
EX 25
QK 16,0,128,40
RV 92,65,768
CV 36,24,25
QK 16,4,132,16
EX 26
QK 16,8,136,16
RV 94,65,4864
QK 16,12,140,16
EX 27
QK 20,16,128,40
EX 28
QK 20,20,132,20
EX 29
QK 20,24,136,20
CV 37,26,27
CV 38,28,29
QK 20,28,140,20
EX 30
PV 192,96,32
EX 31
PV 196,100,32
EX 16
PV 200,104,32
EX 17
PV 204,108,32
CV 39,30,31
PV 208,112,32
s_waitcnt lgkmcnt(0)
EX 18
PV 212,116,32
s_add_u32 s40, s40, s58
PV 216,120,32
s_add_u32 m0, s42, 0x2000
EX 19
PV 220,124,32
s_mov_b32 s58, s59
RK 32,60,8192
QK 24,0,144,44
s_mov_b32 s59, 0x20000
EX 20
QK 24,4,148,24
RK 36,61,8192
QK 24,8,152,24
buffer_load_dwordx4 v66, s[16:19], s40 offen lds
QK 24,12,156,24
RK 40,62,8192
v_smfmac_f32_16x16x64_bf16 a[244:247], v[56:59], v[32:39], v71
s_sub_u32 s57, s57, 1
s_cselect_b64 s[58:59], s[60:61], s[58:59]
CV 32,16,17
QK 28,16,144,44
RK 44,63,8192
CV 33,18,19
QK 28,20,148,28
EX 21
QK 28,24,152,28
RK 48,60,12288
CV 34,20,21
QK 28,28,156,28
EX 22
PV 224,96,36
RK 52,61,12288
v_xor_b32 v60, s43, v60
PV 228,100,36
buffer_load_dwordx4 v67, s[16:19], s40 offen offset:1024 lds
PV 232,104,36
EX 23
PV 236,108,36
RK 56,62,12288
CV 35,22,23
PV 240,112,36
EX 24
PV 244,116,36
s_add_u32 m0, s42, 0x12000
RK 60,63,12288
v_xor_b32 v61, s43, v61
PV 248,120,36
EX 25
PV 252,124,36
RV 96,64,8192
CV 36,24,25
QK 16,0,160,48
EX 26
QK 16,4,164,16
buffer_load_dwordx4 v68, s[20:23], s40 offen lds
QK 16,8,168,16
RV 98,64,12288
v_xor_b32 v62, s43, v62
QK 16,12,172,16
EX 27
QK 20,16,160,48
RV 100,65,8192
CV 37,26,27
QK 20,20,164,20
EX 28
QK 20,24,168,20
RV 102,65,12288
v_xor_b32 v63, s43, v63
QK 20,28,172,20
EX 29
PV 128,64,32
EX 30
PV 132,68,32
buffer_load_dwordx4 v69, s[20:23], s40 offen offset:1024 lds
PV 136,72,32
RV 104,64,8448
CV 38,28,29
PV 140,76,32
EX 31
PV 144,80,32
RV 106,64,12544
CV 39,30,31
PV 148,84,32
EX 16
PV 152,88,32
RV 108,65,8448
PV 156,92,32
EX 17
QK 24,0,176,52
EX 18
QK 24,4,180,24
RV 110,65,12544
QK 24,8,184,24
EX 19
QK 24,12,188,24
RV 112,64,8704
v_smfmac_f32_16x16x64_bf16 a[240:243], v[56:59], v[32:39], v71
RV 114,64,12800
QK 28,16,176,52
CV 32,16,17
CV 33,18,19
QK 28,20,180,28
EX 20
QK 28,24,184,28
EX 21
QK 28,28,188,28
RV 116,65,8704
CV 34,20,21
PV 160,64,36
EX 22
PV 164,68,36
RV 118,65,12800
PV 168,72,36
EX 23
PV 172,76,36
RV 120,64,8960
CV 35,22,23
PV 176,80,36
EX 24
PV 180,84,36
EX 25
PV 184,88,36
RV 122,64,13056
v_xor_b32 v64, s43, v64
PV 188,92,36
s_waitcnt lgkmcnt(14)
RV 124,65,8960
CV 36,24,25
QK 16,32,128,40
EX 26
QK 16,36,132,16
EX 27
QK 16,40,136,16
RV 126,65,13056
CV 37,26,27
QK 16,44,140,16
EX 28
QK 20,48,128,40
EX 29
QK 20,52,132,20
EX 30
QK 20,56,136,20
EX 31
QK 20,60,140,20
CV 38,28,29
CV 39,30,31
PV 192,64,32
EX 16
PV 196,68,32
v_xor_b32 v65, s43, v65
PV 200,72,32
EX 17
PV 204,76,32
PV 208,80,32
s_waitcnt vmcnt(8) lgkmcnt(0)
s_barrier
PV 212,84,32
s_sub_u32 s56, s56, 1
s_cbranch_scc0 L_t7_loop0
PV 216,88,32
s_xor_b32 s41, s41, s43
EX 18
PV 220,92,32
s_xor_b32 s42, s41, 0xc000
EX 19
QK 24,32,144,44
s_add_u32 s40, s40, s58
RK 0,60,0
RK 4,61,0
QK 24,36,148,24
s_add_u32 m0, s42, 0x0
EX 20
QK 24,40,152,24
buffer_load_dwordx4 v66, s[16:19], s40 offen lds
QK 24,44,156,24
s_add_u32 s52, s45, 0x0
EX 21
v_smfmac_f32_16x16x64_bf16 a[244:247], v[56:59], v[32:39], v71
s_mov_b32 s58, s59
s_mov_b32 s59, 0x20000
RK 8,62,0
QK 28,48,144,44
buffer_load_dwordx4 v[80:83], v72, s[32:35], s52 offen nt
QK 28,52,148,28
s_xor_b32 s43, s43, 0xc000
RK 12,63,0
CV 32,16,17
QK 28,56,152,28
RK 16,60,4096
CV 33,18,19
QK 28,60,156,28
EX 22
PV 224,64,36
RK 20,61,4096
CV 34,20,21
PV 228,68,36
buffer_load_dwordx4 v67, s[16:19], s40 offen offset:1024 lds
PV 232,72,36
EX 23
PV 236,76,36
RK 24,62,4096
CV 35,22,23
PV 240,80,36
EX 24
PV 244,84,36
s_add_u32 m0, s42, 0x10000
EX 25
PV 248,88,36
EX 26
PV 252,92,36
RK 28,63,4096
RV 64,64,0
QK 16,32,160,48
EX 27
QK 16,36,164,16
buffer_load_dwordx4 v68, s[20:23], s40 offen lds
QK 16,40,168,16
RV 66,64,4096
CV 36,24,25
QK 16,44,172,16
EX 28
QK 20,48,160,48
RV 68,65,0
CV 37,26,27
QK 20,52,164,20
EX 29
QK 20,56,168,20
RV 70,65,4096
CV 38,28,29
QK 20,60,172,20
EX 30
PV 128,96,32
EX 31
PV 132,100,32
buffer_load_dwordx4 v69, s[20:23], s40 offen offset:1024 lds
PV 136,104,32
RV 72,64,256
CV 39,30,31
PV 140,108,32
EX 16
PV 144,112,32
EX 17
PV 148,116,32
RV 74,64,4352
RV 76,65,256
PV 152,120,32
EX 18
PV 156,124,32
EX 19
QK 24,32,176,52
EX 20
QK 24,36,180,24
RV 78,65,4352
QK 24,40,184,24
EX 21
QK 24,44,188,24
RV 80,64,512
v_smfmac_f32_16x16x64_bf16 a[240:243], v[56:59], v[32:39], v71
s_sub_u32 s57, s57, 1
s_cselect_b64 s[58:59], s[60:61], s[58:59]
RV 82,64,4608
QK 28,48,176,52
CV 32,16,17
CV 33,18,19
QK 28,52,180,28
EX 22
QK 28,56,184,28
buffer_load_dwordx4 v[84:87], v73, s[32:35], s52 offen nt
QK 28,60,188,28
RV 84,65,512
CV 34,20,21
PV 160,96,36
EX 23
PV 164,100,36
RV 86,65,4608
CV 35,22,23
PV 168,104,36
EX 24
PV 172,108,36
EX 25
PV 176,112,36
EX 26
PV 180,116,36
RV 88,64,768
RV 90,64,4864
PV 184,120,36
EX 27
PV 188,124,36
s_waitcnt lgkmcnt(14)
RV 92,65,768
CV 36,24,25
QK 16,0,128,40
EX 28
QK 16,4,132,16
RV 94,65,4864
CV 37,26,27
QK 16,8,136,16
EX 29
QK 16,12,140,16
CV 38,28,29
QK 20,16,128,40
EX 30
QK 20,20,132,20
QK 20,24,136,20
EX 31
QK 20,28,140,20
CV 39,30,31
PV 192,96,32
EX 16
PV 196,100,32
PV 200,104,32
EX 17
PV 204,108,32
PV 208,112,32
s_waitcnt lgkmcnt(0)
EX 18
PV 212,116,32
s_add_u32 s40, s40, s58
PV 216,120,32
s_add_u32 m0, s42, 0x2000
EX 19
PV 220,124,32
s_mov_b32 s58, s59
RK 32,60,8192
QK 24,0,144,44
s_mov_b32 s59, 0x20000
EX 20
QK 24,4,148,24
RK 36,61,8192
QK 24,8,152,24
buffer_load_dwordx4 v66, s[16:19], s40 offen lds
QK 24,12,156,24
EX 21
v_smfmac_f32_16x16x64_bf16 a[244:247], v[56:59], v[32:39], v71
s_sub_u32 s57, s57, 1
s_cselect_b64 s[58:59], s[60:61], s[58:59]
RK 40,62,8192
QK 28,16,144,44
RK 44,63,8192
CV 32,16,17
QK 28,20,148,28
CV 33,18,19
CV 34,20,21
QK 28,24,152,28
EX 22
QK 28,28,156,28
EX 23
PV 224,96,36
RK 48,60,12288
RK 52,61,12288
PV 228,100,36
buffer_load_dwordx4 v67, s[16:19], s40 offen offset:1024 lds
PV 232,104,36
CV 35,22,23
v_xor_b32 v60, s43, v60
PV 236,108,36
RK 56,62,12288
v_xor_b32 v61, s43, v61
PV 240,112,36
EX 24
PV 244,116,36
buffer_load_dwordx4 v[88:91], v74, s[32:35], s52 offen nt
PV 248,120,36
s_add_u32 m0, s42, 0x12000
RK 60,63,12288
v_xor_b32 v62, s43, v62
PV 252,124,36
RV 96,64,8192
v_xor_b32 v63, s43, v63
QK 16,0,160,48
EX 25
QK 16,4,164,16
buffer_load_dwordx4 v68, s[20:23], s40 offen lds
QK 16,8,168,16
RV 98,64,12288
CV 36,24,25
QK 16,12,172,16
EX 26
QK 20,16,160,48
EX 27
QK 20,20,164,20
RV 100,65,8192
CV 37,26,27
QK 20,24,168,20
EX 28
QK 20,28,172,20
EX 29
PV 128,64,32
RV 102,65,12288
CV 38,28,29
PV 132,68,32
buffer_load_dwordx4 v69, s[20:23], s40 offen offset:1024 lds
PV 136,72,32
EX 30
PV 140,76,32
RV 104,64,8448
RV 106,64,12544
PV 144,80,32
EX 31
PV 148,84,32
RV 108,65,8448
CV 39,30,31
PV 152,88,32
EX 16
PV 156,92,32
L_t7_pad3:
s_cbranch_execz L_t7_go
EX 17
QK 24,0,176,52
EX 18
QK 24,4,180,24
EX 19
QK 24,8,184,24
RV 110,65,12544
RV 112,64,8704
QK 24,12,188,24
EX 20
v_smfmac_f32_16x16x64_bf16 a[240:243], v[56:59], v[32:39], v71
RV 114,64,12800
QK 28,16,176,52
CV 32,16,17
CV 33,18,19
QK 28,20,180,28
EX 21
QK 28,24,184,28
RV 116,65,8704
CV 34,20,21
QK 28,28,188,28
EX 22
PV 160,64,36
EX 23
PV 164,68,36
RV 118,65,12800
CV 35,22,23
PV 168,72,36
EX 24
PV 172,76,36
EX 25
PV 176,80,36
EX 26
PV 180,84,36
RV 120,64,8960
RV 122,64,13056
PV 184,88,36
buffer_load_dwordx4 v[92:95], v75, s[32:35], s52 offen nt
PV 188,92,36
s_waitcnt lgkmcnt(14)
RV 124,65,8960
CV 36,24,25
QK 16,32,128,40
EX 27
QK 16,36,132,16
RV 126,65,13056
CV 37,26,27
QK 16,40,136,16
EX 28
QK 16,44,140,16
EX 29
QK 20,48,128,40
EX 30
QK 20,52,132,20
CV 38,28,29
v_xor_b32 v64, s43, v64
QK 20,56,136,20
EX 31
QK 20,60,140,20
CV 39,30,31
v_xor_b32 v65, s43, v65
PV 192,64,32
EX 16
PV 196,68,32
PV 200,72,32
EX 17
PV 204,76,32
PV 208,80,32
s_waitcnt vmcnt(12) lgkmcnt(0)
s_barrier
PV 212,84,32
s_add_u32 s40, s40, s58
EX 18
PV 216,88,32
s_xor_b32 s41, s41, s43
EX 19
PV 220,92,32
s_xor_b32 s42, s41, 0xc000
RK 0,60,0
QK 24,32,144,44
s_add_u32 m0, s42, 0x0
EX 20
QK 24,36,148,24
s_mov_b32 s58, s59
RK 4,61,0
QK 24,40,152,24
buffer_load_dwordx4 v66, s[16:19], s40 offen lds
QK 24,44,156,24
s_mov_b32 s59, 0x20000
EX 21
v_smfmac_f32_16x16x64_bf16 a[244:247], v[56:59], v[32:39], v71
s_sub_u32 s57, s57, 1
s_cselect_b64 s[58:59], s[60:61], s[58:59]
RK 8,62,0
QK 28,48,144,44
s_xor_b32 s43, s43, 0xc000
RK 12,63,0
CV 32,16,17
QK 28,52,148,28
CV 33,18,19
CV 34,20,21
QK 28,56,152,28
EX 22
QK 28,60,156,28
EX 23
PV 224,64,36
RK 16,60,4096
RK 20,61,4096
PV 228,68,36
buffer_load_dwordx4 v67, s[16:19], s40 offen offset:1024 lds
PV 232,72,36
EX 24
PV 236,76,36
RK 24,62,4096
CV 35,22,23
PV 240,80,36
EX 25
PV 244,84,36
s_add_u32 m0, s42, 0x10000
EX 26
PV 248,88,36
EX 27
PV 252,92,36
RK 28,63,4096
RV 64,64,0
QK 16,32,160,48
s_add_u32 s53, s45, 0x10000
CV 36,24,25
CV 37,26,27
QK 16,36,164,16
buffer_load_dwordx4 v68, s[20:23], s40 offen lds
QK 16,40,168,16
EX 28
QK 16,44,172,16
EX 29
QK 20,48,160,48
RV 66,64,4096
RV 68,65,0
QK 20,52,164,20
buffer_load_dwordx4 v[96:99], v72, s[32:35], s53 offen nt
QK 20,56,168,20
RV 70,65,4096
CV 38,28,29
QK 20,60,172,20
EX 30
PV 128,96,32
EX 31
PV 132,100,32
buffer_load_dwordx4 v69, s[20:23], s40 offen offset:1024 lds
PV 136,104,32
RV 72,64,256
CV 39,30,31
PV 140,108,32
EX 16
PV 144,112,32
EX 17
PV 148,116,32
RV 74,64,4352
RV 76,65,256
PV 152,120,32
EX 18
PV 156,124,32
EX 19
QK 24,32,176,52
EX 20
QK 24,36,180,24
RV 78,65,4352
QK 24,40,184,24
EX 21
QK 24,44,188,24
RV 80,64,512
v_smfmac_f32_16x16x64_bf16 a[240:243], v[56:59], v[32:39], v71
RV 82,64,4608
QK 28,48,176,52
CV 32,16,17
CV 33,18,19
QK 28,52,180,28
EX 22
QK 28,56,184,28
RV 84,65,512
CV 34,20,21
QK 28,60,188,28
EX 23
PV 160,96,36
RV 86,65,4608
CV 35,22,23
PV 164,100,36
EX 24
PV 168,104,36
EX 25
PV 172,108,36
RV 88,64,768
PV 176,112,36
EX 26
PV 180,116,36
RV 90,64,4864
PV 184,120,36
EX 27
PV 188,124,36
s_waitcnt lgkmcnt(14)
RV 92,65,768
CV 36,24,25
QK 16,0,128,40
EX 28
QK 16,4,132,16
RV 94,65,4864
CV 37,26,27
QK 16,8,136,16
EX 29
QK 16,12,140,16
CV 38,28,29
QK 20,16,128,40
EX 30
QK 20,20,132,20
QK 20,24,136,20
buffer_load_dwordx4 v[100:103], v73, s[32:35], s53 offen nt
QK 20,28,140,20
EX 31
PV 192,96,32
EX 16
PV 196,100,32
CV 39,30,31
PV 200,104,32
EX 17
PV 204,108,32
PV 208,112,32
s_waitcnt lgkmcnt(0)
EX 18
PV 212,116,32
s_add_u32 s40, s40, s58
PV 216,120,32
s_add_u32 m0, s42, 0x2000
EX 19
PV 220,124,32
s_mov_b32 s58, s59
RK 32,60,8192
QK 24,0,144,44
s_mov_b32 s59, 0x20000
EX 20
QK 24,4,148,24
RK 36,61,8192
QK 24,8,152,24
buffer_load_dwordx4 v66, s[16:19], s40 offen lds
QK 24,12,156,24
EX 21
v_smfmac_f32_16x16x64_bf16 a[244:247], v[56:59], v[32:39], v71
s_sub_u32 s57, s57, 1
s_cselect_b64 s[58:59], s[60:61], s[58:59]
RK 40,62,8192
QK 28,16,144,44
RK 44,63,8192
CV 32,16,17
QK 28,20,148,28
CV 33,18,19
CV 34,20,21
QK 28,24,152,28
EX 22
QK 28,28,156,28
EX 23
PV 224,96,36
RK 48,60,12288
RK 52,61,12288
PV 228,100,36
buffer_load_dwordx4 v67, s[16:19], s40 offen offset:1024 lds
PV 232,104,36
CV 35,22,23
v_xor_b32 v60, s43, v60
PV 236,108,36
RK 56,62,12288
v_xor_b32 v61, s43, v61
PV 240,112,36
EX 24
PV 244,116,36
s_add_u32 m0, s42, 0x12000
RK 60,63,12288
v_xor_b32 v62, s43, v62
PV 248,120,36
EX 25
PV 252,124,36
RV 96,64,8192
CV 36,24,25
QK 16,0,160,48
EX 26
QK 16,4,164,16
buffer_load_dwordx4 v68, s[20:23], s40 offen lds
QK 16,8,168,16
RV 98,64,12288
v_xor_b32 v63, s43, v63
QK 16,12,172,16
EX 27
QK 20,16,160,48
RV 100,65,8192
CV 37,26,27
QK 20,20,164,20
EX 28
QK 20,24,168,20
EX 29
QK 20,28,172,20
RV 102,65,12288
CV 38,28,29
PV 128,64,32
EX 30
PV 132,68,32
buffer_load_dwordx4 v69, s[20:23], s40 offen offset:1024 lds
PV 136,72,32
EX 31
PV 140,76,32
RV 104,64,8448
RV 106,64,12544
PV 144,80,32
EX 16
PV 148,84,32
buffer_load_dwordx4 v[104:107], v74, s[32:35], s53 offen nt
PV 152,88,32
RV 108,65,8448
CV 39,30,31
PV 156,92,32
EX 17
QK 24,0,176,52
EX 18
QK 24,4,180,24
EX 19
QK 24,8,184,24
RV 110,65,12544
RV 112,64,8704
QK 24,12,188,24
EX 20
v_smfmac_f32_16x16x64_bf16 a[240:243], v[56:59], v[32:39], v71
RV 114,64,12800
QK 28,16,176,52
CV 32,16,17
CV 33,18,19
QK 28,20,180,28
EX 21
QK 28,24,184,28
RV 116,65,8704
CV 34,20,21
QK 28,28,188,28
EX 22
PV 160,64,36
EX 23
PV 164,68,36
RV 118,65,12800
CV 35,22,23
PV 168,72,36
EX 24
PV 172,76,36
EX 25
PV 176,80,36
EX 26
PV 180,84,36
RV 120,64,8960
RV 122,64,13056
PV 184,88,36
EX 27
PV 188,92,36
s_waitcnt lgkmcnt(14)
RV 124,65,8960
CV 36,24,25
QK 16,32,128,40
CV 37,26,27
v_xor_b32 v64, s43, v64
QK 16,36,132,16
EX 28
QK 16,40,136,16
EX 29
QK 16,44,140,16
RV 126,65,13056
CV 38,28,29
QK 20,48,128,40
EX 30
QK 20,52,132,20
v_xor_b32 v65, s43, v65
QK 20,56,136,20
EX 31
QK 20,60,140,20
CV 39,30,31
PV 192,64,32
EX 16
PV 196,68,32
PV 200,72,32
EX 17
PV 204,76,32
PV 208,80,32
s_waitcnt vmcnt(12) lgkmcnt(0)
s_barrier
PV 212,84,32
s_add_u32 s40, s40, s58
EX 18
PV 216,88,32
buffer_load_dwordx4 v[108:111], v75, s[32:35], s53 offen nt
PV 220,92,32
s_xor_b32 s41, s41, s43
EX 19
QK 24,32,144,44
s_xor_b32 s42, s41, 0xc000
RK 0,60,0
RK 4,61,0
QK 24,36,148,24
s_add_u32 m0, s42, 0x0
EX 20
QK 24,40,152,24
buffer_load_dwordx4 v66, s[16:19], s40 offen lds
QK 24,44,156,24
s_mov_b32 s58, s59
EX 21
v_smfmac_f32_16x16x64_bf16 a[244:247], v[56:59], v[32:39], v71
s_mov_b32 s59, 0x20000
s_xor_b32 s43, s43, 0xc000
RK 8,62,0
QK 28,48,144,44
RK 12,63,0
CV 32,16,17
QK 28,52,148,28
CV 33,18,19
CV 34,20,21
QK 28,56,152,28
EX 22
QK 28,60,156,28
EX 23
PV 224,64,36
RK 16,60,4096
RK 20,61,4096
PV 228,68,36
buffer_load_dwordx4 v67, s[16:19], s40 offen offset:1024 lds
PV 232,72,36
EX 24
PV 236,76,36
RK 24,62,4096
CV 35,22,23
PV 240,80,36
EX 25
PV 244,84,36
s_add_u32 m0, s42, 0x10000
EX 26
PV 248,88,36
EX 27
PV 252,92,36
RK 28,63,4096
RV 64,64,0
QK 16,32,160,48
CV 36,24,25
CV 37,26,27
QK 16,36,164,16
buffer_load_dwordx4 v68, s[20:23], s40 offen lds
QK 16,40,168,16
EX 28
QK 16,44,172,16
EX 29
QK 20,48,160,48
RV 66,64,4096
RV 68,65,0
QK 20,52,164,20
EX 30
QK 20,56,168,20
RV 70,65,4096
CV 38,28,29
QK 20,60,172,20
EX 31
PV 128,96,32
EX 16
PV 132,100,32
buffer_load_dwordx4 v69, s[20:23], s40 offen offset:1024 lds
PV 136,104,32
RV 72,64,256
CV 39,30,31
PV 140,108,32
EX 17
PV 144,112,32
EX 18
PV 148,116,32
RV 74,64,4352
RV 76,65,256
PV 152,120,32
EX 19
PV 156,124,32
QK 24,32,176,52
EX 20
QK 24,36,180,24
RV 78,65,4352
QK 24,40,184,24
EX 21
QK 24,44,188,24
RV 80,64,512
v_smfmac_f32_16x16x64_bf16 a[240:243], v[56:59], v[32:39], v71
s_sub_u32 s57, s57, 1
s_cselect_b64 s[58:59], s[60:61], s[58:59]
RV 82,64,4608
QK 28,48,176,52
CV 32,16,17
CV 33,18,19
QK 28,52,180,28
EX 22
QK 28,56,184,28
RV 84,65,512
CV 34,20,21
QK 28,60,188,28
EX 23
PV 160,96,36
RV 86,65,4608
CV 35,22,23
PV 164,100,36
EX 24
PV 168,104,36
EX 25
PV 172,108,36
RV 88,64,768
PV 176,112,36
EX 26
PV 180,116,36
RV 90,64,4864
PV 184,120,36
EX 27
PV 188,124,36
s_waitcnt lgkmcnt(14)
RV 92,65,768
CV 36,24,25
QK 16,0,128,40
EX 28
QK 16,4,132,16
RV 94,65,4864
CV 37,26,27
QK 16,8,136,16
EX 29
QK 16,12,140,16
CV 38,28,29
QK 20,16,128,40
EX 30
QK 20,20,132,20
QK 20,24,136,20
EX 31
QK 20,28,140,20
CV 39,30,31
PV 192,96,32
EX 16
PV 196,100,32
EX 17
PV 200,104,32
EX 18
PV 204,108,32
EX 19
PV 208,112,32
s_waitcnt lgkmcnt(0)
EX 20
PV 212,116,32
s_add_u32 s40, s40, s58
EX 21
PV 216,120,32
s_add_u32 m0, s42, 0x2000
RK 32,60,8192
RK 36,61,8192
PV 220,124,32
s_mov_b32 s58, s59
RK 40,62,8192
v_xor_b32 v60, s43, v60
QK 24,0,144,44
s_mov_b32 s59, 0x20000
RK 44,63,8192
v_xor_b32 v61, s43, v61
QK 24,4,148,24
EX 22
QK 24,8,152,24
buffer_load_dwordx4 v66, s[16:19], s40 offen lds
QK 24,12,156,24
EX 23
v_smfmac_f32_16x16x64_bf16 a[244:247], v[56:59], v[32:39], v71
CV 32,16,17
QK 28,16,144,44
CV 33,18,19
CV 34,20,21
QK 28,20,148,28
CV 35,22,23
v_xor_b32 v62, s43, v62
QK 28,24,152,28
EX 24
QK 28,28,156,28
EX 25
PV 224,96,36
RV 96,64,8192
RV 98,64,12288
PV 228,100,36
RV 100,65,8192
v_xor_b32 v63, s43, v63
PV 232,104,36
RV 102,65,12288
RV 104,64,8448
PV 236,108,36
EX 26
PV 240,112,36
RV 106,64,12544
RV 108,65,8448
PV 244,116,36
L_t7_pad4:
s_cbranch_execz L_t7_go
EX 27
PV 248,120,36
RV 110,65,12544
RV 112,64,8704
PV 252,124,36
RV 114,64,12800
CV 36,24,25
QK 16,0,160,48
buffer_load_dwordx4 v67, s[16:19], s40 offen offset:1024 lds
RV 116,65,8704
RV 118,65,12800
v_lshlrev_b32 v0, 16, v80
v_and_b32 v1, s71, v80
v_lshlrev_b32 v2, 16, v81
v_and_b32 v3, s71, v81
v_pk_mul_f32 v[0:1], v[0:1], s[14:15]
v_pk_mul_f32 v[2:3], v[2:3], s[14:15]
QK 16,4,164,16
s_add_u32 m0, s42, 0x12000
RV 120,64,8960
RV 122,64,13056
v_lshlrev_b32 v4, 16, v82
v_and_b32 v5, s71, v82
v_lshlrev_b32 v6, 16, v83
v_and_b32 v7, s71, v83
v_pk_mul_f32 v[4:5], v[4:5], s[14:15]
v_pk_mul_f32 v[6:7], v[6:7], s[14:15]
CV 80,0,1
CV 81,2,3
QK 16,8,168,16
buffer_load_dwordx4 v68, s[20:23], s40 offen lds
RV 124,65,8960
RV 126,65,13056
CV 82,4,5
CV 83,6,7
v_lshlrev_b32 v0, 16, v84
v_and_b32 v1, s71, v84
v_lshlrev_b32 v2, 16, v85
v_and_b32 v3, s71, v85
v_pk_mul_f32 v[0:1], v[0:1], s[14:15]
v_pk_mul_f32 v[2:3], v[2:3], s[14:15]
QK 16,12,172,16
ds_write_b128 v15, v[80:83] offset:0
v_lshlrev_b32 v4, 16, v86
v_and_b32 v5, s71, v86
v_lshlrev_b32 v6, 16, v87
v_and_b32 v7, s71, v87
v_pk_mul_f32 v[4:5], v[4:5], s[14:15]
v_pk_mul_f32 v[6:7], v[6:7], s[14:15]
CV 84,0,1
CV 85,2,3
QK 20,16,160,48
CV 86,4,5
CV 87,6,7
v_lshlrev_b32 v0, 16, v88
v_and_b32 v1, s71, v88
v_lshlrev_b32 v2, 16, v89
v_and_b32 v3, s71, v89
v_pk_mul_f32 v[0:1], v[0:1], s[14:15]
v_pk_mul_f32 v[2:3], v[2:3], s[14:15]
QK 20,20,164,20
ds_write_b128 v15, v[84:87] offset:544
v_lshlrev_b32 v4, 16, v90
v_and_b32 v5, s71, v90
v_lshlrev_b32 v6, 16, v91
v_and_b32 v7, s71, v91
v_pk_mul_f32 v[4:5], v[4:5], s[14:15]
v_pk_mul_f32 v[6:7], v[6:7], s[14:15]
CV 88,0,1
CV 89,2,3
QK 20,24,168,20
s_waitcnt vmcnt(19)
CV 90,4,5
CV 91,6,7
v_lshlrev_b32 v0, 16, v92
v_and_b32 v1, s71, v92
v_lshlrev_b32 v2, 16, v93
v_and_b32 v3, s71, v93
v_pk_mul_f32 v[0:1], v[0:1], s[14:15]
v_pk_mul_f32 v[2:3], v[2:3], s[14:15]
QK 20,28,172,20
ds_write_b128 v15, v[88:91] offset:1152
v_lshlrev_b32 v4, 16, v94
v_and_b32 v5, s71, v94
v_lshlrev_b32 v6, 16, v95
v_and_b32_e64 v7, s71, v95
v_pk_mul_f32 v[4:5], v[4:5], s[14:15]
v_pk_mul_f32 v[6:7], v[6:7], s[14:15]
CV 92,0,1
CV 93,2,3
EX 28
EX 29
EX 30
EX 31
CV 37,26,27
CV 38,28,29
CV 39,30,31
v_xor_b32 v64, s43, v64
v_xor_b32 v65, s43, v65
v_smfmac_f32_16x16x64_bf16 a[240:243], v[56:59], v[32:39], v71
s_add_u32 s48, s44, 0x0
CV 94,4,5
CV 95,6,7
PV 128,64,32
buffer_load_dwordx4 v69, s[20:23], s40 offen offset:1024 lds
PV 132,68,32
ds_write_b128 v15, v[92:95] offset:1696
PV 136,72,32
RK 192,14,0
RK 196,14,64
PV 140,76,32
RK 200,14,128
v_accvgpr_read_b32 v76, a240
v_accvgpr_read_b32 v40, a241
RK 204,14,192
v_add_f32 v76, v76, v40
v_accvgpr_read_b32 v77, a242
v_cmp_nge_f32 s[4:5], s55, v76
v_rcp_f32 v76, v76
v_accvgpr_read_b32 v44, a243
PM 128,76,0
v_add_f32 v77, v77, v44
PM 130,76,0
PV 144,80,32
v_cmp_nge_f32 s[6:7], s55, v77
v_rcp_f32_e64 v77, v77
CV 128,128,129
CV 129,130,131
PM 132,76,0
PM 134,76,0
PV 148,84,32
ds_write_b64 v70, v[128:129] offset:0
CV 132,132,133
CV 133,134,135
PM 136,76,0
PM 138,76,0
PV 152,88,32
ds_write_b64 v70, v[132:133] offset:32
CV 136,136,137
CV 137,138,139
PM 140,76,0
PM 142,76,0
PV 156,92,32
ds_write_b64 v70, v[136:137] offset:64
CV 140,140,141
CV 141,142,143
PM 144,76,0
PM 146,76,0
QK 24,0,176,52
ds_write_b64 v70, v[140:141] offset:96
CV 144,144,145
CV 145,146,147
PM 148,76,0
PM 150,76,0
s_waitcnt vmcnt(16)
v_lshlrev_b32 v0, 16, v96
v_and_b32 v1, s71, v96
v_lshlrev_b32 v2, 16, v97
v_and_b32_e64 v3, s71, v97
v_pk_mul_f32 v[0:1], v[0:1], s[14:15]
v_pk_mul_f32 v[2:3], v[2:3], s[14:15]
QK 24,4,180,24
ds_write_b64 v70, v[144:145] offset:128
CV 148,148,149
CV 149,150,151
PM 152,76,0
PM 154,76,0
v_lshlrev_b32 v4, 16, v98
v_and_b32 v5, s71, v98
v_lshlrev_b32 v6, 16, v99
v_and_b32 v7, s71, v99
v_pk_mul_f32 v[4:5], v[4:5], s[14:15]
v_pk_mul_f32 v[6:7], v[6:7], s[14:15]
CV 96,0,1
CV 97,2,3
QK 24,8,184,24
ds_write_b64 v70, v[148:149] offset:160
CV 152,152,153
CV 153,154,155
PM 156,76,0
PM 158,76,0
CV 98,4,5
CV 99,6,7
s_waitcnt vmcnt(14)
v_lshlrev_b32 v0, 16, v100
v_and_b32 v1, s71, v100
v_lshlrev_b32 v2, 16, v101
v_and_b32 v3, s71, v101
v_pk_mul_f32 v[0:1], v[0:1], s[14:15]
v_pk_mul_f32 v[2:3], v[2:3], s[14:15]
QK 24,12,188,24
ds_write_b64 v70, v[152:153] offset:192
CV 156,156,157
CV 157,158,159
v_lshlrev_b32 v4, 16, v102
v_and_b32 v5, s71, v102
v_lshlrev_b32 v6, 16, v103
v_and_b32_e64 v7, s71, v103
v_pk_mul_f32 v[4:5], v[4:5], s[14:15]
v_pk_mul_f32 v[6:7], v[6:7], s[14:15]
CV 100,0,1
CV 101,2,3
QK 28,16,176,52
ds_write_b64 v70, v[156:157] offset:224
RK 128,15,0
RK 132,15,528
CV 102,4,5
RK 136,15,1056
CV 103,6,7
RK 140,15,1584
ds_write_b128 v15, v[96:99] offset:0
s_waitcnt vmcnt(9)
v_lshlrev_b32 v0, 16, v104
v_and_b32 v1, s71, v104
v_lshlrev_b32 v2, 16, v105
v_and_b32 v3, s71, v105
v_pk_mul_f32 v[0:1], v[0:1], s[14:15]
v_pk_mul_f32 v[2:3], v[2:3], s[14:15]
QK 28,20,180,28
s_waitcnt lgkmcnt(4)
buffer_store_dwordx4 a[128:131], v72, s[28:31], s48 offen nt
ds_write_b128 v15, v[100:103] offset:544
v_lshlrev_b32 v4, 16, v106
v_and_b32 v5, s71, v106
v_lshlrev_b32 v6, 16, v107
v_and_b32 v7, s71, v107
v_pk_mul_f32 v[4:5], v[4:5], s[14:15]
v_pk_mul_f32 v[6:7], v[6:7], s[14:15]
CV 104,0,1
CV 105,2,3
QK 28,24,184,28
s_waitcnt vmcnt(9) lgkmcnt(4)
buffer_store_dwordx4 a[132:135], v73, s[28:31], s48 offen nt
CV 106,4,5
CV 107,6,7
v_lshlrev_b32 v0, 16, v108
v_and_b32 v1, s71, v108
v_lshlrev_b32 v2, 16, v109
v_and_b32 v3, s71, v109
v_pk_mul_f32 v[0:1], v[0:1], s[14:15]
v_pk_mul_f32 v[2:3], v[2:3], s[14:15]
QK 28,28,188,28
s_add_u32 s49, s44, 0x10000
ds_write_b128 v15, v[104:107] offset:1152
s_waitcnt lgkmcnt(4)
buffer_store_dwordx4 a[136:139], v74, s[28:31], s48 offen nt
v_lshlrev_b32 v4, 16, v110
v_and_b32 v5, s71, v110
v_lshlrev_b32 v6, 16, v111
v_and_b32 v7, s71, v111
v_pk_mul_f32 v[4:5], v[4:5], s[14:15]
v_pk_mul_f32 v[6:7], v[6:7], s[14:15]
CV 108,0,1
CV 109,2,3
PV 160,64,36
CV 110,4,5
CV 111,6,7
PV 164,68,36
s_waitcnt lgkmcnt(3)
buffer_store_dwordx4 a[140:143], v75, s[28:31], s48 offen nt
PV 168,72,36
ds_write_b128 v15, v[108:111] offset:1696
PV 172,76,36
RK 208,14,0
RK 212,14,64
EX 16
RK 216,14,128
PM 160,76,1
RK 220,14,192
PM 162,76,1
PV 176,80,36
CV 160,160,161
CV 161,162,163
EX 17
EX 18
PM 164,76,1
PM 166,76,1
PV 180,84,36
ds_write_b64 v70, v[160:161] offset:0
CV 164,164,165
CV 165,166,167
PM 168,76,1
PM 170,76,1
PV 184,88,36
ds_write_b64 v70, v[164:165] offset:32
CV 168,168,169
CV 169,170,171
PM 172,76,1
PM 174,76,1
PV 188,92,36
ds_write_b64 v70, v[168:169] offset:64
CV 172,172,173
CV 173,174,175
PM 176,76,1
PM 178,76,1
v_exp_f32_e64 v19, v19
CV 32,16,17
CV 33,18,19
QZ 16,32,192
ds_write_b64 v70, v[172:173] offset:96
CV 176,176,177
CV 177,178,179
PM 180,76,1
PM 182,76,1
QK 16,36,196,16
ds_write_b64 v70, v[176:177] offset:128
CV 180,180,181
CV 181,182,183
PM 184,76,1
PM 186,76,1
QK 16,40,200,16
ds_write_b64 v70, v[180:181] offset:160
CV 184,184,185
CV 185,186,187
PM 188,76,1
PM 190,76,1
QK 16,44,204,16
ds_write_b64 v70, v[184:185] offset:192
CV 188,188,189
CV 189,190,191
EX 20
EX 21
EX 22
EX 23
EX 24
v_max3_f32 v8, v16, v17, v18
EX 25
v_max_f32 v8, v8, v19
EX 26
v_mov_b32 v9, v8
EX 27
EX 28
v_permlane32_swap_b32 v8, v9
v_max_f32 v8, v8, v9
EX 29
v_mov_b32 v9, v8
EX 30
EX 31
v_permlane16_swap_b32 v8, v9
v_min_f32_e64 v40, -v8, -v9
CV 34,20,21
CV 35,22,23
CV 36,24,25
CV 37,26,27
CV 38,28,29
CV 39,30,31
v_add_f32 v8, v40, v12
v_add_f32 v9, v40, v13
v_smfmac_f32_16x16x64_bf16 a[244:247], v[56:59], v[32:39], v71
s_add_u32 s50, s44, 0x20000
v_add_f32 v16, v8, v16
ds_write_b64 v70, v[188:189] offset:224
PV 192,64,32
RK 144,15,0
RK 148,15,528
PV 196,68,32
RK 152,15,1056
v_add_f32 v17, v9, v17
PV 200,72,32
RK 156,15,1584
v_add_f32 v18, v9, v18
PV 204,76,32
v_accvgpr_read_b32 v78, a244
v_accvgpr_read_b32 v48, a245
v_accvgpr_read_b32 v79, a246
v_add_f32 v78, v78, v48
v_accvgpr_read_b32 v52, a247
v_cmp_nge_f32 s[8:9], s55, v78
v_rcp_f32 v78, v78
v_add_f32 v79, v79, v52
PM 192,78,0
v_cmp_nge_f32 s[10:11], s55, v79
v_rcp_f32_e64 v79, v79
PM 194,78,0
PV 208,80,32
s_waitcnt vmcnt(63) lgkmcnt(0)
s_barrier
buffer_store_dwordx4 a[144:147], v72, s[28:31], s49 offen nt
CV 192,192,193
CV 193,194,195
PM 196,78,0
PM 198,78,0
PV 212,84,32
s_add_u32 s40, s40, 0x20000
ds_write_b64 v70, v[192:193] offset:0
CV 196,196,197
CV 197,198,199
PM 200,78,0
PM 202,78,0
PV 216,88,32
buffer_store_dwordx4 a[148:151], v73, s[28:31], s49 offen nt
ds_write_b64 v70, v[196:197] offset:32
RK 0,60,0
RK 4,61,0
CV 200,200,201
CV 201,202,203
PM 204,78,0
PM 206,78,0
PV 220,92,32
s_xor_b32 s41, s41, s43
ds_write_b64 v70, v[200:201] offset:64
RK 8,62,0
RK 12,63,0
buffer_store_dwordx4 a[152:155], v74, s[28:31], s49 offen nt
CV 204,204,205
CV 205,206,207
PM 208,78,0
PM 210,78,0
QZ 24,32,208
s_xor_b32 s42, s41, 0xc000
ds_write_b64 v70, v[204:205] offset:96
RK 16,60,4096
RK 20,61,4096
CV 208,208,209
CV 209,210,211
PM 212,78,0
PM 214,78,0
QK 24,36,212,24
buffer_store_dwordx4 a[156:159], v75, s[28:31], s49 offen nt
ds_write_b64 v70, v[208:209] offset:128
RK 24,62,4096
RK 28,63,4096
CV 212,212,213
CV 213,214,215
PM 216,78,0
PM 218,78,0
QK 24,40,216,24
s_add_u32 m0, s42, 0x0
ds_write_b64 v70, v[212:213] offset:160
CV 216,216,217
CV 217,218,219
PM 220,78,0
PM 222,78,0
QK 24,44,220,24
buffer_load_dwordx4 v66, s[16:19], s40 offen lds
ds_write_b64 v70, v[216:217] offset:192
CV 220,220,221
CV 221,222,223
PV 224,64,36
s_add_u32 s51, s44, 0x30000
RV 64,64,0
RV 66,64,4096
ds_write_b64 v70, v[220:221] offset:224
PV 228,68,36
s_xor_b32 s43, s43, 0xc000
RK 160,15,0
RK 164,15,528
PV 232,72,36
RK 168,15,1056
v_max3_f32 v10, v24, v25, v26
PV 236,76,36
RK 172,15,1584
v_max_f32 v10, v10, v27
v_add_f32 v19, v9, v19
v_mov_b32 v11, v10
EX 16
PM 224,78,1
v_permlane32_swap_b32 v10, v11
v_max_f32 v10, v10, v11
PM 226,78,1
PV 240,80,36
RV 68,65,0
RV 70,65,4096
v_mov_b32 v11, v10
CV 224,224,225
CV 225,226,227
v_permlane16_swap_b32 v10, v11
v_min_f32_e64 v44, -v10, -v11
PM 228,78,1
PM 230,78,1
PV 244,84,36
s_waitcnt lgkmcnt(5)
buffer_store_dwordx4 a[160:163], v72, s[28:31], s50 offen nt
ds_write_b64 v70, v[224:225] offset:0
RV 72,64,256
RV 74,64,4352
CV 228,228,229
CV 229,230,231
PM 232,78,1
PM 234,78,1
PV 248,88,36
s_waitcnt lgkmcnt(7)
buffer_store_dwordx4 a[164:167], v73, s[28:31], s50 offen nt
ds_write_b64 v70, v[228:229] offset:32
RV 76,65,256
RV 78,65,4352
CV 232,232,233
CV 233,234,235
PM 236,78,1
PM 238,78,1
PV 252,92,36
ds_write_b64 v70, v[232:233] offset:64
RV 80,64,512
RV 82,64,4608
s_waitcnt lgkmcnt(12)
buffer_store_dwordx4 a[168:171], v74, s[28:31], s50 offen nt
CV 236,236,237
CV 237,238,239
PM 240,78,1
PM 242,78,1
EX 17
EX 18
EX 19
v_mov_b32 v41, v40
v_mov_b32 v42, v40
v_mov_b32_e64 v43, v40
CV 32,16,17
CV 33,18,19
QK 16,0,192,40
buffer_load_dwordx4 v67, s[16:19], s40 offen offset:1024 lds
ds_write_b64 v70, v[236:237] offset:96
RV 84,65,512
RV 86,65,4608
CV 240,240,241
CV 241,242,243
PM 244,78,1
PM 246,78,1
QK 16,4,196,16
ds_write_b64 v70, v[240:241] offset:128
RV 88,64,768
RV 90,64,4864
s_waitcnt lgkmcnt(15)
buffer_store_dwordx4 a[172:175], v75, s[28:31], s50 offen nt
CV 244,244,245
CV 245,246,247
PM 248,78,1
PM 250,78,1
QK 16,8,200,16
s_add_u32 m0, s42, 0x10000
ds_write_b64 v70, v[244:245] offset:160
RV 92,65,768
RV 94,65,4864
CV 248,248,249
CV 249,250,251
PM 252,78,1
PM 254,78,1
QK 16,12,204,16
ds_write_b64 v70, v[248:249] offset:192
CV 252,252,253
CV 253,254,255
QK 20,16,192,40
v_mov_b32 v34, 0
v_mov_b32 v35, 0
ds_write_b64 v70, v[252:253] offset:224
QK 20,20,196,20
RK 176,15,0
RK 180,15,528
QK 20,24,200,20
RK 184,15,1056
v_add_f32 v10, v44, v12
QK 20,28,204,20
RK 188,15,1584
v_add_f32 v11, v44, v13
PZ 128,96,32
buffer_load_dwordx4 v68, s[20:23], s40 offen lds
PZ 132,100,32
v_add_f32 v24, v10, v24
v_add_f32 v25, v11, v25
PZ 136,104,32
v_add_f32 v26, v11, v26
v_add_f32 v27, v11, v27
PZ 140,108,32
s_waitcnt lgkmcnt(3)
buffer_store_dwordx4 a[176:179], v72, s[28:31], s51 offen nt
PZ 144,112,32
EX 24
PZ 148,116,32
EX 25
PZ 152,120,32
EX 26
PZ 156,124,32
s_waitcnt lgkmcnt(2)
buffer_store_dwordx4 a[180:183], v73, s[28:31], s51 offen nt
RK 32,60,8192
RK 36,61,8192
EX 27
v_mov_b32 v45, v44
v_mov_b32 v46, v44
v_mov_b32 v47, v44
CV 36,24,25
CV 37,26,27
QK 24,0,208,44
RK 40,62,8192
RK 44,63,8192
QK 24,4,212,24
s_waitcnt lgkmcnt(5)
buffer_store_dwordx4 a[184:187], v74, s[28:31], s51 offen nt
QK 24,8,216,24
L_t7_pad5:
s_cbranch_execz L_t7_go
v_mov_b32 v38, 0
v_mov_b32 v39, 0
QK 24,12,220,24
RK 48,60,12288
RK 52,61,12288
v_smfmac_f32_16x16x64_bf16 a[248:251], v[56:59], v[32:39], v71
RK 56,62,12288
QK 28,16,208,44
s_waitcnt lgkmcnt(7)
buffer_store_dwordx4 a[188:191], v75, s[28:31], s51 offen nt
QK 28,20,212,28
RK 60,63,12288
v_xor_b32 v60, s43, v60
QK 28,24,216,28
EX 16
QK 28,28,220,28
EX 17
PZ 160,96,36
buffer_load_dwordx4 v69, s[20:23], s40 offen offset:1024 lds
PZ 164,100,36
s_add_u32 s40, s40, 0x20000
RV 96,64,8192
s_add_u32 m0, s42, 0x2000
PZ 168,104,36
RV 98,64,12288
RV 100,65,8192
PZ 172,108,36
RV 102,65,12288
CV 32,16,17
PZ 176,112,36
buffer_load_dwordx4 v66, s[16:19], s40 offen lds
PZ 180,116,36
RV 104,64,8448
RV 106,64,12544
PZ 184,120,36
RV 108,65,8448
v_xor_b32 v61, s43, v61
PZ 188,124,36
s_waitcnt lgkmcnt(7)
RV 110,65,12544
RV 112,64,8704
EX 18
EX 19
EX 20
CV 33,18,19
QK 16,32,192,40
buffer_load_dwordx4 v67, s[16:19], s40 offen offset:1024 lds
QK 16,36,196,16
s_add_u32 m0, s42, 0x12000
RV 114,64,12800
RV 116,65,8704
QK 16,40,200,16
RV 118,65,12800
v_xor_b32_e64 v62, s43, v62
QK 16,44,204,16
RV 120,64,8960
RV 122,64,13056
EX 21
v_exp_f32_e64 v22, v22
EX 23
CV 34,20,21
CV 35,22,23
QK 20,48,192,40
RV 124,65,8960
RV 126,65,13056
QK 20,52,196,20
buffer_load_dwordx4 v68, s[20:23], s40 offen lds
QK 20,56,200,20
v_exp_f32_e64 v24, v24
QK 20,60,204,20
EX 25
PV 128,64,32
v_exp_f32_e64 v26, v26
PV 132,68,32
EX 27
PV 136,72,32
CV 36,24,25
CV 37,26,27
PV 140,76,32
v_xor_b32_e64 v63, s43, v63
PV 144,80,32
s_waitcnt vmcnt(23) lgkmcnt(0)
s_barrier
PV 148,84,32
buffer_load_dwordx4 v69, s[20:23], s40 offen offset:1024 lds
s_mov_b32 s56, 2
L_t7_loop1:
PV 152,88,32
s_xor_b32 s41, s41, s43
RK 0,60,0
RK 4,61,0
PV 156,92,32
s_xor_b32 s42, s41, 0xc000
RK 8,62,0
v_xor_b32 v64, s43, v64
QK 24,32,208,44
s_add_u32 s40, s40, 0x20000
EX 28
QK 24,36,212,24
s_add_u32 m0, s42, 0x0
EX 29
QK 24,40,216,24
buffer_load_dwordx4 v66, s[16:19], s40 offen lds
QK 24,44,220,24
EX 30
EX 31
CV 38,28,29
CV 39,30,31
v_xor_b32 v65, s43, v65
s_xor_b32 s43, s43, 0xc000
v_smfmac_f32_16x16x64_bf16 a[248:251], v[56:59], v[32:39], v71
RK 12,63,0
QK 28,48,208,44
RK 16,60,4096
RK 20,61,4096
QK 28,52,212,28
EX 16
QK 28,56,216,28
RK 24,62,4096
RK 28,63,4096
QK 28,60,220,28
EX 17
PV 160,64,36
RV 64,64,0
RV 66,64,4096
PV 164,68,36
RV 68,65,0
CV 32,16,17
PV 168,72,36
buffer_load_dwordx4 v67, s[16:19], s40 offen offset:1024 lds
PV 172,76,36
RV 70,65,4096
RV 72,64,256
PV 176,80,36
RV 74,64,4352
PV 180,84,36
s_add_u32 m0, s42, 0x10000
RV 76,65,256
RV 78,65,4352
PV 184,88,36
RV 80,64,512
PV 188,92,36
s_waitcnt lgkmcnt(9)
EX 18
EX 19
EX 20
CV 33,18,19
QK 16,0,192,40
RV 82,64,4608
RV 84,65,512
QK 16,4,196,16
buffer_load_dwordx4 v68, s[20:23], s40 offen lds
QK 16,8,200,16
RV 86,65,4608
RV 88,64,768
QK 16,12,204,16
EX 21
EX 22
EX 23
CV 34,20,21
CV 35,22,23
QK 20,16,192,40
RV 90,64,4864
RV 92,65,768
QK 20,20,196,20
RV 94,65,4864
QK 20,24,200,20
EX 24
QK 20,28,204,20
EX 25
PV 128,96,32
EX 26
PV 132,100,32
buffer_load_dwordx4 v69, s[20:23], s40 offen offset:1024 lds
PV 136,104,32
EX 27
PV 140,108,32
s_add_u32 s40, s40, 0x20000
CV 36,24,25
CV 37,26,27
PV 144,112,32
s_waitcnt lgkmcnt(0)
EX 28
PV 148,116,32
s_add_u32 m0, s42, 0x2000
EX 29
PV 152,120,32
RK 32,60,8192
RK 36,61,8192
PV 156,124,32
RK 40,62,8192
CV 38,28,29
QK 24,0,208,44
EX 30
QK 24,4,212,24
buffer_load_dwordx4 v66, s[16:19], s40 offen lds
QK 24,8,216,24
EX 31
QK 24,12,220,24
RK 44,63,8192
CV 39,30,31
EX 16
s_nop 0
v_smfmac_f32_16x16x64_bf16 a[248:251], v[56:59], v[32:39], v71
RK 48,60,12288
QK 28,16,208,44
RK 52,61,12288
RK 56,62,12288
QK 28,20,212,28
EX 17
QK 28,24,216,28
RK 60,63,12288
CV 32,16,17
QK 28,28,220,28
EX 18
PV 160,96,36
RV 96,64,8192
RV 98,64,12288
PV 164,100,36
buffer_load_dwordx4 v67, s[16:19], s40 offen offset:1024 lds
PV 168,104,36
RV 100,65,8192
RV 102,65,12288
PV 172,108,36
RV 104,64,8448
v_xor_b32 v60, s43, v60
PV 176,112,36
s_add_u32 m0, s42, 0x12000
RV 106,64,12544
RV 108,65,8448
PV 180,116,36
RV 110,65,12544
v_xor_b32 v61, s43, v61
PV 184,120,36
RV 112,64,8704
RV 114,64,12800
PV 188,124,36
s_waitcnt lgkmcnt(10)
EX 19
EX 20
CV 33,18,19
QK 16,32,192,40
buffer_load_dwordx4 v68, s[20:23], s40 offen lds
QK 16,36,196,16
RV 116,65,8704
RV 118,65,12800
QK 16,40,200,16
RV 120,64,8960
v_xor_b32 v62, s43, v62
QK 16,44,204,16
EX 21
EX 22
EX 23
CV 34,20,21
CV 35,22,23
QK 20,48,192,40
RV 122,64,13056
RV 124,65,8960
QK 20,52,196,20
RV 126,65,13056
v_xor_b32 v63, s43, v63
QK 20,56,200,20
EX 24
QK 20,60,204,20
EX 25
PV 128,64,32
buffer_load_dwordx4 v69, s[20:23], s40 offen offset:1024 lds
PV 132,68,32
EX 26
PV 136,72,32
EX 27
PV 140,76,32
CV 36,24,25
CV 37,26,27
PV 144,80,32
s_waitcnt vmcnt(8) lgkmcnt(0)
s_barrier
PV 148,84,32
s_sub_u32 s56, s56, 1
s_cbranch_scc0 L_t7_loop1
PV 152,88,32
s_xor_b32 s41, s41, s43
RK 0,60,0
RK 4,61,0
PV 156,92,32
s_xor_b32 s42, s41, 0xc000
RK 8,62,0
v_xor_b32 v64, s43, v64
QK 24,32,208,44
EX 28
QK 24,36,212,24
EX 29
QK 24,40,216,24
EX 30
QK 24,44,220,24
RK 12,63,0
RK 16,60,4096
EX 31
CV 38,28,29
CV 39,30,31
v_xor_b32 v65, s43, v65
s_xor_b32 s43, s43, 0xc000
v_smfmac_f32_16x16x64_bf16 a[248:251], v[56:59], v[32:39], v71
RK 20,61,4096
QK 28,48,208,44
RK 24,62,4096
RK 28,63,4096
QK 28,52,212,28
EX 16
QK 28,56,216,28
EX 17
QK 28,60,220,28
EX 18
PV 160,64,36
RV 64,64,0
RV 66,64,4096
PV 164,68,36
RV 68,65,0
CV 32,16,17
PV 168,72,36
RV 70,65,4096
RV 72,64,256
PV 172,76,36
EX 19
PV 176,80,36
RV 74,64,4352
RV 76,65,256
PV 180,84,36
RV 78,65,4352
CV 33,18,19
PV 184,88,36
RV 80,64,512
RV 82,64,4608
PV 188,92,36
s_waitcnt lgkmcnt(10)
EX 20
QK 16,0,192,40
RV 84,65,512
RV 86,65,4608
QK 16,4,196,16
EX 21
QK 16,8,200,16
RV 88,64,768
RV 90,64,4864
QK 16,12,204,16
RV 92,65,768
EX 22
EX 23
CV 34,20,21
CV 35,22,23
QK 20,16,192,40
EX 24
QK 20,20,196,20
RV 94,65,4864
QK 20,24,200,20
EX 25
QK 20,28,204,20
EX 26
PV 128,96,32
EX 27
PV 132,100,32
CV 36,24,25
CV 37,26,27
PV 136,104,32
EX 28
PV 140,108,32
EX 29
PV 144,112,32
s_waitcnt lgkmcnt(0)
EX 30
PV 148,116,32
EX 31
PV 152,120,32
RK 32,60,8192
RK 36,61,8192
PV 156,124,32
RK 40,62,8192
CV 38,28,29
QK 24,0,208,44
RK 44,63,8192
CV 39,30,31
QK 24,4,212,24
EX 16
QK 24,8,216,24
RK 48,60,12288
RK 52,61,12288
QK 24,12,220,24
RK 56,62,12288
v_xor_b32 v60, s43, v60
v_smfmac_f32_16x16x64_bf16 a[248:251], v[56:59], v[32:39], v71
RK 60,63,12288
QK 28,16,208,44
EX 17
QK 28,20,212,28
EX 18
QK 28,24,216,28
EX 19
QK 28,28,220,28
CV 32,16,17
CV 33,18,19
PV 160,96,36
RV 96,64,8192
RV 98,64,12288
PV 164,100,36
RV 100,65,8192
v_xor_b32 v61, s43, v61
PV 168,104,36
RV 102,65,12288
RV 104,64,8448
PV 172,108,36
RV 106,64,12544
v_xor_b32 v62, s43, v62
PV 176,112,36
RV 108,65,8448
RV 110,65,12544
PV 180,116,36
RV 112,64,8704
v_xor_b32 v63, s43, v63
PV 184,120,36
RV 114,64,12800
RV 116,65,8704
PV 188,124,36
s_waitcnt lgkmcnt(11)
EX 20
QK 16,32,192,40
RV 118,65,12800
RV 120,64,8960
QK 16,36,196,16
EX 21
QK 16,40,200,16
EX 22
QK 16,44,204,16
RV 122,64,13056
RV 124,65,8960
EX 23
CV 34,20,21
CV 35,22,23
QK 20,48,192,40
RV 126,65,13056
v_xor_b32 v64, s43, v64
QK 20,52,196,20
EX 24
QK 20,56,200,20
EX 25
QK 20,60,204,20
EX 26
PV 128,64,32
EX 27
PV 132,68,32
CV 36,24,25
CV 37,26,27
PV 136,72,32
EX 28
PV 140,76,32
EX 29
PV 144,80,32
s_waitcnt vmcnt(0) lgkmcnt(0)
s_barrier
PV 148,84,32
EX 30
PV 152,88,32
s_xor_b32 s41, s41, s43
RK 0,60,0
RK 4,61,0
PV 156,92,32
s_xor_b32 s42, s41, 0xc000
RK 8,62,0
CV 38,28,29
QK 24,32,208,44
EX 31
QK 24,36,212,24
RK 12,63,0
CV 39,30,31
QK 24,40,216,24
RK 16,60,4096
RK 20,61,4096
QK 24,44,220,24
RK 24,62,4096
v_xor_b32 v65, s43, v65
v_smfmac_f32_16x16x64_bf16 a[248:251], v[56:59], v[32:39], v71
s_xor_b32 s43, s43, 0xc000
RK 28,63,4096
QK 28,48,208,44
EX 16
QK 28,52,212,28
EX 17
QK 28,56,216,28
EX 18
QK 28,60,220,28
EX 19
PV 160,64,36
RV 64,64,0
RV 66,64,4096
PV 164,68,36
RV 68,65,0
CV 32,16,17
PV 168,72,36
RV 70,65,4096
RV 72,64,256
PV 172,76,36
RV 74,64,4352
CV 33,18,19
PV 176,80,36
RV 76,65,256
RV 78,65,4352
PV 180,84,36
EX 20
PV 184,88,36
RV 80,64,512
RV 82,64,4608
PV 188,92,36
s_waitcnt lgkmcnt(10)
EX 21
QK 16,0,192,40
RV 84,65,512
RV 86,65,4608
QK 16,4,196,16
RV 88,64,768
CV 34,20,21
QK 16,8,200,16
EX 22
QK 16,12,204,16
EX 23
EX 24
CV 35,22,23
QK 20,16,192,40
RV 90,64,4864
RV 92,65,768
QK 20,20,196,20
RV 94,65,4864
QK 20,24,200,20
EX 25
QK 20,28,204,20
EX 26
PV 128,96,32
EX 27
PV 132,100,32
CV 36,24,25
CV 37,26,27
PV 136,104,32
EX 28
PV 140,108,32
EX 29
PV 144,112,32
s_waitcnt lgkmcnt(0)
EX 30
PV 148,116,32
EX 31
PV 152,120,32
RK 32,60,8192
RK 36,61,8192
PV 156,124,32
RK 40,62,8192
CV 38,28,29
QK 24,0,208,44
RK 44,63,8192
CV 39,30,31
QK 24,4,212,24
EX 16
QK 24,8,216,24
RK 48,60,12288
RK 52,61,12288
QK 24,12,220,24
EX 17
v_smfmac_f32_16x16x64_bf16 a[248:251], v[56:59], v[32:39], v71
RK 56,62,12288
QK 28,16,208,44
RK 60,63,12288
CV 32,16,17
QK 28,20,212,28
EX 18
QK 28,24,216,28
EX 19
QK 28,28,220,28
EX 20
PV 160,96,36
RV 96,64,8192
RV 98,64,12288
PV 164,100,36
RV 100,65,8192
CV 33,18,19
PV 168,104,36
L_t7_pad6:
s_cbranch_execz L_t7_go
RV 102,65,12288
RV 104,64,8448
PV 172,108,36
EX 21
PV 176,112,36
RV 106,64,12544
RV 108,65,8448
PV 180,116,36
RV 110,65,12544
CV 34,20,21
PV 184,120,36
RV 112,64,8704
RV 114,64,12800
PV 188,124,36
s_waitcnt lgkmcnt(10)
EX 22
QK 16,32,192,40
RV 116,65,8704
RV 118,65,12800
QK 16,36,196,16
EX 23
QK 16,40,200,16
RV 120,64,8960
RV 122,64,13056
QK 16,44,204,16
RV 124,65,8960
CV 35,22,23
QK 20,48,192,40
EX 24
QK 20,52,196,20
RV 126,65,13056
QK 20,56,200,20
EX 25
QK 20,60,204,20
EX 26
PV 128,64,32
EX 27
PV 132,68,32
CV 36,24,25
CV 37,26,27
PV 136,72,32
EX 28
PV 140,76,32
EX 29
PV 144,80,32
s_waitcnt lgkmcnt(0)
EX 30
PV 148,84,32
EX 31
PV 152,88,32
CV 38,28,29
CV 39,30,31
PV 156,92,32
EX 16
QK 24,32,208,44
EX 17
QK 24,36,212,24
EX 18
QK 24,40,216,24
EX 19
QK 24,44,220,24
EX 20
v_smfmac_f32_16x16x64_bf16 a[248:251], v[56:59], v[32:39], v71
CV 32,16,17
QK 28,48,208,44
EX 21
QK 28,52,212,28
EX 22
QK 28,56,216,28
EX 23
QK 28,60,220,28
EX 24
PV 160,64,36
EX 25
PV 164,68,36
EX 26
PV 168,72,36
EX 27
PV 172,76,36
EX 28
PV 176,80,36
EX 29
PV 180,84,36
EX 30
PV 184,88,36
EX 31
PV 188,92,36
CV 33,18,19
CV 34,20,21
CV 35,22,23
CV 36,24,25
CV 37,26,27
CV 38,28,29
CV 39,30,31
s_nop 1
v_smfmac_f32_16x16x64_bf16 a[248:251], v[56:59], v[32:39], v71
s_add_u32 s52, s45, 0x0
s_nop 0
PV 128,96,32
s_nop 2
PV 132,100,32
s_nop 2
PV 136,104,32
s_nop 0
v_accvgpr_read_b32 v76, a248
PV 140,108,32
v_accvgpr_read_b32 v40, a249
v_accvgpr_read_b32 v77, a250
v_add_f32 v76, v76, v40
v_accvgpr_read_b32 v44, a251
v_cmp_nge_f32 s[96:97], s55, v76
v_rcp_f32 v76, v76
v_add_f32 v77, v77, v44
PM 128,76,0
v_cmp_nge_f32 s[98:99], s55, v77
v_rcp_f32 v77, v77
PM 130,76,0
PV 144,112,32
CV 128,128,129
CV 129,130,131
PM 132,76,0
PM 134,76,0
PV 148,116,32
ds_write_b64 v70, v[128:129] offset:0
CV 132,132,133
CV 133,134,135
PM 136,76,0
PM 138,76,0
PV 152,120,32
ds_write_b64 v70, v[132:133] offset:32
CV 136,136,137
CV 137,138,139
PM 140,76,0
PM 142,76,0
PV 156,124,32
s_add_u32 s53, s45, 0x10000
ds_write_b64 v70, v[136:137] offset:64
CV 140,140,141
CV 141,142,143
PM 144,76,0
PM 146,76,0
PV 160,96,36
ds_write_b64 v70, v[140:141] offset:96
CV 144,144,145
CV 145,146,147
PM 148,76,0
PM 150,76,0
PV 164,100,36
ds_write_b64 v70, v[144:145] offset:128
CV 148,148,149
CV 149,150,151
PM 152,76,0
PM 154,76,0
PV 168,104,36
ds_write_b64 v70, v[148:149] offset:160
CV 152,152,153
CV 153,154,155
PM 156,76,0
PM 158,76,0
PV 172,108,36
ds_write_b64 v70, v[152:153] offset:192
CV 156,156,157
CV 157,158,159
PM 160,76,1
PM 162,76,1
PV 176,112,36
ds_write_b64 v70, v[156:157] offset:224
RK 192,15,0
RK 196,15,528
CV 160,160,161
RK 200,15,1056
CV 161,162,163
RK 204,15,1584
PM 164,76,1
PM 166,76,1
PV 180,116,36
ds_write_b64 v70, v[160:161] offset:0
CV 164,164,165
CV 165,166,167
PM 168,76,1
PM 170,76,1
PV 184,120,36
s_waitcnt lgkmcnt(4)
buffer_store_dwordx4 a[192:195], v72, s[36:39], s52 offen nt
ds_write_b64 v70, v[164:165] offset:32
CV 168,168,169
CV 169,170,171
PM 172,76,1
PM 174,76,1
PV 188,124,36
s_waitcnt lgkmcnt(4)
ds_write_b64 v70, v[168:169] offset:64
buffer_store_dwordx4 a[196:199], v73, s[36:39], s52 offen nt
CV 172,172,173
CV 173,174,175
ds_write_b64 v70, v[172:173] offset:96
PM 176,76,1
PM 178,76,1
CV 176,176,177
CV 177,178,179
ds_write_b64 v70, v[176:177] offset:128
s_waitcnt lgkmcnt(6)
buffer_store_dwordx4 a[200:203], v74, s[36:39], s52 offen nt
PM 180,76,1
PM 182,76,1
CV 180,180,181
CV 181,182,183
ds_write_b64 v70, v[180:181] offset:160
PM 184,76,1
PM 186,76,1
CV 184,184,185
CV 185,186,187
ds_write_b64 v70, v[184:185] offset:192
s_waitcnt lgkmcnt(7)
buffer_store_dwordx4 a[204:207], v75, s[36:39], s52 offen nt
PM 188,76,1
PM 190,76,1
CV 188,188,189
CV 189,190,191
ds_write_b64 v70, v[188:189] offset:224
RK 208,15,0
RK 212,15,528
RK 216,15,1056
RK 220,15,1584
s_waitcnt lgkmcnt(3)
buffer_store_dwordx4 a[208:211], v72, s[36:39], s53 offen nt
s_waitcnt lgkmcnt(2)
buffer_store_dwordx4 a[212:215], v73, s[36:39], s53 offen nt
s_waitcnt lgkmcnt(1)
buffer_store_dwordx4 a[216:219], v74, s[36:39], s53 offen nt
s_waitcnt lgkmcnt(0)
buffer_store_dwordx4 a[220:223], v75, s[36:39], s53 offen nt
s_cmp_lg_u64 s[4:5], 0
s_cselect_b32 s62, 1, 0
s_or_b32 s54, s54, s62
s_cmp_lg_u64 s[6:7], 0
s_cselect_b32 s62, 2, 0
s_or_b32 s54, s54, s62
s_cmp_lg_u64 s[8:9], 0
s_cselect_b32 s62, 4, 0
s_or_b32 s54, s54, s62
s_cmp_lg_u64 s[10:11], 0
s_cselect_b32 s62, 8, 0
s_or_b32 s54, s54, s62
s_cmp_lg_u64 s[96:97], 0
s_cselect_b32 s62, 16, 0
s_or_b32 s54, s54, s62
s_cmp_lg_u64 s[98:99], 0
s_cselect_b32 s62, 32, 0
s_or_b32 s54, s54, s62
s_cbranch_scc0 L_done7
s_mov_b32 s4, 0x78d000
s_mov_b32 s5, 650
s_mov_b32 s6, 0xc75000
s_mov_b32 s7, 389
s_getpc_b64 s[62:63]
L_fpc7:
s_add_u32 s62, s62, L_fallback-L_fpc7
s_addc_u32 s63, s63, 0
s_setpc_b64 s[62:63]
L_done7:
s_endpgm
L_end7:
.p2align 12
L_type8:
s_mov_b64 exec, 0
s_cmp_eq_u32 s12, 0
s_cbranch_scc1 L_t8_pad1
s_cmp_eq_u32 s12, 1
s_cbranch_scc1 L_t8_pad2
s_cmp_eq_u32 s12, 2
s_cbranch_scc1 L_t8_pad3
s_branch L_t8_pad4
L_t8_go:
s_mov_b64 exec, -1
s_add_u32 m0, s47, 0x12000
s_add_u32 s50, s44, 0x10000
s_add_u32 s51, s44, 0x20000
s_add_u32 s52, s44, 0x30000
s_waitcnt vmcnt(3)
buffer_load_dwordx4 v68, s[20:23], s40 offen lds
s_barrier
v_lshlrev_b32 v0, 16, v128
RK 0,60,8192
RK 4,61,8192
v_and_b32 v1, s71, v128
RK 8,62,8192
v_lshlrev_b32 v2, 16, v129
buffer_load_dwordx4 v69, s[20:23], s40 offen offset:1024 lds
RK 12,63,8192
s_mov_b32 s40, 0x5ad000
s_add_u32 m0, s47, 0x4000
v_and_b32 v3, s71, v129
v_lshlrev_b32 v4, 16, v130
v_and_b32 v5, s71, v130
v_lshlrev_b32 v6, 16, v131
v_and_b32_e64 v7, s71, v131
v_pk_mul_f32 v[0:1], v[0:1], s[14:15]
v_pk_mul_f32 v[2:3], v[2:3], s[14:15]
buffer_load_dwordx4 v[160:163], v72, s[24:27], s50 offen nt
v_pk_mul_f32 v[4:5], v[4:5], s[14:15]
v_pk_mul_f32 v[6:7], v[6:7], s[14:15]
CV 128,0,1
CV 129,2,3
CV 130,4,5
CV 131,6,7
ds_write_b128 v15, v[128:131] offset:0
buffer_load_dwordx4 v[164:167], v73, s[24:27], s50 offen nt
s_waitcnt vmcnt(6)
v_lshlrev_b32 v0, 16, v132
v_and_b32 v1, s71, v132
v_lshlrev_b32 v2, 16, v133
v_and_b32 v3, s71, v133
v_lshlrev_b32 v4, 16, v134
v_and_b32 v5, s71, v134
v_lshlrev_b32 v6, 16, v135
v_and_b32_e64 v7, s71, v135
v_pk_mul_f32 v[0:1], v[0:1], s[14:15]
v_pk_mul_f32 v[2:3], v[2:3], s[14:15]
buffer_load_dwordx4 v[168:171], v74, s[24:27], s50 offen nt
v_pk_mul_f32 v[4:5], v[4:5], s[14:15]
v_pk_mul_f32 v[6:7], v[6:7], s[14:15]
CV 132,0,1
CV 133,2,3
CV 134,4,5
CV 135,6,7
ds_write_b128 v15, v[132:135] offset:544
buffer_load_dwordx4 v[172:175], v75, s[24:27], s50 offen nt
s_waitcnt vmcnt(7)
v_lshlrev_b32 v0, 16, v136
v_and_b32 v1, s71, v136
v_lshlrev_b32 v2, 16, v137
v_and_b32 v3, s71, v137
v_lshlrev_b32 v4, 16, v138
v_and_b32 v5, s71, v138
v_lshlrev_b32 v6, 16, v139
v_and_b32_e64 v7, s71, v139
v_pk_mul_f32 v[0:1], v[0:1], s[14:15]
v_pk_mul_f32 v[2:3], v[2:3], s[14:15]
buffer_load_dwordx4 v[192:195], v72, s[24:27], s51 offen nt
v_pk_mul_f32 v[4:5], v[4:5], s[14:15]
v_pk_mul_f32 v[6:7], v[6:7], s[14:15]
CV 136,0,1
CV 137,2,3
CV 138,4,5
CV 139,6,7
ds_write_b128 v15, v[136:139] offset:1152
buffer_load_dwordx4 v[196:199], v73, s[24:27], s51 offen nt
s_waitcnt vmcnt(8)
v_lshlrev_b32 v0, 16, v140
v_and_b32 v1, s71, v140
v_lshlrev_b32 v2, 16, v141
v_and_b32 v3, s71, v141
v_lshlrev_b32 v4, 16, v142
v_and_b32 v5, s71, v142
v_lshlrev_b32 v6, 16, v143
v_and_b32_e64 v7, s71, v143
v_pk_mul_f32 v[0:1], v[0:1], s[14:15]
v_pk_mul_f32 v[2:3], v[2:3], s[14:15]
buffer_load_dwordx4 v[200:203], v74, s[24:27], s51 offen nt
v_pk_mul_f32 v[4:5], v[4:5], s[14:15]
v_pk_mul_f32 v[6:7], v[6:7], s[14:15]
CV 140,0,1
CV 141,2,3
CV 142,4,5
CV 143,6,7
ds_write_b128 v15, v[140:143] offset:1696
RK 128,14,0
v_subrev_u32 v12, 0x10000, v71
RK 132,14,64
v_ashrrev_i32 v12, 31, v12
RK 136,14,128
v_not_b32 v12, v12
RK 140,14,192
v_and_b32 v12, 0xff800000, v12
v_accvgpr_write_b32 a240, 0
v_accvgpr_write_b32 a241, 0
v_accvgpr_write_b32 a242, 0
v_accvgpr_write_b32 a243, 0
v_xor_b32 v60, s43, v60
v_xor_b32 v61, s43, v61
v_xor_b32 v62, s43, v62
v_xor_b32 v63, s43, v63
s_waitcnt lgkmcnt(3)
QZ 16,0,128
s_waitcnt lgkmcnt(2)
buffer_load_dwordx4 v[204:207], v75, s[24:27], s51 offen nt
QK 16,4,132,16
s_waitcnt lgkmcnt(1)
s_sub_u32 s53, s26, s44
v_accvgpr_write_b32 a244, 0
v_accvgpr_write_b32 a245, 0
QK 16,8,136,16
s_waitcnt lgkmcnt(0)
s_ashr_i32 s53, s53, 8
v_accvgpr_write_b32 a246, 0
v_accvgpr_write_b32 a247, 0
QK 16,12,140,16
s_sub_u32 s53, s53, 512
v_mov_b32 v33, 0
v_mov_b32 v34, 0
v_mov_b32 v35, 0
v_and_b32 v49, 0xf0, v72
s_sub_u32 s48, s26, s44
v_sub_u32 v49, s53, v49
s_ashr_i32 s48, s48, 8
v_ashrrev_i32 v49, 31, v49
v_max3_f32 v8, v16, v17, v18
v_and_b32 v53, 0xf0, v72
v_max_f32 v8, v8, v19
s_sub_u32 s48, s48, 768
v_mov_b32 v9, v8
v_sub_u32 v53, s48, v53
s_xor_b32 s41, s41, s43
v_permlane32_swap_b32 v8, v9
v_max_f32 v8, v8, v9
v_ashrrev_i32 v53, 31, v53
v_mov_b32 v9, v8
s_xor_b32 s42, s41, 0xc000
s_mul_i32 s45, s12, 0x30000
v_permlane16_swap_b32 v8, v9
v_min_f32_e64 v40, -v8, -v9
s_mul_i32 s49, s46, 0xc0000
v_add_f32 v8, v40, v12
v_mov_b32 v41, v40
v_add_f32 v16, v8, v16
v_add_f32 v17, v8, v17
EX 16
EX 17
v_mov_b32 v42, v40
CV 32,16,17
v_mov_b32 v43, v40
s_waitcnt vmcnt(7)
buffer_load_dwordx4 v[224:227], v72, s[24:27], s52 offen nt
s_barrier
v_lshlrev_b32 v0, 16, v160
RV 64,64,8192
RV 66,64,12288
v_and_b32 v1, s71, v160
RV 68,65,8192
buffer_load_dwordx4 v[228:231], v73, s[24:27], s52 offen nt
RV 70,65,12288
RV 72,64,8448
v_lshlrev_b32 v2, 16, v161
RV 74,64,12544
RV 76,65,8448
v_and_b32 v3, s71, v161
RV 78,65,12544
v_lshlrev_b32 v4, 16, v162
buffer_load_dwordx4 v[232:235], v74, s[24:27], s52 offen nt
RV 80,64,8704
RV 82,64,12800
v_and_b32 v5, s71, v162
RV 84,65,8704
RV 86,65,12800
v_lshlrev_b32_e64 v6, 16, v163
RV 88,64,8960
RV 90,64,13056
buffer_load_dwordx4 v[236:239], v75, s[24:27], s52 offen nt
RV 92,65,8960
v_and_b32_e64 v7, s71, v163
RV 94,65,13056
v_pk_mul_f32 v[0:1], v[0:1], s[14:15]
v_pk_mul_f32 v[2:3], v[2:3], s[14:15]
v_pk_mul_f32 v[4:5], v[4:5], s[14:15]
v_pk_mul_f32 v[6:7], v[6:7], s[14:15]
CV 160,0,1
CV 161,2,3
CV 162,4,5
CV 163,6,7
ds_write_b128 v15, v[160:163] offset:0
s_waitcnt vmcnt(10)
v_lshlrev_b32 v0, 16, v164
v_and_b32 v1, s71, v164
v_lshlrev_b32 v2, 16, v165
v_and_b32 v3, s71, v165
v_lshlrev_b32 v4, 16, v166
v_and_b32 v5, s71, v166
v_lshlrev_b32 v6, 16, v167
v_and_b32_e64 v7, s71, v167
v_pk_mul_f32 v[0:1], v[0:1], s[14:15]
v_pk_mul_f32 v[2:3], v[2:3], s[14:15]
v_pk_mul_f32 v[4:5], v[4:5], s[14:15]
v_pk_mul_f32 v[6:7], v[6:7], s[14:15]
CV 164,0,1
CV 165,2,3
CV 166,4,5
CV 167,6,7
ds_write_b128 v15, v[164:167] offset:544
s_waitcnt vmcnt(9)
v_lshlrev_b32 v0, 16, v168
v_and_b32 v1, s71, v168
v_lshlrev_b32 v2, 16, v169
v_and_b32 v3, s71, v169
v_lshlrev_b32 v4, 16, v170
v_and_b32 v5, s71, v170
v_lshlrev_b32 v6, 16, v171
v_and_b32_e64 v7, s71, v171
v_pk_mul_f32 v[0:1], v[0:1], s[14:15]
v_pk_mul_f32 v[2:3], v[2:3], s[14:15]
v_pk_mul_f32 v[4:5], v[4:5], s[14:15]
v_pk_mul_f32 v[6:7], v[6:7], s[14:15]
CV 168,0,1
CV 169,2,3
CV 170,4,5
CV 171,6,7
ds_write_b128 v15, v[168:171] offset:1152
s_waitcnt vmcnt(8)
v_lshlrev_b32 v0, 16, v172
v_and_b32 v1, s71, v172
v_lshlrev_b32 v2, 16, v173
v_and_b32 v3, s71, v173
v_lshlrev_b32 v4, 16, v174
v_and_b32 v5, s71, v174
v_lshlrev_b32 v6, 16, v175
v_and_b32_e64 v7, s71, v175
v_pk_mul_f32 v[0:1], v[0:1], s[14:15]
v_pk_mul_f32 v[2:3], v[2:3], s[14:15]
v_pk_mul_f32 v[4:5], v[4:5], s[14:15]
v_pk_mul_f32 v[6:7], v[6:7], s[14:15]
CV 172,0,1
CV 173,2,3
CV 174,4,5
CV 175,6,7
s_waitcnt lgkmcnt(15)
PZ 128,64,32
s_add_u32 s45, s45, s49
ds_write_b128 v15, v[172:175] offset:1696
PZ 132,68,32
s_waitcnt lgkmcnt(14)
s_mov_b32 s57, 7
RK 144,14,0
RK 148,14,64
PZ 136,72,32
s_waitcnt lgkmcnt(14)
s_mov_b32 s58, 0x20000
RK 152,14,128
v_xor_b32 v64, s43, v64
PZ 140,76,32
s_waitcnt lgkmcnt(13)
s_mov_b32 s60, 0xffc73000
RK 156,14,192
v_xor_b32 v65, s43, v65
PZ 144,80,32
s_waitcnt lgkmcnt(12)
s_xor_b32 s43, s43, 0xc000
v_accvgpr_write_b32 a248, 0
v_accvgpr_write_b32 a249, 0
PZ 148,84,32
s_waitcnt lgkmcnt(10)
s_mov_b32 s59, 0x20000
v_accvgpr_write_b32 a252, 0
v_accvgpr_write_b32 a253, 0
PZ 152,88,32
s_waitcnt lgkmcnt(8)
s_mov_b32 s61, 0xb000
v_accvgpr_write_b32 a254, 0
v_accvgpr_write_b32 a255, 0
PZ 156,92,32
s_waitcnt lgkmcnt(3)
s_add_u32 s45, s45, 0x3e0000
QZ 24,0,144
s_waitcnt lgkmcnt(2)
s_mov_b64 s[32:33], s[24:25]
QK 24,4,148,24
s_waitcnt lgkmcnt(1)
s_mov_b32 s34, 0x5aa100
QK 24,8,152,24
s_waitcnt lgkmcnt(0)
s_mov_b32 s35, 0x20000
QK 24,12,156,24
s_mov_b64 s[36:37], s[28:29]
v_mov_b32 v37, 0
v_mov_b32 v38, 0
v_mov_b32 v39, 0
s_mov_b32 s38, 0x5aa100
s_mov_b32 s39, 0x20000
s_sub_u32 s57, s57, 1
s_cselect_b64 s[58:59], s[60:61], s[58:59]
v_max3_f32 v10, v24, v25, v26
v_max_f32 v10, v10, v27
v_mov_b32 v11, v10
s_nop 1
v_permlane32_swap_b32 v10, v11
v_max_f32 v10, v10, v11
v_mov_b32 v11, v10
s_nop 1
v_permlane16_swap_b32 v10, v11
v_min_f32_e64 v44, -v10, -v11
v_add_f32 v10, v44, v12
v_mov_b32 v45, v44
v_add_f32 v24, v10, v24
v_add_f32 v25, v10, v25
EX 24
EX 25
v_mov_b32 v46, v44
CV 36,24,25
v_mov_b32 v47, v44
s_waitcnt vmcnt(7)
buffer_load_dwordx4 v66, s[16:19], s40 offen lds
v_lshlrev_b32 v0, 16, v192
v_and_b32 v1, s71, v192
v_lshlrev_b32 v2, 16, v193
v_and_b32 v3, s71, v193
v_lshlrev_b32 v4, 16, v194
v_and_b32 v5, s71, v194
v_lshlrev_b32 v6, 16, v195
v_and_b32_e64 v7, s71, v195
buffer_load_dwordx4 v67, s[16:19], s40 offen offset:1024 lds
s_add_u32 m0, s47, 0x14000
v_pk_mul_f32 v[0:1], v[0:1], s[14:15]
v_pk_mul_f32 v[2:3], v[2:3], s[14:15]
v_pk_mul_f32 v[4:5], v[4:5], s[14:15]
v_pk_mul_f32 v[6:7], v[6:7], s[14:15]
CV 192,0,1
CV 193,2,3
CV 194,4,5
CV 195,6,7
ds_write_b128 v15, v[192:195] offset:0
buffer_load_dwordx4 v68, s[20:23], s40 offen lds
s_waitcnt vmcnt(9)
v_lshlrev_b32 v0, 16, v196
v_and_b32 v1, s71, v196
v_lshlrev_b32 v2, 16, v197
v_and_b32 v3, s71, v197
v_lshlrev_b32 v4, 16, v198
v_and_b32 v5, s71, v198
v_lshlrev_b32 v6, 16, v199
v_and_b32_e64 v7, s71, v199
v_pk_mul_f32 v[0:1], v[0:1], s[14:15]
v_pk_mul_f32 v[2:3], v[2:3], s[14:15]
buffer_load_dwordx4 v69, s[20:23], s40 offen offset:1024 lds
s_mov_b32 s40, 0x5cd000
s_add_u32 m0, s47, 0x6000
v_pk_mul_f32 v[4:5], v[4:5], s[14:15]
v_pk_mul_f32 v[6:7], v[6:7], s[14:15]
CV 196,0,1
CV 197,2,3
CV 198,4,5
CV 199,6,7
ds_write_b128 v15, v[196:199] offset:544
s_waitcnt vmcnt(9)
v_lshlrev_b32 v0, 16, v200
v_and_b32 v1, s71, v200
v_lshlrev_b32 v2, 16, v201
v_and_b32 v3, s71, v201
v_lshlrev_b32 v4, 16, v202
v_and_b32 v5, s71, v202
v_lshlrev_b32 v6, 16, v203
v_and_b32_e64 v7, s71, v203
v_pk_mul_f32 v[0:1], v[0:1], s[14:15]
v_pk_mul_f32 v[2:3], v[2:3], s[14:15]
v_pk_mul_f32 v[4:5], v[4:5], s[14:15]
v_pk_mul_f32 v[6:7], v[6:7], s[14:15]
CV 200,0,1
CV 201,2,3
CV 202,4,5
CV 203,6,7
ds_write_b128 v15, v[200:203] offset:1152
s_waitcnt vmcnt(8)
v_lshlrev_b32 v0, 16, v204
v_and_b32 v1, s71, v204
v_lshlrev_b32 v2, 16, v205
v_and_b32 v3, s71, v205
v_lshlrev_b32 v4, 16, v206
v_and_b32 v5, s71, v206
v_lshlrev_b32 v6, 16, v207
v_and_b32 v7, s71, v207
v_pk_mul_f32 v[0:1], v[0:1], s[14:15]
v_pk_mul_f32 v[2:3], v[2:3], s[14:15]
v_pk_mul_f32 v[4:5], v[4:5], s[14:15]
v_pk_mul_f32 v[6:7], v[6:7], s[14:15]
CV 204,0,1
CV 205,2,3
CV 206,4,5
CV 207,6,7
PZ 160,64,36
ds_write_b128 v15, v[204:207] offset:1696
PZ 164,68,36
RK 160,14,0
RK 164,14,64
PZ 168,72,36
RK 168,14,128
PZ 172,76,36
RK 172,14,192
PZ 176,80,36
PZ 180,84,36
PZ 184,88,36
PZ 188,92,36
v_smfmac_f32_16x16x64_bf16 a[240:243], v[56:59], v[32:39], v71
s_waitcnt lgkmcnt(3)
QZ 16,0,160
s_waitcnt lgkmcnt(2)
QK 16,4,164,16
s_waitcnt lgkmcnt(1)
QK 16,8,168,16
s_waitcnt lgkmcnt(0)
QK 16,12,172,16
v_mov_b32 v33, 0
v_mov_b32 v34, 0
v_mov_b32 v35, 0
s_nop 4
v_max3_f32 v8, v16, v17, v18
v_max_f32 v8, v8, v19
v_mov_b32 v9, v8
s_nop 1
v_permlane32_swap_b32 v8, v9
v_max_f32 v8, v8, v9
v_mov_b32 v9, v8
s_nop 1
v_permlane16_swap_b32 v8, v9
v_min_f32_e64 v48, -v8, -v9
v_add_f32 v8, v48, v12
v_bfi_b32 v48, v49, s70, v48
v_add_f32 v16, v8, v16
v_add_f32 v17, v8, v17
EX 16
EX 17
v_mov_b32 v49, v48
CV 32,16,17
v_mov_b32 v50, v48
s_waitcnt vmcnt(7)
buffer_load_dwordx4 v66, s[16:19], s40 offen lds
v_lshlrev_b32 v0, 16, v224
v_and_b32 v1, s71, v224
v_lshlrev_b32 v2, 16, v225
v_and_b32 v3, s71, v225
v_lshlrev_b32 v4, 16, v226
v_and_b32 v5, s71, v226
v_lshlrev_b32 v6, 16, v227
v_and_b32_e64 v7, s71, v227
buffer_load_dwordx4 v67, s[16:19], s40 offen offset:1024 lds
s_add_u32 m0, s47, 0x16000
v_pk_mul_f32 v[0:1], v[0:1], s[14:15]
v_pk_mul_f32 v[2:3], v[2:3], s[14:15]
v_pk_mul_f32 v[4:5], v[4:5], s[14:15]
v_pk_mul_f32 v[6:7], v[6:7], s[14:15]
CV 224,0,1
CV 225,2,3
CV 226,4,5
CV 227,6,7
ds_write_b128 v15, v[224:227] offset:0
buffer_load_dwordx4 v68, s[20:23], s40 offen lds
s_waitcnt vmcnt(9)
v_lshlrev_b32 v0, 16, v228
v_and_b32 v1, s71, v228
v_lshlrev_b32 v2, 16, v229
v_and_b32 v3, s71, v229
v_lshlrev_b32 v4, 16, v230
v_and_b32 v5, s71, v230
v_lshlrev_b32 v6, 16, v231
v_and_b32_e64 v7, s71, v231
v_pk_mul_f32 v[0:1], v[0:1], s[14:15]
v_pk_mul_f32 v[2:3], v[2:3], s[14:15]
buffer_load_dwordx4 v69, s[20:23], s40 offen offset:1024 lds
v_pk_mul_f32 v[4:5], v[4:5], s[14:15]
v_pk_mul_f32 v[6:7], v[6:7], s[14:15]
CV 228,0,1
CV 229,2,3
CV 230,4,5
CV 231,6,7
ds_write_b128 v15, v[228:231] offset:544
s_waitcnt vmcnt(9)
v_lshlrev_b32 v0, 16, v232
v_and_b32 v1, s71, v232
v_lshlrev_b32 v2, 16, v233
v_and_b32 v3, s71, v233
v_lshlrev_b32 v4, 16, v234
v_and_b32 v5, s71, v234
v_lshlrev_b32 v6, 16, v235
v_and_b32_e64 v7, s71, v235
v_pk_mul_f32 v[0:1], v[0:1], s[14:15]
v_pk_mul_f32 v[2:3], v[2:3], s[14:15]
v_pk_mul_f32 v[4:5], v[4:5], s[14:15]
v_pk_mul_f32 v[6:7], v[6:7], s[14:15]
CV 232,0,1
CV 233,2,3
CV 234,4,5
CV 235,6,7
ds_write_b128 v15, v[232:235] offset:1152
s_waitcnt vmcnt(8)
v_lshlrev_b32 v0, 16, v236
v_and_b32 v1, s71, v236
v_lshlrev_b32 v2, 16, v237
v_and_b32 v3, s71, v237
v_lshlrev_b32 v4, 16, v238
v_and_b32 v5, s71, v238
v_lshlrev_b32 v6, 16, v239
v_and_b32_e64 v7, s71, v239
v_pk_mul_f32 v[0:1], v[0:1], s[14:15]
v_pk_mul_f32 v[2:3], v[2:3], s[14:15]
v_pk_mul_f32 v[4:5], v[4:5], s[14:15]
v_pk_mul_f32 v[6:7], v[6:7], s[14:15]
CV 236,0,1
CV 237,2,3
CV 238,4,5
CV 239,6,7
PZ 192,64,32
s_mov_b32 s40, 0x5ed000
ds_write_b128 v15, v[236:239] offset:1696
PZ 196,68,32
s_add_u32 m0, s47, 0xc000
RK 176,14,0
RK 180,14,64
PZ 200,72,32
RK 184,14,128
v_mov_b32 v51, v48
PZ 204,76,32
s_waitcnt vmcnt(6)
s_barrier
PZ 208,80,32
RK 188,14,192
RK 32,60,0
PZ 212,84,32
buffer_load_dwordx4 v66, s[16:19], s40 offen lds
PZ 216,88,32
RK 36,61,0
RK 40,62,0
PZ 220,92,32
s_waitcnt lgkmcnt(6)
RK 44,63,0
QZ 24,0,176
s_waitcnt lgkmcnt(6)
RK 48,60,4096
QK 24,4,180,24
s_waitcnt lgkmcnt(6)
buffer_load_dwordx4 v67, s[16:19], s40 offen offset:1024 lds
QK 24,8,184,24
s_waitcnt lgkmcnt(5)
s_add_u32 m0, s47, 0x1c000
RK 52,61,4096
RK 56,62,4096
QK 24,12,188,24
s_waitcnt lgkmcnt(6)
RK 60,63,4096
s_nop 0
QK 16,32,128,40
s_waitcnt lgkmcnt(6)
v_mov_b32 v37, 0
v_mov_b32 v38, 0
QK 16,36,132,16
s_waitcnt lgkmcnt(5)
buffer_load_dwordx4 v68, s[20:23], s40 offen lds
QK 16,40,136,16
s_waitcnt vmcnt(7) lgkmcnt(4)
s_barrier
QK 16,44,140,16
s_waitcnt lgkmcnt(3)
v_max3_f32 v10, v24, v25, v26
v_mov_b32 v39, 0
QK 20,48,128,40
s_waitcnt lgkmcnt(2)
RV 96,64,0
v_max_f32 v10, v10, v27
QK 20,52,132,20
s_waitcnt lgkmcnt(1)
RV 98,64,4096
v_mov_b32 v11, v10
QK 20,56,136,20
EX 16
QK 20,60,140,20
buffer_load_dwordx4 v69, s[20:23], s40 offen offset:1024 lds
RV 100,65,0
RV 102,65,4096
v_permlane32_swap_b32 v10, v11
v_max_f32 v10, v10, v11
EX 17
v_mov_b32 v11, v10
EX 18
EX 19
v_permlane16_swap_b32 v10, v11
v_min_f32_e64 v52, -v10, -v11
v_add_f32 v10, v52, v12
v_bfi_b32 v52, v53, s70, v52
v_add_f32 v24, v10, v24
v_add_f32 v25, v10, v25
EX 24
EX 25
v_mov_b32 v53, v52
CV 36,24,25
QK 24,32,144,44
RV 104,64,256
RV 106,64,4352
QK 24,36,148,24
s_mov_b32 s40, 0x60d000
RV 108,65,256
v_mov_b32 v54, v52
QK 24,40,152,24
s_add_u32 m0, s47, 0xe000
RV 110,65,4352
RV 112,64,512
QK 24,44,156,24
RV 114,64,4608
v_mov_b32 v55, v52
v_smfmac_f32_16x16x64_bf16 a[244:247], v[56:59], v[32:39], v71
CV 32,16,17
QK 28,48,144,44
buffer_load_dwordx4 v66, s[16:19], s40 offen lds
QK 28,52,148,28
RV 116,65,512
CV 33,18,19
QK 28,56,152,28
RV 118,65,4608
RV 120,64,768
QK 28,60,156,28
RV 122,64,4864
v_subrev_u32 v12, 0x30000, v71
PZ 224,64,36
RV 124,65,768
RV 126,65,4864
PZ 228,68,36
EX 20
PZ 232,72,36
buffer_load_dwordx4 v67, s[16:19], s40 offen offset:1024 lds
PZ 236,76,36
L_t8_pad1:
s_cbranch_execz L_t8_pad5
EX 21
PZ 240,80,36
EX 22
PZ 244,84,36
EX 23
PZ 248,88,36
CV 34,20,21
CV 35,22,23
PZ 252,92,36
EX 24
QK 16,32,160,48
s_add_u32 m0, s47, 0x1e000
EX 25
QK 16,36,164,16
EX 26
QK 16,40,168,16
buffer_load_dwordx4 v68, s[20:23], s40 offen lds
QK 16,44,172,16
EX 27
QK 20,48,160,48
CV 36,24,25
CV 37,26,27
QK 20,52,164,20
EX 28
QK 20,56,168,20
s_waitcnt lgkmcnt(0)
EX 29
QK 20,60,172,20
EX 30
PV 128,96,32
EX 31
PV 132,100,32
buffer_load_dwordx4 v69, s[20:23], s40 offen offset:1024 lds
PV 136,104,32
CV 38,28,29
CV 39,30,31
PV 140,108,32
EX 16
PV 144,112,32
EX 17
PV 148,116,32
s_mov_b32 s40, 0x62d000
EX 18
PV 152,120,32
s_add_u32 m0, s47, 0x8000
EX 19
PV 156,124,32
v_subrev_u32 v13, 0x20000, v71
v_ashrrev_i32 v12, 31, v12
QK 24,32,176,52
buffer_load_dwordx4 v66, s[16:19], s40 offen lds
QK 24,36,180,24
EX 20
QK 24,40,184,24
EX 21
QK 24,44,188,24
v_ashrrev_i32 v13, 31, v13
v_not_b32 v12, v12
v_smfmac_f32_16x16x64_bf16 a[240:243], v[56:59], v[32:39], v71
s_waitcnt vmcnt(11)
s_barrier
QK 28,48,176,52
RK 0,60,8192
RK 4,61,8192
QK 28,52,180,28
RK 8,62,8192
CV 32,16,17
QK 28,56,184,28
buffer_load_dwordx4 v67, s[16:19], s40 offen offset:1024 lds
QK 28,60,188,28
RK 12,63,8192
RK 16,60,12288
PV 160,96,36
RK 20,61,12288
CV 33,18,19
PV 164,100,36
RK 24,62,12288
CV 34,20,21
PV 168,104,36
RK 28,63,12288
v_xor_b32 v60, s43, v60
PV 172,108,36
EX 22
PV 176,112,36
s_add_u32 m0, s47, 0x18000
EX 23
PV 180,116,36
CV 35,22,23
v_xor_b32 v61, s43, v61
PV 184,120,36
buffer_load_dwordx4 v68, s[20:23], s40 offen lds
PV 188,124,36
s_waitcnt lgkmcnt(7)
EX 24
QK 16,0,128,40
s_waitcnt lgkmcnt(0)
EX 25
QK 16,4,132,16
EX 26
QK 16,8,136,16
EX 27
QK 16,12,140,16
CV 36,24,25
CV 37,26,27
QK 20,16,128,40
EX 28
QK 20,20,132,20
buffer_load_dwordx4 v69, s[20:23], s40 offen offset:1024 lds
QK 20,24,136,20
EX 29
QK 20,28,140,20
EX 30
PV 192,96,32
EX 31
PV 196,100,32
CV 38,28,29
CV 39,30,31
PV 200,104,32
s_waitcnt vmcnt(12)
s_barrier
PV 204,108,32
RV 64,64,8192
RV 66,64,12288
PV 208,112,32
RV 68,65,8192
v_xor_b32 v62, s43, v62
PV 212,116,32
RV 70,65,12288
RV 72,64,8448
PV 216,120,32
s_xor_b32 s41, s41, s43
RV 74,64,12544
v_xor_b32 v63, s43, v63
PV 220,124,32
s_mov_b32 s40, 0x64d000
RV 76,65,8448
RV 78,65,12544
QK 24,0,144,44
s_add_u32 m0, s47, 0xa000
RV 80,64,8704
v_not_b32 v13, v13
QK 24,4,148,24
s_xor_b32 s42, s41, 0xc000
RV 82,64,12800
RV 84,65,8704
QK 24,8,152,24
RV 86,65,12800
v_and_b32 v12, 0xff800000, v12
QK 24,12,156,24
RV 88,64,8960
RV 90,64,13056
v_smfmac_f32_16x16x64_bf16 a[244:247], v[56:59], v[32:39], v71
RV 92,65,8960
QK 28,16,144,44
RV 94,65,13056
v_xor_b32 v64, s43, v64
QK 28,20,148,28
buffer_load_dwordx4 v66, s[16:19], s40 offen lds
QK 28,24,152,28
EX 16
QK 28,28,156,28
EX 17
PV 224,96,36
EX 18
PV 228,100,36
buffer_load_dwordx4 v67, s[16:19], s40 offen offset:1024 lds
PV 232,104,36
EX 19
PV 236,108,36
s_waitcnt vmcnt(10) lgkmcnt(0)
s_barrier
PV 240,112,36
RK 32,60,0
RK 36,61,0
PV 244,116,36
RK 40,62,0
CV 32,16,17
PV 248,120,36
RK 44,63,0
CV 33,18,19
PV 252,124,36
s_add_u32 m0, s47, 0x1a000
RK 48,60,4096
v_xor_b32 v65, s43, v65
QK 16,0,160,48
s_xor_b32 s43, s43, 0xc000
RK 52,61,4096
v_and_b32 v13, 0xff800000, v13
QK 16,4,164,16
EX 20
QK 16,8,168,16
RK 56,62,4096
RK 60,63,4096
QK 16,12,172,16
buffer_load_dwordx4 v68, s[20:23], s40 offen lds
RV 96,64,0
EX 21
EX 22
EX 23
CV 34,20,21
CV 35,22,23
QK 20,16,160,48
RV 98,64,4096
RV 100,65,0
QK 20,20,164,20
EX 24
QK 20,24,168,20
EX 25
QK 20,28,172,20
RV 102,65,4096
CV 36,24,25
PV 128,64,32
EX 26
PV 132,68,32
buffer_load_dwordx4 v69, s[20:23], s40 offen offset:1024 lds
PV 136,72,32
EX 27
PV 140,76,32
RV 104,64,256
RV 106,64,4352
PV 144,80,32
EX 28
PV 148,84,32
RV 108,65,256
CV 37,26,27
PV 152,88,32
EX 29
PV 156,92,32
EX 30
QK 24,0,176,52
EX 31
QK 24,4,180,24
RV 110,65,4352
CV 38,28,29
QK 24,8,184,24
RV 112,64,512
CV 39,30,31
QK 24,12,188,24
EX 16
v_smfmac_f32_16x16x64_bf16 a[240:243], v[56:59], v[32:39], v71
RV 114,64,4608
QK 28,16,176,52
EX 17
QK 28,20,180,28
EX 18
QK 28,24,184,28
RV 116,65,512
CV 32,16,17
QK 28,28,188,28
EX 19
PV 160,64,36
RV 118,65,4608
CV 33,18,19
PV 164,68,36
EX 20
PV 168,72,36
EX 21
PV 172,76,36
RV 120,64,768
CV 34,20,21
PV 176,80,36
EX 22
PV 180,84,36
EX 23
PV 184,88,36
RV 122,64,4864
CV 35,22,23
PV 188,92,36
s_waitcnt lgkmcnt(14)
EX 24
QK 16,32,128,40
EX 25
QK 16,36,132,16
RV 124,65,768
RV 126,65,4864
QK 16,40,136,16
EX 26
QK 16,44,140,16
EX 27
QK 20,48,128,40
CV 36,24,25
CV 37,26,27
QK 20,52,132,20
EX 28
QK 20,56,136,20
EX 29
QK 20,60,140,20
EX 30
PV 192,64,32
EX 31
PV 196,68,32
CV 38,28,29
CV 39,30,31
PV 200,72,32
EX 16
PV 204,76,32
EX 17
PV 208,80,32
s_waitcnt vmcnt(8) lgkmcnt(0)
s_barrier
PV 212,84,32
EX 18
PV 216,88,32
EX 19
PV 220,92,32
RK 0,60,8192
QK 24,32,144,44
EX 20
QK 24,36,148,24
s_mov_b32 s40, 0x66d000
RK 4,61,8192
QK 24,40,152,24
s_add_u32 m0, s47, 0x0
EX 21
QK 24,44,156,24
RK 8,62,8192
v_smfmac_f32_16x16x64_bf16 a[244:247], v[56:59], v[32:39], v71
CV 32,16,17
QK 28,48,144,44
buffer_load_dwordx4 v66, s[16:19], s40 offen lds
QK 28,52,148,28
RK 12,63,8192
CV 33,18,19
QK 28,56,152,28
RK 16,60,12288
CV 34,20,21
QK 28,60,156,28
EX 22
PV 224,64,36
RK 20,61,12288
v_xor_b32 v60, s43, v60
PV 228,68,36
EX 23
PV 232,72,36
buffer_load_dwordx4 v67, s[16:19], s40 offen offset:1024 lds
PV 236,76,36
RK 24,62,12288
CV 35,22,23
PV 240,80,36
EX 24
PV 244,84,36
RK 28,63,12288
v_xor_b32 v61, s43, v61
PV 248,88,36
EX 25
PV 252,92,36
RV 64,64,8192
CV 36,24,25
QK 16,32,160,48
s_add_u32 m0, s47, 0x10000
EX 26
QK 16,36,164,16
EX 27
QK 16,40,168,16
buffer_load_dwordx4 v68, s[20:23], s40 offen lds
QK 16,44,172,16
RV 66,64,12288
CV 37,26,27
QK 20,48,160,48
RV 68,65,8192
v_xor_b32 v62, s43, v62
QK 20,52,164,20
EX 28
QK 20,56,168,20
RV 70,65,12288
v_xor_b32 v63, s43, v63
QK 20,60,172,20
EX 29
PV 128,96,32
EX 30
PV 132,100,32
buffer_load_dwordx4 v69, s[20:23], s40 offen offset:1024 lds
PV 136,104,32
RV 72,64,8448
CV 38,28,29
PV 140,108,32
EX 31
PV 144,112,32
RV 74,64,12544
CV 39,30,31
PV 148,116,32
s_mov_b32 s40, 0x68d000
EX 16
PV 152,120,32
s_add_u32 m0, s47, 0x2000
EX 17
PV 156,124,32
EX 18
QK 24,32,176,52
RV 76,65,8448
RV 78,65,12544
QK 24,36,180,24
buffer_load_dwordx4 v66, s[16:19], s40 offen lds
QK 24,40,184,24
EX 19
QK 24,44,188,24
EX 20
v_smfmac_f32_16x16x64_bf16 a[240:243], v[56:59], v[32:39], v71
RV 80,64,8704
QK 28,48,176,52
RV 82,64,12800
CV 32,16,17
QK 28,52,180,28
EX 21
QK 28,56,184,28
buffer_load_dwordx4 v67, s[16:19], s40 offen offset:1024 lds
QK 28,60,188,28
RV 84,65,8704
CV 33,18,19
PV 160,96,36
RV 86,65,12800
CV 34,20,21
PV 164,100,36
EX 22
PV 168,104,36
EX 23
PV 172,108,36
RV 88,64,8960
CV 35,22,23
PV 176,112,36
s_add_u32 m0, s47, 0x12000
EX 24
PV 180,116,36
EX 25
PV 184,120,36
buffer_load_dwordx4 v68, s[20:23], s40 offen lds
PV 188,124,36
s_waitcnt lgkmcnt(13)
RV 90,64,13056
RV 92,65,8960
QK 16,0,128,40
EX 26
QK 16,4,132,16
RV 94,65,13056
CV 36,24,25
QK 16,8,136,16
EX 27
QK 16,12,140,16
EX 28
QK 20,16,128,40
EX 29
QK 20,20,132,20
buffer_load_dwordx4 v69, s[20:23], s40 offen offset:1024 lds
QK 20,24,136,20
EX 30
QK 20,28,140,20
EX 31
PV 192,96,32
EX 16
PV 196,100,32
CV 37,26,27
CV 38,28,29
PV 200,104,32
EX 17
PV 204,108,32
CV 39,30,31
v_xor_b32 v64, s43, v64
PV 208,112,32
s_waitcnt vmcnt(8) lgkmcnt(0)
s_barrier
PV 212,116,32
v_xor_b32 v65, s43, v65
s_mov_b32 s56, 2
L_t8_loop0:
PV 216,120,32
s_xor_b32 s41, s41, s43
EX 18
PV 220,124,32
s_xor_b32 s42, s41, 0xc000
RK 32,60,0
QK 24,0,144,44
s_add_u32 s40, s40, s58
EX 19
QK 24,4,148,24
s_add_u32 m0, s42, 0x0
RK 36,61,0
QK 24,8,152,24
buffer_load_dwordx4 v66, s[16:19], s40 offen lds
QK 24,12,156,24
s_mov_b32 s58, s59
RK 40,62,0
v_smfmac_f32_16x16x64_bf16 a[244:247], v[56:59], v[32:39], v71
s_mov_b32 s59, 0x20000
s_xor_b32 s43, s43, 0xc000
CV 32,16,17
QK 28,16,144,44
RK 44,63,0
CV 33,18,19
QK 28,20,148,28
EX 20
QK 28,24,152,28
EX 21
QK 28,28,156,28
RK 48,60,4096
CV 34,20,21
PV 224,96,36
EX 22
PV 228,100,36
buffer_load_dwordx4 v67, s[16:19], s40 offen offset:1024 lds
PV 232,104,36
RK 52,61,4096
PV 236,108,36
EX 23
PV 240,112,36
RK 56,62,4096
CV 35,22,23
PV 244,116,36
s_add_u32 m0, s42, 0x10000
EX 24
PV 248,120,36
RK 60,63,4096
PV 252,124,36
EX 25
QK 16,0,160,48
RV 96,64,0
CV 36,24,25
QK 16,4,164,16
buffer_load_dwordx4 v68, s[20:23], s40 offen lds
QK 16,8,168,16
EX 26
QK 16,12,172,16
RV 98,64,4096
QK 20,16,160,48
EX 27
QK 20,20,164,20
RV 100,65,0
CV 37,26,27
QK 20,24,168,20
EX 28
QK 20,28,172,20
RV 102,65,4096
PV 128,64,32
EX 29
PV 132,68,32
buffer_load_dwordx4 v69, s[20:23], s40 offen offset:1024 lds
PV 136,72,32
RV 104,64,256
CV 38,28,29
PV 140,76,32
EX 30
PV 144,80,32
RV 106,64,4352
PV 148,84,32
EX 31
PV 152,88,32
RV 108,65,256
CV 39,30,31
PV 156,92,32
EX 16
QK 24,0,176,52
EX 17
QK 24,4,180,24
RV 110,65,4352
QK 24,8,184,24
EX 18
QK 24,12,188,24
RV 112,64,512
v_smfmac_f32_16x16x64_bf16 a[240:243], v[56:59], v[32:39], v71
s_sub_u32 s57, s57, 1
s_cselect_b64 s[58:59], s[60:61], s[58:59]
RV 114,64,4608
QK 28,16,176,52
EX 19
QK 28,20,180,28
CV 32,16,17
CV 33,18,19
QK 28,24,184,28
EX 20
QK 28,28,188,28
RV 116,65,512
PV 160,64,36
EX 21
PV 164,68,36
RV 118,65,4608
CV 34,20,21
PV 168,72,36
EX 22
PV 172,76,36
RV 120,64,768
PV 176,80,36
EX 23
PV 180,84,36
RV 122,64,4864
CV 35,22,23
PV 184,88,36
EX 24
PV 188,92,36
s_waitcnt lgkmcnt(14)
EX 25
QK 16,32,128,40
RV 124,65,768
CV 36,24,25
QK 16,36,132,16
L_t8_pad2:
s_cbranch_execz L_t8_pad6
EX 26
QK 16,40,136,16
RV 126,65,4864
QK 16,44,140,16
EX 27
QK 20,48,128,40
EX 28
QK 20,52,132,20
EX 29
QK 20,56,136,20
CV 37,26,27
CV 38,28,29
QK 20,60,140,20
EX 30
PV 192,64,32
EX 31
PV 196,68,32
EX 16
PV 200,72,32
EX 17
PV 204,76,32
CV 39,30,31
PV 208,80,32
s_waitcnt lgkmcnt(0)
EX 18
PV 212,84,32
s_add_u32 s40, s40, s58
PV 216,88,32
s_add_u32 m0, s42, 0x2000
EX 19
PV 220,92,32
s_mov_b32 s58, s59
RK 0,60,8192
QK 24,32,144,44
s_mov_b32 s59, 0x20000
EX 20
QK 24,36,148,24
RK 4,61,8192
QK 24,40,152,24
buffer_load_dwordx4 v66, s[16:19], s40 offen lds
QK 24,44,156,24
RK 8,62,8192
v_smfmac_f32_16x16x64_bf16 a[244:247], v[56:59], v[32:39], v71
s_sub_u32 s57, s57, 1
s_cselect_b64 s[58:59], s[60:61], s[58:59]
CV 32,16,17
QK 28,48,144,44
RK 12,63,8192
CV 33,18,19
QK 28,52,148,28
EX 21
QK 28,56,152,28
RK 16,60,12288
CV 34,20,21
QK 28,60,156,28
EX 22
PV 224,64,36
RK 20,61,12288
v_xor_b32 v60, s43, v60
PV 228,68,36
buffer_load_dwordx4 v67, s[16:19], s40 offen offset:1024 lds
PV 232,72,36
EX 23
PV 236,76,36
RK 24,62,12288
CV 35,22,23
PV 240,80,36
EX 24
PV 244,84,36
s_add_u32 m0, s42, 0x12000
RK 28,63,12288
v_xor_b32 v61, s43, v61
PV 248,88,36
EX 25
PV 252,92,36
RV 64,64,8192
CV 36,24,25
QK 16,32,160,48
EX 26
QK 16,36,164,16
buffer_load_dwordx4 v68, s[20:23], s40 offen lds
QK 16,40,168,16
RV 66,64,12288
v_xor_b32 v62, s43, v62
QK 16,44,172,16
EX 27
QK 20,48,160,48
RV 68,65,8192
CV 37,26,27
QK 20,52,164,20
EX 28
QK 20,56,168,20
RV 70,65,12288
v_xor_b32 v63, s43, v63
QK 20,60,172,20
EX 29
PV 128,96,32
EX 30
PV 132,100,32
buffer_load_dwordx4 v69, s[20:23], s40 offen offset:1024 lds
PV 136,104,32
RV 72,64,8448
CV 38,28,29
PV 140,108,32
EX 31
PV 144,112,32
RV 74,64,12544
CV 39,30,31
PV 148,116,32
EX 16
PV 152,120,32
RV 76,65,8448
PV 156,124,32
EX 17
QK 24,32,176,52
EX 18
QK 24,36,180,24
RV 78,65,12544
QK 24,40,184,24
EX 19
QK 24,44,188,24
RV 80,64,8704
v_smfmac_f32_16x16x64_bf16 a[240:243], v[56:59], v[32:39], v71
RV 82,64,12800
QK 28,48,176,52
CV 32,16,17
CV 33,18,19
QK 28,52,180,28
EX 20
QK 28,56,184,28
EX 21
QK 28,60,188,28
RV 84,65,8704
CV 34,20,21
PV 160,96,36
EX 22
PV 164,100,36
RV 86,65,12800
PV 168,104,36
EX 23
PV 172,108,36
RV 88,64,8960
CV 35,22,23
PV 176,112,36
EX 24
PV 180,116,36
EX 25
PV 184,120,36
RV 90,64,13056
v_xor_b32 v64, s43, v64
PV 188,124,36
s_waitcnt lgkmcnt(14)
RV 92,65,8960
CV 36,24,25
QK 16,0,128,40
EX 26
QK 16,4,132,16
EX 27
QK 16,8,136,16
RV 94,65,13056
CV 37,26,27
QK 16,12,140,16
EX 28
QK 20,16,128,40
EX 29
QK 20,20,132,20
EX 30
QK 20,24,136,20
EX 31
QK 20,28,140,20
CV 38,28,29
CV 39,30,31
PV 192,96,32
EX 16
PV 196,100,32
v_xor_b32 v65, s43, v65
PV 200,104,32
EX 17
PV 204,108,32
PV 208,112,32
s_waitcnt vmcnt(8) lgkmcnt(0)
s_barrier
PV 212,116,32
s_sub_u32 s56, s56, 1
s_cbranch_scc0 L_t8_loop0
PV 216,120,32
s_xor_b32 s41, s41, s43
EX 18
PV 220,124,32
s_xor_b32 s42, s41, 0xc000
EX 19
QK 24,0,144,44
s_add_u32 s40, s40, s58
RK 32,60,0
RK 36,61,0
QK 24,4,148,24
s_add_u32 m0, s42, 0x0
EX 20
QK 24,8,152,24
buffer_load_dwordx4 v66, s[16:19], s40 offen lds
QK 24,12,156,24
s_add_u32 s49, s45, 0x0
EX 21
v_smfmac_f32_16x16x64_bf16 a[244:247], v[56:59], v[32:39], v71
s_mov_b32 s58, s59
s_mov_b32 s59, 0x20000
RK 40,62,0
QK 28,16,144,44
buffer_load_dwordx4 v[80:83], v72, s[32:35], s49 offen nt
QK 28,20,148,28
s_xor_b32 s43, s43, 0xc000
RK 44,63,0
CV 32,16,17
QK 28,24,152,28
RK 48,60,4096
CV 33,18,19
QK 28,28,156,28
EX 22
PV 224,96,36
RK 52,61,4096
CV 34,20,21
PV 228,100,36
buffer_load_dwordx4 v67, s[16:19], s40 offen offset:1024 lds
PV 232,104,36
EX 23
PV 236,108,36
RK 56,62,4096
CV 35,22,23
PV 240,112,36
EX 24
PV 244,116,36
s_add_u32 m0, s42, 0x10000
EX 25
PV 248,120,36
EX 26
PV 252,124,36
RK 60,63,4096
RV 96,64,0
QK 16,0,160,48
EX 27
QK 16,4,164,16
buffer_load_dwordx4 v68, s[20:23], s40 offen lds
QK 16,8,168,16
RV 98,64,4096
CV 36,24,25
QK 16,12,172,16
EX 28
QK 20,16,160,48
RV 100,65,0
CV 37,26,27
QK 20,20,164,20
EX 29
QK 20,24,168,20
RV 102,65,4096
CV 38,28,29
QK 20,28,172,20
EX 30
PV 128,64,32
EX 31
PV 132,68,32
buffer_load_dwordx4 v69, s[20:23], s40 offen offset:1024 lds
PV 136,72,32
RV 104,64,256
CV 39,30,31
PV 140,76,32
EX 16
PV 144,80,32
EX 17
PV 148,84,32
buffer_load_dwordx4 v[84:87], v73, s[32:35], s49 offen nt
PV 152,88,32
RV 106,64,4352
RV 108,65,256
PV 156,92,32
EX 18
QK 24,0,176,52
EX 19
QK 24,4,180,24
EX 20
QK 24,8,184,24
RV 110,65,4352
RV 112,64,512
QK 24,12,188,24
EX 21
v_smfmac_f32_16x16x64_bf16 a[240:243], v[56:59], v[32:39], v71
s_sub_u32 s57, s57, 1
s_cselect_b64 s[58:59], s[60:61], s[58:59]
RV 114,64,4608
QK 28,16,176,52
CV 32,16,17
CV 33,18,19
QK 28,20,180,28
EX 22
QK 28,24,184,28
RV 116,65,512
CV 34,20,21
QK 28,28,188,28
EX 23
PV 160,64,36
RV 118,65,4608
CV 35,22,23
PV 164,68,36
EX 24
PV 168,72,36
EX 25
PV 172,76,36
RV 120,64,768
PV 176,80,36
EX 26
PV 180,84,36
RV 122,64,4864
PV 184,88,36
EX 27
PV 188,92,36
s_waitcnt lgkmcnt(14)
RV 124,65,768
CV 36,24,25
QK 16,32,128,40
EX 28
QK 16,36,132,16
RV 126,65,4864
CV 37,26,27
QK 16,40,136,16
buffer_load_dwordx4 v[88:91], v74, s[32:35], s49 offen nt
QK 16,44,140,16
EX 29
QK 20,48,128,40
EX 30
QK 20,52,132,20
CV 38,28,29
QK 20,56,136,20
EX 31
QK 20,60,140,20
CV 39,30,31
PV 192,64,32
EX 16
PV 196,68,32
PV 200,72,32
EX 17
PV 204,76,32
PV 208,80,32
s_waitcnt lgkmcnt(0)
EX 18
PV 212,84,32
s_add_u32 s40, s40, s58
PV 216,88,32
s_add_u32 m0, s42, 0x2000
EX 19
PV 220,92,32
s_mov_b32 s58, s59
RK 0,60,8192
QK 24,32,144,44
s_mov_b32 s59, 0x20000
EX 20
QK 24,36,148,24
RK 4,61,8192
QK 24,40,152,24
buffer_load_dwordx4 v66, s[16:19], s40 offen lds
QK 24,44,156,24
EX 21
v_smfmac_f32_16x16x64_bf16 a[244:247], v[56:59], v[32:39], v71
s_sub_u32 s57, s57, 1
s_cselect_b64 s[58:59], s[60:61], s[58:59]
RK 8,62,8192
QK 28,48,144,44
RK 12,63,8192
CV 32,16,17
QK 28,52,148,28
CV 33,18,19
CV 34,20,21
QK 28,56,152,28
EX 22
QK 28,60,156,28
EX 23
PV 224,64,36
RK 16,60,12288
RK 20,61,12288
PV 228,68,36
buffer_load_dwordx4 v67, s[16:19], s40 offen offset:1024 lds
PV 232,72,36
CV 35,22,23
v_xor_b32 v60, s43, v60
PV 236,76,36
RK 24,62,12288
v_xor_b32 v61, s43, v61
PV 240,80,36
EX 24
PV 244,84,36
buffer_load_dwordx4 v[92:95], v75, s[32:35], s49 offen nt
PV 248,88,36
s_add_u32 m0, s42, 0x12000
RK 28,63,12288
v_xor_b32 v62, s43, v62
PV 252,92,36
RV 64,64,8192
v_xor_b32 v63, s43, v63
QK 16,32,160,48
EX 25
QK 16,36,164,16
buffer_load_dwordx4 v68, s[20:23], s40 offen lds
QK 16,40,168,16
RV 66,64,12288
CV 36,24,25
QK 16,44,172,16
EX 26
QK 20,48,160,48
EX 27
QK 20,52,164,20
RV 68,65,8192
CV 37,26,27
QK 20,56,168,20
EX 28
QK 20,60,172,20
EX 29
PV 128,96,32
RV 70,65,12288
CV 38,28,29
PV 132,100,32
buffer_load_dwordx4 v69, s[20:23], s40 offen offset:1024 lds
PV 136,104,32
EX 30
PV 140,108,32
RV 72,64,8448
RV 74,64,12544
PV 144,112,32
EX 31
PV 148,116,32
RV 76,65,8448
CV 39,30,31
PV 152,120,32
EX 16
PV 156,124,32
EX 17
QK 24,32,176,52
EX 18
QK 24,36,180,24
s_add_u32 s50, s45, 0x10000
EX 19
QK 24,40,184,24
RV 78,65,12544
RV 80,64,8704
QK 24,44,188,24
buffer_load_dwordx4 v[96:99], v72, s[32:35], s50 offen nt
v_smfmac_f32_16x16x64_bf16 a[240:243], v[56:59], v[32:39], v71
RV 82,64,12800
QK 28,48,176,52
CV 32,16,17
CV 33,18,19
QK 28,52,180,28
EX 20
QK 28,56,184,28
EX 21
QK 28,60,188,28
RV 84,65,8704
CV 34,20,21
PV 160,96,36
EX 22
PV 164,100,36
EX 23
PV 168,104,36
RV 86,65,12800
RV 88,64,8960
PV 172,108,36
EX 24
PV 176,112,36
EX 25
PV 180,116,36
RV 90,64,13056
CV 35,22,23
PV 184,120,36
EX 26
PV 188,124,36
s_waitcnt lgkmcnt(14)
RV 92,65,8960
CV 36,24,25
QK 16,0,128,40
EX 27
QK 16,4,132,16
RV 94,65,13056
CV 37,26,27
QK 16,8,136,16
EX 28
QK 16,12,140,16
EX 29
QK 20,16,128,40
EX 30
QK 20,20,132,20
CV 38,28,29
v_xor_b32 v64, s43, v64
QK 20,24,136,20
EX 31
QK 20,28,140,20
CV 39,30,31
v_xor_b32 v65, s43, v65
PV 192,96,32
EX 16
PV 196,100,32
PV 200,104,32
buffer_load_dwordx4 v[100:103], v73, s[32:35], s50 offen nt
PV 204,108,32
EX 17
PV 208,112,32
s_waitcnt vmcnt(14) lgkmcnt(0)
s_barrier
PV 212,116,32
s_add_u32 s40, s40, s58
EX 18
PV 216,120,32
s_xor_b32 s41, s41, s43
EX 19
PV 220,124,32
s_xor_b32 s42, s41, 0xc000
RK 32,60,0
QK 24,0,144,44
s_add_u32 m0, s42, 0x0
EX 20
QK 24,4,148,24
s_mov_b32 s58, s59
RK 36,61,0
QK 24,8,152,24
buffer_load_dwordx4 v66, s[16:19], s40 offen lds
QK 24,12,156,24
s_mov_b32 s59, 0x20000
EX 21
v_smfmac_f32_16x16x64_bf16 a[244:247], v[56:59], v[32:39], v71
s_sub_u32 s57, s57, 1
s_cselect_b64 s[58:59], s[60:61], s[58:59]
RK 40,62,0
QK 28,16,144,44
s_xor_b32 s43, s43, 0xc000
RK 44,63,0
CV 32,16,17
QK 28,20,148,28
CV 33,18,19
CV 34,20,21
QK 28,24,152,28
EX 22
QK 28,28,156,28
EX 23
PV 224,96,36
RK 48,60,4096
RK 52,61,4096
PV 228,100,36
buffer_load_dwordx4 v67, s[16:19], s40 offen offset:1024 lds
PV 232,104,36
EX 24
PV 236,108,36
RK 56,62,4096
CV 35,22,23
PV 240,112,36
EX 25
PV 244,116,36
s_add_u32 m0, s42, 0x10000
EX 26
PV 248,120,36
EX 27
PV 252,124,36
RK 60,63,4096
RV 96,64,0
QK 16,0,160,48
CV 36,24,25
CV 37,26,27
QK 16,4,164,16
buffer_load_dwordx4 v68, s[20:23], s40 offen lds
QK 16,8,168,16
EX 28
QK 16,12,172,16
EX 29
QK 20,16,160,48
RV 98,64,4096
RV 100,65,0
QK 20,20,164,20
buffer_load_dwordx4 v[104:107], v74, s[32:35], s50 offen nt
QK 20,24,168,20
RV 102,65,4096
CV 38,28,29
QK 20,28,172,20
EX 30
PV 128,64,32
EX 31
PV 132,68,32
buffer_load_dwordx4 v69, s[20:23], s40 offen offset:1024 lds
PV 136,72,32
RV 104,64,256
CV 39,30,31
PV 140,76,32
EX 16
PV 144,80,32
EX 17
PV 148,84,32
RV 106,64,4352
RV 108,65,256
PV 152,88,32
L_t8_pad3:
s_cbranch_execz L_t8_go
EX 18
PV 156,92,32
EX 19
QK 24,0,176,52
EX 20
QK 24,4,180,24
RV 110,65,4352
QK 24,8,184,24
EX 21
QK 24,12,188,24
RV 112,64,512
v_smfmac_f32_16x16x64_bf16 a[240:243], v[56:59], v[32:39], v71
RV 114,64,4608
QK 28,16,176,52
CV 32,16,17
CV 33,18,19
QK 28,20,180,28
EX 22
QK 28,24,184,28
RV 116,65,512
CV 34,20,21
QK 28,28,188,28
EX 23
PV 160,64,36
RV 118,65,4608
CV 35,22,23
PV 164,68,36
EX 24
PV 168,72,36
buffer_load_dwordx4 v[108:111], v75, s[32:35], s50 offen nt
PV 172,76,36
EX 25
PV 176,80,36
EX 26
PV 180,84,36
RV 120,64,768
RV 122,64,4864
PV 184,88,36
EX 27
PV 188,92,36
s_waitcnt lgkmcnt(14)
RV 124,65,768
CV 36,24,25
QK 16,32,128,40
EX 28
QK 16,36,132,16
RV 126,65,4864
CV 37,26,27
QK 16,40,136,16
EX 29
QK 16,44,140,16
CV 38,28,29
QK 20,48,128,40
EX 30
QK 20,52,132,20
QK 20,56,136,20
EX 31
QK 20,60,140,20
CV 39,30,31
PV 192,64,32
EX 16
PV 196,68,32
PV 200,72,32
EX 17
PV 204,76,32
PV 208,80,32
s_waitcnt lgkmcnt(0)
EX 18
PV 212,84,32
s_add_u32 s40, s40, s58
PV 216,88,32
s_add_u32 m0, s42, 0x2000
EX 19
PV 220,92,32
s_mov_b32 s58, s59
RK 0,60,8192
QK 24,32,144,44
s_mov_b32 s59, 0x20000
EX 20
QK 24,36,148,24
s_add_u32 s51, s45, 0x20000
RK 4,61,8192
QK 24,40,152,24
buffer_load_dwordx4 v66, s[16:19], s40 offen lds
QK 24,44,156,24
EX 21
v_smfmac_f32_16x16x64_bf16 a[244:247], v[56:59], v[32:39], v71
s_sub_u32 s57, s57, 1
s_cselect_b64 s[58:59], s[60:61], s[58:59]
RK 8,62,8192
QK 28,48,144,44
RK 12,63,8192
CV 32,16,17
QK 28,52,148,28
buffer_load_dwordx4 v[112:115], v72, s[32:35], s51 offen nt
QK 28,56,152,28
RK 16,60,12288
CV 33,18,19
QK 28,60,156,28
EX 22
PV 224,64,36
RK 20,61,12288
CV 34,20,21
PV 228,68,36
buffer_load_dwordx4 v67, s[16:19], s40 offen offset:1024 lds
PV 232,72,36
EX 23
PV 236,76,36
RK 24,62,12288
CV 35,22,23
PV 240,80,36
EX 24
PV 244,84,36
s_add_u32 m0, s42, 0x12000
RK 28,63,12288
v_xor_b32 v60, s43, v60
PV 248,88,36
EX 25
PV 252,92,36
RV 64,64,8192
CV 36,24,25
QK 16,32,160,48
EX 26
QK 16,36,164,16
buffer_load_dwordx4 v68, s[20:23], s40 offen lds
QK 16,40,168,16
RV 66,64,12288
v_xor_b32 v61, s43, v61
QK 16,44,172,16
EX 27
QK 20,48,160,48
RV 68,65,8192
CV 37,26,27
QK 20,52,164,20
EX 28
QK 20,56,168,20
RV 70,65,12288
v_xor_b32 v62, s43, v62
QK 20,60,172,20
EX 29
PV 128,96,32
EX 30
PV 132,100,32
buffer_load_dwordx4 v69, s[20:23], s40 offen offset:1024 lds
PV 136,104,32
RV 72,64,8448
CV 38,28,29
PV 140,108,32
RV 74,64,12544
v_xor_b32 v63, s43, v63
PV 144,112,32
EX 31
PV 148,116,32
buffer_load_dwordx4 v[116:119], v73, s[32:35], s51 offen nt
PV 152,120,32
RV 76,65,8448
CV 39,30,31
PV 156,124,32
EX 16
QK 24,32,176,52
EX 17
QK 24,36,180,24
EX 18
QK 24,40,184,24
RV 78,65,12544
RV 80,64,8704
QK 24,44,188,24
EX 19
v_smfmac_f32_16x16x64_bf16 a[240:243], v[56:59], v[32:39], v71
RV 82,64,12800
QK 28,48,176,52
CV 32,16,17
CV 33,18,19
QK 28,52,180,28
EX 20
QK 28,56,184,28
EX 21
QK 28,60,188,28
RV 84,65,8704
CV 34,20,21
PV 160,96,36
EX 22
PV 164,100,36
EX 23
PV 168,104,36
RV 86,65,12800
RV 88,64,8960
PV 172,108,36
EX 24
PV 176,112,36
EX 25
PV 180,116,36
RV 90,64,13056
CV 35,22,23
PV 184,120,36
EX 26
PV 188,124,36
s_waitcnt lgkmcnt(14)
RV 92,65,8960
CV 36,24,25
QK 16,0,128,40
EX 27
QK 16,4,132,16
RV 94,65,13056
CV 37,26,27
QK 16,8,136,16
buffer_load_dwordx4 v[120:123], v74, s[32:35], s51 offen nt
QK 16,12,140,16
EX 28
QK 20,16,128,40
EX 29
QK 20,20,132,20
EX 30
QK 20,24,136,20
EX 31
QK 20,28,140,20
CV 38,28,29
CV 39,30,31
PV 192,96,32
EX 16
PV 196,100,32
v_xor_b32 v64, s43, v64
v_xor_b32 v65, s43, v65
PV 200,104,32
EX 17
PV 204,108,32
PV 208,112,32
s_waitcnt vmcnt(15) lgkmcnt(0)
s_barrier
PV 212,116,32
s_add_u32 s40, s40, s58
EX 18
PV 216,120,32
s_xor_b32 s41, s41, s43
EX 19
PV 220,124,32
s_xor_b32 s42, s41, 0xc000
RK 32,60,0
QK 24,0,144,44
s_add_u32 m0, s42, 0x0
EX 20
QK 24,4,148,24
s_mov_b32 s58, s59
RK 36,61,0
QK 24,8,152,24
buffer_load_dwordx4 v66, s[16:19], s40 offen lds
QK 24,12,156,24
s_mov_b32 s59, 0x20000
EX 21
v_smfmac_f32_16x16x64_bf16 a[244:247], v[56:59], v[32:39], v71
s_sub_u32 s57, s57, 1
s_cselect_b64 s[58:59], s[60:61], s[58:59]
RK 40,62,0
QK 28,16,144,44
s_xor_b32 s43, s43, 0xc000
RK 44,63,0
CV 32,16,17
QK 28,20,148,28
CV 33,18,19
CV 34,20,21
QK 28,24,152,28
EX 22
QK 28,28,156,28
EX 23
PV 224,96,36
RK 48,60,4096
RK 52,61,4096
PV 228,100,36
buffer_load_dwordx4 v67, s[16:19], s40 offen offset:1024 lds
PV 232,104,36
EX 24
PV 236,108,36
RK 56,62,4096
CV 35,22,23
PV 240,112,36
EX 25
PV 244,116,36
buffer_load_dwordx4 v[124:127], v75, s[32:35], s51 offen nt
PV 248,120,36
s_add_u32 m0, s42, 0x10000
EX 26
PV 252,124,36
RK 60,63,4096
RV 96,64,0
QK 16,0,160,48
EX 27
QK 16,4,164,16
buffer_load_dwordx4 v68, s[20:23], s40 offen lds
QK 16,8,168,16
RV 98,64,4096
CV 36,24,25
QK 16,12,172,16
EX 28
QK 20,16,160,48
RV 100,65,0
CV 37,26,27
QK 20,20,164,20
EX 29
QK 20,24,168,20
RV 102,65,4096
CV 38,28,29
QK 20,28,172,20
EX 30
PV 128,64,32
EX 31
PV 132,68,32
buffer_load_dwordx4 v69, s[20:23], s40 offen offset:1024 lds
PV 136,72,32
RV 104,64,256
CV 39,30,31
PV 140,76,32
EX 16
PV 144,80,32
EX 17
PV 148,84,32
RV 106,64,4352
RV 108,65,256
PV 152,88,32
EX 18
PV 156,92,32
EX 19
QK 24,0,176,52
EX 20
QK 24,4,180,24
RV 110,65,4352
QK 24,8,184,24
EX 21
QK 24,12,188,24
RV 112,64,512
v_smfmac_f32_16x16x64_bf16 a[240:243], v[56:59], v[32:39], v71
RV 114,64,4608
QK 28,16,176,52
CV 32,16,17
CV 33,18,19
QK 28,20,180,28
EX 22
QK 28,24,184,28
RV 116,65,512
CV 34,20,21
QK 28,28,188,28
EX 23
PV 160,64,36
RV 118,65,4608
CV 35,22,23
PV 164,68,36
EX 24
PV 168,72,36
EX 25
PV 172,76,36
RV 120,64,768
PV 176,80,36
EX 26
PV 180,84,36
RV 122,64,4864
PV 184,88,36
EX 27
PV 188,92,36
s_waitcnt lgkmcnt(14)
RV 124,65,768
CV 36,24,25
QK 16,32,128,40
EX 28
QK 16,36,132,16
RV 126,65,4864
CV 37,26,27
QK 16,40,136,16
EX 29
QK 16,44,140,16
CV 38,28,29
QK 20,48,128,40
EX 30
QK 20,52,132,20
QK 20,56,136,20
EX 31
QK 20,60,140,20
CV 39,30,31
PV 192,64,32
EX 16
PV 196,68,32
EX 17
PV 200,72,32
EX 18
PV 204,76,32
EX 19
PV 208,80,32
s_waitcnt lgkmcnt(0)
EX 20
PV 212,84,32
s_add_u32 s40, s40, s58
EX 21
PV 216,88,32
s_add_u32 m0, s42, 0x2000
RK 0,60,8192
RK 4,61,8192
PV 220,92,32
s_mov_b32 s58, s59
RK 8,62,8192
v_xor_b32 v60, s43, v60
QK 24,32,144,44
s_mov_b32 s59, 0x20000
RK 12,63,8192
v_xor_b32 v61, s43, v61
QK 24,36,148,24
EX 22
QK 24,40,152,24
buffer_load_dwordx4 v66, s[16:19], s40 offen lds
QK 24,44,156,24
EX 23
v_smfmac_f32_16x16x64_bf16 a[244:247], v[56:59], v[32:39], v71
CV 32,16,17
QK 28,48,144,44
CV 33,18,19
CV 34,20,21
QK 28,52,148,28
CV 35,22,23
v_xor_b32 v62, s43, v62
QK 28,56,152,28
EX 24
QK 28,60,156,28
EX 25
PV 224,64,36
RV 64,64,8192
RV 66,64,12288
PV 228,68,36
RV 68,65,8192
v_xor_b32 v63, s43, v63
PV 232,72,36
RV 70,65,12288
RV 72,64,8448
PV 236,76,36
EX 26
PV 240,80,36
RV 74,64,12544
RV 76,65,8448
PV 244,84,36
EX 27
PV 248,88,36
RV 78,65,12544
RV 80,64,8704
PV 252,92,36
RV 82,64,12800
CV 36,24,25
QK 16,32,160,48
buffer_load_dwordx4 v67, s[16:19], s40 offen offset:1024 lds
RV 84,65,8704
RV 86,65,12800
v_lshlrev_b32 v0, 16, v80
v_and_b32 v1, s71, v80
v_lshlrev_b32 v2, 16, v81
v_and_b32 v3, s71, v81
v_pk_mul_f32 v[0:1], v[0:1], s[14:15]
v_pk_mul_f32 v[2:3], v[2:3], s[14:15]
QK 16,36,164,16
s_add_u32 m0, s42, 0x12000
RV 88,64,8960
RV 90,64,13056
v_lshlrev_b32 v4, 16, v82
v_and_b32 v5, s71, v82
v_lshlrev_b32 v6, 16, v83
v_and_b32 v7, s71, v83
v_pk_mul_f32 v[4:5], v[4:5], s[14:15]
v_pk_mul_f32 v[6:7], v[6:7], s[14:15]
CV 80,0,1
CV 81,2,3
QK 16,40,168,16
buffer_load_dwordx4 v68, s[20:23], s40 offen lds
RV 92,65,8960
RV 94,65,13056
CV 82,4,5
CV 83,6,7
v_lshlrev_b32 v0, 16, v84
v_and_b32 v1, s71, v84
v_lshlrev_b32 v2, 16, v85
v_and_b32 v3, s71, v85
v_pk_mul_f32 v[0:1], v[0:1], s[14:15]
v_pk_mul_f32 v[2:3], v[2:3], s[14:15]
QK 16,44,172,16
ds_write_b128 v15, v[80:83] offset:0
v_lshlrev_b32 v4, 16, v86
v_and_b32 v5, s71, v86
v_lshlrev_b32 v6, 16, v87
v_and_b32 v7, s71, v87
v_pk_mul_f32 v[4:5], v[4:5], s[14:15]
v_pk_mul_f32 v[6:7], v[6:7], s[14:15]
CV 84,0,1
CV 85,2,3
QK 20,48,160,48
CV 86,4,5
CV 87,6,7
v_lshlrev_b32 v0, 16, v88
v_and_b32 v1, s71, v88
v_lshlrev_b32 v2, 16, v89
v_and_b32 v3, s71, v89
v_pk_mul_f32 v[0:1], v[0:1], s[14:15]
v_pk_mul_f32 v[2:3], v[2:3], s[14:15]
QK 20,52,164,20
ds_write_b128 v15, v[84:87] offset:544
v_lshlrev_b32 v4, 16, v90
v_and_b32 v5, s71, v90
v_lshlrev_b32 v6, 16, v91
v_and_b32 v7, s71, v91
v_pk_mul_f32 v[4:5], v[4:5], s[14:15]
v_pk_mul_f32 v[6:7], v[6:7], s[14:15]
CV 88,0,1
CV 89,2,3
QK 20,56,168,20
CV 90,4,5
CV 91,6,7
v_lshlrev_b32 v0, 16, v92
v_and_b32 v1, s71, v92
v_lshlrev_b32 v2, 16, v93
v_and_b32 v3, s71, v93
v_pk_mul_f32 v[0:1], v[0:1], s[14:15]
v_pk_mul_f32 v[2:3], v[2:3], s[14:15]
QK 20,60,172,20
ds_write_b128 v15, v[88:91] offset:1152
v_lshlrev_b32 v4, 16, v94
v_and_b32 v5, s71, v94
v_lshlrev_b32 v6, 16, v95
v_and_b32 v7, s71, v95
v_pk_mul_f32 v[4:5], v[4:5], s[14:15]
v_pk_mul_f32 v[6:7], v[6:7], s[14:15]
CV 92,0,1
CV 93,2,3
EX 28
EX 29
EX 30
EX 31
CV 37,26,27
CV 38,28,29
CV 39,30,31
v_xor_b32 v64, s43, v64
v_xor_b32 v65, s43, v65
v_smfmac_f32_16x16x64_bf16 a[240:243], v[56:59], v[32:39], v71
s_add_u32 s52, s44, 0x0
CV 94,4,5
CV 95,6,7
PV 128,96,32
buffer_load_dwordx4 v69, s[20:23], s40 offen offset:1024 lds
PV 132,100,32
ds_write_b128 v15, v[92:95] offset:1696
PV 136,104,32
RK 192,14,0
RK 196,14,64
PV 140,108,32
RK 200,14,128
v_accvgpr_read_b32 v76, a240
v_accvgpr_read_b32 v40, a241
RK 204,14,192
v_add_f32 v76, v76, v40
v_accvgpr_read_b32 v77, a242
v_cmp_nge_f32 s[4:5], s55, v76
v_rcp_f32 v76, v76
v_accvgpr_read_b32 v44, a243
PM 128,76,0
v_add_f32 v77, v77, v44
PM 130,76,0
PV 144,112,32
v_cmp_nge_f32 s[6:7], s55, v77
v_rcp_f32_e64 v77, v77
CV 128,128,129
CV 129,130,131
PM 132,76,0
PM 134,76,0
PV 148,116,32
ds_write_b64 v70, v[128:129] offset:0
CV 132,132,133
CV 133,134,135
PM 136,76,0
PM 138,76,0
PV 152,120,32
ds_write_b64 v70, v[132:133] offset:32
CV 136,136,137
CV 137,138,139
PM 140,76,0
PM 142,76,0
PV 156,124,32
ds_write_b64 v70, v[136:137] offset:64
CV 140,140,141
CV 141,142,143
PM 144,76,0
PM 146,76,0
QK 24,32,176,52
ds_write_b64 v70, v[140:141] offset:96
CV 144,144,145
CV 145,146,147
PM 148,76,0
PM 150,76,0
s_waitcnt vmcnt(23)
v_lshlrev_b32 v0, 16, v96
v_and_b32 v1, s71, v96
v_lshlrev_b32 v2, 16, v97
v_and_b32_e64 v3, s71, v97
v_pk_mul_f32 v[0:1], v[0:1], s[14:15]
v_pk_mul_f32 v[2:3], v[2:3], s[14:15]
QK 24,36,180,24
L_t8_pad4:
s_cbranch_execz L_t8_go
ds_write_b64 v70, v[144:145] offset:128
CV 148,148,149
CV 149,150,151
PM 152,76,0
PM 154,76,0
v_lshlrev_b32 v4, 16, v98
v_and_b32 v5, s71, v98
v_lshlrev_b32 v6, 16, v99
v_and_b32_e64 v7, s71, v99
v_pk_mul_f32 v[4:5], v[4:5], s[14:15]
v_pk_mul_f32 v[6:7], v[6:7], s[14:15]
CV 96,0,1
CV 97,2,3
QK 24,40,184,24
ds_write_b64 v70, v[148:149] offset:160
CV 152,152,153
CV 153,154,155
PM 156,76,0
PM 158,76,0
CV 98,4,5
CV 99,6,7
s_waitcnt vmcnt(22)
v_lshlrev_b32 v0, 16, v100
v_and_b32 v1, s71, v100
v_lshlrev_b32 v2, 16, v101
v_and_b32 v3, s71, v101
v_pk_mul_f32 v[0:1], v[0:1], s[14:15]
v_pk_mul_f32 v[2:3], v[2:3], s[14:15]
QK 24,44,188,24
ds_write_b64 v70, v[152:153] offset:192
CV 156,156,157
CV 157,158,159
v_lshlrev_b32 v4, 16, v102
v_and_b32 v5, s71, v102
v_lshlrev_b32 v6, 16, v103
v_and_b32_e64 v7, s71, v103
v_pk_mul_f32 v[4:5], v[4:5], s[14:15]
v_pk_mul_f32 v[6:7], v[6:7], s[14:15]
CV 100,0,1
CV 101,2,3
QK 28,48,176,52
ds_write_b64 v70, v[156:157] offset:224
RK 128,15,0
RK 132,15,528
CV 102,4,5
RK 136,15,1056
CV 103,6,7
RK 140,15,1584
ds_write_b128 v15, v[96:99] offset:0
s_waitcnt vmcnt(18)
v_lshlrev_b32 v0, 16, v104
v_and_b32 v1, s71, v104
v_lshlrev_b32 v2, 16, v105
v_and_b32 v3, s71, v105
v_pk_mul_f32 v[0:1], v[0:1], s[14:15]
v_pk_mul_f32 v[2:3], v[2:3], s[14:15]
QK 28,52,180,28
s_waitcnt lgkmcnt(4)
buffer_store_dwordx4 a[128:131], v72, s[28:31], s52 offen nt
ds_write_b128 v15, v[100:103] offset:544
v_lshlrev_b32 v4, 16, v106
v_and_b32 v5, s71, v106
v_lshlrev_b32 v6, 16, v107
v_and_b32 v7, s71, v107
v_pk_mul_f32 v[4:5], v[4:5], s[14:15]
v_pk_mul_f32 v[6:7], v[6:7], s[14:15]
CV 104,0,1
CV 105,2,3
QK 28,56,184,28
s_waitcnt vmcnt(17) lgkmcnt(4)
buffer_store_dwordx4 a[132:135], v73, s[28:31], s52 offen nt
CV 106,4,5
CV 107,6,7
v_lshlrev_b32 v0, 16, v108
v_and_b32 v1, s71, v108
v_lshlrev_b32 v2, 16, v109
v_and_b32 v3, s71, v109
v_pk_mul_f32 v[0:1], v[0:1], s[14:15]
v_pk_mul_f32 v[2:3], v[2:3], s[14:15]
QK 28,60,188,28
s_add_u32 s53, s44, 0x10000
ds_write_b128 v15, v[104:107] offset:1152
s_waitcnt lgkmcnt(4)
buffer_store_dwordx4 a[136:139], v74, s[28:31], s52 offen nt
v_lshlrev_b32 v4, 16, v110
v_and_b32 v5, s71, v110
v_lshlrev_b32 v6, 16, v111
v_and_b32 v7, s71, v111
v_pk_mul_f32 v[4:5], v[4:5], s[14:15]
v_pk_mul_f32 v[6:7], v[6:7], s[14:15]
CV 108,0,1
CV 109,2,3
PV 160,96,36
CV 110,4,5
CV 111,6,7
PV 164,100,36
s_waitcnt lgkmcnt(3)
buffer_store_dwordx4 a[140:143], v75, s[28:31], s52 offen nt
PV 168,104,36
ds_write_b128 v15, v[108:111] offset:1696
PV 172,108,36
RK 208,14,0
RK 212,14,64
EX 16
RK 216,14,128
PM 160,76,1
RK 220,14,192
PM 162,76,1
PV 176,112,36
CV 160,160,161
CV 161,162,163
EX 17
EX 18
PM 164,76,1
PM 166,76,1
PV 180,116,36
ds_write_b64 v70, v[160:161] offset:0
CV 164,164,165
CV 165,166,167
PM 168,76,1
PM 170,76,1
PV 184,120,36
ds_write_b64 v70, v[164:165] offset:32
CV 168,168,169
CV 169,170,171
PM 172,76,1
PM 174,76,1
PV 188,124,36
ds_write_b64 v70, v[168:169] offset:64
CV 172,172,173
CV 173,174,175
PM 176,76,1
PM 178,76,1
v_exp_f32_e64 v19, v19
CV 32,16,17
CV 33,18,19
QZ 16,0,192
ds_write_b64 v70, v[172:173] offset:96
CV 176,176,177
CV 177,178,179
PM 180,76,1
PM 182,76,1
s_waitcnt vmcnt(18)
v_lshlrev_b32 v0, 16, v112
v_and_b32 v1, s71, v112
v_lshlrev_b32 v2, 16, v113
v_and_b32_e64 v3, s71, v113
v_pk_mul_f32 v[0:1], v[0:1], s[14:15]
v_pk_mul_f32 v[2:3], v[2:3], s[14:15]
QK 16,4,196,16
ds_write_b64 v70, v[176:177] offset:128
CV 180,180,181
CV 181,182,183
PM 184,76,1
PM 186,76,1
v_lshlrev_b32 v4, 16, v114
v_and_b32 v5, s71, v114
v_lshlrev_b32 v6, 16, v115
v_and_b32 v7, s71, v115
v_pk_mul_f32 v[4:5], v[4:5], s[14:15]
v_pk_mul_f32 v[6:7], v[6:7], s[14:15]
CV 112,0,1
CV 113,2,3
QK 16,8,200,16
ds_write_b64 v70, v[180:181] offset:160
CV 184,184,185
CV 185,186,187
PM 188,76,1
PM 190,76,1
CV 114,4,5
CV 115,6,7
s_waitcnt vmcnt(14)
v_lshlrev_b32 v0, 16, v116
v_and_b32 v1, s71, v116
v_lshlrev_b32 v2, 16, v117
v_and_b32 v3, s71, v117
v_pk_mul_f32 v[0:1], v[0:1], s[14:15]
v_pk_mul_f32 v[2:3], v[2:3], s[14:15]
QK 16,12,204,16
ds_write_b64 v70, v[184:185] offset:192
CV 188,188,189
CV 189,190,191
v_lshlrev_b32 v4, 16, v118
v_and_b32 v5, s71, v118
v_lshlrev_b32 v6, 16, v119
v_and_b32 v7, s71, v119
v_pk_mul_f32 v[4:5], v[4:5], s[14:15]
v_max3_f32 v8, v16, v17, v18
v_pk_mul_f32 v[6:7], v[6:7], s[14:15]
v_max_f32 v8, v8, v19
CV 116,0,1
v_mov_b32 v9, v8
CV 117,2,3
EX 20
v_permlane32_swap_b32 v8, v9
v_max_f32 v8, v8, v9
EX 21
v_mov_b32 v9, v8
EX 22
EX 23
v_permlane16_swap_b32 v8, v9
v_min_f32_e64 v40, -v8, -v9
EX 24
EX 25
EX 26
EX 27
EX 28
EX 29
EX 30
v_exp_f32_e64 v31, v31
CV 34,20,21
CV 35,22,23
CV 36,24,25
CV 37,26,27
CV 38,28,29
CV 39,30,31
v_add_f32 v8, v40, v12
v_add_f32 v9, v40, v13
v_smfmac_f32_16x16x64_bf16 a[244:247], v[56:59], v[32:39], v71
s_add_u32 s48, s44, 0x20000
ds_write_b64 v70, v[188:189] offset:224
RK 144,15,0
RK 148,15,528
CV 118,4,5
RK 152,15,1056
CV 119,6,7
RK 156,15,1584
ds_write_b128 v15, v[112:115] offset:0
s_waitcnt vmcnt(13)
v_lshlrev_b32 v0, 16, v120
v_and_b32 v1, s71, v120
v_lshlrev_b32 v2, 16, v121
v_accvgpr_read_b32 v78, a244
v_accvgpr_read_b32 v48, a245
v_accvgpr_read_b32 v79, a246
v_add_f32 v78, v78, v48
v_accvgpr_read_b32 v52, a247
v_cmp_nge_f32 s[8:9], s55, v78
v_rcp_f32 v78, v78
v_add_f32 v79, v79, v52
v_and_b32 v3, s71, v121
v_cmp_nge_f32 s[10:11], s55, v79
v_rcp_f32 v79, v79
v_pk_mul_f32 v[0:1], v[0:1], s[14:15]
v_pk_mul_f32 v[2:3], v[2:3], s[14:15]
PV 192,96,32
s_waitcnt lgkmcnt(4)
buffer_store_dwordx4 a[144:147], v72, s[28:31], s53 offen nt
ds_write_b128 v15, v[116:119] offset:544
v_lshlrev_b32 v4, 16, v122
v_and_b32 v5, s71, v122
v_lshlrev_b32 v6, 16, v123
v_and_b32 v7, s71, v123
v_pk_mul_f32 v[4:5], v[4:5], s[14:15]
v_pk_mul_f32 v[6:7], v[6:7], s[14:15]
CV 120,0,1
CV 121,2,3
PV 196,100,32
s_waitcnt vmcnt(11) lgkmcnt(4)
buffer_store_dwordx4 a[148:151], v73, s[28:31], s53 offen nt
CV 122,4,5
CV 123,6,7
v_lshlrev_b32 v0, 16, v124
v_and_b32 v1, s71, v124
v_lshlrev_b32 v2, 16, v125
v_and_b32 v3, s71, v125
v_pk_mul_f32 v[0:1], v[0:1], s[14:15]
v_pk_mul_f32 v[2:3], v[2:3], s[14:15]
PV 200,104,32
ds_write_b128 v15, v[120:123] offset:1152
s_waitcnt lgkmcnt(4)
buffer_store_dwordx4 a[152:155], v74, s[28:31], s53 offen nt
v_lshlrev_b32 v4, 16, v126
v_and_b32 v5, s71, v126
v_lshlrev_b32 v6, 16, v127
v_and_b32 v7, s71, v127
v_pk_mul_f32 v[4:5], v[4:5], s[14:15]
v_pk_mul_f32 v[6:7], v[6:7], s[14:15]
CV 124,0,1
CV 125,2,3
PV 204,108,32
s_waitcnt lgkmcnt(3)
CV 126,4,5
CV 127,6,7
buffer_store_dwordx4 a[156:159], v75, s[28:31], s53 offen nt
PM 192,78,0
PM 194,78,0
PV 208,112,32
s_waitcnt vmcnt(63) lgkmcnt(0)
s_barrier
ds_write_b128 v15, v[124:127] offset:1696
RK 224,14,0
RK 228,14,64
CV 192,192,193
RK 232,14,128
CV 193,194,195
RK 236,14,192
PM 196,78,0
PM 198,78,0
PV 212,116,32
s_add_u32 s40, s40, 0x20000
ds_write_b64 v70, v[192:193] offset:0
CV 196,196,197
CV 197,198,199
PM 200,78,0
PM 202,78,0
PV 216,120,32
s_xor_b32 s41, s41, s43
ds_write_b64 v70, v[196:197] offset:32
RK 32,60,0
RK 36,61,0
CV 200,200,201
CV 201,202,203
PM 204,78,0
PM 206,78,0
PV 220,124,32
s_xor_b32 s42, s41, 0xc000
ds_write_b64 v70, v[200:201] offset:64
RK 40,62,0
RK 44,63,0
CV 204,204,205
CV 205,206,207
PM 208,78,0
PM 210,78,0
QZ 24,0,208
s_add_u32 m0, s42, 0x0
ds_write_b64 v70, v[204:205] offset:96
RK 48,60,4096
RK 52,61,4096
CV 208,208,209
CV 209,210,211
PM 212,78,0
PM 214,78,0
QK 24,4,212,24
s_bfe_u32 s50, s2, 0x10003
ds_write_b64 v70, v[208:209] offset:128
RK 56,62,4096
RK 60,63,4096
CV 212,212,213
CV 213,214,215
PM 216,78,0
PM 218,78,0
QK 24,8,216,24
buffer_load_dwordx4 v66, s[16:19], s40 offen lds
ds_write_b64 v70, v[212:213] offset:160
CV 216,216,217
CV 217,218,219
PM 220,78,0
PM 222,78,0
QK 24,12,220,24
s_lshl1_add_u32 s50, s46, s50
ds_write_b64 v70, v[216:217] offset:192
CV 220,220,221
CV 221,222,223
PV 224,96,36
s_lshl2_add_u32 s50, s50, s12
RV 96,64,0
RV 98,64,4096
ds_write_b64 v70, v[220:221] offset:224
PV 228,100,36
s_add_u32 s50, s50, 16
RK 160,15,0
RK 164,15,528
PV 232,104,36
s_lshl_b32 s50, s50, 13
RK 168,15,1056
v_max3_f32 v10, v24, v25, v26
PV 236,108,36
s_add_u32 s49, s44, 0x30000
RK 172,15,1584
v_max_f32 v10, v10, v27
v_add_f32 v16, v8, v16
v_mov_b32 v11, v10
v_add_f32 v17, v8, v17
PM 224,78,1
v_permlane32_swap_b32 v10, v11
v_max_f32 v10, v10, v11
PM 226,78,1
PV 240,112,36
s_xor_b32 s43, s43, 0xc000
RV 100,65,0
RV 102,65,4096
v_mov_b32 v11, v10
CV 224,224,225
CV 225,226,227
v_permlane16_swap_b32 v10, v11
v_min_f32_e64 v44, -v10, -v11
PM 228,78,1
PM 230,78,1
PV 244,116,36
s_waitcnt lgkmcnt(5)
buffer_store_dwordx4 a[160:163], v72, s[28:31], s48 offen nt
ds_write_b64 v70, v[224:225] offset:0
RV 104,64,256
RV 106,64,4352
CV 228,228,229
CV 229,230,231
PM 232,78,1
PM 234,78,1
PV 248,120,36
s_waitcnt lgkmcnt(7)
buffer_store_dwordx4 a[164:167], v73, s[28:31], s48 offen nt
ds_write_b64 v70, v[228:229] offset:32
RV 108,65,256
RV 110,65,4352
CV 232,232,233
CV 233,234,235
PM 236,78,1
PM 238,78,1
PV 252,124,36
ds_write_b64 v70, v[232:233] offset:64
RV 112,64,512
RV 114,64,4608
s_waitcnt lgkmcnt(12)
buffer_store_dwordx4 a[168:171], v74, s[28:31], s48 offen nt
CV 236,236,237
CV 237,238,239
PM 240,78,1
PM 242,78,1
v_add_f32 v18, v8, v18
v_add_f32 v19, v9, v19
EX 16
EX 17
EX 18
EX 19
CV 32,16,17
CV 33,18,19
v_mov_b32 v34, 0
v_mov_b32 v35, 0
CV 240,240,241
CV 241,242,243
v_smfmac_f32_16x16x64_bf16 a[248:251], v[56:59], v[32:39], v71
buffer_load_dwordx4 v67, s[16:19], s40 offen offset:1024 lds
ds_write_b64 v70, v[236:237] offset:96
RV 116,65,512
RV 118,65,4608
PM 244,78,1
PM 246,78,1
QZ 16,0,224
ds_write_b64 v70, v[240:241] offset:128
RV 120,64,768
RV 122,64,4864
s_waitcnt lgkmcnt(15)
buffer_store_dwordx4 a[172:175], v75, s[28:31], s48 offen nt
CV 244,244,245
CV 245,246,247
PM 248,78,1
PM 250,78,1
QK 16,4,228,16
ds_write_b64 v70, v[244:245] offset:160
RV 124,65,768
RV 126,65,4864
CV 248,248,249
CV 249,250,251
PM 252,78,1
PM 254,78,1
QK 16,8,232,16
ds_write_b64 v70, v[248:249] offset:192
CV 252,252,253
CV 253,254,255
QK 16,12,236,16
s_add_u32 m0, s42, 0x10000
v_mbcnt_lo_u32_b32 v80, -1, 0
v_accvgpr_write_b32 a250, 0
ds_write_b64 v70, v[252:253] offset:224
PZ 128,64,32
RK 176,15,0
RK 180,15,528
PZ 132,68,32
RK 184,15,1056
v_max3_f32 v8, v16, v17, v18
PZ 136,72,32
RK 188,15,1584
v_max_f32 v8, v8, v19
PZ 140,76,32
v_mov_b32 v9, v8
v_mbcnt_hi_u32_b32 v80, -1, v80
PZ 144,80,32
v_permlane32_swap_b32 v8, v9
PZ 148,84,32
v_max_f32 v8, v8, v9
v_lshl_add_u32 v80, v80, 7, s50
PZ 152,88,32
v_mov_b32 v9, v8
v_min_u32 v80, L_end8-L_type0+4092, v80
PZ 156,92,32
v_permlane16_swap_b32 v8, v9
v_min_f32_e64 v48, -v8, -v9
v_add_f32 v10, v44, v12
v_add_f32 v11, v44, v13
v_add_f32 v24, v10, v24
v_add_f32 v25, v10, v25
v_add_f32 v26, v10, v26
v_add_f32 v27, v11, v27
EX 24
EX 25
EX 26
EX 27
v_mov_b32 v41, v40
v_mov_b32 v42, v40
v_mov_b32 v43, v40
CV 36,24,25
CV 37,26,27
QK 24,32,192,40
global_load_dword v81, v80, s[68:69]
QK 24,36,196,24
v_accvgpr_write_b32 a251, 0
v_mov_b32 v38, 0
QK 24,40,200,24
v_mov_b32 v39, 0
v_add_f32 v8, v48, v12
QK 24,44,204,24
s_waitcnt lgkmcnt(3)
buffer_store_dwordx4 a[176:179], v72, s[28:31], s49 offen nt
QK 28,48,192,40
v_add_f32 v9, v48, v13
v_add_f32 v16, v8, v16
QK 28,52,196,28
v_add_f32 v17, v8, v17
v_add_f32 v18, v8, v18
QK 28,56,200,28
v_add_f32 v19, v9, v19
v_mov_b32 v34, 0
QK 28,60,204,28
buffer_load_dwordx4 v68, s[20:23], s40 offen lds
PZ 160,64,36
EX 16
PZ 164,68,36
EX 17
PZ 168,72,36
EX 18
PZ 172,76,36
s_waitcnt lgkmcnt(2)
buffer_store_dwordx4 a[180:183], v73, s[28:31], s49 offen nt
PZ 176,80,36
EX 19
PZ 180,84,36
CV 32,16,17
CV 33,18,19
PZ 184,88,36
v_mov_b32 v35, 0
v_mov_b32 v45, v44
PZ 188,92,36
s_waitcnt lgkmcnt(1)
buffer_store_dwordx4 a[184:187], v74, s[28:31], s49 offen nt
v_smfmac_f32_16x16x64_bf16 a[252:255], v[56:59], v[32:39], v71
v_mov_b32 v46, v44
v_mov_b32 v47, v44
v_mov_b32 v49, v48
v_mov_b32 v50, v48
QK 16,32,208,44
RK 0,60,8192
RK 4,61,8192
QK 16,36,212,16
s_waitcnt lgkmcnt(2)
buffer_store_dwordx4 a[188:191], v75, s[28:31], s49 offen nt
QK 16,40,216,16
RK 8,62,8192
RK 12,63,8192
QK 16,44,220,16
EX 24
QK 20,48,208,44
RK 16,60,12288
v_mov_b32 v51, v48
QK 20,52,212,20
buffer_load_dwordx4 v69, s[20:23], s40 offen offset:1024 lds
QK 20,56,216,20
s_add_u32 s40, s40, 0x20000
RK 20,61,12288
s_add_u32 m0, s42, 0x2000
QK 20,60,220,20
RK 24,62,12288
v_accvgpr_write_b32 a240, 0
PZ 192,64,32
EX 25
PZ 196,68,32
buffer_load_dwordx4 v66, s[16:19], s40 offen lds
PZ 200,72,32
RK 28,63,12288
CV 36,24,25
PZ 204,76,32
RV 64,64,8192
v_accvgpr_write_b32 a241, 0
PZ 208,80,32
RV 66,64,12288
v_accvgpr_write_b32 a242, 0
PZ 212,84,32
buffer_load_dwordx4 v67, s[16:19], s40 offen offset:1024 lds
PZ 216,88,32
EX 26
PZ 220,92,32
EX 27
EX 28
CV 37,26,27
QK 24,32,224,48
s_add_u32 m0, s42, 0x12000
RV 68,65,8192
RV 70,65,12288
QK 24,36,228,24
L_t8_pad5:
s_cbranch_execz L_t8_go
EX 29
QK 24,40,232,24
EX 30
QK 24,44,236,24
RV 72,64,8448
RV 74,64,12544
v_exp_f32_e64 v31, v31
CV 38,28,29
CV 39,30,31
QK 28,48,224,48
buffer_load_dwordx4 v68, s[20:23], s40 offen lds
QK 28,52,228,28
RV 76,65,8448
v_accvgpr_write_b32 a243, 0
QK 28,56,232,28
RV 78,65,12544
v_xor_b32 v60, s43, v60
QK 28,60,236,28
v_exp_f32_e64 v16, v16
PV 128,96,36
RV 80,64,8704
v_xor_b32 v61, s43, v61
PV 132,100,36
RV 82,64,12800
v_xor_b32_e64 v62, s43, v62
PV 136,104,36
EX 17
PV 140,108,36
RV 84,65,8704
CV 32,16,17
PV 144,112,36
v_exp_f32_e64 v18, v18
PV 148,116,36
buffer_load_dwordx4 v69, s[20:23], s40 offen offset:1024 lds
PV 152,120,36
EX 19
PV 156,124,36
RV 86,65,12800
RV 88,64,8960
v_exp_f32_e64 v20, v20
EX 21
v_exp_f32_e64 v22, v22
EX 23
CV 33,18,19
CV 34,20,21
CV 35,22,23
v_xor_b32_e64 v63, s43, v63
s_nop 0
v_smfmac_f32_16x16x64_bf16 a[240:243], v[56:59], v[32:39], v71
s_waitcnt lgkmcnt(13)
RV 90,64,13056
QK 16,0,192,40
RV 92,65,8960
v_xor_b32 v64, s43, v64
QK 16,4,196,16
v_exp_f32_e64 v24, v24
QK 16,8,200,16
EX 25
QK 16,12,204,16
RV 94,65,13056
CV 36,24,25
QK 20,16,192,40
v_exp_f32_e64 v26, v26
QK 20,20,196,20
EX 27
QK 20,24,200,20
v_exp_f32_e64 v28, v28
QK 20,28,204,20
EX 29
PV 160,96,32
v_exp_f32_e64 v30, v30
PV 164,100,32
EX 31
PV 168,104,32
CV 37,26,27
CV 38,28,29
PV 172,108,32
CV 39,30,31
v_xor_b32_e64 v65, s43, v65
PV 176,112,32
s_waitcnt vmcnt(25) lgkmcnt(0)
s_barrier
PV 180,116,32
s_mov_b32 s56, 3
L_t8_loop1:
PV 184,120,32
s_xor_b32 s41, s41, s43
EX 16
PV 188,124,32
s_xor_b32 s42, s41, 0xc000
RK 32,60,0
RK 36,61,0
QK 24,0,208,44
s_add_u32 s40, s40, 0x20000
EX 17
QK 24,4,212,24
s_add_u32 m0, s42, 0x0
RK 40,62,0
CV 32,16,17
QK 24,8,216,24
buffer_load_dwordx4 v66, s[16:19], s40 offen lds
QK 24,12,220,24
s_xor_b32 s43, s43, 0xc000
EX 18
QK 28,16,208,44
RK 44,63,0
RK 48,60,4096
QK 28,20,212,28
EX 19
QK 28,24,216,28
RK 52,61,4096
CV 33,18,19
QK 28,28,220,28
EX 20
PV 192,96,36
EX 21
PV 196,100,36
RK 56,62,4096
RK 60,63,4096
PV 200,104,36
EX 22
PV 204,108,36
buffer_load_dwordx4 v67, s[16:19], s40 offen offset:1024 lds
PV 208,112,36
EX 23
PV 212,116,36
CV 34,20,21
CV 35,22,23
PV 216,120,36
RV 96,64,0
RV 98,64,4096
PV 220,124,36
EX 24
v_smfmac_f32_16x16x64_bf16 a[248:251], v[56:59], v[32:39], v71
s_add_u32 m0, s42, 0x10000
RV 100,65,0
QK 16,0,224,48
EX 25
QK 16,4,228,16
RV 102,65,4096
RV 104,64,256
QK 16,8,232,16
RV 106,64,4352
CV 36,24,25
QK 16,12,236,16
buffer_load_dwordx4 v68, s[20:23], s40 offen lds
QK 20,16,224,48
EX 26
QK 20,20,228,20
EX 27
QK 20,24,232,20
RV 108,65,256
RV 110,65,4352
QK 20,28,236,20
RV 112,64,512
CV 37,26,27
PV 128,64,32
EX 28
PV 132,68,32
EX 29
PV 136,72,32
RV 114,64,4608
CV 38,28,29
PV 140,76,32
EX 30
PV 144,80,32
buffer_load_dwordx4 v69, s[20:23], s40 offen offset:1024 lds
PV 148,84,32
RV 116,65,512
RV 118,65,4608
PV 152,88,32
EX 31
PV 156,92,32
s_waitcnt lgkmcnt(12)
RV 120,64,768
CV 39,30,31
QK 24,32,192,40
EX 16
QK 24,36,196,24
RV 122,64,4864
RV 124,65,768
QK 24,40,200,24
EX 17
QK 24,44,204,24
RV 126,65,4864
CV 32,16,17
QK 28,48,192,40
EX 18
QK 28,52,196,28
EX 19
QK 28,56,200,28
EX 20
QK 28,60,204,28
EX 21
PV 160,64,36
EX 22
PV 164,68,36
EX 23
PV 168,72,36
CV 33,18,19
CV 34,20,21
PV 172,76,36
EX 24
PV 176,80,36
EX 25
PV 180,84,36
s_waitcnt lgkmcnt(0)
EX 26
PV 184,88,36
s_add_u32 s40, s40, 0x20000
CV 35,22,23
PV 188,92,36
s_add_u32 m0, s42, 0x2000
EX 27
v_smfmac_f32_16x16x64_bf16 a[252:255], v[56:59], v[32:39], v71
RK 0,60,8192
QK 16,32,208,44
RK 4,61,8192
CV 36,24,25
QK 16,36,212,16
RK 8,62,8192
CV 37,26,27
QK 16,40,216,16
buffer_load_dwordx4 v66, s[16:19], s40 offen lds
QK 16,44,220,16
EX 28
QK 20,48,208,44
RK 12,63,8192
RK 16,60,12288
QK 20,52,212,20
EX 29
QK 20,56,216,20
RK 20,61,12288
CV 38,28,29
QK 20,60,220,20
RK 24,62,12288
v_xor_b32 v60, s43, v60
PV 192,64,32
EX 30
PV 196,68,32
RK 28,63,12288
v_xor_b32 v61, s43, v61
PV 200,72,32
EX 31
PV 204,76,32
buffer_load_dwordx4 v67, s[16:19], s40 offen offset:1024 lds
PV 208,80,32
RV 64,64,8192
RV 66,64,12288
PV 212,84,32
CV 39,30,31
v_xor_b32 v62, s43, v62
PV 216,88,32
RV 68,65,8192
v_xor_b32 v63, s43, v63
PV 220,92,32
EX 16
QK 24,32,224,48
s_add_u32 m0, s42, 0x12000
EX 17
QK 24,36,228,24
RV 70,65,12288
RV 72,64,8448
QK 24,40,232,24
EX 18
QK 24,44,236,24
RV 74,64,12544
CV 32,16,17
QK 28,48,224,48
buffer_load_dwordx4 v68, s[20:23], s40 offen lds
QK 28,52,228,28
EX 19
QK 28,56,232,28
RV 76,65,8448
RV 78,65,12544
QK 28,60,236,28
EX 20
PV 128,96,36
RV 80,64,8704
CV 33,18,19
PV 132,100,36
EX 21
PV 136,104,36
RV 82,64,12800
CV 34,20,21
PV 140,108,36
EX 22
PV 144,112,36
EX 23
PV 148,116,36
buffer_load_dwordx4 v69, s[20:23], s40 offen offset:1024 lds
PV 152,120,36
RV 84,65,8704
CV 35,22,23
PV 156,124,36
RV 86,65,12800
RV 88,64,8960
v_smfmac_f32_16x16x64_bf16 a[240:243], v[56:59], v[32:39], v71
s_waitcnt lgkmcnt(13)
RV 90,64,13056
QK 16,0,192,40
RV 92,65,8960
v_xor_b32 v64, s43, v64
QK 16,4,196,16
EX 24
QK 16,8,200,16
EX 25
QK 16,12,204,16
RV 94,65,13056
CV 36,24,25
QK 20,16,192,40
EX 26
QK 20,20,196,20
EX 27
QK 20,24,200,20
CV 37,26,27
v_xor_b32 v65, s43, v65
QK 20,28,204,20
EX 28
PV 160,96,32
EX 29
PV 164,100,32
EX 30
PV 168,104,32
EX 31
PV 172,108,32
CV 38,28,29
CV 39,30,31
PV 176,112,32
s_waitcnt vmcnt(8) lgkmcnt(0)
s_barrier
PV 180,116,32
s_sub_u32 s56, s56, 1
s_cbranch_scc0 L_t8_loop1
PV 184,120,32
s_xor_b32 s41, s41, s43
EX 16
PV 188,124,32
s_xor_b32 s43, s43, 0xc000
RK 32,60,0
RK 36,61,0
QK 24,0,208,44
s_xor_b32 s42, s41, 0xc000
EX 17
QK 24,4,212,24
RK 40,62,0
CV 32,16,17
QK 24,8,216,24
EX 18
QK 24,12,220,24
EX 19
QK 28,16,208,44
RK 44,63,0
RK 48,60,4096
QK 28,20,212,28
EX 20
QK 28,24,216,28
RK 52,61,4096
CV 33,18,19
QK 28,28,220,28
EX 21
PV 192,96,36
RK 56,62,4096
CV 34,20,21
PV 196,100,36
EX 22
PV 200,104,36
EX 23
PV 204,108,36
RK 60,63,4096
RV 96,64,0
PV 208,112,36
EX 24
PV 212,116,36
RV 98,64,4096
CV 35,22,23
PV 216,120,36
EX 25
PV 220,124,36
EX 26
v_smfmac_f32_16x16x64_bf16 a[248:251], v[56:59], v[32:39], v71
RV 100,65,0
QK 16,0,224,48
RV 102,65,4096
CV 36,24,25
QK 16,4,228,16
EX 27
QK 16,8,232,16
RV 104,64,256
RV 106,64,4352
QK 16,12,236,16
EX 28
QK 20,16,224,48
RV 108,65,256
CV 37,26,27
QK 20,20,228,20
EX 29
QK 20,24,232,20
RV 110,65,4352
CV 38,28,29
QK 20,28,236,20
EX 30
PV 128,64,32
EX 31
PV 132,68,32
RV 112,64,512
RV 114,64,4608
PV 136,72,32
EX 16
PV 140,76,32
RV 116,65,512
CV 39,30,31
PV 144,80,32
EX 17
PV 148,84,32
EX 18
PV 152,88,32
RV 118,65,4608
RV 120,64,768
PV 156,92,32
s_waitcnt lgkmcnt(13)
EX 19
QK 24,32,192,40
RV 122,64,4864
CV 32,16,17
QK 24,36,196,24
RV 124,65,768
CV 33,18,19
QK 24,40,200,24
EX 20
QK 24,44,204,24
EX 21
QK 28,48,192,40
RV 126,65,4864
CV 34,20,21
QK 28,52,196,28
EX 22
QK 28,56,200,28
EX 23
QK 28,60,204,28
CV 35,22,23
PV 160,64,36
PV 164,68,36
EX 24
PV 168,72,36
PV 172,76,36
EX 25
PV 176,80,36
PV 180,84,36
s_waitcnt lgkmcnt(0)
EX 26
PV 184,88,36
PV 188,92,36
EX 27
v_smfmac_f32_16x16x64_bf16 a[252:255], v[56:59], v[32:39], v71
RK 0,60,8192
QK 16,32,208,44
RK 4,61,8192
CV 36,24,25
QK 16,36,212,16
RK 8,62,8192
CV 37,26,27
QK 16,40,216,16
EX 28
QK 16,44,220,16
EX 29
QK 20,48,208,44
RK 12,63,8192
RK 16,60,12288
QK 20,52,212,20
EX 30
QK 20,56,216,20
RK 20,61,12288
CV 38,28,29
QK 20,60,220,20
RK 24,62,12288
v_xor_b32 v60, s43, v60
PV 192,64,32
EX 31
PV 196,68,32
RK 28,63,12288
CV 39,30,31
PV 200,72,32
EX 16
PV 204,76,32
RV 64,64,8192
v_xor_b32 v61, s43, v61
PV 208,80,32
RV 66,64,12288
v_xor_b32 v62, s43, v62
PV 212,84,32
EX 17
PV 216,88,32
RV 68,65,8192
v_xor_b32 v63, s43, v63
PV 220,92,32
RV 70,65,12288
CV 32,16,17
QK 24,32,224,48
EX 18
QK 24,36,228,24
EX 19
QK 24,40,232,24
RV 72,64,8448
CV 33,18,19
QK 24,44,236,24
EX 20
QK 28,48,224,48
RV 74,64,12544
RV 76,65,8448
QK 28,52,228,28
EX 21
QK 28,56,232,28
RV 78,65,12544
CV 34,20,21
QK 28,60,236,28
EX 22
PV 128,96,36
EX 23
PV 132,100,36
RV 80,64,8704
RV 82,64,12800
PV 136,104,36
EX 24
PV 140,108,36
RV 84,65,8704
CV 35,22,23
PV 144,112,36
EX 25
PV 148,116,36
EX 26
PV 152,120,36
RV 86,65,12800
RV 88,64,8960
PV 156,124,36
EX 27
v_smfmac_f32_16x16x64_bf16 a[240:243], v[56:59], v[32:39], v71
s_waitcnt lgkmcnt(13)
RV 90,64,13056
QK 16,0,192,40
RV 92,65,8960
CV 36,24,25
QK 16,4,196,16
CV 37,26,27
v_xor_b32 v64, s43, v64
QK 16,8,200,16
EX 28
QK 16,12,204,16
EX 29
QK 20,16,192,40
RV 94,65,13056
CV 38,28,29
QK 20,20,196,20
EX 30
QK 20,24,200,20
EX 31
QK 20,28,204,20
CV 39,30,31
v_xor_b32 v65, s43, v65
PV 160,96,32
EX 16
PV 164,100,32
PV 168,104,32
EX 17
PV 172,108,32
PV 176,112,32
s_waitcnt vmcnt(0) lgkmcnt(0)
s_barrier
PV 180,116,32
EX 18
PV 184,120,32
s_xor_b32 s41, s41, s43
EX 19
PV 188,124,32
s_xor_b32 s42, s41, 0xc000
RK 32,60,0
RK 36,61,0
QK 24,0,208,44
s_xor_b32 s43, s43, 0xc000
EX 20
QK 24,4,212,24
RK 40,62,0
CV 32,16,17
QK 24,8,216,24
L_t8_pad6:
s_cbranch_execz L_t8_go
EX 21
QK 24,12,220,24
RK 44,63,0
CV 33,18,19
QK 28,16,208,44
RK 48,60,4096
CV 34,20,21
QK 28,20,212,28
EX 22
QK 28,24,216,28
EX 23
QK 28,28,220,28
RK 52,61,4096
CV 35,22,23
PV 192,96,36
RK 56,62,4096
PV 196,100,36
EX 24
PV 200,104,36
RK 60,63,4096
PV 204,108,36
EX 25
PV 208,112,36
RV 96,64,0
PV 212,116,36
EX 26
PV 216,120,36
RV 98,64,4096
RV 100,65,0
PV 220,124,36
EX 27
v_smfmac_f32_16x16x64_bf16 a[248:251], v[56:59], v[32:39], v71
RV 102,65,4096
QK 16,0,224,48
CV 36,24,25
CV 37,26,27
QK 16,4,228,16
EX 28
QK 16,8,232,16
RV 104,64,256
RV 106,64,4352
QK 16,12,236,16
EX 29
QK 20,16,224,48
RV 108,65,256
CV 38,28,29
QK 20,20,228,20
EX 30
QK 20,24,232,20
EX 31
QK 20,28,236,20
RV 110,65,4352
RV 112,64,512
PV 128,64,32
EX 16
PV 132,68,32
RV 114,64,4608
CV 39,30,31
PV 136,72,32
EX 17
PV 140,76,32
RV 116,65,512
PV 144,80,32
EX 18
PV 148,84,32
RV 118,65,4608
PV 152,88,32
EX 19
PV 156,92,32
s_waitcnt lgkmcnt(12)
RV 120,64,768
CV 32,16,17
QK 24,32,192,40
RV 122,64,4864
CV 33,18,19
QK 24,36,196,24
EX 20
QK 24,40,200,24
EX 21
QK 24,44,204,24
RV 124,65,768
RV 126,65,4864
QK 28,48,192,40
EX 22
QK 28,52,196,28
CV 34,20,21
QK 28,56,200,28
EX 23
QK 28,60,204,28
CV 35,22,23
PV 160,64,36
PV 164,68,36
EX 24
PV 168,72,36
PV 172,76,36
EX 25
PV 176,80,36
PV 180,84,36
s_waitcnt lgkmcnt(0)
EX 26
PV 184,88,36
PV 188,92,36
EX 27
v_smfmac_f32_16x16x64_bf16 a[252:255], v[56:59], v[32:39], v71
RK 0,60,8192
QK 16,32,208,44
RK 4,61,8192
CV 36,24,25
QK 16,36,212,16
RK 8,62,8192
CV 37,26,27
QK 16,40,216,16
EX 28
QK 16,44,220,16
EX 29
QK 20,48,208,44
RK 12,63,8192
RK 16,60,12288
QK 20,52,212,20
EX 30
QK 20,56,216,20
RK 20,61,12288
CV 38,28,29
QK 20,60,220,20
EX 31
PV 192,64,32
RK 24,62,12288
CV 39,30,31
PV 196,68,32
EX 16
PV 200,72,32
EX 17
PV 204,76,32
RK 28,63,12288
RV 64,64,8192
PV 208,80,32
EX 18
PV 212,84,32
RV 66,64,12288
PV 216,88,32
EX 19
PV 220,92,32
RV 68,65,8192
RV 70,65,12288
QK 24,32,224,48
EX 20
QK 24,36,228,24
RV 72,64,8448
CV 32,16,17
QK 24,40,232,24
EX 21
QK 24,44,236,24
RV 74,64,12544
CV 33,18,19
QK 28,48,224,48
RV 76,65,8448
CV 34,20,21
QK 28,52,228,28
EX 22
QK 28,56,232,28
EX 23
QK 28,60,236,28
RV 78,65,12544
CV 35,22,23
PV 128,96,36
RV 80,64,8704
PV 132,100,36
EX 24
PV 136,104,36
RV 82,64,12800
PV 140,108,36
EX 25
PV 144,112,36
RV 84,65,8704
RV 86,65,12800
PV 148,116,36
EX 26
PV 152,120,36
RV 88,64,8960
PV 156,124,36
EX 27
v_smfmac_f32_16x16x64_bf16 a[240:243], v[56:59], v[32:39], v71
s_waitcnt lgkmcnt(13)
RV 90,64,13056
QK 16,0,192,40
RV 92,65,8960
CV 36,24,25
QK 16,4,196,16
EX 28
QK 16,8,200,16
RV 94,65,13056
CV 37,26,27
QK 16,12,204,16
EX 29
QK 20,16,192,40
v_accvgpr_read_b32 v76, a242
v_accvgpr_read_b32 v77, a240
QK 20,20,196,20
v_accvgpr_read_b32 v40, a243
CV 38,28,29
QK 20,24,200,20
EX 30
QK 20,28,204,20
EX 31
PV 160,96,32
v_add_f32 v76, v76, v40
CV 39,30,31
PV 164,100,32
EX 16
PV 168,104,32
EX 17
PV 172,108,32
EX 18
PV 176,112,32
s_waitcnt lgkmcnt(0)
EX 19
PV 180,116,32
EX 20
PV 184,120,32
EX 21
PV 188,124,32
EX 22
QK 24,0,208,44
EX 23
QK 24,4,212,24
CV 32,16,17
CV 33,18,19
QK 24,8,216,24
CV 34,20,21
CV 35,22,23
QK 24,12,220,24
QK 28,16,208,44
QK 28,20,212,28
QK 28,24,216,28
s_nop 0
v_accvgpr_read_b32 v44, a241
QK 28,28,220,28
v_add_f32 v77, v77, v44
PV 192,96,36
PV 196,100,36
EX 24
PV 200,104,36
EX 25
PV 204,108,36
EX 26
PV 208,112,36
EX 27
PV 212,116,36
EX 28
PV 216,120,36
EX 29
PV 220,124,36
EX 30
v_smfmac_f32_16x16x64_bf16 a[248:251], v[56:59], v[32:39], v71
CV 36,24,25
QK 16,0,224,48
EX 31
QK 16,4,228,16
CV 37,26,27
CV 38,28,29
QK 16,8,232,16
CV 39,30,31
s_nop 0
QK 16,12,236,16
s_nop 0
QK 20,16,224,48
v_accvgpr_read_b32 v41, a248
v_accvgpr_read_b32 v42, a249
QK 20,20,228,20
v_add_f32 v76, v76, v41
v_accvgpr_read_b32 v78, a250
QK 20,24,232,20
v_add_f32 v76, v76, v42
v_accvgpr_read_b32 v48, a251
QK 20,28,236,20
s_add_u32 s51, s45, 0x0
v_cmp_nge_f32 s[96:97], s55, v76
v_add_f32 v78, v78, v48
PV 128,64,32
v_rcp_f32 v76, v76
PV 132,68,32
EX 16
PV 136,72,32
EX 17
PV 140,76,32
EX 18
EX 19
EX 20
PM 128,76,0
PM 130,76,0
PV 144,80,32
CV 128,128,129
CV 129,130,131
EX 21
EX 22
PM 132,76,0
PM 134,76,0
PV 148,84,32
ds_write_b64 v70, v[128:129] offset:0
CV 132,132,133
CV 133,134,135
PM 136,76,0
PM 138,76,0
PV 152,88,32
ds_write_b64 v70, v[132:133] offset:32
CV 136,136,137
CV 137,138,139
PM 140,76,0
PM 142,76,0
PV 156,92,32
ds_write_b64 v70, v[136:137] offset:64
CV 140,140,141
CV 141,142,143
PM 144,76,0
PM 146,76,0
v_exp_f32_e64 v23, v23
CV 32,16,17
CV 33,18,19
CV 34,20,21
CV 35,22,23
CV 144,144,145
CV 145,146,147
v_smfmac_f32_16x16x64_bf16 a[252:255], v[56:59], v[32:39], v71
s_add_u32 s52, s45, 0x10000
ds_write_b64 v70, v[140:141] offset:96
PM 148,76,0
PM 150,76,0
PV 160,64,36
ds_write_b64 v70, v[144:145] offset:128
CV 148,148,149
CV 149,150,151
PM 152,76,0
PM 154,76,0
PV 164,68,36
ds_write_b64 v70, v[148:149] offset:160
v_accvgpr_read_b32 v45, a254
v_accvgpr_read_b32 v46, a255
v_add_f32 v77, v77, v45
v_accvgpr_read_b32 v49, a252
v_add_f32 v77, v77, v46
v_add_f32 v78, v78, v49
v_cmp_nge_f32 s[98:99], s55, v77
v_rcp_f32 v77, v77
v_accvgpr_read_b32 v50, a253
CV 152,152,153
v_add_f32 v78, v78, v50
CV 153,154,155
v_cmp_nge_f32 s[100:101], s55, v78
v_rcp_f32 v78, v78
PM 156,76,0
PM 158,76,0
PV 168,72,36
ds_write_b64 v70, v[152:153] offset:192
CV 156,156,157
CV 157,158,159
PV 172,76,36
ds_write_b64 v70, v[156:157] offset:224
RK 192,15,0
RK 196,15,528
PM 160,76,1
RK 200,15,1056
PM 162,76,1
PV 176,80,36
RK 204,15,1584
CV 160,160,161
CV 161,162,163
PM 164,76,1
PM 166,76,1
PV 180,84,36
ds_write_b64 v70, v[160:161] offset:0
CV 164,164,165
CV 165,166,167
PM 168,76,1
PM 170,76,1
PV 184,88,36
s_waitcnt lgkmcnt(4)
buffer_store_dwordx4 a[192:195], v72, s[36:39], s51 offen nt
ds_write_b64 v70, v[164:165] offset:32
CV 168,168,169
CV 169,170,171
PM 172,76,1
PM 174,76,1
PV 188,92,36
s_waitcnt lgkmcnt(4)
s_add_u32 s53, s45, 0x20000
ds_write_b64 v70, v[168:169] offset:64
buffer_store_dwordx4 a[196:199], v73, s[36:39], s51 offen nt
CV 172,172,173
CV 173,174,175
PM 176,76,1
PM 178,76,1
PV 192,64,32
ds_write_b64 v70, v[172:173] offset:96
CV 176,176,177
CV 177,178,179
PM 180,76,1
PM 182,76,1
PV 196,68,32
s_waitcnt lgkmcnt(5)
buffer_store_dwordx4 a[200:203], v74, s[36:39], s51 offen nt
ds_write_b64 v70, v[176:177] offset:128
CV 180,180,181
CV 181,182,183
PM 184,76,1
PM 186,76,1
PV 200,72,32
s_waitcnt lgkmcnt(5)
ds_write_b64 v70, v[180:181] offset:160
buffer_store_dwordx4 a[204:207], v75, s[36:39], s51 offen nt
CV 184,184,185
CV 185,186,187
PM 188,76,1
PM 190,76,1
PV 204,76,32
ds_write_b64 v70, v[184:185] offset:192
CV 188,188,189
CV 189,190,191
PM 192,78,0
PM 194,78,0
PV 208,80,32
ds_write_b64 v70, v[188:189] offset:224
RK 208,15,0
RK 212,15,528
CV 192,192,193
RK 216,15,1056
CV 193,194,195
RK 220,15,1584
PM 196,78,0
PM 198,78,0
PV 212,84,32
ds_write_b64 v70, v[192:193] offset:0
CV 196,196,197
CV 197,198,199
PM 200,78,0
PM 202,78,0
PV 216,88,32
s_waitcnt lgkmcnt(4)
buffer_store_dwordx4 a[208:211], v72, s[36:39], s52 offen nt
ds_write_b64 v70, v[196:197] offset:32
CV 200,200,201
CV 201,202,203
PM 204,78,0
PM 206,78,0
PV 220,92,32
s_waitcnt lgkmcnt(4)
ds_write_b64 v70, v[200:201] offset:64
buffer_store_dwordx4 a[212:215], v73, s[36:39], s52 offen nt
CV 204,204,205
CV 205,206,207
ds_write_b64 v70, v[204:205] offset:96
PM 208,78,0
PM 210,78,0
CV 208,208,209
CV 209,210,211
ds_write_b64 v70, v[208:209] offset:128
s_waitcnt lgkmcnt(6)
buffer_store_dwordx4 a[216:219], v74, s[36:39], s52 offen nt
PM 212,78,0
PM 214,78,0
CV 212,212,213
CV 213,214,215
ds_write_b64 v70, v[212:213] offset:160
PM 216,78,0
PM 218,78,0
CV 216,216,217
CV 217,218,219
ds_write_b64 v70, v[216:217] offset:192
s_waitcnt lgkmcnt(7)
buffer_store_dwordx4 a[220:223], v75, s[36:39], s52 offen nt
PM 220,78,0
PM 222,78,0
CV 220,220,221
CV 221,222,223
ds_write_b64 v70, v[220:221] offset:224
RK 224,15,0
RK 228,15,528
RK 232,15,1056
RK 236,15,1584
s_waitcnt lgkmcnt(3)
buffer_store_dwordx4 a[224:227], v72, s[36:39], s53 offen nt
s_waitcnt lgkmcnt(2)
buffer_store_dwordx4 a[228:231], v73, s[36:39], s53 offen nt
s_waitcnt lgkmcnt(1)
buffer_store_dwordx4 a[232:235], v74, s[36:39], s53 offen nt
s_waitcnt lgkmcnt(0)
buffer_store_dwordx4 a[236:239], v75, s[36:39], s53 offen nt
s_cmp_lg_u64 s[4:5], 0
s_cselect_b32 s62, 1, 0
s_or_b32 s54, s54, s62
s_cmp_lg_u64 s[6:7], 0
s_cselect_b32 s62, 2, 0
s_or_b32 s54, s54, s62
s_cmp_lg_u64 s[8:9], 0
s_cselect_b32 s62, 4, 0
s_or_b32 s54, s54, s62
s_cmp_lg_u64 s[10:11], 0
s_cselect_b32 s62, 8, 0
s_or_b32 s54, s54, s62
s_cmp_lg_u64 s[96:97], 0
s_cselect_b32 s62, 16, 0
s_or_b32 s54, s54, s62
s_cmp_lg_u64 s[98:99], 0
s_cselect_b32 s62, 32, 0
s_or_b32 s54, s54, s62
s_cmp_lg_u64 s[100:101], 0
s_cselect_b32 s62, 64, 0
s_or_b32 s54, s54, s62
s_cbranch_scc0 L_done8
s_mov_b32 s4, 0x5ab000
s_mov_b32 s5, 482
s_mov_b32 s6, 0x3e0000
s_mov_b32 s7, 459
s_getpc_b64 s[62:63]
L_fpc8:
s_add_u32 s62, s62, L_fallback-L_fpc8
s_addc_u32 s63, s63, 0
s_setpc_b64 s[62:63]
L_done8:
s_endpgm
L_end8:
.p2align 8
L_fallback:
s_waitcnt vmcnt(0) lgkmcnt(0)
v_mbcnt_lo_u32_b32 v8, -1, 0
v_mbcnt_hi_u32_b32 v8, -1, v8
v_lshrrev_b32 v71, 4, v8
v_mov_b32 v56, 0x3f803f80
v_mov_b32 v57, 0x3f803f80
v_mov_b32 v58, 0x3f803f80
v_mov_b32 v59, 0x3f803f80
v_and_b32 v9, 15, v8
v_lshlrev_b32 v10, 4, v71
v_lshl_add_u32 v0, v9, 12, v10
v_lshlrev_b32 v1, 2, v71
v_mov_b32 v3, 0xff800000
v_bfe_u32 v9, v8, 2, 2
v_and_b32 v10, 3, v8
v_lshlrev_b32 v11, 4, v10
v_lshl_add_u32 v11, v71, 6, v11
v_lshl_add_u32 v4, v9, 12, v11
v_xor_b32 v5, 32, v4
v_add_u32 v5, 0x3c00, v5
s_mul_i32 s49, s12, 4576
s_add_u32 s49, s49, 0x20000
v_and_b32 v11, 1, v71
v_lshlrev_b32 v11, 5, v11
v_lshl_add_u32 v11, v10, 3, v11
v_lshl_add_u32 v11, v9, 6, v11
v_lshl_add_u32 v11, v71, 10, v11
v_add_u32 v6, s49, v11
v_xor_b32 v11, 32, v11
v_add_u32 v7, s49, v11
L_fb_block:
s_ff1_i32_b32 s3, s54
s_bitset0_b32 s54, s3
s_cmp_ge_u32 s3, 4
s_cselect_b32 s8, s6, s4
s_cselect_b32 s9, s7, s5
s_cselect_b32 s10, s45, s44
s_and_b32 s3, s3, 3
s_lshl_b32 s3, s3, 16
s_add_u32 s10, s10, s3
s_lshl_b32 s3, s9, 12
s_add_u32 s3, s3, s8
s_sub_u32 s3, s3, 0xf00
s_mov_b32 s26, s3
s_mov_b32 s30, s3
s_mov_b32 s18, s3
s_mov_b32 s22, s3
buffer_load_dwordx4 v[80:83], v0, s[24:27], s10 offen offset:0
buffer_load_dwordx4 v[84:87], v0, s[24:27], s10 offen offset:64
buffer_load_dwordx4 v[88:91], v0, s[24:27], s10 offen offset:128
buffer_load_dwordx4 v[92:95], v0, s[24:27], s10 offen offset:192
s_waitcnt vmcnt(0)
v_lshlrev_b32 v8, 16, v80
v_and_b32 v9, s71, v80
v_pk_mul_f32 v[8:9], v[8:9], s[14:15]
CV 80,8,9
v_lshlrev_b32 v8, 16, v81
v_and_b32 v9, s71, v81
v_pk_mul_f32 v[8:9], v[8:9], s[14:15]
CV 81,8,9
v_lshlrev_b32 v8, 16, v82
v_and_b32 v9, s71, v82
v_pk_mul_f32 v[8:9], v[8:9], s[14:15]
CV 82,8,9
v_lshlrev_b32 v8, 16, v83
v_and_b32 v9, s71, v83
v_pk_mul_f32 v[8:9], v[8:9], s[14:15]
CV 83,8,9
v_lshlrev_b32 v8, 16, v84
v_and_b32 v9, s71, v84
v_pk_mul_f32 v[8:9], v[8:9], s[14:15]
CV 84,8,9
v_lshlrev_b32 v8, 16, v85
v_and_b32 v9, s71, v85
v_pk_mul_f32 v[8:9], v[8:9], s[14:15]
CV 85,8,9
v_lshlrev_b32 v8, 16, v86
v_and_b32 v9, s71, v86
v_pk_mul_f32 v[8:9], v[8:9], s[14:15]
CV 86,8,9
v_lshlrev_b32 v8, 16, v87
v_and_b32 v9, s71, v87
v_pk_mul_f32 v[8:9], v[8:9], s[14:15]
CV 87,8,9
v_lshlrev_b32 v8, 16, v88
v_and_b32 v9, s71, v88
v_pk_mul_f32 v[8:9], v[8:9], s[14:15]
CV 88,8,9
v_lshlrev_b32 v8, 16, v89
v_and_b32 v9, s71, v89
v_pk_mul_f32 v[8:9], v[8:9], s[14:15]
CV 89,8,9
v_lshlrev_b32 v8, 16, v90
v_and_b32 v9, s71, v90
v_pk_mul_f32 v[8:9], v[8:9], s[14:15]
CV 90,8,9
v_lshlrev_b32 v8, 16, v91
v_and_b32 v9, s71, v91
v_pk_mul_f32 v[8:9], v[8:9], s[14:15]
CV 91,8,9
v_lshlrev_b32 v8, 16, v92
v_and_b32 v9, s71, v92
v_pk_mul_f32 v[8:9], v[8:9], s[14:15]
CV 92,8,9
v_lshlrev_b32 v8, 16, v93
v_and_b32 v9, s71, v93
v_pk_mul_f32 v[8:9], v[8:9], s[14:15]
CV 93,8,9
v_lshlrev_b32 v8, 16, v94
v_and_b32 v9, s71, v94
v_pk_mul_f32 v[8:9], v[8:9], s[14:15]
CV 94,8,9
v_lshlrev_b32 v8, 16, v95
v_and_b32 v9, s71, v95
v_pk_mul_f32 v[8:9], v[8:9], s[14:15]
CV 95,8,9
v_mov_b32 v2, v3
s_mov_b32 s11, 0
L_fb_max:
s_lshl_b32 s3, s11, 12
s_add_u32 s3, s3, s8
s_add_u32 s48, s3, 0x10000
buffer_load_dwordx4 v[96:99], v0, s[16:19], s3 offen offset:0
buffer_load_dwordx4 v[100:103], v0, s[16:19], s3 offen offset:64
buffer_load_dwordx4 v[104:107], v0, s[16:19], s3 offen offset:128
buffer_load_dwordx4 v[108:111], v0, s[16:19], s3 offen offset:192
buffer_load_dwordx4 v[112:115], v0, s[16:19], s48 offen offset:0
buffer_load_dwordx4 v[116:119], v0, s[16:19], s48 offen offset:64
buffer_load_dwordx4 v[120:123], v0, s[16:19], s48 offen offset:128
buffer_load_dwordx4 v[124:127], v0, s[16:19], s48 offen offset:192
s_waitcnt vmcnt(0)
v_mfma_f32_16x16x32_bf16 v[16:19], v[96:99], v[80:83], 0
v_mfma_f32_16x16x32_bf16 v[16:19], v[100:103], v[84:87], v[16:19]
v_mfma_f32_16x16x32_bf16 v[16:19], v[104:107], v[88:91], v[16:19]
v_mfma_f32_16x16x32_bf16 v[16:19], v[108:111], v[92:95], v[16:19]
v_mfma_f32_16x16x32_bf16 v[20:23], v[112:115], v[80:83], 0
v_mfma_f32_16x16x32_bf16 v[20:23], v[116:119], v[84:87], v[20:23]
v_mfma_f32_16x16x32_bf16 v[20:23], v[120:123], v[88:91], v[20:23]
v_mfma_f32_16x16x32_bf16 v[20:23], v[124:127], v[92:95], v[20:23]
s_sub_u32 s62, s9, s11
s_nop 7
v_add_u32 v8, 0, v1
v_cmp_gt_u32 vcc, s62, v8
s_nop 1
v_cndmask_b32 v16, v3, v16, vcc
v_add_u32 v8, 1, v1
v_cmp_gt_u32 vcc, s62, v8
s_nop 1
v_cndmask_b32 v17, v3, v17, vcc
v_add_u32 v8, 2, v1
v_cmp_gt_u32 vcc, s62, v8
s_nop 1
v_cndmask_b32 v18, v3, v18, vcc
v_add_u32 v8, 3, v1
v_cmp_gt_u32 vcc, s62, v8
s_nop 1
v_cndmask_b32 v19, v3, v19, vcc
v_add_u32 v8, 16, v1
v_cmp_gt_u32 vcc, s62, v8
s_nop 1
v_cndmask_b32 v20, v3, v20, vcc
v_add_u32 v8, 17, v1
v_cmp_gt_u32 vcc, s62, v8
s_nop 1
v_cndmask_b32 v21, v3, v21, vcc
v_add_u32 v8, 18, v1
v_cmp_gt_u32 vcc, s62, v8
s_nop 1
v_cndmask_b32 v22, v3, v22, vcc
v_add_u32 v8, 19, v1
v_cmp_gt_u32 vcc, s62, v8
s_nop 1
v_cndmask_b32 v23, v3, v23, vcc
v_max3_f32 v2, v2, v16, v17
v_max3_f32 v2, v2, v18, v19
v_max3_f32 v2, v2, v20, v21
v_max3_f32 v2, v2, v22, v23
s_add_u32 s11, s11, 32
s_cmp_lt_u32 s11, s9
s_cbranch_scc1 L_fb_max
v_mov_b32 v8, v2
s_nop 1
v_permlane32_swap_b32 v2, v8
v_max_f32 v2, v2, v8
v_mov_b32 v8, v2
s_nop 1
v_permlane16_swap_b32 v2, v8
v_max_f32 v2, v2, v8
v_mov_b32 v128, 0
v_mov_b32 v129, 0
v_mov_b32 v130, 0
v_mov_b32 v131, 0
v_mov_b32 v132, 0
v_mov_b32 v133, 0
v_mov_b32 v134, 0
v_mov_b32 v135, 0
v_mov_b32 v136, 0
v_mov_b32 v137, 0
v_mov_b32 v138, 0
v_mov_b32 v139, 0
v_mov_b32 v140, 0
v_mov_b32 v141, 0
v_mov_b32 v142, 0
v_mov_b32 v143, 0
v_mov_b32 v144, 0
v_mov_b32 v145, 0
v_mov_b32 v146, 0
v_mov_b32 v147, 0
v_mov_b32 v148, 0
v_mov_b32 v149, 0
v_mov_b32 v150, 0
v_mov_b32 v151, 0
v_mov_b32 v152, 0
v_mov_b32 v153, 0
v_mov_b32 v154, 0
v_mov_b32 v155, 0
v_mov_b32 v156, 0
v_mov_b32 v157, 0
v_mov_b32 v158, 0
v_mov_b32 v159, 0
v_accvgpr_write_b32 a240, 0
v_accvgpr_write_b32 a241, 0
v_accvgpr_write_b32 a242, 0
v_accvgpr_write_b32 a243, 0
s_mov_b32 s11, 0
L_fb_pv:
s_lshl_b32 s3, s11, 12
s_add_u32 s3, s3, s8
s_add_u32 s48, s3, 0x10000
buffer_load_dwordx4 v[96:99], v0, s[16:19], s3 offen offset:0
buffer_load_dwordx4 v[100:103], v0, s[16:19], s3 offen offset:64
buffer_load_dwordx4 v[104:107], v0, s[16:19], s3 offen offset:128
buffer_load_dwordx4 v[108:111], v0, s[16:19], s3 offen offset:192
buffer_load_dwordx4 v[112:115], v0, s[16:19], s48 offen offset:0
buffer_load_dwordx4 v[116:119], v0, s[16:19], s48 offen offset:64
buffer_load_dwordx4 v[120:123], v0, s[16:19], s48 offen offset:128
buffer_load_dwordx4 v[124:127], v0, s[16:19], s48 offen offset:192
s_waitcnt vmcnt(0)
v_mfma_f32_16x16x32_bf16 v[16:19], v[96:99], v[80:83], 0
v_mfma_f32_16x16x32_bf16 v[16:19], v[100:103], v[84:87], v[16:19]
v_mfma_f32_16x16x32_bf16 v[16:19], v[104:107], v[88:91], v[16:19]
v_mfma_f32_16x16x32_bf16 v[16:19], v[108:111], v[92:95], v[16:19]
v_mfma_f32_16x16x32_bf16 v[20:23], v[112:115], v[80:83], 0
v_mfma_f32_16x16x32_bf16 v[20:23], v[116:119], v[84:87], v[20:23]
v_mfma_f32_16x16x32_bf16 v[20:23], v[120:123], v[88:91], v[20:23]
v_mfma_f32_16x16x32_bf16 v[20:23], v[124:127], v[92:95], v[20:23]
s_sub_u32 s62, s9, s11
s_nop 7
v_add_u32 v8, 0, v1
v_cmp_gt_u32 vcc, s62, v8
s_nop 1
v_cndmask_b32 v16, v3, v16, vcc
v_add_u32 v8, 1, v1
v_cmp_gt_u32 vcc, s62, v8
s_nop 1
v_cndmask_b32 v17, v3, v17, vcc
v_add_u32 v8, 2, v1
v_cmp_gt_u32 vcc, s62, v8
s_nop 1
v_cndmask_b32 v18, v3, v18, vcc
v_add_u32 v8, 3, v1
v_cmp_gt_u32 vcc, s62, v8
s_nop 1
v_cndmask_b32 v19, v3, v19, vcc
v_add_u32 v8, 16, v1
v_cmp_gt_u32 vcc, s62, v8
s_nop 1
v_cndmask_b32 v20, v3, v20, vcc
v_add_u32 v8, 17, v1
v_cmp_gt_u32 vcc, s62, v8
s_nop 1
v_cndmask_b32 v21, v3, v21, vcc
v_add_u32 v8, 18, v1
v_cmp_gt_u32 vcc, s62, v8
s_nop 1
v_cndmask_b32 v22, v3, v22, vcc
v_add_u32 v8, 19, v1
v_cmp_gt_u32 vcc, s62, v8
s_nop 1
v_cndmask_b32 v23, v3, v23, vcc
v_sub_f32 v16, v16, v2
v_sub_f32 v17, v17, v2
v_sub_f32 v18, v18, v2
v_sub_f32 v19, v19, v2
v_sub_f32 v20, v20, v2
v_sub_f32 v21, v21, v2
v_sub_f32 v22, v22, v2
v_sub_f32 v23, v23, v2
EX 16
EX 17
EX 18
EX 19
EX 20
EX 21
EX 22
EX 23
s_nop 0
CV 32,16,17
CV 33,18,19
CV 34,20,21
CV 35,22,23
s_add_u32 m0, s49, 0
s_add_u32 s62, s3, 0x0
buffer_load_dwordx4 v4, s[20:23], s62 offen lds
buffer_load_dwordx4 v5, s[20:23], s62 offen offset:1024 lds
s_add_u32 m0, s49, 2048
s_add_u32 s62, s3, 0x8000
buffer_load_dwordx4 v4, s[20:23], s62 offen lds
buffer_load_dwordx4 v5, s[20:23], s62 offen offset:1024 lds
s_waitcnt vmcnt(0)
RV 64,6,0
RV 68,7,0
RV 72,6,256
RV 76,7,256
RV 80,6,512
RV 84,7,512
RV 88,6,768
RV 92,7,768
s_waitcnt lgkmcnt(0)
s_add_u32 m0, s49, 0
s_add_u32 s62, s3, 0x10000
buffer_load_dwordx4 v4, s[20:23], s62 offen lds
buffer_load_dwordx4 v5, s[20:23], s62 offen offset:1024 lds
s_add_u32 m0, s49, 2048
s_add_u32 s62, s3, 0x18000
buffer_load_dwordx4 v4, s[20:23], s62 offen lds
buffer_load_dwordx4 v5, s[20:23], s62 offen offset:1024 lds
s_waitcnt vmcnt(0)
RV 66,6,0
RV 70,7,0
RV 74,6,256
RV 78,7,256
RV 82,6,512
RV 86,7,512
RV 90,6,768
RV 94,7,768
s_waitcnt lgkmcnt(0)
PV 128,64,32
PV 132,68,32
PV 136,72,32
PV 140,76,32
PV 144,80,32
PV 148,84,32
PV 152,88,32
PV 156,92,32
LS 240,56,32
s_add_u32 s11, s11, 32
s_cmp_lt_u32 s11, s9
s_cbranch_scc1 L_fb_pv
s_nop 7
v_accvgpr_read_b32 v8, a240
s_nop 0
v_rcp_f32 v8, v8
s_nop 0
v_mul_f32 v128, v8, v128
v_mul_f32 v129, v8, v129
v_mul_f32 v130, v8, v130
v_mul_f32 v131, v8, v131
CV 128,128,129
CV 129,130,131
ds_write_b64 v70, v[128:129] offset:0
v_mul_f32 v132, v8, v132
v_mul_f32 v133, v8, v133
v_mul_f32 v134, v8, v134
v_mul_f32 v135, v8, v135
CV 132,132,133
CV 133,134,135
ds_write_b64 v70, v[132:133] offset:32
v_mul_f32 v136, v8, v136
v_mul_f32 v137, v8, v137
v_mul_f32 v138, v8, v138
v_mul_f32 v139, v8, v139
CV 136,136,137
CV 137,138,139
ds_write_b64 v70, v[136:137] offset:64
v_mul_f32 v140, v8, v140
v_mul_f32 v141, v8, v141
v_mul_f32 v142, v8, v142
v_mul_f32 v143, v8, v143
CV 140,140,141
CV 141,142,143
ds_write_b64 v70, v[140:141] offset:96
v_mul_f32 v144, v8, v144
v_mul_f32 v145, v8, v145
v_mul_f32 v146, v8, v146
v_mul_f32 v147, v8, v147
CV 144,144,145
CV 145,146,147
ds_write_b64 v70, v[144:145] offset:128
v_mul_f32 v148, v8, v148
v_mul_f32 v149, v8, v149
v_mul_f32 v150, v8, v150
v_mul_f32 v151, v8, v151
CV 148,148,149
CV 149,150,151
ds_write_b64 v70, v[148:149] offset:160
v_mul_f32 v152, v8, v152
v_mul_f32 v153, v8, v153
v_mul_f32 v154, v8, v154
v_mul_f32 v155, v8, v155
CV 152,152,153
CV 153,154,155
ds_write_b64 v70, v[152:153] offset:192
v_mul_f32 v156, v8, v156
v_mul_f32 v157, v8, v157
v_mul_f32 v158, v8, v158
v_mul_f32 v159, v8, v159
CV 156,156,157
CV 157,158,159
ds_write_b64 v70, v[156:157] offset:224
ds_read_b128 v[96:99], v15 offset:0
ds_read_b128 v[100:103], v15 offset:528
ds_read_b128 v[104:107], v15 offset:1056
ds_read_b128 v[108:111], v15 offset:1584
s_waitcnt lgkmcnt(0)
buffer_store_dwordx4 v[96:99], v72, s[28:31], s10 offen
buffer_store_dwordx4 v[100:103], v73, s[28:31], s10 offen
buffer_store_dwordx4 v[104:107], v74, s[28:31], s10 offen
buffer_store_dwordx4 v[108:111], v75, s[28:31], s10 offen
s_waitcnt vmcnt(0)
s_cmp_lg_u32 s54, 0
s_cbranch_scc1 L_fb_block
s_endpgm
.section .rodata,"a"
.p2align 6
.amdhsa_kernel standalone__varlen_attn_packed__ragged_kernel
  .amdhsa_next_free_vgpr 512
  .amdhsa_next_free_sgpr 102
  .amdhsa_accum_offset 256
  .amdhsa_group_segment_fixed_size 0
  .amdhsa_kernarg_size 56
  .amdhsa_user_sgpr_count 2
  .amdhsa_user_sgpr_kernarg_segment_ptr 1
  .amdhsa_system_sgpr_workgroup_id_x 1
.end_amdhsa_kernel
```
